```python
import torch

def _softmax(x, axis=-1):
    return torch.softmax(x, dim=axis)
def _gelu(x):
    return torch.nn.functional.gelu(x, approximate="tanh")
def _silu(x):
    return torch.nn.functional.silu(x)
def _sigmoid(x):
    return torch.sigmoid(x)
def _layernorm(x, axis=-1, eps=1e-5):
    m = x.mean(dim=axis, keepdim=True)
    v = x.var(dim=axis, keepdim=True, unbiased=False)
    return (x - m) / torch.sqrt(v + eps)
def _scatter_add(tgt, idx, src, axis=0):
    return tgt.clone().index_add_(axis, idx, src)
def _segment_sum(src, seg, n):
    out = torch.zeros((n,) + src.shape[1:], dtype=src.dtype)
    return out.index_add_(0, seg, src)
def _pad(x, pw):
    flat = tuple(v for pair in reversed(pw) for v in pair)
    return torch.nn.functional.pad(x, flat)

kernel_name = 'concat_heads__mha_block_cached__gqa_block_cached__near_ridge'

def setup_inputs():

    _w = (lambda a: (lambda t: t.to(torch.bfloat16) if t.is_floating_point() else t)(torch.as_tensor(a)))
    def _A_setup():
        B, Sq, D = 16, 112, 512
        H, Sk, Dh = 32, 512, 128
        return {
            "x": _w((lambda *s: torch.randn(*s, dtype=torch.bfloat16) * 0.8)(B, Sq, D)),
            "k_cache": _w((lambda *s: torch.randn(*s, dtype=torch.bfloat16) * 0.8)(B, H, Sk, Dh)),
            "v_cache": _w((lambda *s: torch.randn(*s, dtype=torch.bfloat16) * 0.05)(B, H, Sk, Dh)),
            "wq": _w((lambda *s: torch.randn(*s, dtype=torch.bfloat16) * 0.8)(D, H * Dh) * (D ** -0.5)),
            "wo": _w((lambda *s: torch.randn(*s, dtype=torch.bfloat16) * 0.05)(H * Dh, D) * ((H * Dh) ** -0.5)),
        }
    _A_in = _A_setup()

    def _B_setup():
        B, Sq, D = 16, 112, 512
        Hq, Hkv, Sk, Dh = 32, 32, 512, 128
        assert Hq % Hkv == 0, (Hq, Hkv)
        return {
            "x": _w((lambda *s: torch.randn(*s, dtype=torch.bfloat16) * 0.8)(B, Sq, D)),
            "k_cache": _w((lambda *s: torch.randn(*s, dtype=torch.bfloat16) * 0.8)(B, Hkv, Sk, Dh)),
            "v_cache": _w((lambda *s: torch.randn(*s, dtype=torch.bfloat16) * 0.05)(B, Hkv, Sk, Dh)),
            "wq": _w((lambda *s: torch.randn(*s, dtype=torch.bfloat16) * 0.8)(D, Hq * Dh) * (D ** -0.5)),
            "wo": _w((lambda *s: torch.randn(*s, dtype=torch.bfloat16) * 0.05)(Hq * Dh, D) * ((Hq * Dh) ** -0.5)),
        }
    _B_in = _B_setup()

    return {
        "A_x": _A_in["x"],
        "A_k_cache": _A_in["k_cache"],
        "A_v_cache": _A_in["v_cache"],
        "A_wq": _A_in["wq"],
        "A_wo": _A_in["wo"],
        "B_x": _B_in["x"],
        "B_k_cache": _B_in["k_cache"],
        "B_v_cache": _B_in["v_cache"],
        "B_wq": _B_in["wq"],
        "B_wo": _B_in["wo"],
    }

def reference(A_x, A_k_cache, A_v_cache, A_wq, A_wo, B_x, B_k_cache, B_v_cache, B_wq, B_wo):
    def _A_ref(x, k_cache, v_cache, wq, wo):
        B, Sq, D = x.shape
        H, Dh = 32, 128
        q = (lambda x, *d: x.permute(*d))((x @ wq).reshape(B, Sq, H, Dh), 0, 2, 1, 3)
        scores = torch.einsum("bhqd,bhkd->bhqk", q, k_cache) * (Dh ** -0.5)
        p = _softmax(scores, axis=-1)
        o = torch.einsum("bhqk,bhkd->bhqd", p, v_cache)
        return (lambda x, *d: x.permute(*d))(o, 0, 2, 1, 3).reshape(B, Sq, H * Dh) @ wo

    def _B_ref(x, k_cache, v_cache, wq, wo):
        B, Sq, D = x.shape
        Hq, Dh = 32, 128
        Hkv = k_cache.shape[1]
        rep = Hq // Hkv
        q = (lambda x, *d: x.permute(*d))((x @ wq).reshape(B, Sq, Hq, Dh), 0, 2, 1, 3)
        k = (lambda x, n, axis: torch.repeat_interleave(x, n, dim=axis))(k_cache, rep, axis=1)
        v = (lambda x, n, axis: torch.repeat_interleave(x, n, dim=axis))(v_cache, rep, axis=1)
        scores = torch.einsum("bhqd,bhkd->bhqk", q, k) * (Dh ** -0.5)
        p = _softmax(scores, axis=-1)
        o = torch.einsum("bhqk,bhkd->bhqd", p, v)
        return (lambda x, *d: x.permute(*d))(o, 0, 2, 1, 3).reshape(B, Sq, Hq * Dh) @ wo

    a = _A_ref(A_x, A_k_cache, A_v_cache, A_wq, A_wo)
    b = _B_ref(B_x, B_k_cache, B_v_cache, B_wq, B_wo)
    return torch.concatenate([a, b], axis=-1)
```

```asm
; @launch grid=(256,1,1) block=(512,1,1) lds=163840
.amdgcn_target "amdgcn-amd-amdhsa--gfx950"
.text
.globl concat_heads__mha_block_cached__gqa_block_cached__near_ridge_kernel
.p2align 8
.type concat_heads__mha_block_cached__gqa_block_cached__near_ridge_kernel,@function
concat_heads__mha_block_cached__gqa_block_cached__near_ridge_kernel:
  s_cmp_ge_u32 s2, 256
  s_cbranch_scc1 L_end
  s_and_b32 s3, s2, 7
  s_lshr_b32 s4, s3, 2
  s_mul_i32 s5, s4, 40
  s_add_u32 s6, s0, s5
  s_addc_u32 s7, s1, 0
  s_load_dwordx8 s[72:79], s[6:7], 0
  s_load_dwordx2 s[80:81], s[6:7], 32
  s_load_dwordx4 s[84:87], s[0:1], 80
  s_load_dwordx2 s[82:83], s[0:1], 96
  s_getpc_b64 s[92:93]
L_pc:
  s_sub_u32 s92, s92, L_pc-concat_heads__mha_block_cached__gqa_block_cached__near_ridge_kernel
  s_subb_u32 s93, s93, 0
  s_mov_b32 s94, L_codeend-concat_heads__mha_block_cached__gqa_block_cached__near_ridge_kernel
  s_mov_b32 s95, 0x20000
  s_lshr_b32 s59, s2, 3
  s_lshl_b32 s59, s59, 12
  v_lshlrev_b32 v24, 3, v0
  buffer_load_dword v25, v24, s[92:95], s59 offen
  v_readfirstlane_b32 s42, v0
  s_lshr_b32 s6, s2, 3
  s_lshr_b32 s7, s6, 1
  s_and_b32 s6, s6, 1
  s_and_b32 s41, s3, 3
  s_lshl1_add_u32 s41, s41, s6
  s_lshl2_add_u32 s45, s6, s7
  s_and_b32 s45, s45, 7
  s_lshr_b32 s42, s42, 6
  s_and_b32 s40, s42, 3
  v_and_b32 v0, 63, v0
  v_bfe_u32 v20, v0, 2, 3
  v_and_b32 v21, 3, v0
  v_lshrrev_b32 v22, 5, v0
  v_lshlrev_b32 v22, 6, v22
  s_and_b32 s59, s40, 1
  s_lshl_b32 s60, s59, 1
  v_bfe_u32 v23, v0, 4, 1
  v_add_u32 v3, s60, v23
  v_sub_u32 v3, 0, v3
  v_and_b32 v3, 3, v3
  v_xor_b32 v3, v3, v21
  v_lshl_add_u32 v3, v3, 4, v22
  v_lshl_add_u32 v1, v20, 8, v3
  v_lshl_add_u32 v3, v20, 10, v3
  v_lshlrev_b32 v2, 1, v23
  v_xor_b32 v2, v2, v21
  v_lshl_add_u32 v22, v2, 4, v22
  v_lshl_add_u32 v2, v20, 8, v22
  v_lshl_add_u32 v4, v20, 10, v22
  v_lshl_add_u32 v20, v23, 2, v20
  v_lshl_add_u32 v8, v20, 13, v22
  s_lshr_b32 s60, s40, 1
  s_lshl3_add_u32 s61, s60, s59
  s_lshl_b32 s65, s61, 10
  s_lshl_b32 s63, s61, 13
  s_lshl2_add_u32 s61, s59, s60
  s_lshl_b32 s54, s61, 15
  s_lshl_b32 s55, s40, 11
  s_lshl2_add_u32 s61, s60, s59
  s_lshl_b32 s43, s61, 11
  s_waitcnt lgkmcnt(0)
  s_mul_i32 s59, s7, 114688
  s_add_u32 s24, s72, s59
  s_addc_u32 s25, s73, 0
  s_mov_b32 s27, 0x20000
  s_mov_b32 s26, 114688
  s_lshl_b32 s59, s41, 10
  s_add_u32 s16, s78, s59
  s_addc_u32 s17, s79, 0
  s_mov_b32 s19, 0x20000
  s_sub_u32 s18, 0x400000, s59
  s_cmp_ge_u32 s42, 4
  s_cbranch_scc1 L_setup2
  s_add_u32 s59, s45, 0
  s_and_b32 s59, s59, 7
  s_lshl_b32 s59, s59, 7
  s_add_u32 s59, s59, s63
  s_add_u32 m0, s65, 65536
  s_nop 0
  buffer_load_dwordx4 v3, s[24:27], s59 offen lds
  s_add_u32 m0, s65, 67584
  s_add_u32 s59, s59, 16384
  buffer_load_dwordx4 v3, s[24:27], s59 offen lds
  s_add_u32 m0, s65, 69632
  s_add_u32 s59, s59, 16384
  buffer_load_dwordx4 v3, s[24:27], s59 offen lds
  s_add_u32 m0, s65, 71680
  s_add_u32 s59, s59, 16384
  buffer_load_dwordx4 v3, s[24:27], s59 offen lds
  s_add_u32 s59, s45, 0
  s_and_b32 s59, s59, 7
  s_lshl_b32 s59, s59, 19
  s_add_u32 s59, s59, s54
  s_add_u32 s59, s59, 0
  s_add_u32 m0, s55, 81920
  s_nop 0
  buffer_load_dwordx4 v8, s[16:19], s59 offen lds
  s_add_u32 m0, s55, 82816
  s_nop 0
  buffer_load_dwordx4 v8, s[16:19], s59 offen offset:128 lds
  s_add_u32 s59, s45, 0
  s_and_b32 s59, s59, 7
  s_lshl_b32 s59, s59, 19
  s_add_u32 s59, s59, s54
  s_add_u32 s59, s59, 262144
  s_add_u32 m0, s55, 90112
  s_nop 0
  buffer_load_dwordx4 v8, s[16:19], s59 offen lds
  s_add_u32 m0, s55, 91008
  s_nop 0
  buffer_load_dwordx4 v8, s[16:19], s59 offen offset:128 lds
  s_add_u32 s59, s45, 1
  s_and_b32 s59, s59, 7
  s_lshl_b32 s59, s59, 7
  s_add_u32 s59, s59, s63
  s_add_u32 m0, s65, 131072
  s_nop 0
  buffer_load_dwordx4 v3, s[24:27], s59 offen lds
  s_add_u32 m0, s65, 133120
  s_add_u32 s59, s59, 16384
  buffer_load_dwordx4 v3, s[24:27], s59 offen lds
  s_add_u32 m0, s65, 135168
  s_add_u32 s59, s59, 16384
  buffer_load_dwordx4 v3, s[24:27], s59 offen lds
  s_add_u32 m0, s65, 137216
  s_add_u32 s59, s59, 16384
  buffer_load_dwordx4 v3, s[24:27], s59 offen lds
L_setup2:
  s_lshl3_add_u32 s59, s7, s41
  s_lshl_b32 s59, s59, 19
  s_add_u32 s8, s74, s59
  s_addc_u32 s9, s75, 0
  s_mov_b32 s11, 0x20000
  s_mov_b32 s10, 0x80000
  s_add_u32 s12, s76, s59
  s_addc_u32 s13, s77, 0
  s_mov_b32 s15, 0x20000
  s_mov_b32 s14, 0x80000
  s_lshl_b32 s59, s41, 19
  s_add_u32 s20, s80, s59
  s_addc_u32 s21, s81, 0
  s_mov_b32 s23, 0x20000
  s_mov_b32 s22, 0x80000
  s_lshl4_add_u32 s62, s4, s7
  s_lshl_b32 s59, s62, 20
  s_add_u32 s28, s82, s59
  s_addc_u32 s29, s83, 0
  s_mov_b32 s31, 0x20000
  s_mov_b32 s30, 0x100000
  s_lshl_b32 s60, s4, 10
  s_lshl_b32 s61, s41, 7
  s_add_u32 s60, s60, s61
  s_mul_i32 s59, s7, 229376
  s_add_u32 s59, s59, s60
  s_add_u32 s32, s84, s59
  s_addc_u32 s33, s85, 0
  s_mov_b32 s35, 0x20000
  s_sub_u32 s34, 229376, s60
  s_lshl_b32 s59, s62, 3
  s_add_u32 s36, s86, s59
  s_addc_u32 s37, s87, 0
  s_mov_b32 s39, 0x20000
  s_mov_b32 s38, 4
  s_and_b32 s46, s7, 3
  s_lshr_b32 s47, s7, 2
  s_xor_b32 s47, s47, s41
  s_and_b32 s47, s47, 1
  s_cmp_ge_u32 s42, 4
  s_cbranch_scc1 L_helper
  s_add_u32 s59, s45, 1
  s_and_b32 s59, s59, 7
  s_lshl_b32 s59, s59, 19
  s_add_u32 s59, s59, s54
  s_add_u32 s59, s59, 0
  s_add_u32 m0, s55, 147456
  s_nop 0
  buffer_load_dwordx4 v8, s[16:19], s59 offen lds
  s_add_u32 m0, s55, 148352
  s_nop 0
  buffer_load_dwordx4 v8, s[16:19], s59 offen offset:128 lds
  s_add_u32 s59, s45, 1
  s_and_b32 s59, s59, 7
  s_lshl_b32 s59, s59, 19
  s_add_u32 s59, s59, s54
  s_add_u32 s59, s59, 262144
  s_add_u32 m0, s55, 155648
  s_nop 0
  buffer_load_dwordx4 v8, s[16:19], s59 offen lds
  s_add_u32 m0, s55, 156544
  s_nop 0
  buffer_load_dwordx4 v8, s[16:19], s59 offen offset:128 lds
  s_waitcnt vmcnt(8)
  s_barrier
  s_add_u32 s59, s45, 2
  s_and_b32 s59, s59, 7
  s_lshl_b32 s59, s59, 7
  s_add_u32 s59, s59, s63
  s_add_u32 m0, s65, 98304
  s_nop 0
  buffer_load_dwordx4 v3, s[24:27], s59 offen lds
  s_add_u32 m0, s65, 100352
  s_add_u32 s59, s59, 16384
  buffer_load_dwordx4 v3, s[24:27], s59 offen lds
  s_add_u32 m0, s65, 102400
  s_add_u32 s59, s59, 16384
  buffer_load_dwordx4 v3, s[24:27], s59 offen lds
  s_add_u32 m0, s65, 104448
  s_add_u32 s59, s59, 16384
  buffer_load_dwordx4 v3, s[24:27], s59 offen lds
  s_add_u32 s59, s45, 2
  s_and_b32 s59, s59, 7
  s_lshl_b32 s59, s59, 19
  s_add_u32 s59, s59, s54
  s_add_u32 s59, s59, 0
  s_add_u32 m0, s55, 114688
  s_nop 0
  buffer_load_dwordx4 v8, s[16:19], s59 offen lds
  s_add_u32 m0, s55, 115584
  s_nop 0
  buffer_load_dwordx4 v8, s[16:19], s59 offen offset:128 lds
  s_add_u32 s59, s45, 2
  s_and_b32 s59, s59, 7
  s_lshl_b32 s59, s59, 19
  s_add_u32 s59, s59, s54
  s_add_u32 s59, s59, 262144
  s_add_u32 m0, s55, 122880
  s_nop 0
  buffer_load_dwordx4 v8, s[16:19], s59 offen lds
  s_add_u32 m0, s55, 123776
  s_nop 0
  buffer_load_dwordx4 v8, s[16:19], s59 offen offset:128 lds
  s_mov_b32 s52, s43
  s_mov_b32 s58, 0
  s_lshl_b32 s48, s40, 12
  s_lshr_b32 s59, s46, 1
  s_lshl_b32 s59, s59, 7
  s_add_u32 s70, s48, s59
  s_sub_u32 s53, s70, 8192
  s_cmp_lt_u32 s40, 2
  s_cselect_b32 s53, 1073741824, s53
  s_add_u32 s48, s48, 16384
  s_and_b32 s59, s46, 1
  s_lshl_b32 s59, s59, 6
  v_xor_b32 v2, s59, v2
  s_mov_b32 s49, 0x47800000
  s_mov_b32 s51, 0
  s_mov_b32 s44, 0
  s_mov_b32 s56, 32768
  s_mov_b32 s57, -65536
  s_mov_b32 s67, 0x2d400000
  s_waitcnt vmcnt(8)
  s_barrier
  s_add_u32 s59, s45, 3
  s_and_b32 s59, s59, 7
  s_lshl_b32 s59, s59, 7
  s_add_u32 s59, s59, s63
  s_add_u32 m0, s65, 65536
  s_nop 0
  buffer_load_dwordx4 v3, s[24:27], s59 offen lds
  s_add_u32 m0, s65, 67584
  s_add_u32 s59, s59, 16384
  buffer_load_dwordx4 v3, s[24:27], s59 offen lds
  s_add_u32 m0, s65, 69632
  s_add_u32 s59, s59, 16384
  buffer_load_dwordx4 v3, s[24:27], s59 offen lds
  s_add_u32 m0, s65, 71680
  s_add_u32 s59, s59, 16384
  buffer_load_dwordx4 v3, s[24:27], s59 offen lds
  s_add_u32 s59, s45, 3
  s_and_b32 s59, s59, 7
  s_lshl_b32 s59, s59, 19
  s_add_u32 s59, s59, s54
  s_add_u32 s59, s59, 0
  s_add_u32 m0, s55, 81920
  s_nop 0
  buffer_load_dwordx4 v8, s[16:19], s59 offen lds
  s_add_u32 m0, s55, 82816
  s_nop 0
  buffer_load_dwordx4 v8, s[16:19], s59 offen offset:128 lds
  s_add_u32 s59, s45, 3
  s_and_b32 s59, s59, 7
  s_lshl_b32 s59, s59, 19
  s_add_u32 s59, s59, s54
  s_add_u32 s59, s59, 262144
  s_add_u32 m0, s55, 90112
  s_nop 0
  buffer_load_dwordx4 v8, s[16:19], s59 offen lds
  s_add_u32 m0, s55, 91008
  s_nop 0
  buffer_load_dwordx4 v8, s[16:19], s59 offen offset:128 lds
  s_waitcnt vmcnt(8)
  s_barrier
  s_add_u32 s59, s45, 4
  s_and_b32 s59, s59, 7
  s_lshl_b32 s59, s59, 7
  s_add_u32 s59, s59, s63
  s_add_u32 m0, s65, 131072
  s_nop 0
  buffer_load_dwordx4 v3, s[24:27], s59 offen lds
  s_add_u32 m0, s65, 133120
  s_add_u32 s59, s59, 16384
  buffer_load_dwordx4 v3, s[24:27], s59 offen lds
  s_add_u32 m0, s65, 135168
  s_add_u32 s59, s59, 16384
  buffer_load_dwordx4 v3, s[24:27], s59 offen lds
  s_add_u32 m0, s65, 137216
  s_add_u32 s59, s59, 16384
  buffer_load_dwordx4 v3, s[24:27], s59 offen lds
  s_add_u32 s59, s45, 4
  s_and_b32 s59, s59, 7
  s_lshl_b32 s59, s59, 19
  s_add_u32 s59, s59, s54
  s_add_u32 s59, s59, 0
  s_add_u32 m0, s55, 147456
  s_nop 0
  buffer_load_dwordx4 v8, s[16:19], s59 offen lds
  s_add_u32 m0, s55, 148352
  s_nop 0
  buffer_load_dwordx4 v8, s[16:19], s59 offen offset:128 lds
  s_add_u32 s59, s45, 4
  s_and_b32 s59, s59, 7
  s_lshl_b32 s59, s59, 19
  s_add_u32 s59, s59, s54
  s_add_u32 s59, s59, 262144
  s_add_u32 m0, s55, 155648
  s_nop 0
  buffer_load_dwordx4 v8, s[16:19], s59 offen lds
  s_add_u32 m0, s55, 156544
  s_nop 0
  buffer_load_dwordx4 v8, s[16:19], s59 offen offset:128 lds
  s_waitcnt vmcnt(8)
  s_barrier
  s_add_u32 s59, s45, 5
  s_and_b32 s59, s59, 7
  s_lshl_b32 s59, s59, 7
  s_add_u32 s59, s59, s63
  s_add_u32 m0, s65, 98304
  s_nop 0
  buffer_load_dwordx4 v3, s[24:27], s59 offen lds
  s_add_u32 m0, s65, 100352
  s_add_u32 s59, s59, 16384
  buffer_load_dwordx4 v3, s[24:27], s59 offen lds
  s_add_u32 m0, s65, 102400
  s_add_u32 s59, s59, 16384
  buffer_load_dwordx4 v3, s[24:27], s59 offen lds
  s_add_u32 m0, s65, 104448
  s_add_u32 s59, s59, 16384
  buffer_load_dwordx4 v3, s[24:27], s59 offen lds
  s_add_u32 s59, s45, 5
  s_and_b32 s59, s59, 7
  s_lshl_b32 s59, s59, 19
  s_add_u32 s59, s59, s54
  s_add_u32 s59, s59, 0
  s_add_u32 m0, s55, 114688
  s_nop 0
  buffer_load_dwordx4 v8, s[16:19], s59 offen lds
  s_add_u32 m0, s55, 115584
  s_nop 0
  buffer_load_dwordx4 v8, s[16:19], s59 offen offset:128 lds
  s_add_u32 s59, s45, 5
  s_and_b32 s59, s59, 7
  s_lshl_b32 s59, s59, 19
  s_add_u32 s59, s59, s54
  s_add_u32 s59, s59, 262144
  s_add_u32 m0, s55, 122880
  s_nop 0
  buffer_load_dwordx4 v8, s[16:19], s59 offen lds
  s_add_u32 m0, s55, 123776
  s_nop 0
  buffer_load_dwordx4 v8, s[16:19], s59 offen offset:128 lds
  s_waitcnt vmcnt(8)
  s_barrier
  s_add_u32 s59, s45, 6
  s_and_b32 s59, s59, 7
  s_lshl_b32 s59, s59, 7
  s_add_u32 s59, s59, s63
  s_add_u32 m0, s65, 65536
  s_nop 0
  buffer_load_dwordx4 v3, s[24:27], s59 offen lds
  s_add_u32 m0, s65, 67584
  s_add_u32 s59, s59, 16384
  buffer_load_dwordx4 v3, s[24:27], s59 offen lds
  s_add_u32 m0, s65, 69632
  s_add_u32 s59, s59, 16384
  buffer_load_dwordx4 v3, s[24:27], s59 offen lds
  s_add_u32 m0, s65, 71680
  s_add_u32 s59, s59, 16384
  buffer_load_dwordx4 v3, s[24:27], s59 offen lds
  s_add_u32 s59, s45, 6
  s_and_b32 s59, s59, 7
  s_lshl_b32 s59, s59, 19
  s_add_u32 s59, s59, s54
  s_add_u32 s59, s59, 0
  s_add_u32 m0, s55, 81920
  s_nop 0
  buffer_load_dwordx4 v8, s[16:19], s59 offen lds
  s_add_u32 m0, s55, 82816
  s_nop 0
  buffer_load_dwordx4 v8, s[16:19], s59 offen offset:128 lds
  s_add_u32 s59, s45, 6
  s_and_b32 s59, s59, 7
  s_lshl_b32 s59, s59, 19
  s_add_u32 s59, s59, s54
  s_add_u32 s59, s59, 262144
  s_add_u32 m0, s55, 90112
  s_nop 0
  buffer_load_dwordx4 v8, s[16:19], s59 offen lds
  s_add_u32 m0, s55, 91008
  s_nop 0
  buffer_load_dwordx4 v8, s[16:19], s59 offen offset:128 lds
  s_waitcnt vmcnt(8)
  s_barrier
  s_add_u32 s59, s45, 7
  s_and_b32 s59, s59, 7
  s_lshl_b32 s59, s59, 7
  s_add_u32 s59, s59, s63
  s_add_u32 m0, s65, 131072
  s_nop 0
  buffer_load_dwordx4 v3, s[24:27], s59 offen lds
  s_add_u32 m0, s65, 133120
  s_add_u32 s59, s59, 16384
  buffer_load_dwordx4 v3, s[24:27], s59 offen lds
  s_add_u32 m0, s65, 135168
  s_add_u32 s59, s59, 16384
  buffer_load_dwordx4 v3, s[24:27], s59 offen lds
  s_add_u32 m0, s65, 137216
  s_add_u32 s59, s59, 16384
  buffer_load_dwordx4 v3, s[24:27], s59 offen lds
  s_add_u32 s59, s45, 7
  s_and_b32 s59, s59, 7
  s_lshl_b32 s59, s59, 19
  s_add_u32 s59, s59, s54
  s_add_u32 s59, s59, 0
  s_add_u32 m0, s55, 147456
  s_nop 0
  buffer_load_dwordx4 v8, s[16:19], s59 offen lds
  s_add_u32 m0, s55, 148352
  s_nop 0
  buffer_load_dwordx4 v8, s[16:19], s59 offen offset:128 lds
  s_add_u32 s59, s45, 7
  s_and_b32 s59, s59, 7
  s_lshl_b32 s59, s59, 19
  s_add_u32 s59, s59, s54
  s_add_u32 s59, s59, 262144
  s_add_u32 m0, s55, 155648
  s_nop 0
  buffer_load_dwordx4 v8, s[16:19], s59 offen lds
  s_add_u32 m0, s55, 156544
  s_nop 0
  buffer_load_dwordx4 v8, s[16:19], s59 offen offset:128 lds
  s_add_u32 s60, s58, s43
  s_add_u32 m0, s60, 0
  s_nop 0
  buffer_load_dwordx4 v1, s[8:11], s52 offen nt lds
  s_add_u32 m0, s60, 896
  s_nop 0
  buffer_load_dwordx4 v1, s[8:11], s52 offen offset:128 nt lds
  s_add_u32 m0, s60, 4096
  s_add_u32 s59, s52, 4096
  buffer_load_dwordx4 v1, s[8:11], s59 offen nt lds
  s_add_u32 m0, s60, 4992
  s_nop 0
  buffer_load_dwordx4 v1, s[8:11], s59 offen offset:128 nt lds
  s_add_u32 s60, s58, s48
  s_xor_b32 s59, s53, 128
  s_add_u32 m0, s60, 0
  s_nop 0
  buffer_load_dwordx4 v2, s[12:15], s53 offen nt lds
  s_add_u32 m0, s60, 1024
  s_nop 0
  buffer_load_dwordx4 v2, s[12:15], s59 offen nt lds
  s_add_u32 m0, s60, 0
  s_nop 0
  buffer_load_dwordx4 v2, s[12:15], s53 offen offset:2048 nt lds
  s_add_u32 m0, s60, 1024
  s_nop 0
  buffer_load_dwordx4 v2, s[12:15], s59 offen offset:2048 nt lds
  s_add_u32 s52, s52, 16384
  s_add_u32 s53, s53, 16384
  s_add_u32 s58, s58, 32768
  s_cmp_ge_u32 s58, 98304
  s_cselect_b32 s58, 0, s58
  s_add_u32 s53, s70, 8192
  s_waitcnt vmcnt(16)
  s_barrier
  s_add_u32 s59, s45, 0
  s_and_b32 s59, s59, 7
  s_lshl_b32 s59, s59, 19
  s_add_u32 s59, s59, s54
  s_add_u32 s59, s59, 256
  s_add_u32 m0, s55, 98304
  s_nop 0
  buffer_load_dwordx4 v8, s[16:19], s59 offen lds
  s_add_u32 m0, s55, 99200
  s_nop 0
  buffer_load_dwordx4 v8, s[16:19], s59 offen offset:128 lds
  s_add_u32 s59, s45, 0
  s_and_b32 s59, s59, 7
  s_lshl_b32 s59, s59, 19
  s_add_u32 s59, s59, s54
  s_add_u32 s59, s59, 262400
  s_add_u32 m0, s55, 106496
  s_nop 0
  buffer_load_dwordx4 v8, s[16:19], s59 offen lds
  s_add_u32 m0, s55, 107392
  s_nop 0
  buffer_load_dwordx4 v8, s[16:19], s59 offen offset:128 lds
  s_add_u32 s59, s45, 1
  s_and_b32 s59, s59, 7
  s_lshl_b32 s59, s59, 19
  s_add_u32 s59, s59, s54
  s_add_u32 s59, s59, 256
  s_add_u32 m0, s55, 114688
  s_nop 0
  buffer_load_dwordx4 v8, s[16:19], s59 offen lds
  s_add_u32 m0, s55, 115584
  s_nop 0
  buffer_load_dwordx4 v8, s[16:19], s59 offen offset:128 lds
  s_waitcnt vmcnt(14)
  s_barrier
  s_add_u32 s60, s58, s43
  s_add_u32 m0, s60, 0
  s_nop 0
  buffer_load_dwordx4 v1, s[8:11], s52 offen nt lds
  s_add_u32 m0, s60, 896
  s_nop 0
  buffer_load_dwordx4 v1, s[8:11], s52 offen offset:128 nt lds
  s_add_u32 m0, s60, 4096
  s_add_u32 s59, s52, 4096
  buffer_load_dwordx4 v1, s[8:11], s59 offen nt lds
  s_add_u32 m0, s60, 4992
  s_nop 0
  buffer_load_dwordx4 v1, s[8:11], s59 offen offset:128 nt lds
  s_add_u32 s60, s58, s48
  s_xor_b32 s59, s53, 128
  s_add_u32 m0, s60, 0
  s_nop 0
  buffer_load_dwordx4 v2, s[12:15], s53 offen nt lds
  s_add_u32 m0, s60, 1024
  s_nop 0
  buffer_load_dwordx4 v2, s[12:15], s59 offen nt lds
  s_add_u32 m0, s60, 0
  s_nop 0
  buffer_load_dwordx4 v2, s[12:15], s53 offen offset:2048 nt lds
  s_add_u32 m0, s60, 1024
  s_nop 0
  buffer_load_dwordx4 v2, s[12:15], s59 offen offset:2048 nt lds
  s_add_u32 s52, s52, 16384
  s_add_u32 s53, s53, 16384
  s_add_u32 s58, s58, 32768
  s_cmp_ge_u32 s58, 98304
  s_cselect_b32 s58, 0, s58
  s_setprio 1
  v_mov_b32 v21, v1
  v_xor_b32 v20, 32, v1
  v_mov_b32 v22, v2
  s_mov_b32 s76, s16
  s_mov_b32 s77, s17
  s_mov_b32 s78, s18
  s_mov_b32 s79, 0x20000
  s_lshl_b32 s80, s7, 18
  s_add_u32 s80, s80, 512
  s_mov_b32 s81, 32768
  s_mov_b32 s82, -229120
  s_mov_b32 s83, 3
  s_add_u32 s78, s80, 261632
  v_lshrrev_b32 v23, 4, v0
  v_lshlrev_b32 v23, 13, v23
  v_and_b32 v12, 15, v0
  v_lshl_add_u32 v23, v12, 4, v23
  v_bfe_u32 v12, v0, 2, 2
  v_sub_u32 v12, 0, v12
  v_and_b32 v12, 3, v12
  v_lshrrev_b32 v13, 4, v0
  v_xor_b32 v12, v12, v13
  v_lshlrev_b32 v1, 4, v12
  v_and_b32 v12, 7, v0
  v_lshl_add_u32 v1, v12, 6, v1
  v_bfe_u32 v12, v0, 3, 1
  v_mul_u32_u24 v12, 2048, v12
  v_add_u32 v1, v1, v12
  v_lshrrev_b32 v2, 5, v0
  v_mul_u32_u24 v2, 2048, v2
  v_bfe_u32 v12, v0, 2, 3
  v_lshl_add_u32 v2, v12, 6, v2
  v_bfe_u32 v12, v0, 4, 1
  v_lshl_add_u32 v2, v12, 5, v2
  v_and_b32 v12, 3, v0
  v_lshl_add_u32 v2, v12, 3, v2
  v_xor_b32 v3, 32, v2
  v_lshlrev_b32 v4, 4, v0
  s_waitcnt vmcnt(8)
  s_cmp_eq_u32 s40, 3
  s_cbranch_scc1 L_att1
  s_branch L_att2
L_helper:
  s_mov_b32 s50, 0x3e0293ee
  s_lshl_b32 s68, s46, 15
  s_lshl1_add_u32 s59, s40, s47
  s_lshl_b32 s59, s59, 7
  s_add_u32 s68, s68, s59
  s_lshl_b32 s69, s40, 13
  s_add_u32 s69, s69, 131072
  v_lshrrev_b32 v9, 5, v0
  v_mul_u32_u24 v9, 2048, v9
  v_bfe_u32 v13, v0, 2, 3
  v_lshl_add_u32 v9, v13, 6, v9
  v_bfe_u32 v13, v0, 4, 1
  v_lshl_add_u32 v9, v13, 5, v9
  v_and_b32 v13, 3, v0
  v_lshl_add_u32 v9, v13, 3, v9
  v_xor_b32 v10, 32, v9
  v_lshrrev_b32 v5, 5, v0
  v_mul_u32_u24 v5, 1024, v5
  v_bfe_u32 v13, v0, 2, 3
  v_lshl_add_u32 v5, v13, 6, v5
  v_bfe_u32 v13, v0, 4, 1
  v_lshl_add_u32 v5, v13, 5, v5
  v_and_b32 v13, 3, v0
  v_lshl_add_u32 v5, v13, 3, v5
  v_xor_b32 v6, 32, v5
  v_add_u32 v5, s69, v5
  v_add_u32 v6, s69, v6
  v_bfe_u32 v13, v0, 2, 2
  v_sub_u32 v13, 0, v13
  v_and_b32 v13, 3, v13
  v_lshrrev_b32 v14, 4, v0
  v_xor_b32 v13, v13, v14
  v_lshlrev_b32 v12, 4, v13
  v_and_b32 v13, 7, v0
  v_lshl_add_u32 v12, v13, 6, v12
  v_bfe_u32 v13, v0, 3, 1
  v_mul_u32_u24 v13, 1024, v13
  v_add_u32 v12, v12, v13
  s_lshl_b32 s59, s40, 12
  v_add_u32 v12, s59, v12
  v_lshlrev_b32 v7, 4, v0
  v_and_b32 v13, 15, v0
  v_lshrrev_b32 v14, 5, v0
  v_lshl_add_u32 v13, v14, 4, v13
  v_bfe_u32 v14, v0, 4, 1
  v_lshl_add_u32 v13, v14, 5, v13
  v_lshlrev_b32 v13, 4, v13
  s_lshl_b32 s59, s40, 13
  v_add_u32 v11, s59, v13
  s_add_u32 s62, s41, s40
  v_add_u32 v2, 65536, v9
  v_add_u32 v3, 65536, v10
  v_add_u32 v9, 98304, v9
  v_add_u32 v10, 98304, v10
  v_add_u32 v1, 65536, v12
  v_add_u32 v12, 98304, v12
  s_waitcnt vmcnt(0)
  s_barrier
  ds_read_b128 v[128:131], v1 offset:0
  ds_read_b128 v[192:195], v1 offset:2048
  ds_read_b128 v[132:135], v1 offset:512
  ds_read_b128 v[196:199], v1 offset:2560
  ds_read_b64_tr_b16 v[16:17], v2 offset:16384
  ds_read_b64_tr_b16 v[18:19], v2 offset:20480
  ds_read_b64_tr_b16 v[20:21], v3 offset:16384
  ds_read_b64_tr_b16 v[22:23], v3 offset:20480
  ds_read_b64_tr_b16 v[24:25], v2 offset:16896
  ds_read_b64_tr_b16 v[26:27], v2 offset:20992
  s_waitcnt lgkmcnt(2)
  v_mfma_f32_16x16x32_bf16 v[64:67], v[16:19], v[128:131], 0
  ds_read_b64_tr_b16 v[28:29], v3 offset:16896
  ds_read_b64_tr_b16 v[30:31], v3 offset:20992
  v_mfma_f32_16x16x32_bf16 v[96:99], v[16:19], v[192:195], 0
  v_mfma_f32_16x16x32_bf16 v[68:71], v[20:23], v[128:131], 0
  ds_read_b64_tr_b16 v[16:17], v2 offset:17408
  ds_read_b64_tr_b16 v[18:19], v2 offset:21504
  v_mfma_f32_16x16x32_bf16 v[100:103], v[20:23], v[192:195], 0
  s_waitcnt lgkmcnt(2)
  v_mfma_f32_16x16x32_bf16 v[72:75], v[24:27], v[128:131], 0
  ds_read_b64_tr_b16 v[20:21], v3 offset:17408
  ds_read_b64_tr_b16 v[22:23], v3 offset:21504
  v_mfma_f32_16x16x32_bf16 v[104:107], v[24:27], v[192:195], 0
  v_mfma_f32_16x16x32_bf16 v[76:79], v[28:31], v[128:131], 0
  ds_read_b64_tr_b16 v[24:25], v2 offset:17920
  ds_read_b64_tr_b16 v[26:27], v2 offset:22016
  v_mfma_f32_16x16x32_bf16 v[108:111], v[28:31], v[192:195], 0
  s_waitcnt lgkmcnt(2)
  v_mfma_f32_16x16x32_bf16 v[80:83], v[16:19], v[128:131], 0
  ds_read_b64_tr_b16 v[28:29], v3 offset:17920
  ds_read_b64_tr_b16 v[30:31], v3 offset:22016
  v_mfma_f32_16x16x32_bf16 v[112:115], v[16:19], v[192:195], 0
  v_mfma_f32_16x16x32_bf16 v[84:87], v[20:23], v[128:131], 0
  ds_read_b64_tr_b16 v[16:17], v2 offset:24576
  ds_read_b64_tr_b16 v[18:19], v2 offset:28672
  v_mfma_f32_16x16x32_bf16 v[116:119], v[20:23], v[192:195], 0
  s_waitcnt lgkmcnt(2)
  v_mfma_f32_16x16x32_bf16 v[88:91], v[24:27], v[128:131], 0
  ds_read_b64_tr_b16 v[20:21], v3 offset:24576
  ds_read_b64_tr_b16 v[22:23], v3 offset:28672
  v_mfma_f32_16x16x32_bf16 v[120:123], v[24:27], v[192:195], 0
  v_mfma_f32_16x16x32_bf16 v[92:95], v[28:31], v[128:131], 0
  ds_read_b64_tr_b16 v[24:25], v2 offset:25088
  ds_read_b64_tr_b16 v[26:27], v2 offset:29184
  v_mfma_f32_16x16x32_bf16 v[124:127], v[28:31], v[192:195], 0
  s_waitcnt lgkmcnt(2)
  v_mfma_f32_16x16x32_bf16 v[64:67], v[16:19], v[132:135], v[64:67]
  ds_read_b64_tr_b16 v[28:29], v3 offset:25088
  ds_read_b64_tr_b16 v[30:31], v3 offset:29184
  v_mfma_f32_16x16x32_bf16 v[96:99], v[16:19], v[196:199], v[96:99]
  v_mfma_f32_16x16x32_bf16 v[68:71], v[20:23], v[132:135], v[68:71]
  ds_read_b64_tr_b16 v[16:17], v2 offset:25600
  ds_read_b64_tr_b16 v[18:19], v2 offset:29696
  v_mfma_f32_16x16x32_bf16 v[100:103], v[20:23], v[196:199], v[100:103]
  s_waitcnt lgkmcnt(2)
  v_mfma_f32_16x16x32_bf16 v[72:75], v[24:27], v[132:135], v[72:75]
  ds_read_b64_tr_b16 v[20:21], v3 offset:25600
  ds_read_b64_tr_b16 v[22:23], v3 offset:29696
  v_mfma_f32_16x16x32_bf16 v[104:107], v[24:27], v[196:199], v[104:107]
  v_mfma_f32_16x16x32_bf16 v[76:79], v[28:31], v[132:135], v[76:79]
  ds_read_b64_tr_b16 v[24:25], v2 offset:26112
  ds_read_b64_tr_b16 v[26:27], v2 offset:30208
  v_mfma_f32_16x16x32_bf16 v[108:111], v[28:31], v[196:199], v[108:111]
  s_waitcnt lgkmcnt(2)
  v_mfma_f32_16x16x32_bf16 v[80:83], v[16:19], v[132:135], v[80:83]
  ds_read_b64_tr_b16 v[28:29], v3 offset:26112
  ds_read_b64_tr_b16 v[30:31], v3 offset:30208
  v_mfma_f32_16x16x32_bf16 v[112:115], v[16:19], v[196:199], v[112:115]
  v_mfma_f32_16x16x32_bf16 v[84:87], v[20:23], v[132:135], v[84:87]
  v_mfma_f32_16x16x32_bf16 v[116:119], v[20:23], v[196:199], v[116:119]
  s_waitcnt lgkmcnt(0)
  s_barrier
  ds_read_b128 v[136:139], v12 offset:32768
  ds_read_b128 v[200:203], v12 offset:34816
  ds_read_b128 v[140:143], v12 offset:33280
  ds_read_b128 v[204:207], v12 offset:35328
  ds_read_b64_tr_b16 v[16:17], v9 offset:49152
  ds_read_b64_tr_b16 v[18:19], v9 offset:53248
  ds_read_b64_tr_b16 v[20:21], v10 offset:49152
  ds_read_b64_tr_b16 v[22:23], v10 offset:53248
  v_mfma_f32_16x16x32_bf16 v[88:91], v[24:27], v[132:135], v[88:91]
  v_mfma_f32_16x16x32_bf16 v[120:123], v[24:27], v[196:199], v[120:123]
  v_mfma_f32_16x16x32_bf16 v[92:95], v[28:31], v[132:135], v[92:95]
  ds_read_b64_tr_b16 v[24:25], v9 offset:49664
  ds_read_b64_tr_b16 v[26:27], v9 offset:53760
  v_mfma_f32_16x16x32_bf16 v[124:127], v[28:31], v[196:199], v[124:127]
  s_waitcnt lgkmcnt(2)
  v_mfma_f32_16x16x32_bf16 v[64:67], v[16:19], v[136:139], v[64:67]
  ds_read_b64_tr_b16 v[28:29], v10 offset:49664
  ds_read_b64_tr_b16 v[30:31], v10 offset:53760
  v_mfma_f32_16x16x32_bf16 v[96:99], v[16:19], v[200:203], v[96:99]
  v_mfma_f32_16x16x32_bf16 v[68:71], v[20:23], v[136:139], v[68:71]
  ds_read_b64_tr_b16 v[16:17], v9 offset:50176
  ds_read_b64_tr_b16 v[18:19], v9 offset:54272
  v_mfma_f32_16x16x32_bf16 v[100:103], v[20:23], v[200:203], v[100:103]
  s_waitcnt lgkmcnt(2)
  v_mfma_f32_16x16x32_bf16 v[72:75], v[24:27], v[136:139], v[72:75]
  ds_read_b64_tr_b16 v[20:21], v10 offset:50176
  ds_read_b64_tr_b16 v[22:23], v10 offset:54272
  v_mfma_f32_16x16x32_bf16 v[104:107], v[24:27], v[200:203], v[104:107]
  v_mfma_f32_16x16x32_bf16 v[76:79], v[28:31], v[136:139], v[76:79]
  ds_read_b64_tr_b16 v[24:25], v9 offset:50688
  ds_read_b64_tr_b16 v[26:27], v9 offset:54784
  v_mfma_f32_16x16x32_bf16 v[108:111], v[28:31], v[200:203], v[108:111]
  s_waitcnt lgkmcnt(2)
  v_mfma_f32_16x16x32_bf16 v[80:83], v[16:19], v[136:139], v[80:83]
  ds_read_b64_tr_b16 v[28:29], v10 offset:50688
  ds_read_b64_tr_b16 v[30:31], v10 offset:54784
  v_mfma_f32_16x16x32_bf16 v[112:115], v[16:19], v[200:203], v[112:115]
  v_mfma_f32_16x16x32_bf16 v[84:87], v[20:23], v[136:139], v[84:87]
  ds_read_b64_tr_b16 v[16:17], v9 offset:57344
  ds_read_b64_tr_b16 v[18:19], v9 offset:61440
  v_mfma_f32_16x16x32_bf16 v[116:119], v[20:23], v[200:203], v[116:119]
  s_waitcnt lgkmcnt(2)
  v_mfma_f32_16x16x32_bf16 v[88:91], v[24:27], v[136:139], v[88:91]
  ds_read_b64_tr_b16 v[20:21], v10 offset:57344
  ds_read_b64_tr_b16 v[22:23], v10 offset:61440
  v_mfma_f32_16x16x32_bf16 v[120:123], v[24:27], v[200:203], v[120:123]
  v_mfma_f32_16x16x32_bf16 v[92:95], v[28:31], v[136:139], v[92:95]
  ds_read_b64_tr_b16 v[24:25], v9 offset:57856
  ds_read_b64_tr_b16 v[26:27], v9 offset:61952
  v_mfma_f32_16x16x32_bf16 v[124:127], v[28:31], v[200:203], v[124:127]
  s_waitcnt lgkmcnt(2)
  v_mfma_f32_16x16x32_bf16 v[64:67], v[16:19], v[140:143], v[64:67]
  ds_read_b64_tr_b16 v[28:29], v10 offset:57856
  ds_read_b64_tr_b16 v[30:31], v10 offset:61952
  v_mfma_f32_16x16x32_bf16 v[96:99], v[16:19], v[204:207], v[96:99]
  s_cmp_lg_u32 s40, 3
  s_cbranch_scc1 L_skip_1
  v_mov_b32 v14, 0
  s_mov_b32 s59, 80896
  buffer_load_dword v43, v14, s[8:11], 0 offen nt
  buffer_load_dword v44, v14, s[12:15], 0 offen nt
  buffer_load_dword v40, v14, s[20:23], 0 offen
  buffer_load_dword v41, v14, s[28:31], s59 offen
  buffer_load_dword v42, v14, s[32:35], 0 offen nt
L_skip_1:
  v_mfma_f32_16x16x32_bf16 v[68:71], v[20:23], v[140:143], v[68:71]
  ds_read_b64_tr_b16 v[16:17], v9 offset:58368
  ds_read_b64_tr_b16 v[18:19], v9 offset:62464
  v_mfma_f32_16x16x32_bf16 v[100:103], v[20:23], v[204:207], v[100:103]
  s_waitcnt lgkmcnt(2)
  v_mfma_f32_16x16x32_bf16 v[72:75], v[24:27], v[140:143], v[72:75]
  ds_read_b64_tr_b16 v[20:21], v10 offset:58368
  ds_read_b64_tr_b16 v[22:23], v10 offset:62464
  v_mfma_f32_16x16x32_bf16 v[104:107], v[24:27], v[204:207], v[104:107]
  v_mfma_f32_16x16x32_bf16 v[76:79], v[28:31], v[140:143], v[76:79]
  ds_read_b64_tr_b16 v[24:25], v9 offset:58880
  ds_read_b64_tr_b16 v[26:27], v9 offset:62976
  v_mfma_f32_16x16x32_bf16 v[108:111], v[28:31], v[204:207], v[108:111]
  s_waitcnt lgkmcnt(2)
  v_mfma_f32_16x16x32_bf16 v[80:83], v[16:19], v[140:143], v[80:83]
  ds_read_b64_tr_b16 v[28:29], v10 offset:58880
  ds_read_b64_tr_b16 v[30:31], v10 offset:62976
  v_mfma_f32_16x16x32_bf16 v[112:115], v[16:19], v[204:207], v[112:115]
  v_mfma_f32_16x16x32_bf16 v[84:87], v[20:23], v[140:143], v[84:87]
  v_mfma_f32_16x16x32_bf16 v[116:119], v[20:23], v[204:207], v[116:119]
  s_waitcnt lgkmcnt(0)
  s_barrier
  ds_read_b128 v[144:147], v12 offset:0
  ds_read_b128 v[208:211], v12 offset:2048
  ds_read_b128 v[148:151], v12 offset:512
  ds_read_b128 v[212:215], v12 offset:2560
  ds_read_b64_tr_b16 v[16:17], v9 offset:16384
  ds_read_b64_tr_b16 v[18:19], v9 offset:20480
  ds_read_b64_tr_b16 v[20:21], v10 offset:16384
  ds_read_b64_tr_b16 v[22:23], v10 offset:20480
  v_mfma_f32_16x16x32_bf16 v[88:91], v[24:27], v[140:143], v[88:91]
  v_mfma_f32_16x16x32_bf16 v[120:123], v[24:27], v[204:207], v[120:123]
  v_mfma_f32_16x16x32_bf16 v[92:95], v[28:31], v[140:143], v[92:95]
  ds_read_b64_tr_b16 v[24:25], v9 offset:16896
  ds_read_b64_tr_b16 v[26:27], v9 offset:20992
  v_mfma_f32_16x16x32_bf16 v[124:127], v[28:31], v[204:207], v[124:127]
  s_waitcnt lgkmcnt(2)
  v_mfma_f32_16x16x32_bf16 v[64:67], v[16:19], v[144:147], v[64:67]
  ds_read_b64_tr_b16 v[28:29], v10 offset:16896
  ds_read_b64_tr_b16 v[30:31], v10 offset:20992
  v_mfma_f32_16x16x32_bf16 v[96:99], v[16:19], v[208:211], v[96:99]
  v_mfma_f32_16x16x32_bf16 v[68:71], v[20:23], v[144:147], v[68:71]
  ds_read_b64_tr_b16 v[16:17], v9 offset:17408
  ds_read_b64_tr_b16 v[18:19], v9 offset:21504
  v_mfma_f32_16x16x32_bf16 v[100:103], v[20:23], v[208:211], v[100:103]
  s_waitcnt lgkmcnt(2)
  v_mfma_f32_16x16x32_bf16 v[72:75], v[24:27], v[144:147], v[72:75]
  ds_read_b64_tr_b16 v[20:21], v10 offset:17408
  ds_read_b64_tr_b16 v[22:23], v10 offset:21504
  v_mfma_f32_16x16x32_bf16 v[104:107], v[24:27], v[208:211], v[104:107]
  v_mfma_f32_16x16x32_bf16 v[76:79], v[28:31], v[144:147], v[76:79]
  ds_read_b64_tr_b16 v[24:25], v9 offset:17920
  ds_read_b64_tr_b16 v[26:27], v9 offset:22016
  v_mfma_f32_16x16x32_bf16 v[108:111], v[28:31], v[208:211], v[108:111]
  s_waitcnt lgkmcnt(2)
  v_mfma_f32_16x16x32_bf16 v[80:83], v[16:19], v[144:147], v[80:83]
  ds_read_b64_tr_b16 v[28:29], v10 offset:17920
  ds_read_b64_tr_b16 v[30:31], v10 offset:22016
  v_mfma_f32_16x16x32_bf16 v[112:115], v[16:19], v[208:211], v[112:115]
  v_mfma_f32_16x16x32_bf16 v[84:87], v[20:23], v[144:147], v[84:87]
  ds_read_b64_tr_b16 v[16:17], v9 offset:24576
  ds_read_b64_tr_b16 v[18:19], v9 offset:28672
  v_mfma_f32_16x16x32_bf16 v[116:119], v[20:23], v[208:211], v[116:119]
  s_waitcnt lgkmcnt(2)
  v_mfma_f32_16x16x32_bf16 v[88:91], v[24:27], v[144:147], v[88:91]
  ds_read_b64_tr_b16 v[20:21], v10 offset:24576
  ds_read_b64_tr_b16 v[22:23], v10 offset:28672
  v_mfma_f32_16x16x32_bf16 v[120:123], v[24:27], v[208:211], v[120:123]
  v_mfma_f32_16x16x32_bf16 v[92:95], v[28:31], v[144:147], v[92:95]
  ds_read_b64_tr_b16 v[24:25], v9 offset:25088
  ds_read_b64_tr_b16 v[26:27], v9 offset:29184
  v_mfma_f32_16x16x32_bf16 v[124:127], v[28:31], v[208:211], v[124:127]
  s_waitcnt lgkmcnt(2)
  v_mfma_f32_16x16x32_bf16 v[64:67], v[16:19], v[148:151], v[64:67]
  ds_read_b64_tr_b16 v[28:29], v10 offset:25088
  ds_read_b64_tr_b16 v[30:31], v10 offset:29184
  v_mfma_f32_16x16x32_bf16 v[96:99], v[16:19], v[212:215], v[96:99]
  v_mfma_f32_16x16x32_bf16 v[68:71], v[20:23], v[148:151], v[68:71]
  ds_read_b64_tr_b16 v[16:17], v9 offset:25600
  ds_read_b64_tr_b16 v[18:19], v9 offset:29696
  v_mfma_f32_16x16x32_bf16 v[100:103], v[20:23], v[212:215], v[100:103]
  s_waitcnt lgkmcnt(2)
  v_mfma_f32_16x16x32_bf16 v[72:75], v[24:27], v[148:151], v[72:75]
  ds_read_b64_tr_b16 v[20:21], v10 offset:25600
  ds_read_b64_tr_b16 v[22:23], v10 offset:29696
  v_mfma_f32_16x16x32_bf16 v[104:107], v[24:27], v[212:215], v[104:107]
  v_mfma_f32_16x16x32_bf16 v[76:79], v[28:31], v[148:151], v[76:79]
  ds_read_b64_tr_b16 v[24:25], v9 offset:26112
  ds_read_b64_tr_b16 v[26:27], v9 offset:30208
  v_mfma_f32_16x16x32_bf16 v[108:111], v[28:31], v[212:215], v[108:111]
  s_waitcnt lgkmcnt(2)
  v_mfma_f32_16x16x32_bf16 v[80:83], v[16:19], v[148:151], v[80:83]
  ds_read_b64_tr_b16 v[28:29], v10 offset:26112
  ds_read_b64_tr_b16 v[30:31], v10 offset:30208
  v_mfma_f32_16x16x32_bf16 v[112:115], v[16:19], v[212:215], v[112:115]
  v_mfma_f32_16x16x32_bf16 v[84:87], v[20:23], v[148:151], v[84:87]
  v_mfma_f32_16x16x32_bf16 v[116:119], v[20:23], v[212:215], v[116:119]
  s_waitcnt lgkmcnt(0)
  s_barrier
  ds_read_b128 v[152:155], v1 offset:0
  ds_read_b128 v[216:219], v1 offset:2048
  ds_read_b128 v[156:159], v1 offset:512
  ds_read_b128 v[220:223], v1 offset:2560
  ds_read_b64_tr_b16 v[16:17], v2 offset:16384
  ds_read_b64_tr_b16 v[18:19], v2 offset:20480
  ds_read_b64_tr_b16 v[20:21], v3 offset:16384
  ds_read_b64_tr_b16 v[22:23], v3 offset:20480
  v_mfma_f32_16x16x32_bf16 v[88:91], v[24:27], v[148:151], v[88:91]
  v_mfma_f32_16x16x32_bf16 v[120:123], v[24:27], v[212:215], v[120:123]
  v_mfma_f32_16x16x32_bf16 v[92:95], v[28:31], v[148:151], v[92:95]
  ds_read_b64_tr_b16 v[24:25], v2 offset:16896
  ds_read_b64_tr_b16 v[26:27], v2 offset:20992
  v_mfma_f32_16x16x32_bf16 v[124:127], v[28:31], v[212:215], v[124:127]
  s_waitcnt lgkmcnt(2)
  v_mfma_f32_16x16x32_bf16 v[64:67], v[16:19], v[152:155], v[64:67]
  ds_read_b64_tr_b16 v[28:29], v3 offset:16896
  ds_read_b64_tr_b16 v[30:31], v3 offset:20992
  v_mfma_f32_16x16x32_bf16 v[96:99], v[16:19], v[216:219], v[96:99]
  v_mfma_f32_16x16x32_bf16 v[68:71], v[20:23], v[152:155], v[68:71]
  ds_read_b64_tr_b16 v[16:17], v2 offset:17408
  ds_read_b64_tr_b16 v[18:19], v2 offset:21504
  v_mfma_f32_16x16x32_bf16 v[100:103], v[20:23], v[216:219], v[100:103]
  s_waitcnt lgkmcnt(2)
  v_mfma_f32_16x16x32_bf16 v[72:75], v[24:27], v[152:155], v[72:75]
  ds_read_b64_tr_b16 v[20:21], v3 offset:17408
  ds_read_b64_tr_b16 v[22:23], v3 offset:21504
  v_mfma_f32_16x16x32_bf16 v[104:107], v[24:27], v[216:219], v[104:107]
  v_mfma_f32_16x16x32_bf16 v[76:79], v[28:31], v[152:155], v[76:79]
  ds_read_b64_tr_b16 v[24:25], v2 offset:17920
  ds_read_b64_tr_b16 v[26:27], v2 offset:22016
  v_mfma_f32_16x16x32_bf16 v[108:111], v[28:31], v[216:219], v[108:111]
  s_waitcnt lgkmcnt(2)
  v_mfma_f32_16x16x32_bf16 v[80:83], v[16:19], v[152:155], v[80:83]
  ds_read_b64_tr_b16 v[28:29], v3 offset:17920
  ds_read_b64_tr_b16 v[30:31], v3 offset:22016
  v_mfma_f32_16x16x32_bf16 v[112:115], v[16:19], v[216:219], v[112:115]
  v_mfma_f32_16x16x32_bf16 v[84:87], v[20:23], v[152:155], v[84:87]
  ds_read_b64_tr_b16 v[16:17], v2 offset:24576
  ds_read_b64_tr_b16 v[18:19], v2 offset:28672
  v_mfma_f32_16x16x32_bf16 v[116:119], v[20:23], v[216:219], v[116:119]
  s_waitcnt lgkmcnt(2)
  v_mfma_f32_16x16x32_bf16 v[88:91], v[24:27], v[152:155], v[88:91]
  ds_read_b64_tr_b16 v[20:21], v3 offset:24576
  ds_read_b64_tr_b16 v[22:23], v3 offset:28672
  v_mfma_f32_16x16x32_bf16 v[120:123], v[24:27], v[216:219], v[120:123]
  v_mfma_f32_16x16x32_bf16 v[92:95], v[28:31], v[152:155], v[92:95]
  ds_read_b64_tr_b16 v[24:25], v2 offset:25088
  ds_read_b64_tr_b16 v[26:27], v2 offset:29184
  v_mfma_f32_16x16x32_bf16 v[124:127], v[28:31], v[216:219], v[124:127]
  s_waitcnt lgkmcnt(2)
  v_mfma_f32_16x16x32_bf16 v[64:67], v[16:19], v[156:159], v[64:67]
  ds_read_b64_tr_b16 v[28:29], v3 offset:25088
  ds_read_b64_tr_b16 v[30:31], v3 offset:29184
  v_mfma_f32_16x16x32_bf16 v[96:99], v[16:19], v[220:223], v[96:99]
  s_cmp_lg_u32 s62, 0
  s_cbranch_scc1 L_skip_2
  v_mov_b32 v36, 0
  v_mov_b32 v37, 0
  v_mov_b32 v38, 0
  v_mov_b32 v39, 0
  v_lshrrev_b32 v13, 3, v0
  v_lshlrev_b32 v13, 24, v13
  v_and_b32 v14, 0x70, v7
  v_add_u32 v13, v13, v14
  s_mov_b32 s59, 14336
  buffer_store_dwordx4 v[36:39], v13, s[28:31], s59 offen sc1
L_skip_2:
  v_mfma_f32_16x16x32_bf16 v[68:71], v[20:23], v[156:159], v[68:71]
  ds_read_b64_tr_b16 v[16:17], v2 offset:25600
  ds_read_b64_tr_b16 v[18:19], v2 offset:29696
  v_mfma_f32_16x16x32_bf16 v[100:103], v[20:23], v[220:223], v[100:103]
  s_waitcnt lgkmcnt(2)
  v_mfma_f32_16x16x32_bf16 v[72:75], v[24:27], v[156:159], v[72:75]
  ds_read_b64_tr_b16 v[20:21], v3 offset:25600
  ds_read_b64_tr_b16 v[22:23], v3 offset:29696
  v_mfma_f32_16x16x32_bf16 v[104:107], v[24:27], v[220:223], v[104:107]
  v_mfma_f32_16x16x32_bf16 v[76:79], v[28:31], v[156:159], v[76:79]
  ds_read_b64_tr_b16 v[24:25], v2 offset:26112
  ds_read_b64_tr_b16 v[26:27], v2 offset:30208
  v_mfma_f32_16x16x32_bf16 v[108:111], v[28:31], v[220:223], v[108:111]
  s_waitcnt lgkmcnt(2)
  v_mfma_f32_16x16x32_bf16 v[80:83], v[16:19], v[156:159], v[80:83]
  ds_read_b64_tr_b16 v[28:29], v3 offset:26112
  ds_read_b64_tr_b16 v[30:31], v3 offset:30208
  v_mfma_f32_16x16x32_bf16 v[112:115], v[16:19], v[220:223], v[112:115]
  v_mfma_f32_16x16x32_bf16 v[84:87], v[20:23], v[156:159], v[84:87]
  v_mfma_f32_16x16x32_bf16 v[116:119], v[20:23], v[220:223], v[116:119]
  s_waitcnt lgkmcnt(0)
  s_barrier
  ds_read_b128 v[160:163], v12 offset:32768
  ds_read_b128 v[224:227], v12 offset:34816
  ds_read_b128 v[164:167], v12 offset:33280
  ds_read_b128 v[228:231], v12 offset:35328
  ds_read_b64_tr_b16 v[16:17], v9 offset:49152
  ds_read_b64_tr_b16 v[18:19], v9 offset:53248
  ds_read_b64_tr_b16 v[20:21], v10 offset:49152
  ds_read_b64_tr_b16 v[22:23], v10 offset:53248
  v_mfma_f32_16x16x32_bf16 v[88:91], v[24:27], v[156:159], v[88:91]
  v_mfma_f32_16x16x32_bf16 v[120:123], v[24:27], v[220:223], v[120:123]
  v_mfma_f32_16x16x32_bf16 v[92:95], v[28:31], v[156:159], v[92:95]
  ds_read_b64_tr_b16 v[24:25], v9 offset:49664
  ds_read_b64_tr_b16 v[26:27], v9 offset:53760
  v_mfma_f32_16x16x32_bf16 v[124:127], v[28:31], v[220:223], v[124:127]
  s_waitcnt lgkmcnt(2)
  v_mfma_f32_16x16x32_bf16 v[64:67], v[16:19], v[160:163], v[64:67]
  ds_read_b64_tr_b16 v[28:29], v10 offset:49664
  ds_read_b64_tr_b16 v[30:31], v10 offset:53760
  v_mfma_f32_16x16x32_bf16 v[96:99], v[16:19], v[224:227], v[96:99]
  v_mfma_f32_16x16x32_bf16 v[68:71], v[20:23], v[160:163], v[68:71]
  ds_read_b64_tr_b16 v[16:17], v9 offset:50176
  ds_read_b64_tr_b16 v[18:19], v9 offset:54272
  v_mfma_f32_16x16x32_bf16 v[100:103], v[20:23], v[224:227], v[100:103]
  s_waitcnt lgkmcnt(2)
  v_mfma_f32_16x16x32_bf16 v[72:75], v[24:27], v[160:163], v[72:75]
  ds_read_b64_tr_b16 v[20:21], v10 offset:50176
  ds_read_b64_tr_b16 v[22:23], v10 offset:54272
  v_mfma_f32_16x16x32_bf16 v[104:107], v[24:27], v[224:227], v[104:107]
  v_mfma_f32_16x16x32_bf16 v[76:79], v[28:31], v[160:163], v[76:79]
  ds_read_b64_tr_b16 v[24:25], v9 offset:50688
  ds_read_b64_tr_b16 v[26:27], v9 offset:54784
  v_mfma_f32_16x16x32_bf16 v[108:111], v[28:31], v[224:227], v[108:111]
  s_waitcnt lgkmcnt(2)
  v_mfma_f32_16x16x32_bf16 v[80:83], v[16:19], v[160:163], v[80:83]
  ds_read_b64_tr_b16 v[28:29], v10 offset:50688
  ds_read_b64_tr_b16 v[30:31], v10 offset:54784
  v_mfma_f32_16x16x32_bf16 v[112:115], v[16:19], v[224:227], v[112:115]
  v_mfma_f32_16x16x32_bf16 v[84:87], v[20:23], v[160:163], v[84:87]
  ds_read_b64_tr_b16 v[16:17], v9 offset:57344
  ds_read_b64_tr_b16 v[18:19], v9 offset:61440
  v_mfma_f32_16x16x32_bf16 v[116:119], v[20:23], v[224:227], v[116:119]
  s_waitcnt lgkmcnt(2)
  v_mfma_f32_16x16x32_bf16 v[88:91], v[24:27], v[160:163], v[88:91]
  ds_read_b64_tr_b16 v[20:21], v10 offset:57344
  ds_read_b64_tr_b16 v[22:23], v10 offset:61440
  v_mfma_f32_16x16x32_bf16 v[120:123], v[24:27], v[224:227], v[120:123]
  v_mfma_f32_16x16x32_bf16 v[92:95], v[28:31], v[160:163], v[92:95]
  ds_read_b64_tr_b16 v[24:25], v9 offset:57856
  ds_read_b64_tr_b16 v[26:27], v9 offset:61952
  v_mfma_f32_16x16x32_bf16 v[124:127], v[28:31], v[224:227], v[124:127]
  s_waitcnt lgkmcnt(2)
  v_mfma_f32_16x16x32_bf16 v[64:67], v[16:19], v[164:167], v[64:67]
  ds_read_b64_tr_b16 v[28:29], v10 offset:57856
  ds_read_b64_tr_b16 v[30:31], v10 offset:61952
  v_mfma_f32_16x16x32_bf16 v[96:99], v[16:19], v[228:231], v[96:99]
  v_mfma_f32_16x16x32_bf16 v[68:71], v[20:23], v[164:167], v[68:71]
  ds_read_b64_tr_b16 v[16:17], v9 offset:58368
  ds_read_b64_tr_b16 v[18:19], v9 offset:62464
  v_mfma_f32_16x16x32_bf16 v[100:103], v[20:23], v[228:231], v[100:103]
  s_waitcnt lgkmcnt(2)
  v_mfma_f32_16x16x32_bf16 v[72:75], v[24:27], v[164:167], v[72:75]
  ds_read_b64_tr_b16 v[20:21], v10 offset:58368
  ds_read_b64_tr_b16 v[22:23], v10 offset:62464
  v_mfma_f32_16x16x32_bf16 v[104:107], v[24:27], v[228:231], v[104:107]
  v_mfma_f32_16x16x32_bf16 v[76:79], v[28:31], v[164:167], v[76:79]
  ds_read_b64_tr_b16 v[24:25], v9 offset:58880
  ds_read_b64_tr_b16 v[26:27], v9 offset:62976
  v_mfma_f32_16x16x32_bf16 v[108:111], v[28:31], v[228:231], v[108:111]
  s_waitcnt lgkmcnt(2)
  v_mfma_f32_16x16x32_bf16 v[80:83], v[16:19], v[164:167], v[80:83]
  ds_read_b64_tr_b16 v[28:29], v10 offset:58880
  ds_read_b64_tr_b16 v[30:31], v10 offset:62976
  v_mfma_f32_16x16x32_bf16 v[112:115], v[16:19], v[228:231], v[112:115]
  v_mfma_f32_16x16x32_bf16 v[84:87], v[20:23], v[164:167], v[84:87]
  v_mfma_f32_16x16x32_bf16 v[116:119], v[20:23], v[228:231], v[116:119]
  s_waitcnt lgkmcnt(0)
  s_barrier
  ds_read_b128 v[168:171], v12 offset:0
  ds_read_b128 v[232:235], v12 offset:2048
  ds_read_b128 v[172:175], v12 offset:512
  ds_read_b128 v[236:239], v12 offset:2560
  ds_read_b64_tr_b16 v[16:17], v9 offset:16384
  ds_read_b64_tr_b16 v[18:19], v9 offset:20480
  ds_read_b64_tr_b16 v[20:21], v10 offset:16384
  ds_read_b64_tr_b16 v[22:23], v10 offset:20480
  v_mfma_f32_16x16x32_bf16 v[88:91], v[24:27], v[164:167], v[88:91]
  v_mfma_f32_16x16x32_bf16 v[120:123], v[24:27], v[228:231], v[120:123]
  v_mfma_f32_16x16x32_bf16 v[92:95], v[28:31], v[164:167], v[92:95]
  ds_read_b64_tr_b16 v[24:25], v9 offset:16896
  ds_read_b64_tr_b16 v[26:27], v9 offset:20992
  v_mfma_f32_16x16x32_bf16 v[124:127], v[28:31], v[228:231], v[124:127]
  s_waitcnt lgkmcnt(2)
  v_mfma_f32_16x16x32_bf16 v[64:67], v[16:19], v[168:171], v[64:67]
  ds_read_b64_tr_b16 v[28:29], v10 offset:16896
  ds_read_b64_tr_b16 v[30:31], v10 offset:20992
  v_mfma_f32_16x16x32_bf16 v[96:99], v[16:19], v[232:235], v[96:99]
  v_mfma_f32_16x16x32_bf16 v[68:71], v[20:23], v[168:171], v[68:71]
  ds_read_b64_tr_b16 v[16:17], v9 offset:17408
  ds_read_b64_tr_b16 v[18:19], v9 offset:21504
  v_mfma_f32_16x16x32_bf16 v[100:103], v[20:23], v[232:235], v[100:103]
  s_waitcnt lgkmcnt(2)
  v_mfma_f32_16x16x32_bf16 v[72:75], v[24:27], v[168:171], v[72:75]
  ds_read_b64_tr_b16 v[20:21], v10 offset:17408
  ds_read_b64_tr_b16 v[22:23], v10 offset:21504
  v_mfma_f32_16x16x32_bf16 v[104:107], v[24:27], v[232:235], v[104:107]
  v_mfma_f32_16x16x32_bf16 v[76:79], v[28:31], v[168:171], v[76:79]
  ds_read_b64_tr_b16 v[24:25], v9 offset:17920
  ds_read_b64_tr_b16 v[26:27], v9 offset:22016
  v_mfma_f32_16x16x32_bf16 v[108:111], v[28:31], v[232:235], v[108:111]
  s_waitcnt lgkmcnt(2)
  v_mfma_f32_16x16x32_bf16 v[80:83], v[16:19], v[168:171], v[80:83]
  ds_read_b64_tr_b16 v[28:29], v10 offset:17920
  ds_read_b64_tr_b16 v[30:31], v10 offset:22016
  v_mfma_f32_16x16x32_bf16 v[112:115], v[16:19], v[232:235], v[112:115]
  v_mfma_f32_16x16x32_bf16 v[84:87], v[20:23], v[168:171], v[84:87]
  ds_read_b64_tr_b16 v[16:17], v9 offset:24576
  ds_read_b64_tr_b16 v[18:19], v9 offset:28672
  v_mfma_f32_16x16x32_bf16 v[116:119], v[20:23], v[232:235], v[116:119]
  s_waitcnt lgkmcnt(2)
  v_mfma_f32_16x16x32_bf16 v[88:91], v[24:27], v[168:171], v[88:91]
  ds_read_b64_tr_b16 v[20:21], v10 offset:24576
  ds_read_b64_tr_b16 v[22:23], v10 offset:28672
  v_mfma_f32_16x16x32_bf16 v[120:123], v[24:27], v[232:235], v[120:123]
  v_mfma_f32_16x16x32_bf16 v[92:95], v[28:31], v[168:171], v[92:95]
  ds_read_b64_tr_b16 v[24:25], v9 offset:25088
  ds_read_b64_tr_b16 v[26:27], v9 offset:29184
  v_mfma_f32_16x16x32_bf16 v[124:127], v[28:31], v[232:235], v[124:127]
  s_waitcnt lgkmcnt(2)
  v_mfma_f32_16x16x32_bf16 v[64:67], v[16:19], v[172:175], v[64:67]
  ds_read_b64_tr_b16 v[28:29], v10 offset:25088
  ds_read_b64_tr_b16 v[30:31], v10 offset:29184
  v_mfma_f32_16x16x32_bf16 v[96:99], v[16:19], v[236:239], v[96:99]
  v_mfma_f32_16x16x32_bf16 v[68:71], v[20:23], v[172:175], v[68:71]
  ds_read_b64_tr_b16 v[16:17], v9 offset:25600
  ds_read_b64_tr_b16 v[18:19], v9 offset:29696
  v_mfma_f32_16x16x32_bf16 v[100:103], v[20:23], v[236:239], v[100:103]
  s_waitcnt lgkmcnt(2)
  v_mfma_f32_16x16x32_bf16 v[72:75], v[24:27], v[172:175], v[72:75]
  ds_read_b64_tr_b16 v[20:21], v10 offset:25600
  ds_read_b64_tr_b16 v[22:23], v10 offset:29696
  v_mfma_f32_16x16x32_bf16 v[104:107], v[24:27], v[236:239], v[104:107]
  v_mfma_f32_16x16x32_bf16 v[76:79], v[28:31], v[172:175], v[76:79]
  ds_read_b64_tr_b16 v[24:25], v9 offset:26112
  ds_read_b64_tr_b16 v[26:27], v9 offset:30208
  v_mfma_f32_16x16x32_bf16 v[108:111], v[28:31], v[236:239], v[108:111]
  s_waitcnt lgkmcnt(2)
  v_mfma_f32_16x16x32_bf16 v[80:83], v[16:19], v[172:175], v[80:83]
  ds_read_b64_tr_b16 v[28:29], v10 offset:26112
  ds_read_b64_tr_b16 v[30:31], v10 offset:30208
  v_mfma_f32_16x16x32_bf16 v[112:115], v[16:19], v[236:239], v[112:115]
  v_mfma_f32_16x16x32_bf16 v[84:87], v[20:23], v[172:175], v[84:87]
  v_mfma_f32_16x16x32_bf16 v[116:119], v[20:23], v[236:239], v[116:119]
  s_waitcnt lgkmcnt(0)
  s_barrier
  ds_read_b128 v[176:179], v1 offset:0
  ds_read_b128 v[240:243], v1 offset:2048
  ds_read_b128 v[180:183], v1 offset:512
  ds_read_b128 v[244:247], v1 offset:2560
  ds_read_b64_tr_b16 v[16:17], v2 offset:16384
  ds_read_b64_tr_b16 v[18:19], v2 offset:20480
  ds_read_b64_tr_b16 v[20:21], v3 offset:16384
  ds_read_b64_tr_b16 v[22:23], v3 offset:20480
  v_mfma_f32_16x16x32_bf16 v[88:91], v[24:27], v[172:175], v[88:91]
  v_mfma_f32_16x16x32_bf16 v[120:123], v[24:27], v[236:239], v[120:123]
  v_mfma_f32_16x16x32_bf16 v[92:95], v[28:31], v[172:175], v[92:95]
  ds_read_b64_tr_b16 v[24:25], v2 offset:16896
  ds_read_b64_tr_b16 v[26:27], v2 offset:20992
  v_mfma_f32_16x16x32_bf16 v[124:127], v[28:31], v[236:239], v[124:127]
  s_waitcnt lgkmcnt(2)
  v_mfma_f32_16x16x32_bf16 v[64:67], v[16:19], v[176:179], v[64:67]
  ds_read_b64_tr_b16 v[28:29], v3 offset:16896
  ds_read_b64_tr_b16 v[30:31], v3 offset:20992
  v_mfma_f32_16x16x32_bf16 v[96:99], v[16:19], v[240:243], v[96:99]
  v_mfma_f32_16x16x32_bf16 v[68:71], v[20:23], v[176:179], v[68:71]
  ds_read_b64_tr_b16 v[16:17], v2 offset:17408
  ds_read_b64_tr_b16 v[18:19], v2 offset:21504
  v_mfma_f32_16x16x32_bf16 v[100:103], v[20:23], v[240:243], v[100:103]
  s_waitcnt lgkmcnt(2)
  v_mfma_f32_16x16x32_bf16 v[72:75], v[24:27], v[176:179], v[72:75]
  ds_read_b64_tr_b16 v[20:21], v3 offset:17408
  ds_read_b64_tr_b16 v[22:23], v3 offset:21504
  v_mfma_f32_16x16x32_bf16 v[104:107], v[24:27], v[240:243], v[104:107]
  v_mfma_f32_16x16x32_bf16 v[76:79], v[28:31], v[176:179], v[76:79]
  ds_read_b64_tr_b16 v[24:25], v2 offset:17920
  ds_read_b64_tr_b16 v[26:27], v2 offset:22016
  v_mfma_f32_16x16x32_bf16 v[108:111], v[28:31], v[240:243], v[108:111]
  s_waitcnt lgkmcnt(2)
  v_mfma_f32_16x16x32_bf16 v[80:83], v[16:19], v[176:179], v[80:83]
  ds_read_b64_tr_b16 v[28:29], v3 offset:17920
  ds_read_b64_tr_b16 v[30:31], v3 offset:22016
  v_mfma_f32_16x16x32_bf16 v[112:115], v[16:19], v[240:243], v[112:115]
  v_mfma_f32_16x16x32_bf16 v[84:87], v[20:23], v[176:179], v[84:87]
  ds_read_b64_tr_b16 v[16:17], v2 offset:24576
  ds_read_b64_tr_b16 v[18:19], v2 offset:28672
  v_mfma_f32_16x16x32_bf16 v[116:119], v[20:23], v[240:243], v[116:119]
  s_waitcnt lgkmcnt(2)
  v_mfma_f32_16x16x32_bf16 v[88:91], v[24:27], v[176:179], v[88:91]
  ds_read_b64_tr_b16 v[20:21], v3 offset:24576
  ds_read_b64_tr_b16 v[22:23], v3 offset:28672
  v_mfma_f32_16x16x32_bf16 v[120:123], v[24:27], v[240:243], v[120:123]
  v_mfma_f32_16x16x32_bf16 v[92:95], v[28:31], v[176:179], v[92:95]
  ds_read_b64_tr_b16 v[24:25], v2 offset:25088
  ds_read_b64_tr_b16 v[26:27], v2 offset:29184
  v_mfma_f32_16x16x32_bf16 v[124:127], v[28:31], v[240:243], v[124:127]
  s_waitcnt lgkmcnt(2)
  v_mfma_f32_16x16x32_bf16 v[64:67], v[16:19], v[180:183], v[64:67]
  ds_read_b64_tr_b16 v[28:29], v3 offset:25088
  ds_read_b64_tr_b16 v[30:31], v3 offset:29184
  v_mfma_f32_16x16x32_bf16 v[96:99], v[16:19], v[244:247], v[96:99]
  v_mfma_f32_16x16x32_bf16 v[68:71], v[20:23], v[180:183], v[68:71]
  ds_read_b64_tr_b16 v[16:17], v2 offset:25600
  ds_read_b64_tr_b16 v[18:19], v2 offset:29696
  v_mfma_f32_16x16x32_bf16 v[100:103], v[20:23], v[244:247], v[100:103]
  s_waitcnt lgkmcnt(2)
  v_mfma_f32_16x16x32_bf16 v[72:75], v[24:27], v[180:183], v[72:75]
  ds_read_b64_tr_b16 v[20:21], v3 offset:25600
  ds_read_b64_tr_b16 v[22:23], v3 offset:29696
  v_mfma_f32_16x16x32_bf16 v[104:107], v[24:27], v[244:247], v[104:107]
  v_mfma_f32_16x16x32_bf16 v[76:79], v[28:31], v[180:183], v[76:79]
  ds_read_b64_tr_b16 v[24:25], v2 offset:26112
  ds_read_b64_tr_b16 v[26:27], v2 offset:30208
  v_mfma_f32_16x16x32_bf16 v[108:111], v[28:31], v[244:247], v[108:111]
  s_waitcnt lgkmcnt(2)
  v_mfma_f32_16x16x32_bf16 v[80:83], v[16:19], v[180:183], v[80:83]
  ds_read_b64_tr_b16 v[28:29], v3 offset:26112
  ds_read_b64_tr_b16 v[30:31], v3 offset:30208
  v_mfma_f32_16x16x32_bf16 v[112:115], v[16:19], v[244:247], v[112:115]
  v_mfma_f32_16x16x32_bf16 v[84:87], v[20:23], v[180:183], v[84:87]
  v_mfma_f32_16x16x32_bf16 v[116:119], v[20:23], v[244:247], v[116:119]
  s_waitcnt lgkmcnt(0)
  s_barrier
  ds_read_b128 v[184:187], v12 offset:32768
  ds_read_b128 v[248:251], v12 offset:34816
  ds_read_b128 v[188:191], v12 offset:33280
  ds_read_b128 v[252:255], v12 offset:35328
  ds_read_b64_tr_b16 v[16:17], v9 offset:49152
  ds_read_b64_tr_b16 v[18:19], v9 offset:53248
  ds_read_b64_tr_b16 v[20:21], v10 offset:49152
  ds_read_b64_tr_b16 v[22:23], v10 offset:53248
  v_mfma_f32_16x16x32_bf16 v[88:91], v[24:27], v[180:183], v[88:91]
  v_mfma_f32_16x16x32_bf16 v[120:123], v[24:27], v[244:247], v[120:123]
  v_mfma_f32_16x16x32_bf16 v[92:95], v[28:31], v[180:183], v[92:95]
  ds_read_b64_tr_b16 v[24:25], v9 offset:49664
  ds_read_b64_tr_b16 v[26:27], v9 offset:53760
  v_mfma_f32_16x16x32_bf16 v[124:127], v[28:31], v[244:247], v[124:127]
  s_waitcnt lgkmcnt(2)
  v_mfma_f32_16x16x32_bf16 v[64:67], v[16:19], v[184:187], v[64:67]
  ds_read_b64_tr_b16 v[28:29], v10 offset:49664
  ds_read_b64_tr_b16 v[30:31], v10 offset:53760
  v_mfma_f32_16x16x32_bf16 v[96:99], v[16:19], v[248:251], v[96:99]
  v_mfma_f32_16x16x32_bf16 v[68:71], v[20:23], v[184:187], v[68:71]
  ds_read_b64_tr_b16 v[16:17], v9 offset:50176
  ds_read_b64_tr_b16 v[18:19], v9 offset:54272
  v_mfma_f32_16x16x32_bf16 v[100:103], v[20:23], v[248:251], v[100:103]
  s_waitcnt lgkmcnt(2)
  v_mfma_f32_16x16x32_bf16 v[72:75], v[24:27], v[184:187], v[72:75]
  ds_read_b64_tr_b16 v[20:21], v10 offset:50176
  ds_read_b64_tr_b16 v[22:23], v10 offset:54272
  v_mfma_f32_16x16x32_bf16 v[104:107], v[24:27], v[248:251], v[104:107]
  v_mfma_f32_16x16x32_bf16 v[76:79], v[28:31], v[184:187], v[76:79]
  ds_read_b64_tr_b16 v[24:25], v9 offset:50688
  ds_read_b64_tr_b16 v[26:27], v9 offset:54784
  v_mfma_f32_16x16x32_bf16 v[108:111], v[28:31], v[248:251], v[108:111]
  s_waitcnt lgkmcnt(2)
  v_mfma_f32_16x16x32_bf16 v[80:83], v[16:19], v[184:187], v[80:83]
  ds_read_b64_tr_b16 v[28:29], v10 offset:50688
  ds_read_b64_tr_b16 v[30:31], v10 offset:54784
  v_mfma_f32_16x16x32_bf16 v[112:115], v[16:19], v[248:251], v[112:115]
  v_mfma_f32_16x16x32_bf16 v[84:87], v[20:23], v[184:187], v[84:87]
  ds_read_b64_tr_b16 v[16:17], v9 offset:57344
  ds_read_b64_tr_b16 v[18:19], v9 offset:61440
  v_mfma_f32_16x16x32_bf16 v[116:119], v[20:23], v[248:251], v[116:119]
  s_waitcnt lgkmcnt(2)
  v_mfma_f32_16x16x32_bf16 v[88:91], v[24:27], v[184:187], v[88:91]
  ds_read_b64_tr_b16 v[20:21], v10 offset:57344
  ds_read_b64_tr_b16 v[22:23], v10 offset:61440
  v_mfma_f32_16x16x32_bf16 v[120:123], v[24:27], v[248:251], v[120:123]
  v_mfma_f32_16x16x32_bf16 v[92:95], v[28:31], v[184:187], v[92:95]
  ds_read_b64_tr_b16 v[24:25], v9 offset:57856
  ds_read_b64_tr_b16 v[26:27], v9 offset:61952
  v_mfma_f32_16x16x32_bf16 v[124:127], v[28:31], v[248:251], v[124:127]
  s_waitcnt lgkmcnt(2)
  v_mfma_f32_16x16x32_bf16 v[64:67], v[16:19], v[188:191], v[64:67]
  ds_read_b64_tr_b16 v[28:29], v10 offset:57856
  ds_read_b64_tr_b16 v[30:31], v10 offset:61952
  v_mfma_f32_16x16x32_bf16 v[96:99], v[16:19], v[252:255], v[96:99]
  v_mfma_f32_16x16x32_bf16 v[68:71], v[20:23], v[188:191], v[68:71]
  ds_read_b64_tr_b16 v[16:17], v9 offset:58368
  ds_read_b64_tr_b16 v[18:19], v9 offset:62464
  v_mfma_f32_16x16x32_bf16 v[100:103], v[20:23], v[252:255], v[100:103]
  s_waitcnt vmcnt(0)
  s_waitcnt lgkmcnt(2)
  v_mfma_f32_16x16x32_bf16 v[72:75], v[24:27], v[188:191], v[72:75]
  ds_read_b64_tr_b16 v[20:21], v10 offset:58368
  ds_read_b64_tr_b16 v[22:23], v10 offset:62464
  v_mfma_f32_16x16x32_bf16 v[104:107], v[24:27], v[252:255], v[104:107]
  v_mul_f32 v64, s50, v64
  v_mul_f32 v65, s50, v65
  v_mul_f32 v66, s50, v66
  v_mul_f32 v67, s50, v67
  v_cvt_pk_bf16_f32 v32, v64, v65
  v_cvt_pk_bf16_f32 v33, v66, v67
  v_mul_f32 v96, s50, v96
  v_mul_f32 v97, s50, v97
  v_mul_f32 v98, s50, v98
  v_mul_f32 v99, s50, v99
  v_cvt_pk_bf16_f32 v48, v96, v97
  v_cvt_pk_bf16_f32 v49, v98, v99
  v_mfma_f32_16x16x32_bf16 v[76:79], v[28:31], v[188:191], v[76:79]
  ds_read_b64_tr_b16 v[24:25], v9 offset:58880
  ds_read_b64_tr_b16 v[26:27], v9 offset:62976
  v_mfma_f32_16x16x32_bf16 v[108:111], v[28:31], v[252:255], v[108:111]
  v_mul_f32 v68, s50, v68
  v_mul_f32 v69, s50, v69
  v_mul_f32 v70, s50, v70
  v_mul_f32 v71, s50, v71
  v_cvt_pk_bf16_f32 v34, v68, v69
  v_cvt_pk_bf16_f32 v35, v70, v71
  v_mul_f32 v100, s50, v100
  v_mul_f32 v101, s50, v101
  v_mul_f32 v102, s50, v102
  v_mul_f32 v103, s50, v103
  v_cvt_pk_bf16_f32 v50, v100, v101
  v_cvt_pk_bf16_f32 v51, v102, v103
  v_permlane16_swap_b32 v32, v34
  v_permlane16_swap_b32 v33, v35
  v_permlane16_swap_b32 v48, v50
  v_permlane16_swap_b32 v49, v51
  s_waitcnt lgkmcnt(2)
  v_mfma_f32_16x16x32_bf16 v[80:83], v[16:19], v[188:191], v[80:83]
  ds_read_b64_tr_b16 v[28:29], v10 offset:58880
  ds_read_b64_tr_b16 v[30:31], v10 offset:62976
  v_mfma_f32_16x16x32_bf16 v[112:115], v[16:19], v[252:255], v[112:115]
  v_mul_f32 v72, s50, v72
  v_mul_f32 v73, s50, v73
  v_mul_f32 v74, s50, v74
  v_mul_f32 v75, s50, v75
  v_cvt_pk_bf16_f32 v36, v72, v73
  v_cvt_pk_bf16_f32 v37, v74, v75
  v_mul_f32 v104, s50, v104
  v_mul_f32 v105, s50, v105
  v_mul_f32 v106, s50, v106
  v_mul_f32 v107, s50, v107
  v_cvt_pk_bf16_f32 v52, v104, v105
  v_cvt_pk_bf16_f32 v53, v106, v107
  v_mfma_f32_16x16x32_bf16 v[84:87], v[20:23], v[188:191], v[84:87]
  v_mfma_f32_16x16x32_bf16 v[116:119], v[20:23], v[252:255], v[116:119]
  v_mul_f32 v76, s50, v76
  v_mul_f32 v77, s50, v77
  v_mul_f32 v78, s50, v78
  v_mul_f32 v79, s50, v79
  v_cvt_pk_bf16_f32 v38, v76, v77
  v_cvt_pk_bf16_f32 v39, v78, v79
  v_mul_f32 v108, s50, v108
  v_mul_f32 v109, s50, v109
  v_mul_f32 v110, s50, v110
  v_mul_f32 v111, s50, v111
  v_cvt_pk_bf16_f32 v54, v108, v109
  v_cvt_pk_bf16_f32 v55, v110, v111
  v_permlane16_swap_b32 v36, v38
  v_permlane16_swap_b32 v37, v39
  v_permlane16_swap_b32 v52, v54
  v_permlane16_swap_b32 v53, v55
  s_waitcnt lgkmcnt(0)
  v_mfma_f32_16x16x32_bf16 v[88:91], v[24:27], v[188:191], v[88:91]
  v_mfma_f32_16x16x32_bf16 v[120:123], v[24:27], v[252:255], v[120:123]
  v_mul_f32 v80, s50, v80
  v_mul_f32 v81, s50, v81
  v_mul_f32 v82, s50, v82
  v_mul_f32 v83, s50, v83
  v_cvt_pk_bf16_f32 v40, v80, v81
  v_cvt_pk_bf16_f32 v41, v82, v83
  v_mul_f32 v112, s50, v112
  v_mul_f32 v113, s50, v113
  v_mul_f32 v114, s50, v114
  v_mul_f32 v115, s50, v115
  v_cvt_pk_bf16_f32 v56, v112, v113
  v_cvt_pk_bf16_f32 v57, v114, v115
  v_mfma_f32_16x16x32_bf16 v[92:95], v[28:31], v[188:191], v[92:95]
  v_mfma_f32_16x16x32_bf16 v[124:127], v[28:31], v[252:255], v[124:127]
  v_mul_f32 v84, s50, v84
  v_mul_f32 v85, s50, v85
  v_mul_f32 v86, s50, v86
  v_mul_f32 v87, s50, v87
  v_cvt_pk_bf16_f32 v42, v84, v85
  v_cvt_pk_bf16_f32 v43, v86, v87
  v_mul_f32 v116, s50, v116
  v_mul_f32 v117, s50, v117
  v_mul_f32 v118, s50, v118
  v_mul_f32 v119, s50, v119
  v_cvt_pk_bf16_f32 v58, v116, v117
  v_cvt_pk_bf16_f32 v59, v118, v119
  v_permlane16_swap_b32 v40, v42
  v_permlane16_swap_b32 v41, v43
  v_permlane16_swap_b32 v56, v58
  v_permlane16_swap_b32 v57, v59
  v_mul_f32 v88, s50, v88
  v_mul_f32 v89, s50, v89
  v_mul_f32 v90, s50, v90
  v_mul_f32 v91, s50, v91
  v_cvt_pk_bf16_f32 v44, v88, v89
  v_cvt_pk_bf16_f32 v45, v90, v91
  v_mul_f32 v120, s50, v120
  v_mul_f32 v121, s50, v121
  v_mul_f32 v122, s50, v122
  v_mul_f32 v123, s50, v123
  v_cvt_pk_bf16_f32 v60, v120, v121
  v_cvt_pk_bf16_f32 v61, v122, v123
  v_mul_f32 v92, s50, v92
  v_mul_f32 v93, s50, v93
  v_mul_f32 v94, s50, v94
  v_mul_f32 v95, s50, v95
  v_cvt_pk_bf16_f32 v46, v92, v93
  v_cvt_pk_bf16_f32 v47, v94, v95
  v_mul_f32 v124, s50, v124
  v_mul_f32 v125, s50, v125
  v_mul_f32 v126, s50, v126
  v_mul_f32 v127, s50, v127
  v_cvt_pk_bf16_f32 v62, v124, v125
  v_cvt_pk_bf16_f32 v63, v126, v127
  v_permlane16_swap_b32 v44, v46
  v_permlane16_swap_b32 v45, v47
  v_permlane16_swap_b32 v60, v62
  v_permlane16_swap_b32 v61, v63
  v_add_u32 v13, 65536, v11
  ds_write_b128 v13, v[32:35] offset:0
  ds_write_b128 v13, v[36:39] offset:1024
  ds_write_b128 v13, v[40:43] offset:2048
  ds_write_b128 v13, v[44:47] offset:3072
  ds_write_b128 v13, v[48:51] offset:4096
  ds_write_b128 v13, v[52:55] offset:5120
  ds_write_b128 v13, v[56:59] offset:6144
  ds_write_b128 v13, v[60:63] offset:7168
  s_cmp_lg_u32 s62, 0
  s_cbranch_scc1 L_skip_3
  s_waitcnt vmcnt(0)
  v_mov_b32 v13, 1
  buffer_store_dword v13, v7, s[36:39], 0 offen sc1
L_skip_3:
  s_waitcnt lgkmcnt(0)
  s_cmp_eq_u32 s40, 3
  s_cbranch_scc1 L_h1
  s_branch L_h2
L_att2:
  s_barrier
  s_lshl_b32 s59, s40, 13
  s_add_u32 s59, s59, 65536
  v_add_u32 v18, s59, v4
  ds_read_b128 v[96:99], v18 offset:0
  ds_read_b128 v[100:103], v18 offset:1024
  ds_read_b128 v[104:107], v18 offset:2048
  ds_read_b128 v[108:111], v18 offset:3072
  ds_read_b128 v[112:115], v18 offset:4096
  ds_read_b128 v[116:119], v18 offset:5120
  ds_read_b128 v[120:123], v18 offset:6144
  ds_read_b128 v[124:127], v18 offset:7168
  s_mov_b32 s52, 32768
  s_lshr_b32 s53, s46, 1
  s_lshl_b32 s53, s53, 7
  s_add_u32 s53, s53, 24576
  ds_read_b128 v[176:179], v1 offset:0
  ds_read_b128 v[180:183], v1 offset:512
  ds_read_b128 v[184:187], v1 offset:1024
  s_waitcnt lgkmcnt(1)
  v_mfma_f32_16x16x32_bf16 v[128:131], v[176:179], v[96:99], 0
  ds_read_b128 v[188:191], v1 offset:1536
  v_mfma_f32_16x16x32_bf16 v[136:139], v[176:179], v[112:115], 0
  v_mfma_f32_16x16x32_bf16 v[128:131], v[180:183], v[100:103], v[128:131]
  ds_read_b128 v[176:179], v1 offset:4096
  v_mfma_f32_16x16x32_bf16 v[136:139], v[180:183], v[116:119], v[136:139]
  s_waitcnt lgkmcnt(1)
  v_mfma_f32_16x16x32_bf16 v[128:131], v[184:187], v[104:107], v[128:131]
  ds_read_b128 v[180:183], v1 offset:4608
  v_mfma_f32_16x16x32_bf16 v[136:139], v[184:187], v[120:123], v[136:139]
  v_mfma_f32_16x16x32_bf16 v[128:131], v[188:191], v[108:111], v[128:131]
  ds_read_b128 v[184:187], v1 offset:5120
  v_mfma_f32_16x16x32_bf16 v[136:139], v[188:191], v[124:127], v[136:139]
  s_waitcnt lgkmcnt(1)
  v_mfma_f32_16x16x32_bf16 v[132:135], v[176:179], v[96:99], 0
  ds_read_b128 v[188:191], v1 offset:5632
  v_mfma_f32_16x16x32_bf16 v[140:143], v[176:179], v[112:115], 0
  s_barrier
  v_mfma_f32_16x16x32_bf16 v[132:135], v[180:183], v[100:103], v[132:135]
  ds_read_b128 v[176:179], v1 offset:8192
  v_mfma_f32_16x16x32_bf16 v[140:143], v[180:183], v[116:119], v[140:143]
  s_waitcnt lgkmcnt(1)
  v_mfma_f32_16x16x32_bf16 v[132:135], v[184:187], v[104:107], v[132:135]
  ds_read_b128 v[180:183], v1 offset:8704
  v_mfma_f32_16x16x32_bf16 v[140:143], v[184:187], v[120:123], v[140:143]
  v_mfma_f32_16x16x32_bf16 v[132:135], v[188:191], v[108:111], v[132:135]
  ds_read_b128 v[184:187], v1 offset:9216
  v_mfma_f32_16x16x32_bf16 v[140:143], v[188:191], v[124:127], v[140:143]
  v_max3_f32 v12, v128, v129, v130
  v_max3_f32 v14, v136, v137, v138
  s_nop 3
  v_max3_f32 v13, v131, v132, v133
  s_nop 0
  v_max3_f32 v15, v139, v140, v141
  v_max3_f32 v12, v12, v134, v135
  v_max3_f32 v14, v14, v142, v143
  v_max_f32 v12, v12, v13
  v_max_f32 v14, v14, v15
  v_mov_b32 v13, v12
  v_mov_b32 v15, v14
  s_nop 0
  v_permlane16_swap_b32 v12, v13
  v_permlane16_swap_b32 v14, v15
  v_max_f32 v12, v12, v13
  v_max_f32 v14, v14, v15
  v_mov_b32 v13, v12
  v_mov_b32 v15, v14
  s_nop 0
  v_permlane32_swap_b32 v12, v13
  v_permlane32_swap_b32 v14, v15
  v_max_f32 v12, v12, v13
  v_max_f32 v14, v14, v15
  v_sub_f32 v24, 0, v12
  v_sub_f32 v25, 0, v12
  v_sub_f32 v26, 0, v12
  v_sub_f32 v27, 0, v12
  v_sub_f32 v28, 0, v14
  v_sub_f32 v29, 0, v14
  v_sub_f32 v30, 0, v14
  v_sub_f32 v31, 0, v14
  s_waitcnt lgkmcnt(1)
  v_mfma_f32_16x16x32_bf16 v[144:147], v[176:179], v[96:99], v[24:27]
  ds_read_b128 v[188:191], v1 offset:9728
  v_add_f32 v128, v128, v24
  v_add_f32 v136, v136, v28
  v_add_f32 v129, v129, v24
  v_add_f32 v137, v137, v28
  v_mfma_f32_16x16x32_bf16 v[152:155], v[176:179], v[112:115], v[28:31]
  v_add_f32 v130, v130, v24
  v_add_f32 v138, v138, v28
  v_add_f32 v131, v131, v24
  v_add_f32 v139, v139, v28
  v_add_f32 v132, v132, v24
  v_mfma_f32_16x16x32_bf16 v[144:147], v[180:183], v[100:103], v[144:147]
  ds_read_b128 v[176:179], v1 offset:12288
  v_add_f32 v140, v140, v28
  v_add_f32 v133, v133, v24
  v_add_f32 v141, v141, v28
  v_add_f32 v134, v134, v24
  v_add_f32 v142, v142, v28
  v_mfma_f32_16x16x32_bf16 v[152:155], v[180:183], v[116:119], v[152:155]
  v_add_f32 v135, v135, v24
  v_add_f32 v143, v143, v28
  v_exp_f32 v12, v128
  v_exp_f32 v13, v129
  s_waitcnt lgkmcnt(1)
  v_mfma_f32_16x16x32_bf16 v[144:147], v[184:187], v[104:107], v[144:147]
  ds_read_b128 v[180:183], v1 offset:12800
  v_exp_f32 v14, v136
  v_exp_f32 v15, v137
  v_mfma_f32_16x16x32_bf16 v[152:155], v[184:187], v[120:123], v[152:155]
  v_cvt_pk_bf16_f32 v160, v12, v13
  v_add_f32 v7, v12, v13
  v_exp_f32 v12, v130
  v_mfma_f32_16x16x32_bf16 v[144:147], v[188:191], v[108:111], v[144:147]
  ds_read_b128 v[184:187], v1 offset:13312
  v_exp_f32 v13, v131
  v_cvt_pk_bf16_f32 v164, v14, v15
  v_add_f32 v8, v14, v15
  v_mfma_f32_16x16x32_bf16 v[152:155], v[188:191], v[124:127], v[152:155]
  v_exp_f32 v14, v138
  v_exp_f32 v15, v139
  v_cvt_pk_bf16_f32 v161, v12, v13
  v_add_f32 v7, v7, v12
  s_waitcnt lgkmcnt(1)
  v_mfma_f32_16x16x32_bf16 v[148:151], v[176:179], v[96:99], v[24:27]
  ds_read_b128 v[188:191], v1 offset:13824
  v_add_f32 v7, v7, v13
  v_exp_f32 v12, v132
  v_exp_f32 v13, v133
  v_mfma_f32_16x16x32_bf16 v[156:159], v[176:179], v[112:115], v[28:31]
  v_cvt_pk_bf16_f32 v165, v14, v15
  v_add_f32 v8, v8, v14
  v_add_f32 v8, v8, v15
  v_mfma_f32_16x16x32_bf16 v[148:151], v[180:183], v[100:103], v[148:151]
  ds_read_b64_tr_b16 v[176:177], v2 offset:24576
  ds_read_b64_tr_b16 v[178:179], v2 offset:28672
  v_exp_f32 v14, v140
  v_exp_f32 v15, v141
  v_mfma_f32_16x16x32_bf16 v[156:159], v[180:183], v[116:119], v[156:159]
  v_cvt_pk_bf16_f32 v162, v12, v13
  v_add_f32 v7, v7, v12
  v_add_f32 v7, v7, v13
  v_exp_f32 v12, v134
  s_waitcnt lgkmcnt(2)
  v_mfma_f32_16x16x32_bf16 v[148:151], v[184:187], v[104:107], v[148:151]
  ds_read_b64_tr_b16 v[180:181], v3 offset:24576
  ds_read_b64_tr_b16 v[182:183], v3 offset:28672
  v_exp_f32 v13, v135
  v_cvt_pk_bf16_f32 v166, v14, v15
  v_add_f32 v8, v8, v14
  v_mfma_f32_16x16x32_bf16 v[156:159], v[184:187], v[120:123], v[156:159]
  v_add_f32 v8, v8, v15
  v_exp_f32 v14, v142
  v_exp_f32 v15, v143
  v_mfma_f32_16x16x32_bf16 v[148:151], v[188:191], v[108:111], v[148:151]
  ds_read_b64_tr_b16 v[184:185], v2 offset:25088
  ds_read_b64_tr_b16 v[186:187], v2 offset:29184
  v_cvt_pk_bf16_f32 v163, v12, v13
  v_add_f32 v7, v7, v12
  v_add_f32 v7, v7, v13
  v_mfma_f32_16x16x32_bf16 v[156:159], v[188:191], v[124:127], v[156:159]
  v_cvt_pk_bf16_f32 v167, v14, v15
  v_add_f32 v8, v8, v14
  v_add_f32 v8, v8, v15
  v_mov_b32 v5, v7
  v_mov_b32 v6, v8
  s_waitcnt lgkmcnt(2)
  v_mfma_f32_16x16x32_bf16 v[32:35], v[176:179], v[160:163], 0
  ds_read_b64_tr_b16 v[188:189], v3 offset:25088
  ds_read_b64_tr_b16 v[190:191], v3 offset:29184
  v_mov_b32 v56, 0
  v_mov_b32 v57, 0
  v_mov_b32 v58, 0
  v_mov_b32 v59, 0
  v_mov_b32 v60, 0
  v_mov_b32 v61, 0
  v_mov_b32 v62, 0
  v_mov_b32 v63, 0
  v_mov_b32 v88, 0
  v_mov_b32 v89, 0
  v_mfma_f32_16x16x32_bf16 v[64:67], v[176:179], v[164:167], 0
  v_mov_b32 v90, 0
  v_mov_b32 v91, 0
  v_mov_b32 v92, 0
  v_mov_b32 v93, 0
  v_mov_b32 v94, 0
  v_mov_b32 v95, 0
  s_add_u32 s51, s51, 1
  s_cmp_eq_u32 s51, 3
  s_cselect_b32 s61, s57, s56
  s_cselect_b32 s51, 0, s51
  s_add_u32 s44, s44, 1
  v_add_u32 v1, s61, v1
  v_mfma_f32_16x16x32_bf16 v[36:39], v[180:183], v[160:163], 0
  ds_read_b64_tr_b16 v[176:177], v2 offset:25600
  ds_read_b64_tr_b16 v[178:179], v2 offset:29696
  v_exp_f32 v12, v144
  v_mfma_f32_16x16x32_bf16 v[68:71], v[180:183], v[164:167], 0
  v_exp_f32 v13, v145
  s_waitcnt lgkmcnt(2)
  v_mfma_f32_16x16x32_bf16 v[40:43], v[184:187], v[160:163], 0
  ds_read_b64_tr_b16 v[180:181], v3 offset:25600
  ds_read_b64_tr_b16 v[182:183], v3 offset:29696
  v_exp_f32 v14, v152
  v_mfma_f32_16x16x32_bf16 v[72:75], v[184:187], v[164:167], 0
  v_exp_f32 v15, v153
  v_cvt_pk_bf16_f32 v168, v12, v13
  v_mfma_f32_16x16x32_bf16 v[44:47], v[188:191], v[160:163], 0
  ds_read_b64_tr_b16 v[184:185], v2 offset:26112
  ds_read_b64_tr_b16 v[186:187], v2 offset:30208
  v_add_f32 v7, v12, v13
  v_exp_f32 v12, v146
  v_mfma_f32_16x16x32_bf16 v[76:79], v[188:191], v[164:167], 0
  v_exp_f32 v13, v147
  s_waitcnt lgkmcnt(2)
  v_mfma_f32_16x16x32_bf16 v[48:51], v[176:179], v[160:163], 0
  ds_read_b64_tr_b16 v[188:189], v3 offset:26112
  ds_read_b64_tr_b16 v[190:191], v3 offset:30208
  v_cvt_pk_bf16_f32 v172, v14, v15
  v_mfma_f32_16x16x32_bf16 v[80:83], v[176:179], v[164:167], 0
  v_add_f32 v8, v14, v15
  v_exp_f32 v14, v154
  v_mfma_f32_16x16x32_bf16 v[52:55], v[180:183], v[160:163], 0
  v_add_u32 v2, s61, v2
  v_add_u32 v3, s61, v3
  v_exp_f32 v15, v155
  v_mfma_f32_16x16x32_bf16 v[84:87], v[180:183], v[164:167], 0
  v_cvt_pk_bf16_f32 v169, v12, v13
  v_add_f32 v7, v7, v12
  s_waitcnt vmcnt(0) lgkmcnt(0)
L_loop2_0:
  s_barrier
  ds_read_b128 v[176:179], v1 offset:0
  ds_read_b128 v[180:183], v1 offset:512
  v_mfma_f32_16x16x32_bf16 v[56:59], v[184:187], v[160:163], v[56:59]
  v_add_f32 v7, v7, v13
  v_exp_f32 v12, v148
  v_mfma_f32_16x16x32_bf16 v[88:91], v[184:187], v[164:167], v[88:91]
  v_exp_f32 v13, v149
  v_mfma_f32_16x16x32_bf16 v[60:63], v[188:191], v[160:163], v[60:63]
  ds_read_b128 v[184:187], v1 offset:1024
  v_cvt_pk_bf16_f32 v173, v14, v15
  v_mfma_f32_16x16x32_bf16 v[92:95], v[188:191], v[164:167], v[92:95]
  v_add_f32 v8, v8, v14
  v_add_f32 v8, v8, v15
  s_waitcnt lgkmcnt(1)
  v_mfma_f32_16x16x32_bf16 v[128:131], v[176:179], v[96:99], v[24:27]
  ds_read_b128 v[188:191], v1 offset:1536
  v_exp_f32 v14, v156
  v_mfma_f32_16x16x32_bf16 v[136:139], v[176:179], v[112:115], v[28:31]
  v_exp_f32 v15, v157
  v_cvt_pk_bf16_f32 v170, v12, v13
  v_mfma_f32_16x16x32_bf16 v[128:131], v[180:183], v[100:103], v[128:131]
  ds_read_b128 v[176:179], v1 offset:4096
  v_add_f32 v7, v7, v12
  v_add_f32 v7, v7, v13
  v_mfma_f32_16x16x32_bf16 v[136:139], v[180:183], v[116:119], v[136:139]
  v_exp_f32 v12, v150
  s_waitcnt lgkmcnt(1)
  v_mfma_f32_16x16x32_bf16 v[128:131], v[184:187], v[104:107], v[128:131]
  ds_read_b128 v[180:183], v1 offset:4608
  v_exp_f32 v13, v151
  v_mfma_f32_16x16x32_bf16 v[136:139], v[184:187], v[120:123], v[136:139]
  v_cvt_pk_bf16_f32 v174, v14, v15
  v_add_f32 v8, v8, v14
  v_mfma_f32_16x16x32_bf16 v[128:131], v[188:191], v[108:111], v[128:131]
  ds_read_b128 v[184:187], v1 offset:5120
  v_add_f32 v8, v8, v15
  v_mfma_f32_16x16x32_bf16 v[136:139], v[188:191], v[124:127], v[136:139]
  v_exp_f32 v14, v158
  s_waitcnt lgkmcnt(1)
  v_mfma_f32_16x16x32_bf16 v[132:135], v[176:179], v[96:99], v[24:27]
  ds_read_b128 v[188:191], v1 offset:5632
  v_exp_f32 v15, v159
  v_cvt_pk_bf16_f32 v171, v12, v13
  v_mfma_f32_16x16x32_bf16 v[140:143], v[176:179], v[112:115], v[28:31]
  v_add_f32 v7, v7, v12
  v_add_f32 v7, v7, v13
  v_mfma_f32_16x16x32_bf16 v[132:135], v[180:183], v[100:103], v[132:135]
  ds_read_b64_tr_b16 v[176:177], v2 offset:16384
  ds_read_b64_tr_b16 v[178:179], v2 offset:20480
  v_cvt_pk_bf16_f32 v175, v14, v15
  v_mfma_f32_16x16x32_bf16 v[140:143], v[180:183], v[116:119], v[140:143]
  v_add_f32 v8, v8, v14
  v_add_f32 v8, v8, v15
  s_waitcnt lgkmcnt(2)
  v_mfma_f32_16x16x32_bf16 v[132:135], v[184:187], v[104:107], v[132:135]
  ds_read_b64_tr_b16 v[180:181], v3 offset:16384
  ds_read_b64_tr_b16 v[182:183], v3 offset:20480
  v_mfma_f32_16x16x32_bf16 v[140:143], v[184:187], v[120:123], v[140:143]
  v_mfma_f32_16x16x32_bf16 v[132:135], v[188:191], v[108:111], v[132:135]
  ds_read_b64_tr_b16 v[184:185], v2 offset:16896
  ds_read_b64_tr_b16 v[186:187], v2 offset:20992
  v_mfma_f32_16x16x32_bf16 v[140:143], v[188:191], v[124:127], v[140:143]
  v_max_f32 v12, v7, v8
  v_cmp_nge_f32 vcc, s49, v12
  s_nop 0
  s_cbranch_vccnz L_rare_4
L_back_5:
  v_add_f32 v5, v5, v7
  v_add_f32 v6, v6, v8
  s_waitcnt lgkmcnt(2)
  v_mfma_f32_16x16x32_bf16 v[32:35], v[176:179], v[168:171], v[32:35]
  ds_read_b64_tr_b16 v[188:189], v3 offset:16896
  ds_read_b64_tr_b16 v[190:191], v3 offset:20992
  v_mfma_f32_16x16x32_bf16 v[64:67], v[176:179], v[172:175], v[64:67]
  v_mfma_f32_16x16x32_bf16 v[36:39], v[180:183], v[168:171], v[36:39]
  ds_read_b64_tr_b16 v[176:177], v2 offset:17408
  ds_read_b64_tr_b16 v[178:179], v2 offset:21504
  v_exp_f32 v12, v128
  v_mfma_f32_16x16x32_bf16 v[68:71], v[180:183], v[172:175], v[68:71]
  v_exp_f32 v13, v129
  s_waitcnt lgkmcnt(2)
  v_mfma_f32_16x16x32_bf16 v[40:43], v[184:187], v[168:171], v[40:43]
  ds_read_b64_tr_b16 v[180:181], v3 offset:17408
  ds_read_b64_tr_b16 v[182:183], v3 offset:21504
  v_exp_f32 v14, v136
  v_mfma_f32_16x16x32_bf16 v[72:75], v[184:187], v[172:175], v[72:75]
  v_exp_f32 v15, v137
  v_mfma_f32_16x16x32_bf16 v[44:47], v[188:191], v[168:171], v[44:47]
  ds_read_b64_tr_b16 v[184:185], v2 offset:17920
  ds_read_b64_tr_b16 v[186:187], v2 offset:22016
  v_cvt_pk_bf16_f32 v160, v12, v13
  v_mfma_f32_16x16x32_bf16 v[76:79], v[188:191], v[172:175], v[76:79]
  v_add_f32 v7, v12, v13
  s_waitcnt lgkmcnt(2)
  v_mfma_f32_16x16x32_bf16 v[48:51], v[176:179], v[168:171], v[48:51]
  ds_read_b64_tr_b16 v[188:189], v3 offset:17920
  ds_read_b64_tr_b16 v[190:191], v3 offset:22016
  v_exp_f32 v12, v130
  v_mfma_f32_16x16x32_bf16 v[80:83], v[176:179], v[172:175], v[80:83]
  v_exp_f32 v13, v131
  v_mfma_f32_16x16x32_bf16 v[52:55], v[180:183], v[168:171], v[52:55]
  ds_read_b128 v[176:179], v1 offset:8192
  v_cvt_pk_bf16_f32 v164, v14, v15
  v_add_f32 v8, v14, v15
  v_mfma_f32_16x16x32_bf16 v[84:87], v[180:183], v[172:175], v[84:87]
  v_exp_f32 v14, v138
  s_waitcnt lgkmcnt(1)
  v_mfma_f32_16x16x32_bf16 v[56:59], v[184:187], v[168:171], v[56:59]
  ds_read_b128 v[180:183], v1 offset:8704
  v_exp_f32 v15, v139
  v_cvt_pk_bf16_f32 v161, v12, v13
  v_mfma_f32_16x16x32_bf16 v[88:91], v[184:187], v[172:175], v[88:91]
  v_add_f32 v7, v7, v12
  v_add_f32 v7, v7, v13
  v_mfma_f32_16x16x32_bf16 v[60:63], v[188:191], v[168:171], v[60:63]
  ds_read_b128 v[184:187], v1 offset:9216
  v_exp_f32 v12, v132
  v_mfma_f32_16x16x32_bf16 v[92:95], v[188:191], v[172:175], v[92:95]
  v_exp_f32 v13, v133
  s_waitcnt lgkmcnt(1)
  v_mfma_f32_16x16x32_bf16 v[144:147], v[176:179], v[96:99], v[24:27]
  ds_read_b128 v[188:191], v1 offset:9728
  v_cvt_pk_bf16_f32 v165, v14, v15
  v_add_f32 v8, v8, v14
  v_mfma_f32_16x16x32_bf16 v[152:155], v[176:179], v[112:115], v[28:31]
  v_add_f32 v8, v8, v15
  v_exp_f32 v14, v140
  v_mfma_f32_16x16x32_bf16 v[144:147], v[180:183], v[100:103], v[144:147]
  ds_read_b128 v[176:179], v1 offset:12288
  v_exp_f32 v15, v141
  v_mfma_f32_16x16x32_bf16 v[152:155], v[180:183], v[116:119], v[152:155]
  v_cvt_pk_bf16_f32 v162, v12, v13
  v_add_f32 v7, v7, v12
  s_waitcnt lgkmcnt(1)
  v_mfma_f32_16x16x32_bf16 v[144:147], v[184:187], v[104:107], v[144:147]
  ds_read_b128 v[180:183], v1 offset:12800
  v_add_f32 v7, v7, v13
  v_exp_f32 v12, v134
  v_mfma_f32_16x16x32_bf16 v[152:155], v[184:187], v[120:123], v[152:155]
  v_exp_f32 v13, v135
  v_mfma_f32_16x16x32_bf16 v[144:147], v[188:191], v[108:111], v[144:147]
  ds_read_b128 v[184:187], v1 offset:13312
  v_cvt_pk_bf16_f32 v166, v14, v15
  v_mfma_f32_16x16x32_bf16 v[152:155], v[188:191], v[124:127], v[152:155]
  v_add_f32 v8, v8, v14
  v_add_f32 v8, v8, v15
  s_waitcnt lgkmcnt(1)
  v_mfma_f32_16x16x32_bf16 v[148:151], v[176:179], v[96:99], v[24:27]
  ds_read_b128 v[188:191], v1 offset:13824
  v_exp_f32 v14, v142
  v_mfma_f32_16x16x32_bf16 v[156:159], v[176:179], v[112:115], v[28:31]
  v_exp_f32 v15, v143
  v_cvt_pk_bf16_f32 v163, v12, v13
  v_mfma_f32_16x16x32_bf16 v[148:151], v[180:183], v[100:103], v[148:151]
  ds_read_b64_tr_b16 v[176:177], v2 offset:24576
  ds_read_b64_tr_b16 v[178:179], v2 offset:28672
  v_add_f32 v7, v7, v12
  v_add_f32 v7, v7, v13
  v_mfma_f32_16x16x32_bf16 v[156:159], v[180:183], v[116:119], v[156:159]
  v_cvt_pk_bf16_f32 v167, v14, v15
  v_add_f32 v8, v8, v14
  s_waitcnt lgkmcnt(2)
  v_mfma_f32_16x16x32_bf16 v[148:151], v[184:187], v[104:107], v[148:151]
  ds_read_b64_tr_b16 v[180:181], v3 offset:24576
  ds_read_b64_tr_b16 v[182:183], v3 offset:28672
  v_mfma_f32_16x16x32_bf16 v[156:159], v[184:187], v[120:123], v[156:159]
  v_add_f32 v8, v8, v15
  v_mfma_f32_16x16x32_bf16 v[148:151], v[188:191], v[108:111], v[148:151]
  ds_read_b64_tr_b16 v[184:185], v2 offset:25088
  ds_read_b64_tr_b16 v[186:187], v2 offset:29184
  v_mfma_f32_16x16x32_bf16 v[156:159], v[188:191], v[124:127], v[156:159]
  v_max_f32 v12, v7, v8
  v_cmp_nge_f32 vcc, s49, v12
  s_nop 0
  s_cbranch_vccnz L_rare_6
L_back_7:
  v_add_f32 v5, v5, v7
  v_add_f32 v6, v6, v8
  s_waitcnt lgkmcnt(2)
  v_mfma_f32_16x16x32_bf16 v[32:35], v[176:179], v[160:163], v[32:35]
  ds_read_b64_tr_b16 v[188:189], v3 offset:25088
  ds_read_b64_tr_b16 v[190:191], v3 offset:29184
  s_add_u32 s51, s51, 1
  s_cmp_eq_u32 s51, 3
  s_cselect_b32 s61, s57, s56
  s_cselect_b32 s51, 0, s51
  s_add_u32 s44, s44, 1
  v_mfma_f32_16x16x32_bf16 v[64:67], v[176:179], v[164:167], v[64:67]
  v_add_u32 v1, s61, v1
  v_mfma_f32_16x16x32_bf16 v[36:39], v[180:183], v[160:163], v[36:39]
  ds_read_b64_tr_b16 v[176:177], v2 offset:25600
  ds_read_b64_tr_b16 v[178:179], v2 offset:29696
  v_exp_f32 v12, v144
  v_mfma_f32_16x16x32_bf16 v[68:71], v[180:183], v[164:167], v[68:71]
  v_exp_f32 v13, v145
  s_waitcnt lgkmcnt(2)
  v_mfma_f32_16x16x32_bf16 v[40:43], v[184:187], v[160:163], v[40:43]
  ds_read_b64_tr_b16 v[180:181], v3 offset:25600
  ds_read_b64_tr_b16 v[182:183], v3 offset:29696
  v_exp_f32 v14, v152
  v_mfma_f32_16x16x32_bf16 v[72:75], v[184:187], v[164:167], v[72:75]
  v_exp_f32 v15, v153
  v_cvt_pk_bf16_f32 v168, v12, v13
  v_mfma_f32_16x16x32_bf16 v[44:47], v[188:191], v[160:163], v[44:47]
  ds_read_b64_tr_b16 v[184:185], v2 offset:26112
  ds_read_b64_tr_b16 v[186:187], v2 offset:30208
  v_add_f32 v7, v12, v13
  v_exp_f32 v12, v146
  v_mfma_f32_16x16x32_bf16 v[76:79], v[188:191], v[164:167], v[76:79]
  v_exp_f32 v13, v147
  s_waitcnt lgkmcnt(2)
  v_mfma_f32_16x16x32_bf16 v[48:51], v[176:179], v[160:163], v[48:51]
  ds_read_b64_tr_b16 v[188:189], v3 offset:26112
  ds_read_b64_tr_b16 v[190:191], v3 offset:30208
  v_cvt_pk_bf16_f32 v172, v14, v15
  v_mfma_f32_16x16x32_bf16 v[80:83], v[176:179], v[164:167], v[80:83]
  v_add_f32 v8, v14, v15
  v_exp_f32 v14, v154
  v_mfma_f32_16x16x32_bf16 v[52:55], v[180:183], v[160:163], v[52:55]
  v_add_u32 v2, s61, v2
  v_add_u32 v3, s61, v3
  v_exp_f32 v15, v155
  v_mfma_f32_16x16x32_bf16 v[84:87], v[180:183], v[164:167], v[84:87]
  v_cvt_pk_bf16_f32 v169, v12, v13
  v_add_f32 v7, v7, v12
  s_bitcmp1_b32 s67, s44
  s_cbranch_scc1 L_hook2
L_hookback2_0:
  s_waitcnt lgkmcnt(0)
  s_bitcmp0_b32 0x1050101, s44
  s_cbranch_scc1 L_loop2_0
L_next2:
  s_cmp_eq_u32 s44, 16
  s_cbranch_scc1 L_f2_2
  s_cmp_eq_u32 s44, 18
  s_cbranch_scc1 L_tr_2
  s_cmp_eq_u32 s44, 24
  s_cbranch_scc1 L_f3_2
  s_cmp_eq_u32 s44, 32
  s_cbranch_scc1 L_last2
L_f1_2:
  s_barrier
  ds_read_b128 v[176:179], v1 offset:0
  ds_read_b128 v[180:183], v1 offset:512
  s_lshl_b32 s59, s40, 13
  s_add_u32 s59, s59, 131072
  v_add_u32 v18, s59, v4
  ds_read_b128 v[96:99], v18 offset:0
  ds_read_b128 v[112:115], v18 offset:4096
  ds_read_b128 v[100:103], v18 offset:1024
  ds_read_b128 v[116:119], v18 offset:5120
  ds_read_b128 v[104:107], v18 offset:2048
  ds_read_b128 v[120:123], v18 offset:6144
  ds_read_b128 v[108:111], v18 offset:3072
  ds_read_b128 v[124:127], v18 offset:7168
  v_mfma_f32_16x16x32_bf16 v[56:59], v[184:187], v[160:163], v[56:59]
  v_add_f32 v7, v7, v13
  v_exp_f32 v12, v148
  v_mfma_f32_16x16x32_bf16 v[88:91], v[184:187], v[164:167], v[88:91]
  v_exp_f32 v13, v149
  v_mfma_f32_16x16x32_bf16 v[60:63], v[188:191], v[160:163], v[60:63]
  ds_read_b128 v[184:187], v1 offset:1024
  v_cvt_pk_bf16_f32 v173, v14, v15
  v_mfma_f32_16x16x32_bf16 v[92:95], v[188:191], v[164:167], v[92:95]
  v_add_f32 v8, v8, v14
  v_add_f32 v8, v8, v15
  s_waitcnt lgkmcnt(9)
  s_waitcnt lgkmcnt(8)
  v_mfma_f32_16x16x32_bf16 v[128:131], v[176:179], v[96:99], 0
  ds_read_b128 v[188:191], v1 offset:1536
  v_exp_f32 v14, v156
  s_waitcnt lgkmcnt(8)
  v_mfma_f32_16x16x32_bf16 v[136:139], v[176:179], v[112:115], 0
  v_exp_f32 v15, v157
  v_cvt_pk_bf16_f32 v170, v12, v13
  s_waitcnt lgkmcnt(7)
  v_mfma_f32_16x16x32_bf16 v[128:131], v[180:183], v[100:103], v[128:131]
  ds_read_b128 v[176:179], v1 offset:4096
  v_add_f32 v7, v7, v12
  v_add_f32 v7, v7, v13
  s_waitcnt lgkmcnt(7)
  v_mfma_f32_16x16x32_bf16 v[136:139], v[180:183], v[116:119], v[136:139]
  v_exp_f32 v12, v150
  s_waitcnt lgkmcnt(1)
  v_mfma_f32_16x16x32_bf16 v[128:131], v[184:187], v[104:107], v[128:131]
  ds_read_b128 v[180:183], v1 offset:4608
  v_exp_f32 v13, v151
  v_mfma_f32_16x16x32_bf16 v[136:139], v[184:187], v[120:123], v[136:139]
  v_cvt_pk_bf16_f32 v174, v14, v15
  v_add_f32 v8, v8, v14
  v_mfma_f32_16x16x32_bf16 v[128:131], v[188:191], v[108:111], v[128:131]
  ds_read_b128 v[184:187], v1 offset:5120
  v_add_f32 v8, v8, v15
  v_mfma_f32_16x16x32_bf16 v[136:139], v[188:191], v[124:127], v[136:139]
  v_exp_f32 v14, v158
  s_waitcnt lgkmcnt(1)
  v_mfma_f32_16x16x32_bf16 v[132:135], v[176:179], v[96:99], 0
  ds_read_b128 v[188:191], v1 offset:5632
  v_exp_f32 v15, v159
  v_cvt_pk_bf16_f32 v171, v12, v13
  v_mfma_f32_16x16x32_bf16 v[140:143], v[176:179], v[112:115], 0
  v_add_f32 v7, v7, v12
  v_add_f32 v7, v7, v13
  v_mfma_f32_16x16x32_bf16 v[132:135], v[180:183], v[100:103], v[132:135]
  ds_read_b64_tr_b16 v[176:177], v2 offset:16384
  ds_read_b64_tr_b16 v[178:179], v2 offset:20480
  v_cvt_pk_bf16_f32 v175, v14, v15
  v_mfma_f32_16x16x32_bf16 v[140:143], v[180:183], v[116:119], v[140:143]
  v_add_f32 v8, v8, v14
  v_add_f32 v8, v8, v15
  s_waitcnt lgkmcnt(2)
  v_mfma_f32_16x16x32_bf16 v[132:135], v[184:187], v[104:107], v[132:135]
  ds_read_b64_tr_b16 v[180:181], v3 offset:16384
  ds_read_b64_tr_b16 v[182:183], v3 offset:20480
  v_mfma_f32_16x16x32_bf16 v[140:143], v[184:187], v[120:123], v[140:143]
  v_mfma_f32_16x16x32_bf16 v[132:135], v[188:191], v[108:111], v[132:135]
  ds_read_b64_tr_b16 v[184:185], v2 offset:16896
  ds_read_b64_tr_b16 v[186:187], v2 offset:20992
  v_mfma_f32_16x16x32_bf16 v[140:143], v[188:191], v[124:127], v[140:143]
  v_max_f32 v12, v7, v8
  v_cmp_nge_f32 vcc, s49, v12
  s_nop 0
  s_cbranch_vccnz L_rare_8
L_back_9:
  v_add_f32 v5, v5, v7
  v_add_f32 v6, v6, v8
  s_waitcnt lgkmcnt(2)
  v_mfma_f32_16x16x32_bf16 v[32:35], v[176:179], v[168:171], v[32:35]
  ds_read_b64_tr_b16 v[188:189], v3 offset:16896
  ds_read_b64_tr_b16 v[190:191], v3 offset:20992
  v_mov_b32 v16, v5
  v_mov_b32 v17, v6
  s_nop 0
  v_permlane16_swap_b32 v5, v16
  v_mfma_f32_16x16x32_bf16 v[64:67], v[176:179], v[172:175], v[64:67]
  v_permlane16_swap_b32 v6, v17
  v_add_f32 v5, v5, v16
  v_add_f32 v6, v6, v17
  v_mov_b32 v16, v5
  v_mfma_f32_16x16x32_bf16 v[36:39], v[180:183], v[168:171], v[36:39]
  ds_read_b64_tr_b16 v[176:177], v2 offset:17408
  ds_read_b64_tr_b16 v[178:179], v2 offset:21504
  v_mov_b32 v17, v6
  v_permlane32_swap_b32 v5, v16
  s_nop 0
  v_permlane32_swap_b32 v6, v17
  v_mfma_f32_16x16x32_bf16 v[68:71], v[180:183], v[172:175], v[68:71]
  v_add_f32 v5, v5, v16
  v_add_f32 v6, v6, v17
  v_rcp_f32 v16, v5
  v_rcp_f32 v17, v6
  s_waitcnt lgkmcnt(2)
  v_mfma_f32_16x16x32_bf16 v[40:43], v[184:187], v[168:171], v[40:43]
  ds_read_b64_tr_b16 v[180:181], v3 offset:17408
  ds_read_b64_tr_b16 v[182:183], v3 offset:21504
  v_max3_f32 v12, v128, v129, v130
  v_max3_f32 v14, v136, v137, v138
  v_max3_f32 v13, v131, v132, v133
  v_mfma_f32_16x16x32_bf16 v[72:75], v[184:187], v[172:175], v[72:75]
  v_max3_f32 v15, v139, v140, v141
  v_max3_f32 v12, v12, v134, v135
  v_max3_f32 v14, v14, v142, v143
  v_max_f32 v12, v12, v13
  v_mfma_f32_16x16x32_bf16 v[44:47], v[188:191], v[168:171], v[44:47]
  ds_read_b64_tr_b16 v[184:185], v2 offset:17920
  ds_read_b64_tr_b16 v[186:187], v2 offset:22016
  v_max_f32 v14, v14, v15
  v_mov_b32 v13, v12
  v_mov_b32 v15, v14
  v_mfma_f32_16x16x32_bf16 v[76:79], v[188:191], v[172:175], v[76:79]
  v_permlane16_swap_b32 v12, v13
  v_permlane16_swap_b32 v14, v15
  v_max_f32 v12, v12, v13
  s_waitcnt lgkmcnt(2)
  v_mfma_f32_16x16x32_bf16 v[48:51], v[176:179], v[168:171], v[48:51]
  ds_read_b64_tr_b16 v[188:189], v3 offset:17920
  ds_read_b64_tr_b16 v[190:191], v3 offset:22016
  v_max_f32 v14, v14, v15
  v_mov_b32 v13, v12
  v_mov_b32 v15, v14
  v_mfma_f32_16x16x32_bf16 v[80:83], v[176:179], v[172:175], v[80:83]
  v_permlane32_swap_b32 v12, v13
  v_permlane32_swap_b32 v14, v15
  v_max_f32 v12, v12, v13
  v_max_f32 v14, v14, v15
  v_mfma_f32_16x16x32_bf16 v[52:55], v[180:183], v[168:171], v[52:55]
  ds_read_b128 v[176:179], v1 offset:8192
  v_sub_f32 v24, 0, v12
  v_sub_f32 v25, 0, v12
  v_sub_f32 v26, 0, v12
  v_sub_f32 v27, 0, v12
  v_mfma_f32_16x16x32_bf16 v[84:87], v[180:183], v[172:175], v[84:87]
  v_sub_f32 v28, 0, v14
  v_sub_f32 v29, 0, v14
  v_sub_f32 v30, 0, v14
  v_sub_f32 v31, 0, v14
  s_waitcnt lgkmcnt(1)
  v_mfma_f32_16x16x32_bf16 v[56:59], v[184:187], v[168:171], v[56:59]
  ds_read_b128 v[180:183], v1 offset:8704
  v_add_f32 v128, v128, v24
  v_add_f32 v136, v136, v28
  v_add_f32 v129, v129, v24
  v_add_f32 v137, v137, v28
  v_add_f32 v130, v130, v24
  v_mfma_f32_16x16x32_bf16 v[88:91], v[184:187], v[172:175], v[88:91]
  v_add_f32 v138, v138, v28
  v_add_f32 v131, v131, v24
  v_add_f32 v139, v139, v28
  v_add_f32 v132, v132, v24
  v_add_f32 v140, v140, v28
  v_mfma_f32_16x16x32_bf16 v[60:63], v[188:191], v[168:171], v[60:63]
  ds_read_b128 v[184:187], v1 offset:9216
  v_add_f32 v133, v133, v24
  v_add_f32 v141, v141, v28
  v_add_f32 v134, v134, v24
  v_add_f32 v142, v142, v28
  v_add_f32 v135, v135, v24
  v_mfma_f32_16x16x32_bf16 v[92:95], v[188:191], v[172:175], v[92:95]
  v_add_f32 v143, v143, v28
  v_exp_f32 v12, v128
  v_exp_f32 v13, v129
  s_waitcnt lgkmcnt(1)
  v_mfma_f32_16x16x32_bf16 v[144:147], v[176:179], v[96:99], v[24:27]
  ds_read_b128 v[188:191], v1 offset:9728
  v_exp_f32 v14, v136
  v_exp_f32 v15, v137
  v_cvt_pk_bf16_f32 v160, v12, v13
  v_mfma_f32_16x16x32_bf16 v[152:155], v[176:179], v[112:115], v[28:31]
  v_add_f32 v7, v12, v13
  v_exp_f32 v12, v130
  v_exp_f32 v13, v131
  v_mfma_f32_16x16x32_bf16 v[144:147], v[180:183], v[100:103], v[144:147]
  ds_read_b128 v[176:179], v1 offset:12288
  v_mul_f32 v32, v32, v16
  v_mul_f32 v33, v33, v16
  v_mul_f32 v34, v34, v16
  v_cvt_pk_bf16_f32 v164, v14, v15
  v_mul_f32 v35, v35, v16
  v_mul_f32 v36, v36, v16
  v_mul_f32 v37, v37, v16
  v_add_f32 v8, v14, v15
  v_mul_f32 v38, v38, v16
  v_mul_f32 v39, v39, v16
  v_mfma_f32_16x16x32_bf16 v[152:155], v[180:183], v[116:119], v[152:155]
  v_cvt_pk_bf16_f32 v192, v32, v33
  v_exp_f32 v14, v138
  v_cvt_pk_bf16_f32 v193, v34, v35
  v_cvt_pk_bf16_f32 v194, v36, v37
  v_cvt_pk_bf16_f32 v195, v38, v39
  v_exp_f32 v15, v139
  v_mul_f32 v64, v64, v17
  v_mul_f32 v65, v65, v17
  s_waitcnt lgkmcnt(1)
  v_mfma_f32_16x16x32_bf16 v[144:147], v[184:187], v[104:107], v[144:147]
  ds_read_b128 v[180:183], v1 offset:12800
  v_mul_f32 v66, v66, v17
  v_cvt_pk_bf16_f32 v161, v12, v13
  v_mul_f32 v67, v67, v17
  v_mul_f32 v68, v68, v17
  v_mul_f32 v69, v69, v17
  v_add_f32 v7, v7, v12
  v_mul_f32 v70, v70, v17
  v_mul_f32 v71, v71, v17
  v_cvt_pk_bf16_f32 v208, v64, v65
  v_add_f32 v7, v7, v13
  v_mfma_f32_16x16x32_bf16 v[152:155], v[184:187], v[120:123], v[152:155]
  v_cvt_pk_bf16_f32 v209, v66, v67
  v_cvt_pk_bf16_f32 v210, v68, v69
  v_cvt_pk_bf16_f32 v211, v70, v71
  v_exp_f32 v12, v132
  v_mul_f32 v40, v40, v16
  v_mul_f32 v41, v41, v16
  v_mul_f32 v42, v42, v16
  v_exp_f32 v13, v133
  v_mfma_f32_16x16x32_bf16 v[144:147], v[188:191], v[108:111], v[144:147]
  ds_read_b128 v[184:187], v1 offset:13312
  v_mul_f32 v43, v43, v16
  v_mul_f32 v44, v44, v16
  v_mul_f32 v45, v45, v16
  v_cvt_pk_bf16_f32 v165, v14, v15
  v_mul_f32 v46, v46, v16
  v_mul_f32 v47, v47, v16
  v_cvt_pk_bf16_f32 v196, v40, v41
  v_add_f32 v8, v8, v14
  v_cvt_pk_bf16_f32 v197, v42, v43
  v_cvt_pk_bf16_f32 v198, v44, v45
  v_mfma_f32_16x16x32_bf16 v[152:155], v[188:191], v[124:127], v[152:155]
  v_cvt_pk_bf16_f32 v199, v46, v47
  v_add_f32 v8, v8, v15
  v_mul_f32 v72, v72, v17
  v_mul_f32 v73, v73, v17
  v_mul_f32 v74, v74, v17
  v_exp_f32 v14, v140
  v_mul_f32 v75, v75, v17
  v_mul_f32 v76, v76, v17
  v_mul_f32 v77, v77, v17
  s_waitcnt lgkmcnt(1)
  v_mfma_f32_16x16x32_bf16 v[148:151], v[176:179], v[96:99], v[24:27]
  ds_read_b128 v[188:191], v1 offset:13824
  v_exp_f32 v15, v141
  v_mul_f32 v78, v78, v17
  v_mul_f32 v79, v79, v17
  v_cvt_pk_bf16_f32 v212, v72, v73
  v_cvt_pk_bf16_f32 v162, v12, v13
  v_cvt_pk_bf16_f32 v213, v74, v75
  v_cvt_pk_bf16_f32 v214, v76, v77
  v_cvt_pk_bf16_f32 v215, v78, v79
  v_add_f32 v7, v7, v12
  v_mfma_f32_16x16x32_bf16 v[156:159], v[176:179], v[112:115], v[28:31]
  v_mul_f32 v48, v48, v16
  v_mul_f32 v49, v49, v16
  v_mul_f32 v50, v50, v16
  v_add_f32 v7, v7, v13
  v_mul_f32 v51, v51, v16
  v_mul_f32 v52, v52, v16
  v_mul_f32 v53, v53, v16
  v_exp_f32 v12, v134
  v_mul_f32 v54, v54, v16
  v_mfma_f32_16x16x32_bf16 v[148:151], v[180:183], v[100:103], v[148:151]
  ds_read_b64_tr_b16 v[176:177], v2 offset:24576
  ds_read_b64_tr_b16 v[178:179], v2 offset:28672
  v_mul_f32 v55, v55, v16
  v_cvt_pk_bf16_f32 v200, v48, v49
  v_exp_f32 v13, v135
  v_cvt_pk_bf16_f32 v201, v50, v51
  v_cvt_pk_bf16_f32 v202, v52, v53
  v_cvt_pk_bf16_f32 v203, v54, v55
  v_cvt_pk_bf16_f32 v166, v14, v15
  v_mul_f32 v80, v80, v17
  v_mfma_f32_16x16x32_bf16 v[156:159], v[180:183], v[116:119], v[156:159]
  v_mul_f32 v81, v81, v17
  v_mul_f32 v82, v82, v17
  v_add_f32 v8, v8, v14
  v_mul_f32 v83, v83, v17
  v_mul_f32 v84, v84, v17
  v_mul_f32 v85, v85, v17
  v_add_f32 v8, v8, v15
  v_mul_f32 v86, v86, v17
  v_mul_f32 v87, v87, v17
  v_cvt_pk_bf16_f32 v216, v80, v81
  s_waitcnt lgkmcnt(2)
  v_mfma_f32_16x16x32_bf16 v[148:151], v[184:187], v[104:107], v[148:151]
  ds_read_b64_tr_b16 v[180:181], v3 offset:24576
  ds_read_b64_tr_b16 v[182:183], v3 offset:28672
  v_exp_f32 v14, v142
  v_cvt_pk_bf16_f32 v217, v82, v83
  v_cvt_pk_bf16_f32 v218, v84, v85
  v_cvt_pk_bf16_f32 v219, v86, v87
  v_exp_f32 v15, v143
  v_mul_f32 v56, v56, v16
  v_mul_f32 v57, v57, v16
  v_mul_f32 v58, v58, v16
  v_mfma_f32_16x16x32_bf16 v[156:159], v[184:187], v[120:123], v[156:159]
  v_cvt_pk_bf16_f32 v163, v12, v13
  v_mul_f32 v59, v59, v16
  v_mul_f32 v60, v60, v16
  v_mul_f32 v61, v61, v16
  v_add_f32 v7, v7, v12
  v_mul_f32 v62, v62, v16
  v_mul_f32 v63, v63, v16
  v_cvt_pk_bf16_f32 v204, v56, v57
  v_add_f32 v7, v7, v13
  v_cvt_pk_bf16_f32 v205, v58, v59
  v_mfma_f32_16x16x32_bf16 v[148:151], v[188:191], v[108:111], v[148:151]
  ds_read_b64_tr_b16 v[184:185], v2 offset:25088
  ds_read_b64_tr_b16 v[186:187], v2 offset:29184
  v_cvt_pk_bf16_f32 v206, v60, v61
  v_cvt_pk_bf16_f32 v207, v62, v63
  v_cvt_pk_bf16_f32 v167, v14, v15
  v_mul_f32 v88, v88, v17
  v_mul_f32 v89, v89, v17
  v_mul_f32 v90, v90, v17
  v_add_f32 v8, v8, v14
  v_mul_f32 v91, v91, v17
  v_mul_f32 v92, v92, v17
  v_mfma_f32_16x16x32_bf16 v[156:159], v[188:191], v[124:127], v[156:159]
  v_mul_f32 v93, v93, v17
  v_add_f32 v8, v8, v15
  v_mul_f32 v94, v94, v17
  v_mul_f32 v95, v95, v17
  v_cvt_pk_bf16_f32 v220, v88, v89
  v_mov_b32 v5, v7
  v_cvt_pk_bf16_f32 v221, v90, v91
  v_cvt_pk_bf16_f32 v222, v92, v93
  v_cvt_pk_bf16_f32 v223, v94, v95
  v_mov_b32 v6, v8
  s_waitcnt lgkmcnt(2)
  v_mfma_f32_16x16x32_bf16 v[32:35], v[176:179], v[160:163], 0
  ds_read_b64_tr_b16 v[188:189], v3 offset:25088
  ds_read_b64_tr_b16 v[190:191], v3 offset:29184
  v_mov_b32 v56, 0
  v_mov_b32 v57, 0
  v_mov_b32 v58, 0
  v_mov_b32 v59, 0
  v_mov_b32 v60, 0
  v_mov_b32 v61, 0
  v_mov_b32 v62, 0
  v_mov_b32 v63, 0
  v_mov_b32 v88, 0
  v_mov_b32 v89, 0
  v_mfma_f32_16x16x32_bf16 v[64:67], v[176:179], v[164:167], 0
  v_mov_b32 v90, 0
  v_mov_b32 v91, 0
  v_mov_b32 v92, 0
  v_mov_b32 v93, 0
  v_mov_b32 v94, 0
  v_mov_b32 v95, 0
  s_add_u32 s51, s51, 1
  s_cmp_eq_u32 s51, 3
  s_cselect_b32 s61, s57, s56
  s_cselect_b32 s51, 0, s51
  s_add_u32 s44, s44, 1
  v_add_u32 v1, s61, v1
  v_mfma_f32_16x16x32_bf16 v[36:39], v[180:183], v[160:163], 0
  ds_read_b64_tr_b16 v[176:177], v2 offset:25600
  ds_read_b64_tr_b16 v[178:179], v2 offset:29696
  v_exp_f32 v12, v144
  v_mfma_f32_16x16x32_bf16 v[68:71], v[180:183], v[164:167], 0
  v_exp_f32 v13, v145
  s_waitcnt lgkmcnt(2)
  v_mfma_f32_16x16x32_bf16 v[40:43], v[184:187], v[160:163], 0
  ds_read_b64_tr_b16 v[180:181], v3 offset:25600
  ds_read_b64_tr_b16 v[182:183], v3 offset:29696
  v_exp_f32 v14, v152
  v_mfma_f32_16x16x32_bf16 v[72:75], v[184:187], v[164:167], 0
  v_exp_f32 v15, v153
  v_cvt_pk_bf16_f32 v168, v12, v13
  v_mfma_f32_16x16x32_bf16 v[44:47], v[188:191], v[160:163], 0
  ds_read_b64_tr_b16 v[184:185], v2 offset:26112
  ds_read_b64_tr_b16 v[186:187], v2 offset:30208
  v_add_f32 v7, v12, v13
  v_exp_f32 v12, v146
  v_mfma_f32_16x16x32_bf16 v[76:79], v[188:191], v[164:167], 0
  v_exp_f32 v13, v147
  s_waitcnt lgkmcnt(2)
  v_mfma_f32_16x16x32_bf16 v[48:51], v[176:179], v[160:163], 0
  ds_read_b64_tr_b16 v[188:189], v3 offset:26112
  ds_read_b64_tr_b16 v[190:191], v3 offset:30208
  v_cvt_pk_bf16_f32 v172, v14, v15
  v_mfma_f32_16x16x32_bf16 v[80:83], v[176:179], v[164:167], 0
  v_add_f32 v8, v14, v15
  v_exp_f32 v14, v154
  v_mfma_f32_16x16x32_bf16 v[52:55], v[180:183], v[160:163], 0
  v_add_u32 v2, s61, v2
  v_add_u32 v3, s61, v3
  v_exp_f32 v15, v155
  v_mfma_f32_16x16x32_bf16 v[84:87], v[180:183], v[164:167], 0
  v_cvt_pk_bf16_f32 v169, v12, v13
  v_add_f32 v7, v7, v12
  s_waitcnt lgkmcnt(0)
  s_branch L_loop2_0
L_f2_2:
  s_barrier
  ds_read_b128 v[176:179], v1 offset:0
  ds_read_b128 v[180:183], v1 offset:512
  s_lshl_b32 s59, s40, 13
  s_add_u32 s59, s59, 131072
  v_add_u32 v18, s59, v4
  ds_read_b128 v[96:99], v18 offset:0
  ds_read_b128 v[112:115], v18 offset:4096
  ds_read_b128 v[100:103], v18 offset:1024
  ds_read_b128 v[116:119], v18 offset:5120
  ds_read_b128 v[104:107], v18 offset:2048
  ds_read_b128 v[120:123], v18 offset:6144
  ds_read_b128 v[108:111], v18 offset:3072
  ds_read_b128 v[124:127], v18 offset:7168
  v_mfma_f32_16x16x32_bf16 v[56:59], v[184:187], v[160:163], v[56:59]
  v_add_f32 v7, v7, v13
  v_exp_f32 v12, v148
  v_mfma_f32_16x16x32_bf16 v[88:91], v[184:187], v[164:167], v[88:91]
  v_exp_f32 v13, v149
  v_mfma_f32_16x16x32_bf16 v[60:63], v[188:191], v[160:163], v[60:63]
  ds_read_b128 v[184:187], v1 offset:1024
  v_cvt_pk_bf16_f32 v173, v14, v15
  v_mfma_f32_16x16x32_bf16 v[92:95], v[188:191], v[164:167], v[92:95]
  v_add_f32 v8, v8, v14
  v_add_f32 v8, v8, v15
  s_waitcnt lgkmcnt(9)
  s_waitcnt lgkmcnt(8)
  v_mfma_f32_16x16x32_bf16 v[128:131], v[176:179], v[96:99], 0
  ds_read_b128 v[188:191], v1 offset:1536
  v_exp_f32 v14, v156
  s_waitcnt lgkmcnt(8)
  v_mfma_f32_16x16x32_bf16 v[136:139], v[176:179], v[112:115], 0
  v_exp_f32 v15, v157
  v_cvt_pk_bf16_f32 v170, v12, v13
  s_waitcnt lgkmcnt(7)
  v_mfma_f32_16x16x32_bf16 v[128:131], v[180:183], v[100:103], v[128:131]
  ds_read_b128 v[176:179], v1 offset:4096
  v_add_f32 v7, v7, v12
  v_add_f32 v7, v7, v13
  s_waitcnt lgkmcnt(7)
  v_mfma_f32_16x16x32_bf16 v[136:139], v[180:183], v[116:119], v[136:139]
  v_exp_f32 v12, v150
  s_waitcnt lgkmcnt(1)
  v_mfma_f32_16x16x32_bf16 v[128:131], v[184:187], v[104:107], v[128:131]
  ds_read_b128 v[180:183], v1 offset:4608
  v_exp_f32 v13, v151
  v_mfma_f32_16x16x32_bf16 v[136:139], v[184:187], v[120:123], v[136:139]
  v_cvt_pk_bf16_f32 v174, v14, v15
  v_add_f32 v8, v8, v14
  v_mfma_f32_16x16x32_bf16 v[128:131], v[188:191], v[108:111], v[128:131]
  ds_read_b128 v[184:187], v1 offset:5120
  v_add_f32 v8, v8, v15
  v_mfma_f32_16x16x32_bf16 v[136:139], v[188:191], v[124:127], v[136:139]
  v_exp_f32 v14, v158
  s_waitcnt lgkmcnt(1)
  v_mfma_f32_16x16x32_bf16 v[132:135], v[176:179], v[96:99], 0
  ds_read_b128 v[188:191], v1 offset:5632
  v_exp_f32 v15, v159
  v_cvt_pk_bf16_f32 v171, v12, v13
  v_mfma_f32_16x16x32_bf16 v[140:143], v[176:179], v[112:115], 0
  v_add_f32 v7, v7, v12
  v_add_f32 v7, v7, v13
  v_mfma_f32_16x16x32_bf16 v[132:135], v[180:183], v[100:103], v[132:135]
  ds_read_b64_tr_b16 v[176:177], v2 offset:16384
  ds_read_b64_tr_b16 v[178:179], v2 offset:20480
  v_cvt_pk_bf16_f32 v175, v14, v15
  v_mfma_f32_16x16x32_bf16 v[140:143], v[180:183], v[116:119], v[140:143]
  v_add_f32 v8, v8, v14
  v_add_f32 v8, v8, v15
  s_waitcnt lgkmcnt(2)
  v_mfma_f32_16x16x32_bf16 v[132:135], v[184:187], v[104:107], v[132:135]
  ds_read_b64_tr_b16 v[180:181], v3 offset:16384
  ds_read_b64_tr_b16 v[182:183], v3 offset:20480
  v_mfma_f32_16x16x32_bf16 v[140:143], v[184:187], v[120:123], v[140:143]
  v_mfma_f32_16x16x32_bf16 v[132:135], v[188:191], v[108:111], v[132:135]
  ds_read_b64_tr_b16 v[184:185], v2 offset:16896
  ds_read_b64_tr_b16 v[186:187], v2 offset:20992
  v_mfma_f32_16x16x32_bf16 v[140:143], v[188:191], v[124:127], v[140:143]
  v_max_f32 v12, v7, v8
  v_cmp_nge_f32 vcc, s49, v12
  s_nop 0
  s_cbranch_vccnz L_rare_10
L_back_11:
  v_add_f32 v5, v5, v7
  v_add_f32 v6, v6, v8
  s_waitcnt lgkmcnt(2)
  v_mfma_f32_16x16x32_bf16 v[32:35], v[176:179], v[168:171], v[32:35]
  ds_read_b64_tr_b16 v[188:189], v3 offset:16896
  ds_read_b64_tr_b16 v[190:191], v3 offset:20992
  v_mov_b32 v16, v5
  v_mov_b32 v17, v6
  s_nop 0
  v_permlane16_swap_b32 v5, v16
  v_mfma_f32_16x16x32_bf16 v[64:67], v[176:179], v[172:175], v[64:67]
  v_permlane16_swap_b32 v6, v17
  v_add_f32 v5, v5, v16
  v_add_f32 v6, v6, v17
  v_mov_b32 v16, v5
  v_mfma_f32_16x16x32_bf16 v[36:39], v[180:183], v[168:171], v[36:39]
  ds_read_b64_tr_b16 v[176:177], v2 offset:17408
  ds_read_b64_tr_b16 v[178:179], v2 offset:21504
  v_mov_b32 v17, v6
  v_permlane32_swap_b32 v5, v16
  s_nop 0
  v_permlane32_swap_b32 v6, v17
  v_mfma_f32_16x16x32_bf16 v[68:71], v[180:183], v[172:175], v[68:71]
  v_add_f32 v5, v5, v16
  v_add_f32 v6, v6, v17
  v_rcp_f32 v16, v5
  v_rcp_f32 v17, v6
  s_waitcnt lgkmcnt(2)
  v_mfma_f32_16x16x32_bf16 v[40:43], v[184:187], v[168:171], v[40:43]
  ds_read_b64_tr_b16 v[180:181], v3 offset:17408
  ds_read_b64_tr_b16 v[182:183], v3 offset:21504
  v_max3_f32 v12, v128, v129, v130
  v_max3_f32 v14, v136, v137, v138
  v_max3_f32 v13, v131, v132, v133
  v_mfma_f32_16x16x32_bf16 v[72:75], v[184:187], v[172:175], v[72:75]
  v_max3_f32 v15, v139, v140, v141
  v_max3_f32 v12, v12, v134, v135
  v_max3_f32 v14, v14, v142, v143
  v_max_f32 v12, v12, v13
  v_mfma_f32_16x16x32_bf16 v[44:47], v[188:191], v[168:171], v[44:47]
  ds_read_b64_tr_b16 v[184:185], v2 offset:17920
  ds_read_b64_tr_b16 v[186:187], v2 offset:22016
  v_max_f32 v14, v14, v15
  v_mov_b32 v13, v12
  v_mov_b32 v15, v14
  v_mfma_f32_16x16x32_bf16 v[76:79], v[188:191], v[172:175], v[76:79]
  v_permlane16_swap_b32 v12, v13
  v_permlane16_swap_b32 v14, v15
  v_max_f32 v12, v12, v13
  s_waitcnt lgkmcnt(2)
  v_mfma_f32_16x16x32_bf16 v[48:51], v[176:179], v[168:171], v[48:51]
  ds_read_b64_tr_b16 v[188:189], v3 offset:17920
  ds_read_b64_tr_b16 v[190:191], v3 offset:22016
  v_max_f32 v14, v14, v15
  v_mov_b32 v13, v12
  v_mov_b32 v15, v14
  v_mfma_f32_16x16x32_bf16 v[80:83], v[176:179], v[172:175], v[80:83]
  v_permlane32_swap_b32 v12, v13
  v_permlane32_swap_b32 v14, v15
  v_max_f32 v12, v12, v13
  v_max_f32 v14, v14, v15
  v_mfma_f32_16x16x32_bf16 v[52:55], v[180:183], v[168:171], v[52:55]
  ds_read_b128 v[176:179], v1 offset:8192
  v_sub_f32 v24, 0, v12
  v_sub_f32 v25, 0, v12
  v_sub_f32 v26, 0, v12
  v_sub_f32 v27, 0, v12
  v_mfma_f32_16x16x32_bf16 v[84:87], v[180:183], v[172:175], v[84:87]
  v_sub_f32 v28, 0, v14
  v_sub_f32 v29, 0, v14
  v_sub_f32 v30, 0, v14
  v_sub_f32 v31, 0, v14
  s_waitcnt lgkmcnt(1)
  v_mfma_f32_16x16x32_bf16 v[56:59], v[184:187], v[168:171], v[56:59]
  ds_read_b128 v[180:183], v1 offset:8704
  v_add_f32 v128, v128, v24
  v_add_f32 v136, v136, v28
  v_add_f32 v129, v129, v24
  v_add_f32 v137, v137, v28
  v_add_f32 v130, v130, v24
  v_mfma_f32_16x16x32_bf16 v[88:91], v[184:187], v[172:175], v[88:91]
  v_add_f32 v138, v138, v28
  v_add_f32 v131, v131, v24
  v_add_f32 v139, v139, v28
  v_add_f32 v132, v132, v24
  v_add_f32 v140, v140, v28
  v_mfma_f32_16x16x32_bf16 v[60:63], v[188:191], v[168:171], v[60:63]
  ds_read_b128 v[184:187], v1 offset:9216
  v_add_f32 v133, v133, v24
  v_add_f32 v141, v141, v28
  v_add_f32 v134, v134, v24
  v_add_f32 v142, v142, v28
  v_add_f32 v135, v135, v24
  v_mfma_f32_16x16x32_bf16 v[92:95], v[188:191], v[172:175], v[92:95]
  v_add_f32 v143, v143, v28
  v_exp_f32 v12, v128
  v_exp_f32 v13, v129
  s_waitcnt lgkmcnt(1)
  v_mfma_f32_16x16x32_bf16 v[144:147], v[176:179], v[96:99], v[24:27]
  ds_read_b128 v[188:191], v1 offset:9728
  v_exp_f32 v14, v136
  v_exp_f32 v15, v137
  v_cvt_pk_bf16_f32 v160, v12, v13
  v_mfma_f32_16x16x32_bf16 v[152:155], v[176:179], v[112:115], v[28:31]
  v_add_f32 v7, v12, v13
  v_exp_f32 v12, v130
  v_exp_f32 v13, v131
  v_mfma_f32_16x16x32_bf16 v[144:147], v[180:183], v[100:103], v[144:147]
  ds_read_b128 v[176:179], v1 offset:12288
  v_mul_f32 v32, v32, v16
  v_mul_f32 v33, v33, v16
  v_mul_f32 v34, v34, v16
  v_cvt_pk_bf16_f32 v164, v14, v15
  v_mul_f32 v35, v35, v16
  v_mul_f32 v36, v36, v16
  v_mul_f32 v37, v37, v16
  v_add_f32 v8, v14, v15
  v_mul_f32 v38, v38, v16
  v_mul_f32 v39, v39, v16
  v_mfma_f32_16x16x32_bf16 v[152:155], v[180:183], v[116:119], v[152:155]
  v_cvt_pk_bf16_f32 v224, v32, v33
  v_exp_f32 v14, v138
  v_cvt_pk_bf16_f32 v225, v34, v35
  v_cvt_pk_bf16_f32 v226, v36, v37
  v_cvt_pk_bf16_f32 v227, v38, v39
  v_exp_f32 v15, v139
  v_mul_f32 v64, v64, v17
  v_mul_f32 v65, v65, v17
  s_waitcnt lgkmcnt(1)
  v_mfma_f32_16x16x32_bf16 v[144:147], v[184:187], v[104:107], v[144:147]
  ds_read_b128 v[180:183], v1 offset:12800
  v_mul_f32 v66, v66, v17
  v_cvt_pk_bf16_f32 v161, v12, v13
  v_mul_f32 v67, v67, v17
  v_mul_f32 v68, v68, v17
  v_mul_f32 v69, v69, v17
  v_add_f32 v7, v7, v12
  v_mul_f32 v70, v70, v17
  v_mul_f32 v71, v71, v17
  v_cvt_pk_bf16_f32 v240, v64, v65
  v_add_f32 v7, v7, v13
  v_mfma_f32_16x16x32_bf16 v[152:155], v[184:187], v[120:123], v[152:155]
  v_cvt_pk_bf16_f32 v241, v66, v67
  v_cvt_pk_bf16_f32 v242, v68, v69
  v_cvt_pk_bf16_f32 v243, v70, v71
  v_exp_f32 v12, v132
  v_mul_f32 v40, v40, v16
  v_mul_f32 v41, v41, v16
  v_mul_f32 v42, v42, v16
  v_exp_f32 v13, v133
  v_mfma_f32_16x16x32_bf16 v[144:147], v[188:191], v[108:111], v[144:147]
  ds_read_b128 v[184:187], v1 offset:13312
  v_mul_f32 v43, v43, v16
  v_mul_f32 v44, v44, v16
  v_mul_f32 v45, v45, v16
  v_cvt_pk_bf16_f32 v165, v14, v15
  v_mul_f32 v46, v46, v16
  v_mul_f32 v47, v47, v16
  v_cvt_pk_bf16_f32 v228, v40, v41
  v_add_f32 v8, v8, v14
  v_cvt_pk_bf16_f32 v229, v42, v43
  v_cvt_pk_bf16_f32 v230, v44, v45
  v_mfma_f32_16x16x32_bf16 v[152:155], v[188:191], v[124:127], v[152:155]
  v_cvt_pk_bf16_f32 v231, v46, v47
  v_add_f32 v8, v8, v15
  v_mul_f32 v72, v72, v17
  v_mul_f32 v73, v73, v17
  v_mul_f32 v74, v74, v17
  v_exp_f32 v14, v140
  v_mul_f32 v75, v75, v17
  v_mul_f32 v76, v76, v17
  v_mul_f32 v77, v77, v17
  s_waitcnt lgkmcnt(1)
  v_mfma_f32_16x16x32_bf16 v[148:151], v[176:179], v[96:99], v[24:27]
  ds_read_b128 v[188:191], v1 offset:13824
  v_exp_f32 v15, v141
  v_mul_f32 v78, v78, v17
  v_mul_f32 v79, v79, v17
  v_cvt_pk_bf16_f32 v244, v72, v73
  v_cvt_pk_bf16_f32 v162, v12, v13
  v_cvt_pk_bf16_f32 v245, v74, v75
  v_cvt_pk_bf16_f32 v246, v76, v77
  v_cvt_pk_bf16_f32 v247, v78, v79
  v_add_f32 v7, v7, v12
  v_mfma_f32_16x16x32_bf16 v[156:159], v[176:179], v[112:115], v[28:31]
  v_mul_f32 v48, v48, v16
  v_mul_f32 v49, v49, v16
  v_mul_f32 v50, v50, v16
  v_add_f32 v7, v7, v13
  v_mul_f32 v51, v51, v16
  v_mul_f32 v52, v52, v16
  v_mul_f32 v53, v53, v16
  v_exp_f32 v12, v134
  v_mul_f32 v54, v54, v16
  v_mfma_f32_16x16x32_bf16 v[148:151], v[180:183], v[100:103], v[148:151]
  ds_read_b64_tr_b16 v[176:177], v2 offset:24576
  ds_read_b64_tr_b16 v[178:179], v2 offset:28672
  v_mul_f32 v55, v55, v16
  v_cvt_pk_bf16_f32 v232, v48, v49
  v_exp_f32 v13, v135
  v_cvt_pk_bf16_f32 v233, v50, v51
  v_cvt_pk_bf16_f32 v234, v52, v53
  v_cvt_pk_bf16_f32 v235, v54, v55
  v_cvt_pk_bf16_f32 v166, v14, v15
  v_mul_f32 v80, v80, v17
  v_mfma_f32_16x16x32_bf16 v[156:159], v[180:183], v[116:119], v[156:159]
  v_mul_f32 v81, v81, v17
  v_mul_f32 v82, v82, v17
  v_add_f32 v8, v8, v14
  v_mul_f32 v83, v83, v17
  v_mul_f32 v84, v84, v17
  v_mul_f32 v85, v85, v17
  v_add_f32 v8, v8, v15
  v_mul_f32 v86, v86, v17
  v_mul_f32 v87, v87, v17
  v_cvt_pk_bf16_f32 v248, v80, v81
  s_waitcnt lgkmcnt(2)
  v_mfma_f32_16x16x32_bf16 v[148:151], v[184:187], v[104:107], v[148:151]
  ds_read_b64_tr_b16 v[180:181], v3 offset:24576
  ds_read_b64_tr_b16 v[182:183], v3 offset:28672
  v_exp_f32 v14, v142
  v_cvt_pk_bf16_f32 v249, v82, v83
  v_cvt_pk_bf16_f32 v250, v84, v85
  v_cvt_pk_bf16_f32 v251, v86, v87
  v_exp_f32 v15, v143
  v_mul_f32 v56, v56, v16
  v_mul_f32 v57, v57, v16
  v_mul_f32 v58, v58, v16
  v_mfma_f32_16x16x32_bf16 v[156:159], v[184:187], v[120:123], v[156:159]
  v_cvt_pk_bf16_f32 v163, v12, v13
  v_mul_f32 v59, v59, v16
  v_mul_f32 v60, v60, v16
  v_mul_f32 v61, v61, v16
  v_add_f32 v7, v7, v12
  v_mul_f32 v62, v62, v16
  v_mul_f32 v63, v63, v16
  v_cvt_pk_bf16_f32 v236, v56, v57
  v_add_f32 v7, v7, v13
  v_cvt_pk_bf16_f32 v237, v58, v59
  v_mfma_f32_16x16x32_bf16 v[148:151], v[188:191], v[108:111], v[148:151]
  ds_read_b64_tr_b16 v[184:185], v2 offset:25088
  ds_read_b64_tr_b16 v[186:187], v2 offset:29184
  v_cvt_pk_bf16_f32 v238, v60, v61
  v_cvt_pk_bf16_f32 v239, v62, v63
  v_cvt_pk_bf16_f32 v167, v14, v15
  v_mul_f32 v88, v88, v17
  v_mul_f32 v89, v89, v17
  v_mul_f32 v90, v90, v17
  v_add_f32 v8, v8, v14
  v_mul_f32 v91, v91, v17
  v_mul_f32 v92, v92, v17
  v_mfma_f32_16x16x32_bf16 v[156:159], v[188:191], v[124:127], v[156:159]
  v_mul_f32 v93, v93, v17
  v_add_f32 v8, v8, v15
  v_mul_f32 v94, v94, v17
  v_mul_f32 v95, v95, v17
  v_cvt_pk_bf16_f32 v252, v88, v89
  v_mov_b32 v5, v7
  v_cvt_pk_bf16_f32 v253, v90, v91
  v_cvt_pk_bf16_f32 v254, v92, v93
  v_cvt_pk_bf16_f32 v255, v94, v95
  v_mov_b32 v6, v8
  s_waitcnt lgkmcnt(2)
  v_mfma_f32_16x16x32_bf16 v[32:35], v[176:179], v[160:163], 0
  ds_read_b64_tr_b16 v[188:189], v3 offset:25088
  ds_read_b64_tr_b16 v[190:191], v3 offset:29184
  v_mov_b32 v56, 0
  v_mov_b32 v57, 0
  v_mov_b32 v58, 0
  v_mov_b32 v59, 0
  v_mov_b32 v60, 0
  v_mov_b32 v61, 0
  v_mov_b32 v62, 0
  v_mov_b32 v63, 0
  v_mov_b32 v88, 0
  v_mov_b32 v89, 0
  v_mfma_f32_16x16x32_bf16 v[64:67], v[176:179], v[164:167], 0
  v_mov_b32 v90, 0
  v_mov_b32 v91, 0
  v_mov_b32 v92, 0
  v_mov_b32 v93, 0
  v_mov_b32 v94, 0
  v_mov_b32 v95, 0
  s_add_u32 s51, s51, 1
  s_cmp_eq_u32 s51, 3
  s_cselect_b32 s61, s57, s56
  s_cselect_b32 s51, 0, s51
  s_add_u32 s44, s44, 1
  v_add_u32 v1, s61, v1
  v_mfma_f32_16x16x32_bf16 v[36:39], v[180:183], v[160:163], 0
  ds_read_b64_tr_b16 v[176:177], v2 offset:25600
  ds_read_b64_tr_b16 v[178:179], v2 offset:29696
  v_exp_f32 v12, v144
  v_mfma_f32_16x16x32_bf16 v[68:71], v[180:183], v[164:167], 0
  v_exp_f32 v13, v145
  s_waitcnt lgkmcnt(2)
  v_mfma_f32_16x16x32_bf16 v[40:43], v[184:187], v[160:163], 0
  ds_read_b64_tr_b16 v[180:181], v3 offset:25600
  ds_read_b64_tr_b16 v[182:183], v3 offset:29696
  v_exp_f32 v14, v152
  v_mfma_f32_16x16x32_bf16 v[72:75], v[184:187], v[164:167], 0
  v_exp_f32 v15, v153
  v_cvt_pk_bf16_f32 v168, v12, v13
  v_mfma_f32_16x16x32_bf16 v[44:47], v[188:191], v[160:163], 0
  ds_read_b64_tr_b16 v[184:185], v2 offset:26112
  ds_read_b64_tr_b16 v[186:187], v2 offset:30208
  v_add_f32 v7, v12, v13
  v_exp_f32 v12, v146
  v_mfma_f32_16x16x32_bf16 v[76:79], v[188:191], v[164:167], 0
  v_exp_f32 v13, v147
  s_waitcnt lgkmcnt(2)
  v_mfma_f32_16x16x32_bf16 v[48:51], v[176:179], v[160:163], 0
  ds_read_b64_tr_b16 v[188:189], v3 offset:26112
  ds_read_b64_tr_b16 v[190:191], v3 offset:30208
  v_cvt_pk_bf16_f32 v172, v14, v15
  v_mfma_f32_16x16x32_bf16 v[80:83], v[176:179], v[164:167], 0
  v_add_f32 v8, v14, v15
  v_exp_f32 v14, v154
  v_mfma_f32_16x16x32_bf16 v[52:55], v[180:183], v[160:163], 0
  v_add_u32 v2, s61, v2
  v_add_u32 v3, s61, v3
  v_exp_f32 v15, v155
  v_mfma_f32_16x16x32_bf16 v[84:87], v[180:183], v[164:167], 0
  v_cvt_pk_bf16_f32 v169, v12, v13
  v_add_f32 v7, v7, v12
  s_waitcnt lgkmcnt(0)
  s_branch L_loop2_0
L_f3_2:
  s_barrier
  ds_read_b128 v[176:179], v1 offset:0
  ds_read_b128 v[180:183], v1 offset:512
  v_mfma_f32_16x16x32_bf16 v[56:59], v[184:187], v[160:163], v[56:59]
  v_mov_b32 v96, v192
  v_mov_b32 v97, v193
  v_mov_b32 v98, v194
  v_mov_b32 v99, v195
  v_mfma_f32_16x16x32_bf16 v[88:91], v[184:187], v[164:167], v[88:91]
  v_mov_b32 v112, v208
  v_mov_b32 v113, v209
  v_mov_b32 v114, v210
  v_mov_b32 v115, v211
  v_mfma_f32_16x16x32_bf16 v[60:63], v[188:191], v[160:163], v[60:63]
  ds_read_b128 v[184:187], v1 offset:1024
  v_mov_b32 v100, v196
  v_mov_b32 v101, v197
  v_mov_b32 v102, v198
  v_mov_b32 v103, v199
  v_mfma_f32_16x16x32_bf16 v[92:95], v[188:191], v[164:167], v[92:95]
  v_mov_b32 v116, v212
  v_mov_b32 v117, v213
  v_mov_b32 v118, v214
  v_mov_b32 v119, v215
  s_waitcnt lgkmcnt(1)
  v_mfma_f32_16x16x32_bf16 v[128:131], v[176:179], v[96:99], 0
  ds_read_b128 v[188:191], v1 offset:1536
  v_mov_b32 v104, v200
  v_mov_b32 v105, v201
  v_mov_b32 v106, v202
  v_mov_b32 v107, v203
  v_mfma_f32_16x16x32_bf16 v[136:139], v[176:179], v[112:115], 0
  v_mov_b32 v120, v216
  v_mov_b32 v121, v217
  v_mov_b32 v122, v218
  v_mov_b32 v123, v219
  v_mfma_f32_16x16x32_bf16 v[128:131], v[180:183], v[100:103], v[128:131]
  ds_read_b128 v[176:179], v1 offset:4096
  v_mov_b32 v108, v204
  v_mov_b32 v109, v205
  v_mov_b32 v110, v206
  v_mov_b32 v111, v207
  v_mfma_f32_16x16x32_bf16 v[136:139], v[180:183], v[116:119], v[136:139]
  v_mov_b32 v124, v220
  v_mov_b32 v125, v221
  v_mov_b32 v126, v222
  v_mov_b32 v127, v223
  s_waitcnt lgkmcnt(1)
  v_mfma_f32_16x16x32_bf16 v[128:131], v[184:187], v[104:107], v[128:131]
  ds_read_b128 v[180:183], v1 offset:4608
  v_add_f32 v7, v7, v13
  v_exp_f32 v12, v148
  v_mfma_f32_16x16x32_bf16 v[136:139], v[184:187], v[120:123], v[136:139]
  v_exp_f32 v13, v149
  v_mfma_f32_16x16x32_bf16 v[128:131], v[188:191], v[108:111], v[128:131]
  ds_read_b128 v[184:187], v1 offset:5120
  v_cvt_pk_bf16_f32 v173, v14, v15
  v_add_f32 v8, v8, v14
  v_add_f32 v8, v8, v15
  v_mfma_f32_16x16x32_bf16 v[136:139], v[188:191], v[124:127], v[136:139]
  v_exp_f32 v14, v156
  v_exp_f32 v15, v157
  s_waitcnt lgkmcnt(1)
  v_mfma_f32_16x16x32_bf16 v[132:135], v[176:179], v[96:99], 0
  ds_read_b128 v[188:191], v1 offset:5632
  v_cvt_pk_bf16_f32 v170, v12, v13
  v_add_f32 v7, v7, v12
  v_add_f32 v7, v7, v13
  v_mfma_f32_16x16x32_bf16 v[140:143], v[176:179], v[112:115], 0
  v_exp_f32 v12, v150
  v_exp_f32 v13, v151
  v_mfma_f32_16x16x32_bf16 v[132:135], v[180:183], v[100:103], v[132:135]
  ds_read_b64_tr_b16 v[176:177], v2 offset:16384
  ds_read_b64_tr_b16 v[178:179], v2 offset:20480
  v_cvt_pk_bf16_f32 v174, v14, v15
  v_add_f32 v8, v8, v14
  v_add_f32 v8, v8, v15
  v_mfma_f32_16x16x32_bf16 v[140:143], v[180:183], v[116:119], v[140:143]
  v_exp_f32 v14, v158
  v_exp_f32 v15, v159
  s_waitcnt lgkmcnt(2)
  v_mfma_f32_16x16x32_bf16 v[132:135], v[184:187], v[104:107], v[132:135]
  ds_read_b64_tr_b16 v[180:181], v3 offset:16384
  ds_read_b64_tr_b16 v[182:183], v3 offset:20480
  v_cvt_pk_bf16_f32 v171, v12, v13
  v_add_f32 v7, v7, v12
  v_add_f32 v7, v7, v13
  v_mfma_f32_16x16x32_bf16 v[140:143], v[184:187], v[120:123], v[140:143]
  v_cvt_pk_bf16_f32 v175, v14, v15
  v_add_f32 v8, v8, v14
  v_add_f32 v8, v8, v15
  v_mfma_f32_16x16x32_bf16 v[132:135], v[188:191], v[108:111], v[132:135]
  ds_read_b64_tr_b16 v[184:185], v2 offset:16896
  ds_read_b64_tr_b16 v[186:187], v2 offset:20992
  v_mfma_f32_16x16x32_bf16 v[140:143], v[188:191], v[124:127], v[140:143]
  v_max_f32 v12, v7, v8
  v_cmp_nge_f32 vcc, s49, v12
  s_nop 0
  s_cbranch_vccnz L_rare_12
L_back_13:
  v_add_f32 v5, v5, v7
  v_add_f32 v6, v6, v8
  s_waitcnt lgkmcnt(2)
  v_mfma_f32_16x16x32_bf16 v[32:35], v[176:179], v[168:171], v[32:35]
  ds_read_b64_tr_b16 v[188:189], v3 offset:16896
  ds_read_b64_tr_b16 v[190:191], v3 offset:20992
  v_mov_b32 v16, v5
  v_mov_b32 v17, v6
  s_nop 0
  v_permlane16_swap_b32 v5, v16
  v_mfma_f32_16x16x32_bf16 v[64:67], v[176:179], v[172:175], v[64:67]
  v_permlane16_swap_b32 v6, v17
  v_add_f32 v5, v5, v16
  v_add_f32 v6, v6, v17
  v_mov_b32 v16, v5
  v_mfma_f32_16x16x32_bf16 v[36:39], v[180:183], v[168:171], v[36:39]
  ds_read_b64_tr_b16 v[176:177], v2 offset:17408
  ds_read_b64_tr_b16 v[178:179], v2 offset:21504
  v_mov_b32 v17, v6
  v_permlane32_swap_b32 v5, v16
  s_nop 0
  v_permlane32_swap_b32 v6, v17
  v_mfma_f32_16x16x32_bf16 v[68:71], v[180:183], v[172:175], v[68:71]
  v_add_f32 v5, v5, v16
  v_add_f32 v6, v6, v17
  v_rcp_f32 v16, v5
  v_rcp_f32 v17, v6
  s_waitcnt lgkmcnt(2)
  v_mfma_f32_16x16x32_bf16 v[40:43], v[184:187], v[168:171], v[40:43]
  ds_read_b64_tr_b16 v[180:181], v3 offset:17408
  ds_read_b64_tr_b16 v[182:183], v3 offset:21504
  v_max3_f32 v12, v128, v129, v130
  v_max3_f32 v14, v136, v137, v138
  v_max3_f32 v13, v131, v132, v133
  v_mfma_f32_16x16x32_bf16 v[72:75], v[184:187], v[172:175], v[72:75]
  v_max3_f32 v15, v139, v140, v141
  v_max3_f32 v12, v12, v134, v135
  v_max3_f32 v14, v14, v142, v143
  v_max_f32 v12, v12, v13
  v_mfma_f32_16x16x32_bf16 v[44:47], v[188:191], v[168:171], v[44:47]
  ds_read_b64_tr_b16 v[184:185], v2 offset:17920
  ds_read_b64_tr_b16 v[186:187], v2 offset:22016
  v_max_f32 v14, v14, v15
  v_mov_b32 v13, v12
  v_mov_b32 v15, v14
  v_mfma_f32_16x16x32_bf16 v[76:79], v[188:191], v[172:175], v[76:79]
  v_permlane16_swap_b32 v12, v13
  v_permlane16_swap_b32 v14, v15
  v_max_f32 v12, v12, v13
  s_waitcnt lgkmcnt(2)
  v_mfma_f32_16x16x32_bf16 v[48:51], v[176:179], v[168:171], v[48:51]
  ds_read_b64_tr_b16 v[188:189], v3 offset:17920
  ds_read_b64_tr_b16 v[190:191], v3 offset:22016
  v_max_f32 v14, v14, v15
  v_mov_b32 v13, v12
  v_mov_b32 v15, v14
  v_mfma_f32_16x16x32_bf16 v[80:83], v[176:179], v[172:175], v[80:83]
  v_permlane32_swap_b32 v12, v13
  v_permlane32_swap_b32 v14, v15
  v_max_f32 v12, v12, v13
  v_max_f32 v14, v14, v15
  v_mfma_f32_16x16x32_bf16 v[52:55], v[180:183], v[168:171], v[52:55]
  ds_read_b128 v[176:179], v1 offset:8192
  v_sub_f32 v24, 0, v12
  v_sub_f32 v25, 0, v12
  v_sub_f32 v26, 0, v12
  v_sub_f32 v27, 0, v12
  v_mfma_f32_16x16x32_bf16 v[84:87], v[180:183], v[172:175], v[84:87]
  v_sub_f32 v28, 0, v14
  v_sub_f32 v29, 0, v14
  v_sub_f32 v30, 0, v14
  v_sub_f32 v31, 0, v14
  s_waitcnt lgkmcnt(1)
  v_mfma_f32_16x16x32_bf16 v[56:59], v[184:187], v[168:171], v[56:59]
  ds_read_b128 v[180:183], v1 offset:8704
  v_add_f32 v128, v128, v24
  v_add_f32 v136, v136, v28
  v_add_f32 v129, v129, v24
  v_add_f32 v137, v137, v28
  v_add_f32 v130, v130, v24
  v_mfma_f32_16x16x32_bf16 v[88:91], v[184:187], v[172:175], v[88:91]
  v_add_f32 v138, v138, v28
  v_add_f32 v131, v131, v24
  v_add_f32 v139, v139, v28
  v_add_f32 v132, v132, v24
  v_add_f32 v140, v140, v28
  v_mfma_f32_16x16x32_bf16 v[60:63], v[188:191], v[168:171], v[60:63]
  ds_read_b128 v[184:187], v1 offset:9216
  v_add_f32 v133, v133, v24
  v_add_f32 v141, v141, v28
  v_add_f32 v134, v134, v24
  v_add_f32 v142, v142, v28
  v_add_f32 v135, v135, v24
  v_mfma_f32_16x16x32_bf16 v[92:95], v[188:191], v[172:175], v[92:95]
  v_add_f32 v143, v143, v28
  v_exp_f32 v12, v128
  v_exp_f32 v13, v129
  s_waitcnt lgkmcnt(1)
  v_mfma_f32_16x16x32_bf16 v[144:147], v[176:179], v[96:99], v[24:27]
  ds_read_b128 v[188:191], v1 offset:9728
  v_exp_f32 v14, v136
  v_exp_f32 v15, v137
  v_cvt_pk_bf16_f32 v160, v12, v13
  v_mfma_f32_16x16x32_bf16 v[152:155], v[176:179], v[112:115], v[28:31]
  v_add_f32 v7, v12, v13
  v_exp_f32 v12, v130
  v_exp_f32 v13, v131
  v_mfma_f32_16x16x32_bf16 v[144:147], v[180:183], v[100:103], v[144:147]
  ds_read_b128 v[176:179], v1 offset:12288
  v_mul_f32 v32, v32, v16
  v_mul_f32 v33, v33, v16
  v_mul_f32 v34, v34, v16
  v_cvt_pk_bf16_f32 v164, v14, v15
  v_mul_f32 v35, v35, v16
  v_mul_f32 v36, v36, v16
  v_mul_f32 v37, v37, v16
  v_add_f32 v8, v14, v15
  v_mul_f32 v38, v38, v16
  v_mul_f32 v39, v39, v16
  v_mfma_f32_16x16x32_bf16 v[152:155], v[180:183], v[116:119], v[152:155]
  v_cvt_pk_bf16_f32 v192, v32, v33
  v_exp_f32 v14, v138
  v_cvt_pk_bf16_f32 v193, v34, v35
  v_cvt_pk_bf16_f32 v194, v36, v37
  v_cvt_pk_bf16_f32 v195, v38, v39
  v_exp_f32 v15, v139
  v_mul_f32 v64, v64, v17
  v_mul_f32 v65, v65, v17
  s_waitcnt lgkmcnt(1)
  v_mfma_f32_16x16x32_bf16 v[144:147], v[184:187], v[104:107], v[144:147]
  ds_read_b128 v[180:183], v1 offset:12800
  v_mul_f32 v66, v66, v17
  v_cvt_pk_bf16_f32 v161, v12, v13
  v_mul_f32 v67, v67, v17
  v_mul_f32 v68, v68, v17
  v_mul_f32 v69, v69, v17
  v_add_f32 v7, v7, v12
  v_mul_f32 v70, v70, v17
  v_mul_f32 v71, v71, v17
  v_cvt_pk_bf16_f32 v208, v64, v65
  v_add_f32 v7, v7, v13
  v_mfma_f32_16x16x32_bf16 v[152:155], v[184:187], v[120:123], v[152:155]
  v_cvt_pk_bf16_f32 v209, v66, v67
  v_cvt_pk_bf16_f32 v210, v68, v69
  v_cvt_pk_bf16_f32 v211, v70, v71
  v_exp_f32 v12, v132
  v_mul_f32 v40, v40, v16
  v_mul_f32 v41, v41, v16
  v_mul_f32 v42, v42, v16
  v_exp_f32 v13, v133
  v_mfma_f32_16x16x32_bf16 v[144:147], v[188:191], v[108:111], v[144:147]
  ds_read_b128 v[184:187], v1 offset:13312
  v_mul_f32 v43, v43, v16
  v_mul_f32 v44, v44, v16
  v_mul_f32 v45, v45, v16
  v_cvt_pk_bf16_f32 v165, v14, v15
  v_mul_f32 v46, v46, v16
  v_mul_f32 v47, v47, v16
  v_cvt_pk_bf16_f32 v196, v40, v41
  v_add_f32 v8, v8, v14
  v_cvt_pk_bf16_f32 v197, v42, v43
  v_cvt_pk_bf16_f32 v198, v44, v45
  v_mfma_f32_16x16x32_bf16 v[152:155], v[188:191], v[124:127], v[152:155]
  v_cvt_pk_bf16_f32 v199, v46, v47
  v_add_f32 v8, v8, v15
  v_mul_f32 v72, v72, v17
  v_mul_f32 v73, v73, v17
  v_mul_f32 v74, v74, v17
  v_exp_f32 v14, v140
  v_mul_f32 v75, v75, v17
  v_mul_f32 v76, v76, v17
  v_mul_f32 v77, v77, v17
  s_waitcnt lgkmcnt(1)
  v_mfma_f32_16x16x32_bf16 v[148:151], v[176:179], v[96:99], v[24:27]
  ds_read_b128 v[188:191], v1 offset:13824
  v_exp_f32 v15, v141
  v_mul_f32 v78, v78, v17
  v_mul_f32 v79, v79, v17
  v_cvt_pk_bf16_f32 v212, v72, v73
  v_cvt_pk_bf16_f32 v162, v12, v13
  v_cvt_pk_bf16_f32 v213, v74, v75
  v_cvt_pk_bf16_f32 v214, v76, v77
  v_cvt_pk_bf16_f32 v215, v78, v79
  v_add_f32 v7, v7, v12
  v_mfma_f32_16x16x32_bf16 v[156:159], v[176:179], v[112:115], v[28:31]
  v_mul_f32 v48, v48, v16
  v_mul_f32 v49, v49, v16
  v_mul_f32 v50, v50, v16
  v_add_f32 v7, v7, v13
  v_mul_f32 v51, v51, v16
  v_mul_f32 v52, v52, v16
  v_mul_f32 v53, v53, v16
  v_exp_f32 v12, v134
  v_mul_f32 v54, v54, v16
  v_mfma_f32_16x16x32_bf16 v[148:151], v[180:183], v[100:103], v[148:151]
  ds_read_b64_tr_b16 v[176:177], v2 offset:24576
  ds_read_b64_tr_b16 v[178:179], v2 offset:28672
  v_mul_f32 v55, v55, v16
  v_cvt_pk_bf16_f32 v200, v48, v49
  v_exp_f32 v13, v135
  v_cvt_pk_bf16_f32 v201, v50, v51
  v_cvt_pk_bf16_f32 v202, v52, v53
  v_cvt_pk_bf16_f32 v203, v54, v55
  v_cvt_pk_bf16_f32 v166, v14, v15
  v_mul_f32 v80, v80, v17
  v_mfma_f32_16x16x32_bf16 v[156:159], v[180:183], v[116:119], v[156:159]
  v_mul_f32 v81, v81, v17
  v_mul_f32 v82, v82, v17
  v_add_f32 v8, v8, v14
  v_mul_f32 v83, v83, v17
  v_mul_f32 v84, v84, v17
  v_mul_f32 v85, v85, v17
  v_add_f32 v8, v8, v15
  v_mul_f32 v86, v86, v17
  v_mul_f32 v87, v87, v17
  v_cvt_pk_bf16_f32 v216, v80, v81
  s_waitcnt lgkmcnt(2)
  v_mfma_f32_16x16x32_bf16 v[148:151], v[184:187], v[104:107], v[148:151]
  ds_read_b64_tr_b16 v[180:181], v3 offset:24576
  ds_read_b64_tr_b16 v[182:183], v3 offset:28672
  v_exp_f32 v14, v142
  v_cvt_pk_bf16_f32 v217, v82, v83
  v_cvt_pk_bf16_f32 v218, v84, v85
  v_cvt_pk_bf16_f32 v219, v86, v87
  v_exp_f32 v15, v143
  v_mul_f32 v56, v56, v16
  v_mul_f32 v57, v57, v16
  v_mul_f32 v58, v58, v16
  v_mfma_f32_16x16x32_bf16 v[156:159], v[184:187], v[120:123], v[156:159]
  v_cvt_pk_bf16_f32 v163, v12, v13
  v_mul_f32 v59, v59, v16
  v_mul_f32 v60, v60, v16
  v_mul_f32 v61, v61, v16
  v_add_f32 v7, v7, v12
  v_mul_f32 v62, v62, v16
  v_mul_f32 v63, v63, v16
  v_cvt_pk_bf16_f32 v204, v56, v57
  v_add_f32 v7, v7, v13
  v_cvt_pk_bf16_f32 v205, v58, v59
  v_mfma_f32_16x16x32_bf16 v[148:151], v[188:191], v[108:111], v[148:151]
  ds_read_b64_tr_b16 v[184:185], v2 offset:25088
  ds_read_b64_tr_b16 v[186:187], v2 offset:29184
  v_cvt_pk_bf16_f32 v206, v60, v61
  v_cvt_pk_bf16_f32 v207, v62, v63
  v_cvt_pk_bf16_f32 v167, v14, v15
  v_mul_f32 v88, v88, v17
  v_mul_f32 v89, v89, v17
  v_mul_f32 v90, v90, v17
  v_add_f32 v8, v8, v14
  v_mul_f32 v91, v91, v17
  v_mul_f32 v92, v92, v17
  v_mfma_f32_16x16x32_bf16 v[156:159], v[188:191], v[124:127], v[156:159]
  v_mul_f32 v93, v93, v17
  v_add_f32 v8, v8, v15
  v_mul_f32 v94, v94, v17
  v_mul_f32 v95, v95, v17
  v_cvt_pk_bf16_f32 v220, v88, v89
  v_mov_b32 v5, v7
  v_cvt_pk_bf16_f32 v221, v90, v91
  v_cvt_pk_bf16_f32 v222, v92, v93
  v_cvt_pk_bf16_f32 v223, v94, v95
  v_mov_b32 v6, v8
  s_waitcnt lgkmcnt(2)
  v_mfma_f32_16x16x32_bf16 v[32:35], v[176:179], v[160:163], 0
  ds_read_b64_tr_b16 v[188:189], v3 offset:25088
  ds_read_b64_tr_b16 v[190:191], v3 offset:29184
  v_mov_b32 v56, 0
  v_mov_b32 v57, 0
  v_mov_b32 v58, 0
  v_mov_b32 v59, 0
  v_mov_b32 v60, 0
  v_mov_b32 v61, 0
  v_mov_b32 v62, 0
  v_mov_b32 v63, 0
  v_mov_b32 v88, 0
  v_mov_b32 v89, 0
  v_mfma_f32_16x16x32_bf16 v[64:67], v[176:179], v[164:167], 0
  v_mov_b32 v90, 0
  v_mov_b32 v91, 0
  v_mov_b32 v92, 0
  v_mov_b32 v93, 0
  v_mov_b32 v94, 0
  v_mov_b32 v95, 0
  s_add_u32 s51, s51, 1
  s_cmp_eq_u32 s51, 3
  s_cselect_b32 s61, s57, s56
  s_cselect_b32 s51, 0, s51
  s_add_u32 s44, s44, 1
  v_add_u32 v1, s61, v1
  v_mfma_f32_16x16x32_bf16 v[36:39], v[180:183], v[160:163], 0
  ds_read_b64_tr_b16 v[176:177], v2 offset:25600
  ds_read_b64_tr_b16 v[178:179], v2 offset:29696
  v_exp_f32 v12, v144
  v_mfma_f32_16x16x32_bf16 v[68:71], v[180:183], v[164:167], 0
  v_exp_f32 v13, v145
  s_waitcnt lgkmcnt(2)
  v_mfma_f32_16x16x32_bf16 v[40:43], v[184:187], v[160:163], 0
  ds_read_b64_tr_b16 v[180:181], v3 offset:25600
  ds_read_b64_tr_b16 v[182:183], v3 offset:29696
  v_exp_f32 v14, v152
  v_mfma_f32_16x16x32_bf16 v[72:75], v[184:187], v[164:167], 0
  v_exp_f32 v15, v153
  v_cvt_pk_bf16_f32 v168, v12, v13
  v_mfma_f32_16x16x32_bf16 v[44:47], v[188:191], v[160:163], 0
  ds_read_b64_tr_b16 v[184:185], v2 offset:26112
  ds_read_b64_tr_b16 v[186:187], v2 offset:30208
  v_add_f32 v7, v12, v13
  v_exp_f32 v12, v146
  v_mfma_f32_16x16x32_bf16 v[76:79], v[188:191], v[164:167], 0
  v_exp_f32 v13, v147
  s_waitcnt lgkmcnt(2)
  v_mfma_f32_16x16x32_bf16 v[48:51], v[176:179], v[160:163], 0
  ds_read_b64_tr_b16 v[188:189], v3 offset:26112
  ds_read_b64_tr_b16 v[190:191], v3 offset:30208
  v_cvt_pk_bf16_f32 v172, v14, v15
  v_mfma_f32_16x16x32_bf16 v[80:83], v[176:179], v[164:167], 0
  v_add_f32 v8, v14, v15
  v_exp_f32 v14, v154
  v_mfma_f32_16x16x32_bf16 v[52:55], v[180:183], v[160:163], 0
  v_add_u32 v2, s61, v2
  v_add_u32 v3, s61, v3
  v_exp_f32 v15, v155
  v_mfma_f32_16x16x32_bf16 v[84:87], v[180:183], v[164:167], 0
  v_cvt_pk_bf16_f32 v169, v12, v13
  v_add_f32 v7, v7, v12
  s_waitcnt lgkmcnt(0)
  s_branch L_loop2_0
L_tr_2:
  s_barrier
  ds_read_b128 v[176:179], v1 offset:0
  ds_read_b128 v[180:183], v1 offset:512
  v_mfma_f32_16x16x32_bf16 v[56:59], v[184:187], v[160:163], v[56:59]
  v_add_f32 v7, v7, v13
  v_exp_f32 v12, v148
  v_mfma_f32_16x16x32_bf16 v[88:91], v[184:187], v[164:167], v[88:91]
  s_lshl_b32 s59, s40, 11
  s_add_u32 s59, s59, 98304
  v_add_u32 v18, s59, v4
  ds_write_b128 v18, v[192:195] offset:0
  ds_write_b128 v18, v[208:211] offset:1024
  v_mfma_f32_16x16x32_bf16 v[60:63], v[188:191], v[160:163], v[60:63]
  ds_read_b128 v[184:187], v1 offset:1024
  v_exp_f32 v13, v149
  v_cvt_pk_bf16_f32 v173, v14, v15
  v_mfma_f32_16x16x32_bf16 v[92:95], v[188:191], v[164:167], v[92:95]
  s_lshl_b32 s59, s40, 11
  s_add_u32 s59, s59, 98304
  v_add_u32 v18, s59, v4
  ds_write_b128 v18, v[196:199] offset:8192
  ds_write_b128 v18, v[212:215] offset:9216
  s_waitcnt lgkmcnt(5)
  v_mfma_f32_16x16x32_bf16 v[128:131], v[176:179], v[96:99], v[24:27]
  ds_read_b128 v[188:191], v1 offset:1536
  v_add_f32 v8, v8, v14
  v_add_f32 v8, v8, v15
  v_mfma_f32_16x16x32_bf16 v[136:139], v[176:179], v[112:115], v[28:31]
  s_lshl_b32 s59, s40, 11
  s_add_u32 s59, s59, 98304
  v_add_u32 v18, s59, v4
  ds_write_b128 v18, v[200:203] offset:16384
  ds_write_b128 v18, v[216:219] offset:17408
  v_mfma_f32_16x16x32_bf16 v[128:131], v[180:183], v[100:103], v[128:131]
  ds_read_b128 v[176:179], v1 offset:4096
  v_exp_f32 v14, v156
  v_mfma_f32_16x16x32_bf16 v[136:139], v[180:183], v[116:119], v[136:139]
  s_lshl_b32 s59, s40, 11
  s_add_u32 s59, s59, 98304
  v_add_u32 v18, s59, v4
  ds_write_b128 v18, v[204:207] offset:24576
  ds_write_b128 v18, v[220:223] offset:25600
  s_waitcnt lgkmcnt(5)
  v_mfma_f32_16x16x32_bf16 v[128:131], v[184:187], v[104:107], v[128:131]
  ds_read_b128 v[180:183], v1 offset:4608
  v_exp_f32 v15, v157
  v_mfma_f32_16x16x32_bf16 v[136:139], v[184:187], v[120:123], v[136:139]
  s_lshl_b32 s59, s40, 13
  s_add_u32 s59, s59, 131072
  v_add_u32 v18, s59, v4
  ds_read_b128 v[192:195], v18 offset:0
  ds_read_b128 v[208:211], v18 offset:4096
  ds_read_b128 v[196:199], v18 offset:1024
  ds_read_b128 v[212:215], v18 offset:5120
  v_mfma_f32_16x16x32_bf16 v[128:131], v[188:191], v[108:111], v[128:131]
  ds_read_b128 v[184:187], v1 offset:5120
  v_cvt_pk_bf16_f32 v170, v12, v13
  v_add_f32 v7, v7, v12
  v_add_f32 v7, v7, v13
  v_mfma_f32_16x16x32_bf16 v[136:139], v[188:191], v[124:127], v[136:139]
  ds_read_b128 v[200:203], v18 offset:2048
  ds_read_b128 v[216:219], v18 offset:6144
  ds_read_b128 v[204:207], v18 offset:3072
  ds_read_b128 v[220:223], v18 offset:7168
  s_waitcnt lgkmcnt(9)
  v_mfma_f32_16x16x32_bf16 v[132:135], v[176:179], v[96:99], v[24:27]
  ds_read_b128 v[188:191], v1 offset:5632
  v_exp_f32 v12, v150
  v_exp_f32 v13, v151
  v_mfma_f32_16x16x32_bf16 v[140:143], v[176:179], v[112:115], v[28:31]
  v_cvt_pk_bf16_f32 v174, v14, v15
  s_waitcnt lgkmcnt(1)
  s_barrier
  v_mfma_f32_16x16x32_bf16 v[132:135], v[180:183], v[100:103], v[132:135]
  ds_read_b64_tr_b16 v[176:177], v2 offset:16384
  ds_read_b64_tr_b16 v[178:179], v2 offset:20480
  v_add_f32 v8, v8, v14
  v_add_f32 v8, v8, v15
  v_mfma_f32_16x16x32_bf16 v[140:143], v[180:183], v[116:119], v[140:143]
  v_exp_f32 v14, v158
  v_exp_f32 v15, v159
  v_mfma_f32_16x16x32_bf16 v[132:135], v[184:187], v[104:107], v[132:135]
  ds_read_b64_tr_b16 v[180:181], v3 offset:16384
  ds_read_b64_tr_b16 v[182:183], v3 offset:20480
  v_cvt_pk_bf16_f32 v171, v12, v13
  v_add_f32 v7, v7, v12
  v_add_f32 v7, v7, v13
  v_mfma_f32_16x16x32_bf16 v[140:143], v[184:187], v[120:123], v[140:143]
  v_cvt_pk_bf16_f32 v175, v14, v15
  v_add_f32 v8, v8, v14
  v_add_f32 v8, v8, v15
  s_waitcnt lgkmcnt(2)
  v_mfma_f32_16x16x32_bf16 v[132:135], v[188:191], v[108:111], v[132:135]
  ds_read_b64_tr_b16 v[184:185], v2 offset:16896
  ds_read_b64_tr_b16 v[186:187], v2 offset:20992
  v_mfma_f32_16x16x32_bf16 v[140:143], v[188:191], v[124:127], v[140:143]
  v_max_f32 v12, v7, v8
  v_cmp_nge_f32 vcc, s49, v12
  s_nop 0
  s_cbranch_vccnz L_rare_14
L_back_15:
  v_add_f32 v5, v5, v7
  v_add_f32 v6, v6, v8
  v_mfma_f32_16x16x32_bf16 v[32:35], v[176:179], v[168:171], v[32:35]
  ds_read_b64_tr_b16 v[188:189], v3 offset:16896
  ds_read_b64_tr_b16 v[190:191], v3 offset:20992
  v_mfma_f32_16x16x32_bf16 v[64:67], v[176:179], v[172:175], v[64:67]
  s_waitcnt lgkmcnt(2)
  v_mfma_f32_16x16x32_bf16 v[36:39], v[180:183], v[168:171], v[36:39]
  ds_read_b64_tr_b16 v[176:177], v2 offset:17408
  ds_read_b64_tr_b16 v[178:179], v2 offset:21504
  v_exp_f32 v12, v128
  v_mfma_f32_16x16x32_bf16 v[68:71], v[180:183], v[172:175], v[68:71]
  v_exp_f32 v13, v129
  v_mfma_f32_16x16x32_bf16 v[40:43], v[184:187], v[168:171], v[40:43]
  ds_read_b64_tr_b16 v[180:181], v3 offset:17408
  ds_read_b64_tr_b16 v[182:183], v3 offset:21504
  v_exp_f32 v14, v136
  v_mfma_f32_16x16x32_bf16 v[72:75], v[184:187], v[172:175], v[72:75]
  v_exp_f32 v15, v137
  s_waitcnt lgkmcnt(2)
  v_mfma_f32_16x16x32_bf16 v[44:47], v[188:191], v[168:171], v[44:47]
  ds_read_b64_tr_b16 v[184:185], v2 offset:17920
  ds_read_b64_tr_b16 v[186:187], v2 offset:22016
  v_cvt_pk_bf16_f32 v160, v12, v13
  v_mfma_f32_16x16x32_bf16 v[76:79], v[188:191], v[172:175], v[76:79]
  v_add_f32 v7, v12, v13
  v_mfma_f32_16x16x32_bf16 v[48:51], v[176:179], v[168:171], v[48:51]
  ds_read_b64_tr_b16 v[188:189], v3 offset:17920
  ds_read_b64_tr_b16 v[190:191], v3 offset:22016
  v_exp_f32 v12, v130
  v_mfma_f32_16x16x32_bf16 v[80:83], v[176:179], v[172:175], v[80:83]
  v_exp_f32 v13, v131
  s_waitcnt lgkmcnt(2)
  v_mfma_f32_16x16x32_bf16 v[52:55], v[180:183], v[168:171], v[52:55]
  ds_read_b128 v[176:179], v1 offset:8192
  v_cvt_pk_bf16_f32 v164, v14, v15
  v_add_f32 v8, v14, v15
  v_mfma_f32_16x16x32_bf16 v[84:87], v[180:183], v[172:175], v[84:87]
  v_exp_f32 v14, v138
  v_mfma_f32_16x16x32_bf16 v[56:59], v[184:187], v[168:171], v[56:59]
  ds_read_b128 v[180:183], v1 offset:8704
  v_exp_f32 v15, v139
  v_cvt_pk_bf16_f32 v161, v12, v13
  v_mfma_f32_16x16x32_bf16 v[88:91], v[184:187], v[172:175], v[88:91]
  v_add_f32 v7, v7, v12
  v_add_f32 v7, v7, v13
  s_waitcnt lgkmcnt(1)
  v_mfma_f32_16x16x32_bf16 v[60:63], v[188:191], v[168:171], v[60:63]
  ds_read_b128 v[184:187], v1 offset:9216
  v_exp_f32 v12, v132
  v_mfma_f32_16x16x32_bf16 v[92:95], v[188:191], v[172:175], v[92:95]
  v_exp_f32 v13, v133
  v_mfma_f32_16x16x32_bf16 v[144:147], v[176:179], v[96:99], v[24:27]
  ds_read_b128 v[188:191], v1 offset:9728
  v_cvt_pk_bf16_f32 v165, v14, v15
  v_add_f32 v8, v8, v14
  v_mfma_f32_16x16x32_bf16 v[152:155], v[176:179], v[112:115], v[28:31]
  v_add_f32 v8, v8, v15
  v_exp_f32 v14, v140
  s_waitcnt lgkmcnt(1)
  v_mfma_f32_16x16x32_bf16 v[144:147], v[180:183], v[100:103], v[144:147]
  ds_read_b128 v[176:179], v1 offset:12288
  v_exp_f32 v15, v141
  v_mfma_f32_16x16x32_bf16 v[152:155], v[180:183], v[116:119], v[152:155]
  v_cvt_pk_bf16_f32 v162, v12, v13
  v_add_f32 v7, v7, v12
  v_mfma_f32_16x16x32_bf16 v[144:147], v[184:187], v[104:107], v[144:147]
  ds_read_b128 v[180:183], v1 offset:12800
  v_add_f32 v7, v7, v13
  v_exp_f32 v12, v134
  v_mfma_f32_16x16x32_bf16 v[152:155], v[184:187], v[120:123], v[152:155]
  v_exp_f32 v13, v135
  s_waitcnt lgkmcnt(1)
  v_mfma_f32_16x16x32_bf16 v[144:147], v[188:191], v[108:111], v[144:147]
  ds_read_b128 v[184:187], v1 offset:13312
  v_cvt_pk_bf16_f32 v166, v14, v15
  v_mfma_f32_16x16x32_bf16 v[152:155], v[188:191], v[124:127], v[152:155]
  v_add_f32 v8, v8, v14
  v_add_f32 v8, v8, v15
  v_mfma_f32_16x16x32_bf16 v[148:151], v[176:179], v[96:99], v[24:27]
  ds_read_b128 v[188:191], v1 offset:13824
  v_exp_f32 v14, v142
  v_mfma_f32_16x16x32_bf16 v[156:159], v[176:179], v[112:115], v[28:31]
  v_exp_f32 v15, v143
  v_cvt_pk_bf16_f32 v163, v12, v13
  s_waitcnt lgkmcnt(1)
  v_mfma_f32_16x16x32_bf16 v[148:151], v[180:183], v[100:103], v[148:151]
  ds_read_b64_tr_b16 v[176:177], v2 offset:24576
  ds_read_b64_tr_b16 v[178:179], v2 offset:28672
  v_add_f32 v7, v7, v12
  v_add_f32 v7, v7, v13
  v_mfma_f32_16x16x32_bf16 v[156:159], v[180:183], v[116:119], v[156:159]
  v_cvt_pk_bf16_f32 v167, v14, v15
  v_add_f32 v8, v8, v14
  v_mfma_f32_16x16x32_bf16 v[148:151], v[184:187], v[104:107], v[148:151]
  ds_read_b64_tr_b16 v[180:181], v3 offset:24576
  ds_read_b64_tr_b16 v[182:183], v3 offset:28672
  v_mfma_f32_16x16x32_bf16 v[156:159], v[184:187], v[120:123], v[156:159]
  v_add_f32 v8, v8, v15
  s_waitcnt lgkmcnt(2)
  v_mfma_f32_16x16x32_bf16 v[148:151], v[188:191], v[108:111], v[148:151]
  ds_read_b64_tr_b16 v[184:185], v2 offset:25088
  ds_read_b64_tr_b16 v[186:187], v2 offset:29184
  v_mfma_f32_16x16x32_bf16 v[156:159], v[188:191], v[124:127], v[156:159]
  v_max_f32 v12, v7, v8
  v_cmp_nge_f32 vcc, s49, v12
  s_nop 0
  s_cbranch_vccnz L_rare_16
L_back_17:
  v_add_f32 v5, v5, v7
  v_add_f32 v6, v6, v8
  v_mfma_f32_16x16x32_bf16 v[32:35], v[176:179], v[160:163], v[32:35]
  ds_read_b64_tr_b16 v[188:189], v3 offset:25088
  ds_read_b64_tr_b16 v[190:191], v3 offset:29184
  s_add_u32 s51, s51, 1
  s_cmp_eq_u32 s51, 3
  s_cselect_b32 s61, s57, s56
  s_cselect_b32 s51, 0, s51
  s_add_u32 s44, s44, 1
  v_mfma_f32_16x16x32_bf16 v[64:67], v[176:179], v[164:167], v[64:67]
  v_add_u32 v1, s61, v1
  s_waitcnt lgkmcnt(2)
  v_mfma_f32_16x16x32_bf16 v[36:39], v[180:183], v[160:163], v[36:39]
  ds_read_b64_tr_b16 v[176:177], v2 offset:25600
  ds_read_b64_tr_b16 v[178:179], v2 offset:29696
  v_exp_f32 v12, v144
  v_mfma_f32_16x16x32_bf16 v[68:71], v[180:183], v[164:167], v[68:71]
  v_exp_f32 v13, v145
  v_mfma_f32_16x16x32_bf16 v[40:43], v[184:187], v[160:163], v[40:43]
  ds_read_b64_tr_b16 v[180:181], v3 offset:25600
  ds_read_b64_tr_b16 v[182:183], v3 offset:29696
  v_exp_f32 v14, v152
  v_mfma_f32_16x16x32_bf16 v[72:75], v[184:187], v[164:167], v[72:75]
  v_exp_f32 v15, v153
  v_cvt_pk_bf16_f32 v168, v12, v13
  s_waitcnt lgkmcnt(2)
  v_mfma_f32_16x16x32_bf16 v[44:47], v[188:191], v[160:163], v[44:47]
  ds_read_b64_tr_b16 v[184:185], v2 offset:26112
  ds_read_b64_tr_b16 v[186:187], v2 offset:30208
  v_add_f32 v7, v12, v13
  v_exp_f32 v12, v146
  v_mfma_f32_16x16x32_bf16 v[76:79], v[188:191], v[164:167], v[76:79]
  v_exp_f32 v13, v147
  v_mfma_f32_16x16x32_bf16 v[48:51], v[176:179], v[160:163], v[48:51]
  ds_read_b64_tr_b16 v[188:189], v3 offset:26112
  ds_read_b64_tr_b16 v[190:191], v3 offset:30208
  v_cvt_pk_bf16_f32 v172, v14, v15
  v_mfma_f32_16x16x32_bf16 v[80:83], v[176:179], v[164:167], v[80:83]
  v_add_f32 v8, v14, v15
  v_exp_f32 v14, v154
  s_waitcnt lgkmcnt(2)
  v_mfma_f32_16x16x32_bf16 v[52:55], v[180:183], v[160:163], v[52:55]
  v_add_u32 v2, s61, v2
  v_add_u32 v3, s61, v3
  v_exp_f32 v15, v155
  v_mfma_f32_16x16x32_bf16 v[84:87], v[180:183], v[164:167], v[84:87]
  v_cvt_pk_bf16_f32 v169, v12, v13
  v_add_f32 v7, v7, v12
  s_waitcnt lgkmcnt(0)
  s_branch L_loop2_0
L_hook2:
  s_cmp_eq_u32 s44, 24
  s_cbranch_scc1 L_hk23_2
  s_cmp_eq_u32 s44, 26
  s_cbranch_scc1 L_hk25_2
  s_cmp_eq_u32 s44, 27
  s_cbranch_scc1 L_hk26_2
  s_cmp_eq_u32 s44, 29
  s_cbranch_scc1 L_hk28_2
L_hk21_2:
  s_lshl_b32 s59, s40, 11
  s_add_u32 s59, s59, 98304
  v_add_u32 v18, s59, v4
  ds_write_b128 v18, v[224:227] offset:0
  ds_write_b128 v18, v[240:243] offset:1024
  s_lshl_b32 s59, s40, 11
  s_add_u32 s59, s59, 98304
  v_add_u32 v18, s59, v4
  ds_write_b128 v18, v[228:231] offset:8192
  ds_write_b128 v18, v[244:247] offset:9216
  s_branch L_hookback2_0
L_hk23_2:
  s_lshl_b32 s59, s40, 11
  s_add_u32 s59, s59, 98304
  v_add_u32 v18, s59, v4
  ds_write_b128 v18, v[232:235] offset:16384
  ds_write_b128 v18, v[248:251] offset:17408
  s_branch L_hookback2_0
L_hk25_2:
  s_lshl_b32 s59, s40, 11
  s_add_u32 s59, s59, 98304
  v_add_u32 v18, s59, v4
  ds_write_b128 v18, v[236:239] offset:24576
  ds_write_b128 v18, v[252:255] offset:25600
  s_lshl_b32 s59, s40, 11
  s_add_u32 s59, s59, 98304
  v_add_u32 v18, s59, v4
  ds_write_b128 v18, v[192:195] offset:0
  ds_write_b128 v18, v[208:211] offset:1024
  s_branch L_hookback2_0
L_hk26_2:
  s_lshl_b32 s59, s40, 11
  s_add_u32 s59, s59, 98304
  v_add_u32 v18, s59, v4
  ds_write_b128 v18, v[196:199] offset:8192
  ds_write_b128 v18, v[212:215] offset:9216
  s_branch L_hookback2_0
L_hk28_2:
  s_lshl_b32 s59, s40, 11
  s_add_u32 s59, s59, 98304
  v_add_u32 v18, s59, v4
  ds_write_b128 v18, v[200:203] offset:16384
  ds_write_b128 v18, v[216:219] offset:17408
  s_lshl_b32 s59, s40, 11
  s_add_u32 s59, s59, 98304
  v_add_u32 v18, s59, v4
  ds_write_b128 v18, v[204:207] offset:24576
  ds_write_b128 v18, v[220:223] offset:25600
  s_branch L_hookback2_0
L_last2:
  s_barrier
  ds_read_b64_tr_b16 v[176:177], v2 offset:16384
  ds_read_b64_tr_b16 v[178:179], v2 offset:20480
  ds_read_b64_tr_b16 v[180:181], v3 offset:16384
  ds_read_b64_tr_b16 v[182:183], v3 offset:20480
  v_mfma_f32_16x16x32_bf16 v[56:59], v[184:187], v[160:163], v[56:59]
  v_add_f32 v7, v7, v13
  v_exp_f32 v12, v148
  v_exp_f32 v13, v149
  v_cvt_pk_bf16_f32 v173, v14, v15
  v_add_f32 v8, v8, v14
  v_add_f32 v8, v8, v15
  v_mfma_f32_16x16x32_bf16 v[88:91], v[184:187], v[164:167], v[88:91]
  v_exp_f32 v14, v156
  v_exp_f32 v15, v157
  v_cvt_pk_bf16_f32 v170, v12, v13
  v_add_f32 v7, v7, v12
  v_add_f32 v7, v7, v13
  v_exp_f32 v12, v150
  v_mfma_f32_16x16x32_bf16 v[60:63], v[188:191], v[160:163], v[60:63]
  ds_read_b64_tr_b16 v[184:185], v2 offset:16896
  ds_read_b64_tr_b16 v[186:187], v2 offset:20992
  v_exp_f32 v13, v151
  v_cvt_pk_bf16_f32 v174, v14, v15
  v_add_f32 v8, v8, v14
  v_add_f32 v8, v8, v15
  v_exp_f32 v14, v158
  v_exp_f32 v15, v159
  v_cvt_pk_bf16_f32 v171, v12, v13
  v_mfma_f32_16x16x32_bf16 v[92:95], v[188:191], v[164:167], v[92:95]
  v_add_f32 v7, v7, v12
  v_add_f32 v7, v7, v13
  v_cvt_pk_bf16_f32 v175, v14, v15
  v_add_f32 v8, v8, v14
  v_add_f32 v8, v8, v15
  v_max_f32 v12, v7, v8
  v_cmp_nge_f32 vcc, s49, v12
  s_nop 0
  s_cbranch_vccnz L_rare_18
L_back_19:
  v_add_f32 v5, v5, v7
  v_add_f32 v6, v6, v8
  s_waitcnt lgkmcnt(2)
  v_mfma_f32_16x16x32_bf16 v[32:35], v[176:179], v[168:171], v[32:35]
  ds_read_b64_tr_b16 v[188:189], v3 offset:16896
  ds_read_b64_tr_b16 v[190:191], v3 offset:20992
  v_mov_b32 v16, v5
  v_mfma_f32_16x16x32_bf16 v[64:67], v[176:179], v[172:175], v[64:67]
  v_mov_b32 v17, v6
  v_mfma_f32_16x16x32_bf16 v[36:39], v[180:183], v[168:171], v[36:39]
  ds_read_b64_tr_b16 v[176:177], v2 offset:17408
  ds_read_b64_tr_b16 v[178:179], v2 offset:21504
  v_permlane16_swap_b32 v5, v16
  v_mfma_f32_16x16x32_bf16 v[68:71], v[180:183], v[172:175], v[68:71]
  v_permlane16_swap_b32 v6, v17
  s_waitcnt lgkmcnt(2)
  v_mfma_f32_16x16x32_bf16 v[40:43], v[184:187], v[168:171], v[40:43]
  ds_read_b64_tr_b16 v[180:181], v3 offset:17408
  ds_read_b64_tr_b16 v[182:183], v3 offset:21504
  v_add_f32 v5, v5, v16
  v_mfma_f32_16x16x32_bf16 v[72:75], v[184:187], v[172:175], v[72:75]
  v_add_f32 v6, v6, v17
  v_mfma_f32_16x16x32_bf16 v[44:47], v[188:191], v[168:171], v[44:47]
  ds_read_b64_tr_b16 v[184:185], v2 offset:17920
  ds_read_b64_tr_b16 v[186:187], v2 offset:22016
  v_mfma_f32_16x16x32_bf16 v[76:79], v[188:191], v[172:175], v[76:79]
  v_mov_b32 v16, v5
  s_waitcnt lgkmcnt(2)
  v_mfma_f32_16x16x32_bf16 v[48:51], v[176:179], v[168:171], v[48:51]
  ds_read_b64_tr_b16 v[188:189], v3 offset:17920
  ds_read_b64_tr_b16 v[190:191], v3 offset:22016
  v_mov_b32 v17, v6
  v_mfma_f32_16x16x32_bf16 v[80:83], v[176:179], v[172:175], v[80:83]
  v_permlane32_swap_b32 v5, v16
  v_mfma_f32_16x16x32_bf16 v[52:55], v[180:183], v[168:171], v[52:55]
  v_permlane32_swap_b32 v6, v17
  v_mfma_f32_16x16x32_bf16 v[84:87], v[180:183], v[172:175], v[84:87]
  v_add_f32 v5, v5, v16
  s_waitcnt lgkmcnt(0)
  v_mfma_f32_16x16x32_bf16 v[56:59], v[184:187], v[168:171], v[56:59]
  v_add_f32 v6, v6, v17
  v_mfma_f32_16x16x32_bf16 v[88:91], v[184:187], v[172:175], v[88:91]
  v_rcp_f32 v16, v5
  v_mfma_f32_16x16x32_bf16 v[60:63], v[188:191], v[168:171], v[60:63]
  v_rcp_f32 v17, v6
  v_mfma_f32_16x16x32_bf16 v[92:95], v[188:191], v[172:175], v[92:95]
  s_lshl_b32 s59, s40, 11
  s_add_u32 s59, s59, 32768
  v_add_u32 v18, s59, v4
  v_mul_f32 v32, v32, v16
  v_mul_f32 v33, v33, v16
  v_mul_f32 v34, v34, v16
  v_mul_f32 v35, v35, v16
  v_mul_f32 v36, v36, v16
  v_mul_f32 v37, v37, v16
  v_mul_f32 v38, v38, v16
  v_mul_f32 v39, v39, v16
  v_cvt_pk_bf16_f32 v224, v32, v33
  v_cvt_pk_bf16_f32 v225, v34, v35
  v_cvt_pk_bf16_f32 v226, v36, v37
  v_cvt_pk_bf16_f32 v227, v38, v39
  ds_write_b128 v18, v[224:227] offset:0
  v_mul_f32 v64, v64, v17
  v_mul_f32 v65, v65, v17
  v_mul_f32 v66, v66, v17
  v_mul_f32 v67, v67, v17
  v_mul_f32 v68, v68, v17
  v_mul_f32 v69, v69, v17
  v_mul_f32 v70, v70, v17
  v_mul_f32 v71, v71, v17
  v_cvt_pk_bf16_f32 v240, v64, v65
  v_cvt_pk_bf16_f32 v241, v66, v67
  v_cvt_pk_bf16_f32 v242, v68, v69
  v_cvt_pk_bf16_f32 v243, v70, v71
  ds_write_b128 v18, v[240:243] offset:1024
  v_mul_f32 v40, v40, v16
  v_mul_f32 v41, v41, v16
  v_mul_f32 v42, v42, v16
  v_mul_f32 v43, v43, v16
  v_mul_f32 v44, v44, v16
  v_mul_f32 v45, v45, v16
  v_mul_f32 v46, v46, v16
  v_mul_f32 v47, v47, v16
  v_cvt_pk_bf16_f32 v228, v40, v41
  v_cvt_pk_bf16_f32 v229, v42, v43
  v_cvt_pk_bf16_f32 v230, v44, v45
  v_cvt_pk_bf16_f32 v231, v46, v47
  ds_write_b128 v18, v[228:231] offset:8192
  v_mul_f32 v72, v72, v17
  v_mul_f32 v73, v73, v17
  v_mul_f32 v74, v74, v17
  v_mul_f32 v75, v75, v17
  v_mul_f32 v76, v76, v17
  v_mul_f32 v77, v77, v17
  v_mul_f32 v78, v78, v17
  v_mul_f32 v79, v79, v17
  v_cvt_pk_bf16_f32 v244, v72, v73
  v_cvt_pk_bf16_f32 v245, v74, v75
  v_cvt_pk_bf16_f32 v246, v76, v77
  v_cvt_pk_bf16_f32 v247, v78, v79
  ds_write_b128 v18, v[244:247] offset:9216
  v_mul_f32 v48, v48, v16
  v_mul_f32 v49, v49, v16
  v_mul_f32 v50, v50, v16
  v_mul_f32 v51, v51, v16
  v_mul_f32 v52, v52, v16
  v_mul_f32 v53, v53, v16
  v_mul_f32 v54, v54, v16
  v_mul_f32 v55, v55, v16
  v_cvt_pk_bf16_f32 v232, v48, v49
  v_cvt_pk_bf16_f32 v233, v50, v51
  v_cvt_pk_bf16_f32 v234, v52, v53
  v_cvt_pk_bf16_f32 v235, v54, v55
  ds_write_b128 v18, v[232:235] offset:16384
  v_mul_f32 v80, v80, v17
  v_mul_f32 v81, v81, v17
  v_mul_f32 v82, v82, v17
  v_mul_f32 v83, v83, v17
  v_mul_f32 v84, v84, v17
  v_mul_f32 v85, v85, v17
  v_mul_f32 v86, v86, v17
  v_mul_f32 v87, v87, v17
  v_cvt_pk_bf16_f32 v248, v80, v81
  v_cvt_pk_bf16_f32 v249, v82, v83
  v_cvt_pk_bf16_f32 v250, v84, v85
  v_cvt_pk_bf16_f32 v251, v86, v87
  ds_write_b128 v18, v[248:251] offset:17408
  v_mul_f32 v56, v56, v16
  v_mul_f32 v57, v57, v16
  v_mul_f32 v58, v58, v16
  v_mul_f32 v59, v59, v16
  v_mul_f32 v60, v60, v16
  v_mul_f32 v61, v61, v16
  v_mul_f32 v62, v62, v16
  v_mul_f32 v63, v63, v16
  v_cvt_pk_bf16_f32 v236, v56, v57
  v_cvt_pk_bf16_f32 v237, v58, v59
  v_cvt_pk_bf16_f32 v238, v60, v61
  v_cvt_pk_bf16_f32 v239, v62, v63
  ds_write_b128 v18, v[236:239] offset:24576
  v_mul_f32 v88, v88, v17
  v_mul_f32 v89, v89, v17
  v_mul_f32 v90, v90, v17
  v_mul_f32 v91, v91, v17
  v_mul_f32 v92, v92, v17
  v_mul_f32 v93, v93, v17
  v_mul_f32 v94, v94, v17
  v_mul_f32 v95, v95, v17
  v_cvt_pk_bf16_f32 v252, v88, v89
  v_cvt_pk_bf16_f32 v253, v90, v91
  v_cvt_pk_bf16_f32 v254, v92, v93
  v_cvt_pk_bf16_f32 v255, v94, v95
  ds_write_b128 v18, v[252:255] offset:25600
  s_waitcnt vmcnt(0) lgkmcnt(0)
  s_barrier
  s_barrier
  s_branch L_red2
L_att1:
  s_barrier
  s_lshl_b32 s59, s40, 13
  s_add_u32 s59, s59, 65536
  v_add_u32 v18, s59, v4
  ds_read_b128 v[96:99], v18 offset:0
  ds_read_b128 v[100:103], v18 offset:1024
  ds_read_b128 v[104:107], v18 offset:2048
  ds_read_b128 v[108:111], v18 offset:3072
  s_mov_b32 s52, 32768
  s_lshr_b32 s53, s46, 1
  s_lshl_b32 s53, s53, 7
  s_add_u32 s53, s53, 24576
  ds_read_b128 v[176:179], v1 offset:0
  ds_read_b128 v[180:183], v1 offset:512
  ds_read_b128 v[184:187], v1 offset:1024
  s_waitcnt lgkmcnt(1)
  v_mfma_f32_16x16x32_bf16 v[128:131], v[176:179], v[96:99], 0
  ds_read_b128 v[188:191], v1 offset:1536
  v_mfma_f32_16x16x32_bf16 v[128:131], v[180:183], v[100:103], v[128:131]
  ds_read_b128 v[176:179], v1 offset:4096
  s_waitcnt lgkmcnt(1)
  v_mfma_f32_16x16x32_bf16 v[128:131], v[184:187], v[104:107], v[128:131]
  ds_read_b128 v[180:183], v1 offset:4608
  v_mfma_f32_16x16x32_bf16 v[128:131], v[188:191], v[108:111], v[128:131]
  ds_read_b128 v[184:187], v1 offset:5120
  s_waitcnt lgkmcnt(1)
  v_mfma_f32_16x16x32_bf16 v[132:135], v[176:179], v[96:99], 0
  ds_read_b128 v[188:191], v1 offset:5632
  s_barrier
  v_mfma_f32_16x16x32_bf16 v[132:135], v[180:183], v[100:103], v[132:135]
  ds_read_b128 v[176:179], v1 offset:8192
  s_waitcnt lgkmcnt(1)
  v_mfma_f32_16x16x32_bf16 v[132:135], v[184:187], v[104:107], v[132:135]
  ds_read_b128 v[180:183], v1 offset:8704
  v_mfma_f32_16x16x32_bf16 v[132:135], v[188:191], v[108:111], v[132:135]
  ds_read_b128 v[184:187], v1 offset:9216
  v_max3_f32 v12, v128, v129, v130
  s_nop 5
  v_max3_f32 v13, v131, v132, v133
  v_max3_f32 v12, v12, v134, v135
  v_max_f32 v12, v12, v13
  v_mov_b32 v13, v12
  s_nop 1
  v_permlane16_swap_b32 v12, v13
  v_max_f32 v12, v12, v13
  v_mov_b32 v13, v12
  s_nop 1
  v_permlane32_swap_b32 v12, v13
  v_max_f32 v12, v12, v13
  v_sub_f32 v24, 0, v12
  v_sub_f32 v25, 0, v12
  v_sub_f32 v26, 0, v12
  v_sub_f32 v27, 0, v12
  s_waitcnt lgkmcnt(1)
  s_nop 0
  v_mfma_f32_16x16x32_bf16 v[144:147], v[176:179], v[96:99], v[24:27]
  ds_read_b128 v[188:191], v1 offset:9728
  v_add_f32 v128, v128, v24
  v_add_f32 v129, v129, v24
  v_add_f32 v130, v130, v24
  v_add_f32 v131, v131, v24
  v_add_f32 v132, v132, v24
  buffer_load_dwordx4 v[64:67], v23, s[76:79], s80 offen
  s_add_u32 s80, s80, s81
  buffer_load_dwordx4 v[68:71], v23, s[76:79], s80 offen
  s_and_b32 s59, s44, s83
  s_cmp_eq_u32 s59, s83
  s_cselect_b32 s59, s82, s81
  s_add_u32 s80, s80, s59
  s_add_u32 m0, s58, 0
  s_nop 0
  buffer_load_dwordx4 v20, s[8:11], s52 offen nt lds
  s_add_u32 m0, s58, 896
  s_nop 0
  buffer_load_dwordx4 v20, s[8:11], s52 offen offset:128 nt lds
  v_mfma_f32_16x16x32_bf16 v[144:147], v[180:183], v[100:103], v[144:147]
  ds_read_b128 v[176:179], v1 offset:12288
  v_add_f32 v133, v133, v24
  v_add_f32 v134, v134, v24
  v_add_f32 v135, v135, v24
  v_exp_f32 v12, v128
  s_add_u32 m0, s58, 0
  s_nop 0
  buffer_load_dwordx4 v21, s[8:11], s52 offen offset:2048 nt lds
  s_add_u32 m0, s58, 896
  s_nop 0
  buffer_load_dwordx4 v21, s[8:11], s52 offen offset:2176 nt lds
  s_waitcnt lgkmcnt(1)
  v_mfma_f32_16x16x32_bf16 v[144:147], v[184:187], v[104:107], v[144:147]
  ds_read_b128 v[180:183], v1 offset:12800
  v_exp_f32 v13, v129
  v_exp_f32 v14, v130
  s_add_u32 s52, s52, 4096
  s_add_u32 m0, s58, 4096
  s_nop 0
  buffer_load_dwordx4 v20, s[8:11], s52 offen nt lds
  s_add_u32 m0, s58, 4992
  s_nop 0
  buffer_load_dwordx4 v20, s[8:11], s52 offen offset:128 nt lds
  s_add_u32 m0, s58, 4096
  s_nop 0
  buffer_load_dwordx4 v21, s[8:11], s52 offen offset:2048 nt lds
  v_mfma_f32_16x16x32_bf16 v[144:147], v[188:191], v[108:111], v[144:147]
  ds_read_b128 v[184:187], v1 offset:13312
  v_exp_f32 v15, v131
  v_cvt_pk_bf16_f32 v160, v12, v13
  v_add_f32 v7, v12, v13
  v_exp_f32 v12, v132
  s_add_u32 m0, s58, 4992
  s_nop 0
  buffer_load_dwordx4 v21, s[8:11], s52 offen offset:2176 nt lds
  s_add_u32 s52, s52, 4096
  s_add_u32 m0, s58, 8192
  s_nop 0
  buffer_load_dwordx4 v20, s[8:11], s52 offen nt lds
  s_waitcnt lgkmcnt(1)
  v_mfma_f32_16x16x32_bf16 v[148:151], v[176:179], v[96:99], v[24:27]
  ds_read_b128 v[188:191], v1 offset:13824
  v_exp_f32 v13, v133
  v_cvt_pk_bf16_f32 v161, v14, v15
  v_add_f32 v7, v7, v14
  s_add_u32 m0, s58, 9088
  s_nop 0
  buffer_load_dwordx4 v20, s[8:11], s52 offen offset:128 nt lds
  s_add_u32 m0, s58, 8192
  s_nop 0
  buffer_load_dwordx4 v21, s[8:11], s52 offen offset:2048 nt lds
  s_add_u32 m0, s58, 9088
  s_nop 0
  buffer_load_dwordx4 v21, s[8:11], s52 offen offset:2176 nt lds
  v_mfma_f32_16x16x32_bf16 v[148:151], v[180:183], v[100:103], v[148:151]
  ds_read_b64_tr_b16 v[176:177], v2 offset:24576
  ds_read_b64_tr_b16 v[178:179], v2 offset:28672
  v_add_f32 v7, v7, v15
  v_exp_f32 v14, v134
  v_exp_f32 v15, v135
  s_add_u32 s52, s52, 4096
  s_add_u32 m0, s58, 12288
  s_nop 0
  buffer_load_dwordx4 v20, s[8:11], s52 offen nt lds
  s_add_u32 m0, s58, 13184
  s_nop 0
  buffer_load_dwordx4 v20, s[8:11], s52 offen offset:128 nt lds
  s_waitcnt lgkmcnt(2)
  v_mfma_f32_16x16x32_bf16 v[148:151], v[184:187], v[104:107], v[148:151]
  ds_read_b64_tr_b16 v[180:181], v3 offset:24576
  ds_read_b64_tr_b16 v[182:183], v3 offset:28672
  v_cvt_pk_bf16_f32 v162, v12, v13
  v_add_f32 v7, v7, v12
  v_add_f32 v7, v7, v13
  s_add_u32 m0, s58, 12288
  s_nop 0
  buffer_load_dwordx4 v21, s[8:11], s52 offen offset:2048 nt lds
  s_add_u32 m0, s58, 13184
  s_nop 0
  buffer_load_dwordx4 v21, s[8:11], s52 offen offset:2176 nt lds
  v_mfma_f32_16x16x32_bf16 v[148:151], v[188:191], v[108:111], v[148:151]
  ds_read_b64_tr_b16 v[184:185], v2 offset:25088
  ds_read_b64_tr_b16 v[186:187], v2 offset:29184
  v_cvt_pk_bf16_f32 v163, v14, v15
  v_add_f32 v7, v7, v14
  v_add_f32 v7, v7, v15
  v_mov_b32 v5, v7
  s_xor_b32 s70, s53, 128
  s_add_u32 m0, s58, 16384
  s_nop 0
  buffer_load_dwordx4 v22, s[12:15], s53 offen nt lds
  s_add_u32 m0, s58, 17408
  s_nop 0
  buffer_load_dwordx4 v22, s[12:15], s70 offen nt lds
  s_add_u32 m0, s58, 16384
  s_nop 0
  buffer_load_dwordx4 v22, s[12:15], s53 offen offset:2048 nt lds
  s_waitcnt lgkmcnt(2)
  v_mfma_f32_16x16x32_bf16 v[32:35], v[176:179], v[160:163], 0
  ds_read_b64_tr_b16 v[188:189], v3 offset:25088
  ds_read_b64_tr_b16 v[190:191], v3 offset:29184
  v_mov_b32 v56, 0
  v_mov_b32 v57, 0
  v_mov_b32 v58, 0
  v_mov_b32 v59, 0
  v_mov_b32 v60, 0
  v_mov_b32 v61, 0
  v_mov_b32 v62, 0
  v_mov_b32 v63, 0
  s_add_u32 s51, s51, 1
  s_cmp_eq_u32 s51, 3
  s_cselect_b32 s61, s57, s56
  s_cselect_b32 s51, 0, s51
  s_add_u32 s44, s44, 1
  v_add_u32 v1, s61, v1
  s_add_u32 m0, s58, 17408
  s_nop 0
  buffer_load_dwordx4 v22, s[12:15], s70 offen offset:2048 nt lds
  s_add_u32 s53, s53, 4096
  s_xor_b32 s70, s53, 128
  s_add_u32 m0, s58, 20480
  s_nop 0
  buffer_load_dwordx4 v22, s[12:15], s53 offen nt lds
  v_mfma_f32_16x16x32_bf16 v[36:39], v[180:183], v[160:163], 0
  ds_read_b64_tr_b16 v[176:177], v2 offset:25600
  ds_read_b64_tr_b16 v[178:179], v2 offset:29696
  v_exp_f32 v12, v144
  s_add_u32 m0, s58, 21504
  s_nop 0
  buffer_load_dwordx4 v22, s[12:15], s70 offen nt lds
  s_add_u32 m0, s58, 20480
  s_nop 0
  buffer_load_dwordx4 v22, s[12:15], s53 offen offset:2048 nt lds
  s_add_u32 m0, s58, 21504
  s_nop 0
  buffer_load_dwordx4 v22, s[12:15], s70 offen offset:2048 nt lds
  s_waitcnt lgkmcnt(2)
  v_mfma_f32_16x16x32_bf16 v[40:43], v[184:187], v[160:163], 0
  ds_read_b64_tr_b16 v[180:181], v3 offset:25600
  ds_read_b64_tr_b16 v[182:183], v3 offset:29696
  v_exp_f32 v13, v145
  s_add_u32 s53, s53, 4096
  s_xor_b32 s70, s53, 128
  s_add_u32 m0, s58, 24576
  s_nop 0
  buffer_load_dwordx4 v22, s[12:15], s53 offen nt lds
  s_add_u32 m0, s58, 25600
  s_nop 0
  buffer_load_dwordx4 v22, s[12:15], s70 offen nt lds
  v_mfma_f32_16x16x32_bf16 v[44:47], v[188:191], v[160:163], 0
  ds_read_b64_tr_b16 v[184:185], v2 offset:26112
  ds_read_b64_tr_b16 v[186:187], v2 offset:30208
  v_exp_f32 v14, v146
  v_exp_f32 v15, v147
  s_add_u32 m0, s58, 24576
  s_nop 0
  buffer_load_dwordx4 v22, s[12:15], s53 offen offset:2048 nt lds
  s_add_u32 m0, s58, 25600
  s_nop 0
  buffer_load_dwordx4 v22, s[12:15], s70 offen offset:2048 nt lds
  s_add_u32 s53, s53, 4096
  s_xor_b32 s70, s53, 128
  s_add_u32 m0, s58, 28672
  s_nop 0
  buffer_load_dwordx4 v22, s[12:15], s53 offen nt lds
  s_waitcnt lgkmcnt(2)
  v_mfma_f32_16x16x32_bf16 v[48:51], v[176:179], v[160:163], 0
  ds_read_b64_tr_b16 v[188:189], v3 offset:26112
  ds_read_b64_tr_b16 v[190:191], v3 offset:30208
  v_cvt_pk_bf16_f32 v168, v12, v13
  v_add_f32 v7, v12, v13
  s_add_u32 m0, s58, 29696
  s_nop 0
  buffer_load_dwordx4 v22, s[12:15], s70 offen nt lds
  s_add_u32 m0, s58, 28672
  s_nop 0
  buffer_load_dwordx4 v22, s[12:15], s53 offen offset:2048 nt lds
  v_mfma_f32_16x16x32_bf16 v[52:55], v[180:183], v[160:163], 0
  v_add_u32 v2, s61, v2
  v_add_u32 v3, s61, v3
  v_exp_f32 v12, v148
  s_add_u32 m0, s58, 29696
  s_nop 0
  buffer_load_dwordx4 v22, s[12:15], s70 offen offset:2048 nt lds
  s_add_u32 s52, s52, 4096
  s_add_u32 s53, s53, 4096
  s_add_u32 s58, s58, 32768
  s_cmp_ge_u32 s58, 98304
  s_cselect_b32 s58, 0, s58
  s_waitcnt vmcnt(34) lgkmcnt(0)
L_loop1_0:
  s_barrier
  ds_read_b128 v[176:179], v1 offset:0
  ds_read_b128 v[180:183], v1 offset:512
  v_mfma_f32_16x16x32_bf16 v[56:59], v[184:187], v[160:163], v[56:59]
  v_exp_f32 v13, v149
  v_cvt_pk_bf16_f32 v169, v14, v15
  v_mfma_f32_16x16x32_bf16 v[60:63], v[188:191], v[160:163], v[60:63]
  ds_read_b128 v[184:187], v1 offset:1024
  v_add_f32 v7, v7, v14
  v_add_f32 v7, v7, v15
  s_waitcnt lgkmcnt(1)
  v_mfma_f32_16x16x32_bf16 v[128:131], v[176:179], v[96:99], v[24:27]
  ds_read_b128 v[188:191], v1 offset:1536
  v_exp_f32 v14, v150
  v_mfma_f32_16x16x32_bf16 v[128:131], v[180:183], v[100:103], v[128:131]
  ds_read_b128 v[176:179], v1 offset:4096
  v_exp_f32 v15, v151
  v_cvt_pk_bf16_f32 v170, v12, v13
  s_waitcnt lgkmcnt(1)
  v_mfma_f32_16x16x32_bf16 v[128:131], v[184:187], v[104:107], v[128:131]
  ds_read_b128 v[180:183], v1 offset:4608
  v_add_f32 v7, v7, v12
  v_add_f32 v7, v7, v13
  v_mfma_f32_16x16x32_bf16 v[128:131], v[188:191], v[108:111], v[128:131]
  ds_read_b128 v[184:187], v1 offset:5120
  v_cvt_pk_bf16_f32 v171, v14, v15
  v_add_f32 v7, v7, v14
  s_waitcnt lgkmcnt(1)
  v_mfma_f32_16x16x32_bf16 v[132:135], v[176:179], v[96:99], v[24:27]
  ds_read_b128 v[188:191], v1 offset:5632
  v_add_f32 v7, v7, v15
  v_mfma_f32_16x16x32_bf16 v[132:135], v[180:183], v[100:103], v[132:135]
  ds_read_b64_tr_b16 v[176:177], v2 offset:16384
  ds_read_b64_tr_b16 v[178:179], v2 offset:20480
  s_waitcnt lgkmcnt(2)
  v_mfma_f32_16x16x32_bf16 v[132:135], v[184:187], v[104:107], v[132:135]
  ds_read_b64_tr_b16 v[180:181], v3 offset:16384
  ds_read_b64_tr_b16 v[182:183], v3 offset:20480
  v_mfma_f32_16x16x32_bf16 v[132:135], v[188:191], v[108:111], v[132:135]
  ds_read_b64_tr_b16 v[184:185], v2 offset:16896
  ds_read_b64_tr_b16 v[186:187], v2 offset:20992
  v_cmp_nge_f32 vcc, s49, v7
  s_nop 0
  s_cbranch_vccnz L_rare_20
L_back_21:
  v_add_f32 v5, v5, v7
  s_waitcnt lgkmcnt(2)
  v_mfma_f32_16x16x32_bf16 v[32:35], v[176:179], v[168:171], v[32:35]
  ds_read_b64_tr_b16 v[188:189], v3 offset:16896
  ds_read_b64_tr_b16 v[190:191], v3 offset:20992
  v_mfma_f32_16x16x32_bf16 v[36:39], v[180:183], v[168:171], v[36:39]
  ds_read_b64_tr_b16 v[176:177], v2 offset:17408
  ds_read_b64_tr_b16 v[178:179], v2 offset:21504
  v_exp_f32 v12, v128
  s_waitcnt lgkmcnt(2)
  v_mfma_f32_16x16x32_bf16 v[40:43], v[184:187], v[168:171], v[40:43]
  ds_read_b64_tr_b16 v[180:181], v3 offset:17408
  ds_read_b64_tr_b16 v[182:183], v3 offset:21504
  v_exp_f32 v13, v129
  v_mfma_f32_16x16x32_bf16 v[44:47], v[188:191], v[168:171], v[44:47]
  ds_read_b64_tr_b16 v[184:185], v2 offset:17920
  ds_read_b64_tr_b16 v[186:187], v2 offset:22016
  v_exp_f32 v14, v130
  s_waitcnt lgkmcnt(2)
  v_mfma_f32_16x16x32_bf16 v[48:51], v[176:179], v[168:171], v[48:51]
  ds_read_b64_tr_b16 v[188:189], v3 offset:17920
  ds_read_b64_tr_b16 v[190:191], v3 offset:22016
  v_exp_f32 v15, v131
  v_mfma_f32_16x16x32_bf16 v[52:55], v[180:183], v[168:171], v[52:55]
  ds_read_b128 v[176:179], v1 offset:8192
  v_cvt_pk_bf16_f32 v160, v12, v13
  v_add_f32 v7, v12, v13
  buffer_load_dwordx4 v[64:67], v23, s[76:79], s80 offen
  s_add_u32 s80, s80, s81
  buffer_load_dwordx4 v[68:71], v23, s[76:79], s80 offen
  s_and_b32 s59, s44, s83
  s_cmp_eq_u32 s59, s83
  s_cselect_b32 s59, s82, s81
  s_add_u32 s80, s80, s59
  s_add_u32 m0, s58, 0
  s_nop 0
  buffer_load_dwordx4 v20, s[8:11], s52 offen nt lds
  s_waitcnt lgkmcnt(1)
  v_mfma_f32_16x16x32_bf16 v[56:59], v[184:187], v[168:171], v[56:59]
  ds_read_b128 v[180:183], v1 offset:8704
  v_exp_f32 v12, v132
  s_add_u32 m0, s58, 896
  s_nop 0
  buffer_load_dwordx4 v20, s[8:11], s52 offen offset:128 nt lds
  s_add_u32 m0, s58, 0
  s_nop 0
  buffer_load_dwordx4 v21, s[8:11], s52 offen offset:2048 nt lds
  v_mfma_f32_16x16x32_bf16 v[60:63], v[188:191], v[168:171], v[60:63]
  ds_read_b128 v[184:187], v1 offset:9216
  v_exp_f32 v13, v133
  v_cvt_pk_bf16_f32 v161, v14, v15
  s_add_u32 m0, s58, 896
  s_nop 0
  buffer_load_dwordx4 v21, s[8:11], s52 offen offset:2176 nt lds
  s_add_u32 s52, s52, 4096
  s_add_u32 m0, s58, 4096
  s_nop 0
  buffer_load_dwordx4 v20, s[8:11], s52 offen nt lds
  s_waitcnt lgkmcnt(1)
  v_mfma_f32_16x16x32_bf16 v[144:147], v[176:179], v[96:99], v[24:27]
  ds_read_b128 v[188:191], v1 offset:9728
  v_add_f32 v7, v7, v14
  v_add_f32 v7, v7, v15
  s_add_u32 m0, s58, 4992
  s_nop 0
  buffer_load_dwordx4 v20, s[8:11], s52 offen offset:128 nt lds
  s_add_u32 m0, s58, 4096
  s_nop 0
  buffer_load_dwordx4 v21, s[8:11], s52 offen offset:2048 nt lds
  v_mfma_f32_16x16x32_bf16 v[144:147], v[180:183], v[100:103], v[144:147]
  ds_read_b128 v[176:179], v1 offset:12288
  v_exp_f32 v14, v134
  v_exp_f32 v15, v135
  s_add_u32 m0, s58, 4992
  s_nop 0
  buffer_load_dwordx4 v21, s[8:11], s52 offen offset:2176 nt lds
  s_add_u32 s52, s52, 4096
  s_add_u32 m0, s58, 8192
  s_nop 0
  buffer_load_dwordx4 v20, s[8:11], s52 offen nt lds
  s_waitcnt lgkmcnt(1)
  v_mfma_f32_16x16x32_bf16 v[144:147], v[184:187], v[104:107], v[144:147]
  ds_read_b128 v[180:183], v1 offset:12800
  v_cvt_pk_bf16_f32 v162, v12, v13
  v_add_f32 v7, v7, v12
  s_add_u32 m0, s58, 9088
  s_nop 0
  buffer_load_dwordx4 v20, s[8:11], s52 offen offset:128 nt lds
  s_add_u32 m0, s58, 8192
  s_nop 0
  buffer_load_dwordx4 v21, s[8:11], s52 offen offset:2048 nt lds
  v_mfma_f32_16x16x32_bf16 v[144:147], v[188:191], v[108:111], v[144:147]
  ds_read_b128 v[184:187], v1 offset:13312
  v_add_f32 v7, v7, v13
  v_cvt_pk_bf16_f32 v163, v14, v15
  s_add_u32 m0, s58, 9088
  s_nop 0
  buffer_load_dwordx4 v21, s[8:11], s52 offen offset:2176 nt lds
  s_add_u32 s52, s52, 4096
  s_add_u32 m0, s58, 12288
  s_nop 0
  buffer_load_dwordx4 v20, s[8:11], s52 offen nt lds
  s_waitcnt lgkmcnt(1)
  v_mfma_f32_16x16x32_bf16 v[148:151], v[176:179], v[96:99], v[24:27]
  ds_read_b128 v[188:191], v1 offset:13824
  v_add_f32 v7, v7, v14
  v_add_f32 v7, v7, v15
  s_add_u32 m0, s58, 13184
  s_nop 0
  buffer_load_dwordx4 v20, s[8:11], s52 offen offset:128 nt lds
  s_add_u32 m0, s58, 12288
  s_nop 0
  buffer_load_dwordx4 v21, s[8:11], s52 offen offset:2048 nt lds
  v_mfma_f32_16x16x32_bf16 v[148:151], v[180:183], v[100:103], v[148:151]
  ds_read_b64_tr_b16 v[176:177], v2 offset:24576
  ds_read_b64_tr_b16 v[178:179], v2 offset:28672
  s_add_u32 m0, s58, 13184
  s_nop 0
  buffer_load_dwordx4 v21, s[8:11], s52 offen offset:2176 nt lds
  s_xor_b32 s70, s53, 128
  s_add_u32 m0, s58, 16384
  s_nop 0
  buffer_load_dwordx4 v22, s[12:15], s53 offen nt lds
  s_waitcnt lgkmcnt(2)
  v_mfma_f32_16x16x32_bf16 v[148:151], v[184:187], v[104:107], v[148:151]
  ds_read_b64_tr_b16 v[180:181], v3 offset:24576
  ds_read_b64_tr_b16 v[182:183], v3 offset:28672
  s_add_u32 m0, s58, 17408
  s_nop 0
  buffer_load_dwordx4 v22, s[12:15], s70 offen nt lds
  s_add_u32 m0, s58, 16384
  s_nop 0
  buffer_load_dwordx4 v22, s[12:15], s53 offen offset:2048 nt lds
  v_mfma_f32_16x16x32_bf16 v[148:151], v[188:191], v[108:111], v[148:151]
  ds_read_b64_tr_b16 v[184:185], v2 offset:25088
  ds_read_b64_tr_b16 v[186:187], v2 offset:29184
  v_cmp_nge_f32 vcc, s49, v7
  s_nop 0
  s_cbranch_vccnz L_rare_22
L_back_23:
  v_add_f32 v5, v5, v7
  s_add_u32 m0, s58, 17408
  s_nop 0
  buffer_load_dwordx4 v22, s[12:15], s70 offen offset:2048 nt lds
  s_add_u32 s53, s53, 4096
  s_xor_b32 s70, s53, 128
  s_add_u32 m0, s58, 20480
  s_nop 0
  buffer_load_dwordx4 v22, s[12:15], s53 offen nt lds
  s_waitcnt lgkmcnt(2)
  v_mfma_f32_16x16x32_bf16 v[32:35], v[176:179], v[160:163], v[32:35]
  ds_read_b64_tr_b16 v[188:189], v3 offset:25088
  ds_read_b64_tr_b16 v[190:191], v3 offset:29184
  s_add_u32 s51, s51, 1
  s_cmp_eq_u32 s51, 3
  s_cselect_b32 s61, s57, s56
  s_cselect_b32 s51, 0, s51
  s_add_u32 s44, s44, 1
  v_add_u32 v1, s61, v1
  s_add_u32 m0, s58, 21504
  s_nop 0
  buffer_load_dwordx4 v22, s[12:15], s70 offen nt lds
  s_add_u32 m0, s58, 20480
  s_nop 0
  buffer_load_dwordx4 v22, s[12:15], s53 offen offset:2048 nt lds
  v_mfma_f32_16x16x32_bf16 v[36:39], v[180:183], v[160:163], v[36:39]
  ds_read_b64_tr_b16 v[176:177], v2 offset:25600
  ds_read_b64_tr_b16 v[178:179], v2 offset:29696
  v_exp_f32 v12, v144
  s_add_u32 m0, s58, 21504
  s_nop 0
  buffer_load_dwordx4 v22, s[12:15], s70 offen offset:2048 nt lds
  s_add_u32 s53, s53, 4096
  s_xor_b32 s70, s53, 128
  s_add_u32 m0, s58, 24576
  s_nop 0
  buffer_load_dwordx4 v22, s[12:15], s53 offen nt lds
  s_waitcnt lgkmcnt(2)
  v_mfma_f32_16x16x32_bf16 v[40:43], v[184:187], v[160:163], v[40:43]
  ds_read_b64_tr_b16 v[180:181], v3 offset:25600
  ds_read_b64_tr_b16 v[182:183], v3 offset:29696
  v_exp_f32 v13, v145
  s_add_u32 m0, s58, 25600
  s_nop 0
  buffer_load_dwordx4 v22, s[12:15], s70 offen nt lds
  s_add_u32 m0, s58, 24576
  s_nop 0
  buffer_load_dwordx4 v22, s[12:15], s53 offen offset:2048 nt lds
  v_mfma_f32_16x16x32_bf16 v[44:47], v[188:191], v[160:163], v[44:47]
  ds_read_b64_tr_b16 v[184:185], v2 offset:26112
  ds_read_b64_tr_b16 v[186:187], v2 offset:30208
  v_exp_f32 v14, v146
  v_exp_f32 v15, v147
  s_add_u32 m0, s58, 25600
  s_nop 0
  buffer_load_dwordx4 v22, s[12:15], s70 offen offset:2048 nt lds
  s_add_u32 s53, s53, 4096
  s_xor_b32 s70, s53, 128
  s_add_u32 m0, s58, 28672
  s_nop 0
  buffer_load_dwordx4 v22, s[12:15], s53 offen nt lds
  s_waitcnt lgkmcnt(2)
  v_mfma_f32_16x16x32_bf16 v[48:51], v[176:179], v[160:163], v[48:51]
  ds_read_b64_tr_b16 v[188:189], v3 offset:26112
  ds_read_b64_tr_b16 v[190:191], v3 offset:30208
  v_cvt_pk_bf16_f32 v168, v12, v13
  v_add_f32 v7, v12, v13
  s_add_u32 m0, s58, 29696
  s_nop 0
  buffer_load_dwordx4 v22, s[12:15], s70 offen nt lds
  s_add_u32 m0, s58, 28672
  s_nop 0
  buffer_load_dwordx4 v22, s[12:15], s53 offen offset:2048 nt lds
  v_mfma_f32_16x16x32_bf16 v[52:55], v[180:183], v[160:163], v[52:55]
  v_add_u32 v2, s61, v2
  v_add_u32 v3, s61, v3
  v_exp_f32 v12, v148
  s_add_u32 m0, s58, 29696
  s_nop 0
  buffer_load_dwordx4 v22, s[12:15], s70 offen offset:2048 nt lds
  s_add_u32 s52, s52, 4096
  s_add_u32 s53, s53, 4096
  s_add_u32 s58, s58, 32768
  s_cmp_ge_u32 s58, 98304
  s_cselect_b32 s58, 0, s58
  s_bitcmp1_b32 s67, s44
  s_cbranch_scc1 L_hook1
L_hookback1_0:
  s_waitcnt vmcnt(34) lgkmcnt(0)
  s_bitcmp0_b32 0x1050101, s44
  s_cbranch_scc1 L_loop1_0
  s_branch L_next1
L_loop1_1:
  s_barrier
  ds_read_b128 v[176:179], v1 offset:0
  ds_read_b128 v[180:183], v1 offset:512
  v_mfma_f32_16x16x32_bf16 v[56:59], v[184:187], v[160:163], v[56:59]
  v_exp_f32 v13, v149
  v_cvt_pk_bf16_f32 v169, v14, v15
  v_mfma_f32_16x16x32_bf16 v[60:63], v[188:191], v[160:163], v[60:63]
  ds_read_b128 v[184:187], v1 offset:1024
  v_add_f32 v7, v7, v14
  v_add_f32 v7, v7, v15
  s_waitcnt lgkmcnt(1)
  v_mfma_f32_16x16x32_bf16 v[128:131], v[176:179], v[96:99], v[24:27]
  ds_read_b128 v[188:191], v1 offset:1536
  v_exp_f32 v14, v150
  v_mfma_f32_16x16x32_bf16 v[128:131], v[180:183], v[100:103], v[128:131]
  ds_read_b128 v[176:179], v1 offset:4096
  v_exp_f32 v15, v151
  v_cvt_pk_bf16_f32 v170, v12, v13
  s_waitcnt lgkmcnt(1)
  v_mfma_f32_16x16x32_bf16 v[128:131], v[184:187], v[104:107], v[128:131]
  ds_read_b128 v[180:183], v1 offset:4608
  v_add_f32 v7, v7, v12
  v_add_f32 v7, v7, v13
  v_mfma_f32_16x16x32_bf16 v[128:131], v[188:191], v[108:111], v[128:131]
  ds_read_b128 v[184:187], v1 offset:5120
  v_cvt_pk_bf16_f32 v171, v14, v15
  v_add_f32 v7, v7, v14
  s_waitcnt lgkmcnt(1)
  v_mfma_f32_16x16x32_bf16 v[132:135], v[176:179], v[96:99], v[24:27]
  ds_read_b128 v[188:191], v1 offset:5632
  v_add_f32 v7, v7, v15
  v_mfma_f32_16x16x32_bf16 v[132:135], v[180:183], v[100:103], v[132:135]
  ds_read_b64_tr_b16 v[176:177], v2 offset:16384
  ds_read_b64_tr_b16 v[178:179], v2 offset:20480
  buffer_load_dwordx4 v[64:67], v23, s[76:79], s80 offen
  s_add_u32 s80, s80, s81
  buffer_load_dwordx4 v[68:71], v23, s[76:79], s80 offen
  s_and_b32 s59, s44, s83
  s_cmp_eq_u32 s59, s83
  s_cselect_b32 s59, s82, s81
  s_add_u32 s80, s80, s59
  s_waitcnt vmcnt(18)
  s_add_u32 m0, s58, 0
  s_nop 0
  buffer_load_dwordx4 v20, s[8:11], s52 offen nt lds
  s_waitcnt lgkmcnt(2)
  v_mfma_f32_16x16x32_bf16 v[132:135], v[184:187], v[104:107], v[132:135]
  ds_read_b64_tr_b16 v[180:181], v3 offset:16384
  ds_read_b64_tr_b16 v[182:183], v3 offset:20480
  s_add_u32 m0, s58, 896
  s_nop 0
  buffer_load_dwordx4 v20, s[8:11], s52 offen offset:128 nt lds
  v_mfma_f32_16x16x32_bf16 v[132:135], v[188:191], v[108:111], v[132:135]
  ds_read_b64_tr_b16 v[184:185], v2 offset:16896
  ds_read_b64_tr_b16 v[186:187], v2 offset:20992
  v_cmp_nge_f32 vcc, s49, v7
  s_nop 0
  s_cbranch_vccnz L_rare_24
L_back_25:
  v_add_f32 v5, v5, v7
  s_waitcnt vmcnt(18)
  s_add_u32 m0, s58, 0
  s_nop 0
  buffer_load_dwordx4 v21, s[8:11], s52 offen offset:2048 nt lds
  s_add_u32 m0, s58, 896
  s_nop 0
  buffer_load_dwordx4 v21, s[8:11], s52 offen offset:2176 nt lds
  s_waitcnt lgkmcnt(2)
  v_mfma_f32_16x16x32_bf16 v[32:35], v[176:179], v[168:171], v[32:35]
  ds_read_b64_tr_b16 v[188:189], v3 offset:16896
  ds_read_b64_tr_b16 v[190:191], v3 offset:20992
  s_waitcnt vmcnt(18)
  s_add_u32 s52, s52, 4096
  s_add_u32 m0, s58, 4096
  s_nop 0
  buffer_load_dwordx4 v20, s[8:11], s52 offen nt lds
  v_mfma_f32_16x16x32_bf16 v[36:39], v[180:183], v[168:171], v[36:39]
  ds_read_b64_tr_b16 v[176:177], v2 offset:17408
  ds_read_b64_tr_b16 v[178:179], v2 offset:21504
  v_exp_f32 v12, v128
  s_add_u32 m0, s58, 4992
  s_nop 0
  buffer_load_dwordx4 v20, s[8:11], s52 offen offset:128 nt lds
  s_waitcnt lgkmcnt(2)
  v_mfma_f32_16x16x32_bf16 v[40:43], v[184:187], v[168:171], v[40:43]
  ds_read_b64_tr_b16 v[180:181], v3 offset:17408
  ds_read_b64_tr_b16 v[182:183], v3 offset:21504
  v_exp_f32 v13, v129
  s_waitcnt vmcnt(18)
  s_add_u32 m0, s58, 4096
  s_nop 0
  buffer_load_dwordx4 v21, s[8:11], s52 offen offset:2048 nt lds
  s_add_u32 m0, s58, 4992
  s_nop 0
  buffer_load_dwordx4 v21, s[8:11], s52 offen offset:2176 nt lds
  v_mfma_f32_16x16x32_bf16 v[44:47], v[188:191], v[168:171], v[44:47]
  ds_read_b64_tr_b16 v[184:185], v2 offset:17920
  ds_read_b64_tr_b16 v[186:187], v2 offset:22016
  v_exp_f32 v14, v130
  s_waitcnt vmcnt(18)
  s_add_u32 s52, s52, 4096
  s_add_u32 m0, s58, 8192
  s_nop 0
  buffer_load_dwordx4 v20, s[8:11], s52 offen nt lds
  s_waitcnt lgkmcnt(2)
  v_mfma_f32_16x16x32_bf16 v[48:51], v[176:179], v[168:171], v[48:51]
  ds_read_b64_tr_b16 v[188:189], v3 offset:17920
  ds_read_b64_tr_b16 v[190:191], v3 offset:22016
  v_exp_f32 v15, v131
  s_add_u32 m0, s58, 9088
  s_nop 0
  buffer_load_dwordx4 v20, s[8:11], s52 offen offset:128 nt lds
  v_mfma_f32_16x16x32_bf16 v[52:55], v[180:183], v[168:171], v[52:55]
  ds_read_b128 v[176:179], v1 offset:8192
  v_cvt_pk_bf16_f32 v160, v12, v13
  v_add_f32 v7, v12, v13
  s_waitcnt vmcnt(18)
  s_add_u32 m0, s58, 8192
  s_nop 0
  buffer_load_dwordx4 v21, s[8:11], s52 offen offset:2048 nt lds
  s_add_u32 m0, s58, 9088
  s_nop 0
  buffer_load_dwordx4 v21, s[8:11], s52 offen offset:2176 nt lds
  s_waitcnt lgkmcnt(1)
  v_mfma_f32_16x16x32_bf16 v[56:59], v[184:187], v[168:171], v[56:59]
  ds_read_b128 v[180:183], v1 offset:8704
  v_exp_f32 v12, v132
  s_waitcnt vmcnt(18)
  s_add_u32 s52, s52, 4096
  s_add_u32 m0, s58, 12288
  s_nop 0
  buffer_load_dwordx4 v20, s[8:11], s52 offen nt lds
  v_mfma_f32_16x16x32_bf16 v[60:63], v[188:191], v[168:171], v[60:63]
  ds_read_b128 v[184:187], v1 offset:9216
  v_exp_f32 v13, v133
  v_cvt_pk_bf16_f32 v161, v14, v15
  s_add_u32 m0, s58, 13184
  s_nop 0
  buffer_load_dwordx4 v20, s[8:11], s52 offen offset:128 nt lds
  s_waitcnt lgkmcnt(1)
  v_mfma_f32_16x16x32_bf16 v[144:147], v[176:179], v[96:99], v[24:27]
  ds_read_b128 v[188:191], v1 offset:9728
  v_add_f32 v7, v7, v14
  v_add_f32 v7, v7, v15
  s_waitcnt vmcnt(18)
  s_add_u32 m0, s58, 12288
  s_nop 0
  buffer_load_dwordx4 v21, s[8:11], s52 offen offset:2048 nt lds
  s_add_u32 m0, s58, 13184
  s_nop 0
  buffer_load_dwordx4 v21, s[8:11], s52 offen offset:2176 nt lds
  v_mfma_f32_16x16x32_bf16 v[144:147], v[180:183], v[100:103], v[144:147]
  ds_read_b128 v[176:179], v1 offset:12288
  v_exp_f32 v14, v134
  v_exp_f32 v15, v135
  s_waitcnt vmcnt(18)
  s_xor_b32 s70, s53, 128
  s_add_u32 m0, s58, 16384
  s_nop 0
  buffer_load_dwordx4 v22, s[12:15], s53 offen nt lds
  s_waitcnt lgkmcnt(1)
  v_mfma_f32_16x16x32_bf16 v[144:147], v[184:187], v[104:107], v[144:147]
  ds_read_b128 v[180:183], v1 offset:12800
  v_cvt_pk_bf16_f32 v162, v12, v13
  v_add_f32 v7, v7, v12
  s_add_u32 m0, s58, 17408
  s_nop 0
  buffer_load_dwordx4 v22, s[12:15], s70 offen nt lds
  s_waitcnt vmcnt(18)
  s_add_u32 m0, s58, 16384
  s_nop 0
  buffer_load_dwordx4 v22, s[12:15], s53 offen offset:2048 nt lds
  v_mfma_f32_16x16x32_bf16 v[144:147], v[188:191], v[108:111], v[144:147]
  ds_read_b128 v[184:187], v1 offset:13312
  v_add_f32 v7, v7, v13
  v_cvt_pk_bf16_f32 v163, v14, v15
  s_add_u32 m0, s58, 17408
  s_nop 0
  buffer_load_dwordx4 v22, s[12:15], s70 offen offset:2048 nt lds
  s_waitcnt lgkmcnt(1)
  v_mfma_f32_16x16x32_bf16 v[148:151], v[176:179], v[96:99], v[24:27]
  ds_read_b128 v[188:191], v1 offset:13824
  v_add_f32 v7, v7, v14
  v_add_f32 v7, v7, v15
  s_waitcnt vmcnt(18)
  s_add_u32 s53, s53, 4096
  s_xor_b32 s70, s53, 128
  s_add_u32 m0, s58, 20480
  s_nop 0
  buffer_load_dwordx4 v22, s[12:15], s53 offen nt lds
  v_mfma_f32_16x16x32_bf16 v[148:151], v[180:183], v[100:103], v[148:151]
  ds_read_b64_tr_b16 v[176:177], v2 offset:24576
  ds_read_b64_tr_b16 v[178:179], v2 offset:28672
  s_add_u32 m0, s58, 21504
  s_nop 0
  buffer_load_dwordx4 v22, s[12:15], s70 offen nt lds
  s_waitcnt vmcnt(18)
  s_add_u32 m0, s58, 20480
  s_nop 0
  buffer_load_dwordx4 v22, s[12:15], s53 offen offset:2048 nt lds
  s_waitcnt lgkmcnt(2)
  v_mfma_f32_16x16x32_bf16 v[148:151], v[184:187], v[104:107], v[148:151]
  ds_read_b64_tr_b16 v[180:181], v3 offset:24576
  ds_read_b64_tr_b16 v[182:183], v3 offset:28672
  s_add_u32 m0, s58, 21504
  s_nop 0
  buffer_load_dwordx4 v22, s[12:15], s70 offen offset:2048 nt lds
  v_mfma_f32_16x16x32_bf16 v[148:151], v[188:191], v[108:111], v[148:151]
  ds_read_b64_tr_b16 v[184:185], v2 offset:25088
  ds_read_b64_tr_b16 v[186:187], v2 offset:29184
  v_cmp_nge_f32 vcc, s49, v7
  s_nop 0
  s_cbranch_vccnz L_rare_26
L_back_27:
  v_add_f32 v5, v5, v7
  s_waitcnt vmcnt(18)
  s_add_u32 s53, s53, 4096
  s_xor_b32 s70, s53, 128
  s_add_u32 m0, s58, 24576
  s_nop 0
  buffer_load_dwordx4 v22, s[12:15], s53 offen nt lds
  s_waitcnt lgkmcnt(2)
  v_mfma_f32_16x16x32_bf16 v[32:35], v[176:179], v[160:163], v[32:35]
  ds_read_b64_tr_b16 v[188:189], v3 offset:25088
  ds_read_b64_tr_b16 v[190:191], v3 offset:29184
  s_add_u32 s51, s51, 1
  s_cmp_eq_u32 s51, 3
  s_cselect_b32 s61, s57, s56
  s_cselect_b32 s51, 0, s51
  s_add_u32 s44, s44, 1
  v_add_u32 v1, s61, v1
  s_add_u32 m0, s58, 25600
  s_nop 0
  buffer_load_dwordx4 v22, s[12:15], s70 offen nt lds
  s_waitcnt vmcnt(18)
  s_add_u32 m0, s58, 24576
  s_nop 0
  buffer_load_dwordx4 v22, s[12:15], s53 offen offset:2048 nt lds
  v_mfma_f32_16x16x32_bf16 v[36:39], v[180:183], v[160:163], v[36:39]
  ds_read_b64_tr_b16 v[176:177], v2 offset:25600
  ds_read_b64_tr_b16 v[178:179], v2 offset:29696
  v_exp_f32 v12, v144
  s_add_u32 m0, s58, 25600
  s_nop 0
  buffer_load_dwordx4 v22, s[12:15], s70 offen offset:2048 nt lds
  s_waitcnt lgkmcnt(2)
  v_mfma_f32_16x16x32_bf16 v[40:43], v[184:187], v[160:163], v[40:43]
  ds_read_b64_tr_b16 v[180:181], v3 offset:25600
  ds_read_b64_tr_b16 v[182:183], v3 offset:29696
  v_exp_f32 v13, v145
  s_waitcnt vmcnt(18)
  s_add_u32 s53, s53, 4096
  s_xor_b32 s70, s53, 128
  s_add_u32 m0, s58, 28672
  s_nop 0
  buffer_load_dwordx4 v22, s[12:15], s53 offen nt lds
  v_mfma_f32_16x16x32_bf16 v[44:47], v[188:191], v[160:163], v[44:47]
  ds_read_b64_tr_b16 v[184:185], v2 offset:26112
  ds_read_b64_tr_b16 v[186:187], v2 offset:30208
  v_exp_f32 v14, v146
  v_exp_f32 v15, v147
  s_add_u32 m0, s58, 29696
  s_nop 0
  buffer_load_dwordx4 v22, s[12:15], s70 offen nt lds
  s_waitcnt vmcnt(18)
  s_add_u32 m0, s58, 28672
  s_nop 0
  buffer_load_dwordx4 v22, s[12:15], s53 offen offset:2048 nt lds
  s_waitcnt lgkmcnt(2)
  v_mfma_f32_16x16x32_bf16 v[48:51], v[176:179], v[160:163], v[48:51]
  ds_read_b64_tr_b16 v[188:189], v3 offset:26112
  ds_read_b64_tr_b16 v[190:191], v3 offset:30208
  v_cvt_pk_bf16_f32 v168, v12, v13
  v_add_f32 v7, v12, v13
  s_add_u32 m0, s58, 29696
  s_nop 0
  buffer_load_dwordx4 v22, s[12:15], s70 offen offset:2048 nt lds
  v_mfma_f32_16x16x32_bf16 v[52:55], v[180:183], v[160:163], v[52:55]
  v_add_u32 v2, s61, v2
  v_add_u32 v3, s61, v3
  v_exp_f32 v12, v148
  s_add_u32 s52, s52, 4096
  s_add_u32 s53, s53, 4096
  s_add_u32 s58, s58, 32768
  s_cmp_ge_u32 s58, 98304
  s_cselect_b32 s58, 0, s58
  s_bitcmp1_b32 s67, s44
  s_cbranch_scc1 L_hook1
L_hookback1_1:
  s_waitcnt vmcnt(34) lgkmcnt(0)
  s_bitcmp0_b32 0x1050101, s44
  s_cbranch_scc1 L_loop1_1
L_next1:
  s_cmp_eq_u32 s44, 16
  s_cbranch_scc1 L_f2_1
  s_cmp_eq_u32 s44, 18
  s_cbranch_scc1 L_tr_1
  s_cmp_eq_u32 s44, 24
  s_cbranch_scc1 L_f3_1
  s_cmp_eq_u32 s44, 32
  s_cbranch_scc1 L_last1
L_f1_1:
  s_barrier
  ds_read_b128 v[176:179], v1 offset:0
  ds_read_b128 v[180:183], v1 offset:512
  s_lshl_b32 s59, s40, 13
  s_add_u32 s59, s59, 131072
  v_add_u32 v18, s59, v4
  ds_read_b128 v[96:99], v18 offset:0
  ds_read_b128 v[100:103], v18 offset:1024
  ds_read_b128 v[104:107], v18 offset:2048
  ds_read_b128 v[108:111], v18 offset:3072
  v_mfma_f32_16x16x32_bf16 v[56:59], v[184:187], v[160:163], v[56:59]
  v_exp_f32 v13, v149
  v_cvt_pk_bf16_f32 v169, v14, v15
  v_add_f32 v7, v7, v14
  v_mfma_f32_16x16x32_bf16 v[60:63], v[188:191], v[160:163], v[60:63]
  ds_read_b128 v[184:187], v1 offset:1024
  v_add_f32 v7, v7, v15
  v_exp_f32 v14, v150
  s_waitcnt lgkmcnt(5)
  s_waitcnt lgkmcnt(4)
  v_mfma_f32_16x16x32_bf16 v[128:131], v[176:179], v[96:99], 0
  ds_read_b128 v[188:191], v1 offset:1536
  v_exp_f32 v15, v151
  v_cvt_pk_bf16_f32 v170, v12, v13
  s_waitcnt lgkmcnt(4)
  v_mfma_f32_16x16x32_bf16 v[128:131], v[180:183], v[100:103], v[128:131]
  ds_read_b128 v[176:179], v1 offset:4096
  v_add_f32 v7, v7, v12
  v_add_f32 v7, v7, v13
  s_waitcnt lgkmcnt(1)
  v_mfma_f32_16x16x32_bf16 v[128:131], v[184:187], v[104:107], v[128:131]
  ds_read_b128 v[180:183], v1 offset:4608
  s_mov_b32 s76, s20
  s_mov_b32 s77, s21
  s_mov_b32 s78, s22
  s_lshl_b32 s80, s7, 13
  s_mov_b32 s81, 1024
  s_mov_b32 s82, 123904
  s_mov_b32 s83, 3
  v_mov_b32 v23, v4
  v_mfma_f32_16x16x32_bf16 v[128:131], v[188:191], v[108:111], v[128:131]
  ds_read_b128 v[184:187], v1 offset:5120
  s_waitcnt lgkmcnt(1)
  v_mfma_f32_16x16x32_bf16 v[132:135], v[176:179], v[96:99], 0
  ds_read_b128 v[188:191], v1 offset:5632
  v_cvt_pk_bf16_f32 v171, v14, v15
  v_add_f32 v7, v7, v14
  v_add_f32 v7, v7, v15
  v_mfma_f32_16x16x32_bf16 v[132:135], v[180:183], v[100:103], v[132:135]
  ds_read_b64_tr_b16 v[176:177], v2 offset:16384
  ds_read_b64_tr_b16 v[178:179], v2 offset:20480
  s_waitcnt lgkmcnt(2)
  v_mfma_f32_16x16x32_bf16 v[132:135], v[184:187], v[104:107], v[132:135]
  ds_read_b64_tr_b16 v[180:181], v3 offset:16384
  ds_read_b64_tr_b16 v[182:183], v3 offset:20480
  v_mfma_f32_16x16x32_bf16 v[132:135], v[188:191], v[108:111], v[132:135]
  ds_read_b64_tr_b16 v[184:185], v2 offset:16896
  ds_read_b64_tr_b16 v[186:187], v2 offset:20992
  v_cmp_nge_f32 vcc, s49, v7
  s_nop 0
  s_cbranch_vccnz L_rare_28
L_back_29:
  v_add_f32 v5, v5, v7
  s_waitcnt lgkmcnt(2)
  v_mfma_f32_16x16x32_bf16 v[32:35], v[176:179], v[168:171], v[32:35]
  ds_read_b64_tr_b16 v[188:189], v3 offset:16896
  ds_read_b64_tr_b16 v[190:191], v3 offset:20992
  v_mov_b32 v16, v5
  s_nop 1
  v_permlane16_swap_b32 v5, v16
  v_add_f32 v5, v5, v16
  v_mfma_f32_16x16x32_bf16 v[36:39], v[180:183], v[168:171], v[36:39]
  ds_read_b64_tr_b16 v[176:177], v2 offset:17408
  ds_read_b64_tr_b16 v[178:179], v2 offset:21504
  v_mov_b32 v16, v5
  s_nop 1
  v_permlane32_swap_b32 v5, v16
  v_add_f32 v5, v5, v16
  v_rcp_f32 v16, v5
  s_waitcnt lgkmcnt(2)
  v_mfma_f32_16x16x32_bf16 v[40:43], v[184:187], v[168:171], v[40:43]
  ds_read_b64_tr_b16 v[180:181], v3 offset:17408
  ds_read_b64_tr_b16 v[182:183], v3 offset:21504
  v_max3_f32 v12, v128, v129, v130
  v_max3_f32 v13, v131, v132, v133
  v_max3_f32 v12, v12, v134, v135
  v_mfma_f32_16x16x32_bf16 v[44:47], v[188:191], v[168:171], v[44:47]
  ds_read_b64_tr_b16 v[184:185], v2 offset:17920
  ds_read_b64_tr_b16 v[186:187], v2 offset:22016
  v_max_f32 v12, v12, v13
  v_mov_b32 v13, v12
  s_nop 1
  v_permlane16_swap_b32 v12, v13
  s_waitcnt lgkmcnt(2)
  v_mfma_f32_16x16x32_bf16 v[48:51], v[176:179], v[168:171], v[48:51]
  ds_read_b64_tr_b16 v[188:189], v3 offset:17920
  ds_read_b64_tr_b16 v[190:191], v3 offset:22016
  v_max_f32 v12, v12, v13
  v_mov_b32 v13, v12
  s_nop 1
  v_permlane32_swap_b32 v12, v13
  v_max_f32 v12, v12, v13
  v_mfma_f32_16x16x32_bf16 v[52:55], v[180:183], v[168:171], v[52:55]
  ds_read_b128 v[176:179], v1 offset:8192
  v_sub_f32 v24, 0, v12
  v_sub_f32 v25, 0, v12
  v_sub_f32 v26, 0, v12
  v_sub_f32 v27, 0, v12
  buffer_load_dwordx4 v[64:67], v23, s[76:79], s80 offen
  s_add_u32 s80, s80, s81
  buffer_load_dwordx4 v[68:71], v23, s[76:79], s80 offen
  s_and_b32 s59, s44, s83
  s_cmp_eq_u32 s59, s83
  s_cselect_b32 s59, s82, s81
  s_add_u32 s80, s80, s59
  s_add_u32 m0, s58, 0
  s_nop 0
  buffer_load_dwordx4 v20, s[8:11], s52 offen nt lds
  s_waitcnt lgkmcnt(1)
  v_mfma_f32_16x16x32_bf16 v[56:59], v[184:187], v[168:171], v[56:59]
  ds_read_b128 v[180:183], v1 offset:8704
  v_add_f32 v128, v128, v24
  v_add_f32 v129, v129, v24
  v_add_f32 v130, v130, v24
  v_add_f32 v131, v131, v24
  v_add_f32 v132, v132, v24
  s_add_u32 m0, s58, 896
  s_nop 0
  buffer_load_dwordx4 v20, s[8:11], s52 offen offset:128 nt lds
  s_add_u32 m0, s58, 0
  s_nop 0
  buffer_load_dwordx4 v21, s[8:11], s52 offen offset:2048 nt lds
  v_mfma_f32_16x16x32_bf16 v[60:63], v[188:191], v[168:171], v[60:63]
  ds_read_b128 v[184:187], v1 offset:9216
  v_add_f32 v133, v133, v24
  v_add_f32 v134, v134, v24
  v_add_f32 v135, v135, v24
  v_exp_f32 v12, v128
  s_add_u32 m0, s58, 896
  s_nop 0
  buffer_load_dwordx4 v21, s[8:11], s52 offen offset:2176 nt lds
  s_add_u32 s52, s52, 4096
  s_add_u32 m0, s58, 4096
  s_nop 0
  buffer_load_dwordx4 v20, s[8:11], s52 offen nt lds
  s_waitcnt lgkmcnt(1)
  v_mfma_f32_16x16x32_bf16 v[144:147], v[176:179], v[96:99], v[24:27]
  ds_read_b128 v[188:191], v1 offset:9728
  v_exp_f32 v13, v129
  v_exp_f32 v14, v130
  v_exp_f32 v15, v131
  s_add_u32 m0, s58, 4992
  s_nop 0
  buffer_load_dwordx4 v20, s[8:11], s52 offen offset:128 nt lds
  s_add_u32 m0, s58, 4096
  s_nop 0
  buffer_load_dwordx4 v21, s[8:11], s52 offen offset:2048 nt lds
  v_mfma_f32_16x16x32_bf16 v[144:147], v[180:183], v[100:103], v[144:147]
  ds_read_b128 v[176:179], v1 offset:12288
  v_mul_f32 v32, v32, v16
  v_mul_f32 v33, v33, v16
  v_mul_f32 v34, v34, v16
  v_cvt_pk_bf16_f32 v160, v12, v13
  v_mul_f32 v35, v35, v16
  v_mul_f32 v36, v36, v16
  v_mul_f32 v37, v37, v16
  v_add_f32 v7, v12, v13
  v_mul_f32 v38, v38, v16
  v_mul_f32 v39, v39, v16
  s_add_u32 m0, s58, 4992
  s_nop 0
  buffer_load_dwordx4 v21, s[8:11], s52 offen offset:2176 nt lds
  s_add_u32 s52, s52, 4096
  s_add_u32 m0, s58, 8192
  s_nop 0
  buffer_load_dwordx4 v20, s[8:11], s52 offen nt lds
  s_waitcnt lgkmcnt(1)
  v_mfma_f32_16x16x32_bf16 v[144:147], v[184:187], v[104:107], v[144:147]
  ds_read_b128 v[180:183], v1 offset:12800
  v_cvt_pk_bf16_f32 v192, v32, v33
  v_exp_f32 v12, v132
  v_cvt_pk_bf16_f32 v193, v34, v35
  v_cvt_pk_bf16_f32 v194, v36, v37
  v_cvt_pk_bf16_f32 v195, v38, v39
  v_exp_f32 v13, v133
  v_mul_f32 v40, v40, v16
  v_mul_f32 v41, v41, v16
  s_add_u32 m0, s58, 9088
  s_nop 0
  buffer_load_dwordx4 v20, s[8:11], s52 offen offset:128 nt lds
  s_add_u32 m0, s58, 8192
  s_nop 0
  buffer_load_dwordx4 v21, s[8:11], s52 offen offset:2048 nt lds
  v_mfma_f32_16x16x32_bf16 v[144:147], v[188:191], v[108:111], v[144:147]
  ds_read_b128 v[184:187], v1 offset:13312
  v_mul_f32 v42, v42, v16
  v_cvt_pk_bf16_f32 v161, v14, v15
  v_mul_f32 v43, v43, v16
  v_mul_f32 v44, v44, v16
  v_mul_f32 v45, v45, v16
  v_add_f32 v7, v7, v14
  v_mul_f32 v46, v46, v16
  v_mul_f32 v47, v47, v16
  v_cvt_pk_bf16_f32 v196, v40, v41
  v_add_f32 v7, v7, v15
  s_add_u32 m0, s58, 9088
  s_nop 0
  buffer_load_dwordx4 v21, s[8:11], s52 offen offset:2176 nt lds
  s_add_u32 s52, s52, 4096
  s_add_u32 m0, s58, 12288
  s_nop 0
  buffer_load_dwordx4 v20, s[8:11], s52 offen nt lds
  s_waitcnt lgkmcnt(1)
  v_mfma_f32_16x16x32_bf16 v[148:151], v[176:179], v[96:99], v[24:27]
  ds_read_b128 v[188:191], v1 offset:13824
  v_cvt_pk_bf16_f32 v197, v42, v43
  v_cvt_pk_bf16_f32 v198, v44, v45
  v_cvt_pk_bf16_f32 v199, v46, v47
  v_exp_f32 v14, v134
  v_mul_f32 v48, v48, v16
  v_mul_f32 v49, v49, v16
  v_mul_f32 v50, v50, v16
  v_exp_f32 v15, v135
  v_mul_f32 v51, v51, v16
  s_add_u32 m0, s58, 13184
  s_nop 0
  buffer_load_dwordx4 v20, s[8:11], s52 offen offset:128 nt lds
  s_add_u32 m0, s58, 12288
  s_nop 0
  buffer_load_dwordx4 v21, s[8:11], s52 offen offset:2048 nt lds
  v_mfma_f32_16x16x32_bf16 v[148:151], v[180:183], v[100:103], v[148:151]
  ds_read_b64_tr_b16 v[176:177], v2 offset:24576
  ds_read_b64_tr_b16 v[178:179], v2 offset:28672
  v_mul_f32 v52, v52, v16
  v_mul_f32 v53, v53, v16
  v_cvt_pk_bf16_f32 v162, v12, v13
  v_mul_f32 v54, v54, v16
  v_mul_f32 v55, v55, v16
  v_cvt_pk_bf16_f32 v200, v48, v49
  v_add_f32 v7, v7, v12
  v_cvt_pk_bf16_f32 v201, v50, v51
  v_cvt_pk_bf16_f32 v202, v52, v53
  s_add_u32 m0, s58, 13184
  s_nop 0
  buffer_load_dwordx4 v21, s[8:11], s52 offen offset:2176 nt lds
  s_xor_b32 s70, s53, 128
  s_add_u32 m0, s58, 16384
  s_nop 0
  buffer_load_dwordx4 v22, s[12:15], s53 offen nt lds
  s_waitcnt lgkmcnt(2)
  v_mfma_f32_16x16x32_bf16 v[148:151], v[184:187], v[104:107], v[148:151]
  ds_read_b64_tr_b16 v[180:181], v3 offset:24576
  ds_read_b64_tr_b16 v[182:183], v3 offset:28672
  v_cvt_pk_bf16_f32 v203, v54, v55
  v_add_f32 v7, v7, v13
  v_mul_f32 v56, v56, v16
  v_mul_f32 v57, v57, v16
  v_mul_f32 v58, v58, v16
  v_cvt_pk_bf16_f32 v163, v14, v15
  v_mul_f32 v59, v59, v16
  v_mul_f32 v60, v60, v16
  v_mul_f32 v61, v61, v16
  s_add_u32 m0, s58, 17408
  s_nop 0
  buffer_load_dwordx4 v22, s[12:15], s70 offen nt lds
  s_add_u32 m0, s58, 16384
  s_nop 0
  buffer_load_dwordx4 v22, s[12:15], s53 offen offset:2048 nt lds
  v_mfma_f32_16x16x32_bf16 v[148:151], v[188:191], v[108:111], v[148:151]
  ds_read_b64_tr_b16 v[184:185], v2 offset:25088
  ds_read_b64_tr_b16 v[186:187], v2 offset:29184
  v_add_f32 v7, v7, v14
  v_mul_f32 v62, v62, v16
  v_mul_f32 v63, v63, v16
  v_cvt_pk_bf16_f32 v204, v56, v57
  v_add_f32 v7, v7, v15
  v_cvt_pk_bf16_f32 v205, v58, v59
  v_cvt_pk_bf16_f32 v206, v60, v61
  v_cvt_pk_bf16_f32 v207, v62, v63
  v_mov_b32 v5, v7
  s_add_u32 m0, s58, 17408
  s_nop 0
  buffer_load_dwordx4 v22, s[12:15], s70 offen offset:2048 nt lds
  s_add_u32 s53, s53, 4096
  s_xor_b32 s70, s53, 128
  s_add_u32 m0, s58, 20480
  s_nop 0
  buffer_load_dwordx4 v22, s[12:15], s53 offen nt lds
  s_waitcnt lgkmcnt(2)
  v_mfma_f32_16x16x32_bf16 v[32:35], v[176:179], v[160:163], 0
  ds_read_b64_tr_b16 v[188:189], v3 offset:25088
  ds_read_b64_tr_b16 v[190:191], v3 offset:29184
  v_mov_b32 v56, 0
  v_mov_b32 v57, 0
  v_mov_b32 v58, 0
  v_mov_b32 v59, 0
  v_mov_b32 v60, 0
  v_mov_b32 v61, 0
  v_mov_b32 v62, 0
  v_mov_b32 v63, 0
  s_add_u32 s51, s51, 1
  s_cmp_eq_u32 s51, 3
  s_cselect_b32 s61, s57, s56
  s_cselect_b32 s51, 0, s51
  s_add_u32 s44, s44, 1
  v_add_u32 v1, s61, v1
  s_add_u32 m0, s58, 21504
  s_nop 0
  buffer_load_dwordx4 v22, s[12:15], s70 offen nt lds
  s_add_u32 m0, s58, 20480
  s_nop 0
  buffer_load_dwordx4 v22, s[12:15], s53 offen offset:2048 nt lds
  v_mfma_f32_16x16x32_bf16 v[36:39], v[180:183], v[160:163], 0
  ds_read_b64_tr_b16 v[176:177], v2 offset:25600
  ds_read_b64_tr_b16 v[178:179], v2 offset:29696
  v_exp_f32 v12, v144
  s_add_u32 m0, s58, 21504
  s_nop 0
  buffer_load_dwordx4 v22, s[12:15], s70 offen offset:2048 nt lds
  s_add_u32 s53, s53, 4096
  s_xor_b32 s70, s53, 128
  s_add_u32 m0, s58, 24576
  s_nop 0
  buffer_load_dwordx4 v22, s[12:15], s53 offen nt lds
  s_waitcnt lgkmcnt(2)
  v_mfma_f32_16x16x32_bf16 v[40:43], v[184:187], v[160:163], 0
  ds_read_b64_tr_b16 v[180:181], v3 offset:25600
  ds_read_b64_tr_b16 v[182:183], v3 offset:29696
  v_exp_f32 v13, v145
  s_add_u32 m0, s58, 25600
  s_nop 0
  buffer_load_dwordx4 v22, s[12:15], s70 offen nt lds
  s_add_u32 m0, s58, 24576
  s_nop 0
  buffer_load_dwordx4 v22, s[12:15], s53 offen offset:2048 nt lds
  v_mfma_f32_16x16x32_bf16 v[44:47], v[188:191], v[160:163], 0
  ds_read_b64_tr_b16 v[184:185], v2 offset:26112
  ds_read_b64_tr_b16 v[186:187], v2 offset:30208
  v_exp_f32 v14, v146
  v_exp_f32 v15, v147
  s_add_u32 m0, s58, 25600
  s_nop 0
  buffer_load_dwordx4 v22, s[12:15], s70 offen offset:2048 nt lds
  s_add_u32 s53, s53, 4096
  s_xor_b32 s70, s53, 128
  s_add_u32 m0, s58, 28672
  s_nop 0
  buffer_load_dwordx4 v22, s[12:15], s53 offen nt lds
  s_waitcnt lgkmcnt(2)
  v_mfma_f32_16x16x32_bf16 v[48:51], v[176:179], v[160:163], 0
  ds_read_b64_tr_b16 v[188:189], v3 offset:26112
  ds_read_b64_tr_b16 v[190:191], v3 offset:30208
  v_cvt_pk_bf16_f32 v168, v12, v13
  v_add_f32 v7, v12, v13
  s_add_u32 m0, s58, 29696
  s_nop 0
  buffer_load_dwordx4 v22, s[12:15], s70 offen nt lds
  s_add_u32 m0, s58, 28672
  s_nop 0
  buffer_load_dwordx4 v22, s[12:15], s53 offen offset:2048 nt lds
  v_mfma_f32_16x16x32_bf16 v[52:55], v[180:183], v[160:163], 0
  v_add_u32 v2, s61, v2
  v_add_u32 v3, s61, v3
  v_exp_f32 v12, v148
  s_add_u32 m0, s58, 29696
  s_nop 0
  buffer_load_dwordx4 v22, s[12:15], s70 offen offset:2048 nt lds
  s_add_u32 s52, s52, 4096
  s_add_u32 s53, s53, 4096
  s_add_u32 s58, s58, 32768
  s_cmp_ge_u32 s58, 98304
  s_cselect_b32 s58, 0, s58
  s_waitcnt vmcnt(34) lgkmcnt(0)
  s_branch L_loop1_1
L_f2_1:
  s_barrier
  ds_read_b128 v[176:179], v1 offset:0
  ds_read_b128 v[180:183], v1 offset:512
  s_lshl_b32 s59, s40, 13
  s_add_u32 s59, s59, 131072
  v_add_u32 v18, s59, v4
  ds_read_b128 v[96:99], v18 offset:0
  ds_read_b128 v[100:103], v18 offset:1024
  ds_read_b128 v[104:107], v18 offset:2048
  ds_read_b128 v[108:111], v18 offset:3072
  v_mfma_f32_16x16x32_bf16 v[56:59], v[184:187], v[160:163], v[56:59]
  v_exp_f32 v13, v149
  v_cvt_pk_bf16_f32 v169, v14, v15
  v_mfma_f32_16x16x32_bf16 v[60:63], v[188:191], v[160:163], v[60:63]
  ds_read_b128 v[184:187], v1 offset:1024
  v_add_f32 v7, v7, v14
  v_add_f32 v7, v7, v15
  s_waitcnt lgkmcnt(5)
  s_waitcnt lgkmcnt(4)
  v_mfma_f32_16x16x32_bf16 v[128:131], v[176:179], v[96:99], 0
  ds_read_b128 v[188:191], v1 offset:1536
  v_exp_f32 v14, v150
  s_waitcnt lgkmcnt(4)
  v_mfma_f32_16x16x32_bf16 v[128:131], v[180:183], v[100:103], v[128:131]
  ds_read_b128 v[176:179], v1 offset:4096
  v_exp_f32 v15, v151
  v_cvt_pk_bf16_f32 v170, v12, v13
  s_waitcnt lgkmcnt(1)
  v_mfma_f32_16x16x32_bf16 v[128:131], v[184:187], v[104:107], v[128:131]
  ds_read_b128 v[180:183], v1 offset:4608
  v_add_f32 v7, v7, v12
  v_add_f32 v7, v7, v13
  v_mfma_f32_16x16x32_bf16 v[128:131], v[188:191], v[108:111], v[128:131]
  ds_read_b128 v[184:187], v1 offset:5120
  v_cvt_pk_bf16_f32 v171, v14, v15
  v_add_f32 v7, v7, v14
  s_waitcnt lgkmcnt(1)
  v_mfma_f32_16x16x32_bf16 v[132:135], v[176:179], v[96:99], 0
  ds_read_b128 v[188:191], v1 offset:5632
  v_add_f32 v7, v7, v15
  v_mfma_f32_16x16x32_bf16 v[132:135], v[180:183], v[100:103], v[132:135]
  ds_read_b64_tr_b16 v[176:177], v2 offset:16384
  ds_read_b64_tr_b16 v[178:179], v2 offset:20480
  s_waitcnt lgkmcnt(2)
  v_mfma_f32_16x16x32_bf16 v[132:135], v[184:187], v[104:107], v[132:135]
  ds_read_b64_tr_b16 v[180:181], v3 offset:16384
  ds_read_b64_tr_b16 v[182:183], v3 offset:20480
  v_mfma_f32_16x16x32_bf16 v[132:135], v[188:191], v[108:111], v[132:135]
  ds_read_b64_tr_b16 v[184:185], v2 offset:16896
  ds_read_b64_tr_b16 v[186:187], v2 offset:20992
  v_cmp_nge_f32 vcc, s49, v7
  s_nop 0
  s_cbranch_vccnz L_rare_30
L_back_31:
  v_add_f32 v5, v5, v7
  s_waitcnt lgkmcnt(2)
  v_mfma_f32_16x16x32_bf16 v[32:35], v[176:179], v[168:171], v[32:35]
  ds_read_b64_tr_b16 v[188:189], v3 offset:16896
  ds_read_b64_tr_b16 v[190:191], v3 offset:20992
  v_mov_b32 v16, v5
  s_nop 1
  v_permlane16_swap_b32 v5, v16
  v_add_f32 v5, v5, v16
  v_mfma_f32_16x16x32_bf16 v[36:39], v[180:183], v[168:171], v[36:39]
  ds_read_b64_tr_b16 v[176:177], v2 offset:17408
  ds_read_b64_tr_b16 v[178:179], v2 offset:21504
  v_mov_b32 v16, v5
  s_nop 1
  v_permlane32_swap_b32 v5, v16
  v_add_f32 v5, v5, v16
  v_rcp_f32 v16, v5
  s_waitcnt lgkmcnt(2)
  v_mfma_f32_16x16x32_bf16 v[40:43], v[184:187], v[168:171], v[40:43]
  ds_read_b64_tr_b16 v[180:181], v3 offset:17408
  ds_read_b64_tr_b16 v[182:183], v3 offset:21504
  v_max3_f32 v12, v128, v129, v130
  v_max3_f32 v13, v131, v132, v133
  v_max3_f32 v12, v12, v134, v135
  v_mfma_f32_16x16x32_bf16 v[44:47], v[188:191], v[168:171], v[44:47]
  ds_read_b64_tr_b16 v[184:185], v2 offset:17920
  ds_read_b64_tr_b16 v[186:187], v2 offset:22016
  v_max_f32 v12, v12, v13
  v_mov_b32 v13, v12
  s_nop 1
  v_permlane16_swap_b32 v12, v13
  s_waitcnt lgkmcnt(2)
  v_mfma_f32_16x16x32_bf16 v[48:51], v[176:179], v[168:171], v[48:51]
  ds_read_b64_tr_b16 v[188:189], v3 offset:17920
  ds_read_b64_tr_b16 v[190:191], v3 offset:22016
  v_max_f32 v12, v12, v13
  v_mov_b32 v13, v12
  s_nop 1
  v_permlane32_swap_b32 v12, v13
  v_max_f32 v12, v12, v13
  v_mfma_f32_16x16x32_bf16 v[52:55], v[180:183], v[168:171], v[52:55]
  ds_read_b128 v[176:179], v1 offset:8192
  v_sub_f32 v24, 0, v12
  v_sub_f32 v25, 0, v12
  v_sub_f32 v26, 0, v12
  v_sub_f32 v27, 0, v12
  buffer_load_dwordx4 v[64:67], v23, s[76:79], s80 offen
  s_add_u32 s80, s80, s81
  buffer_load_dwordx4 v[68:71], v23, s[76:79], s80 offen
  s_and_b32 s59, s44, s83
  s_cmp_eq_u32 s59, s83
  s_cselect_b32 s59, s82, s81
  s_add_u32 s80, s80, s59
  s_add_u32 m0, s58, 0
  s_nop 0
  buffer_load_dwordx4 v20, s[8:11], s52 offen nt lds
  s_waitcnt lgkmcnt(1)
  v_mfma_f32_16x16x32_bf16 v[56:59], v[184:187], v[168:171], v[56:59]
  ds_read_b128 v[180:183], v1 offset:8704
  v_add_f32 v128, v128, v24
  v_add_f32 v129, v129, v24
  v_add_f32 v130, v130, v24
  v_add_f32 v131, v131, v24
  v_add_f32 v132, v132, v24
  s_add_u32 m0, s58, 896
  s_nop 0
  buffer_load_dwordx4 v20, s[8:11], s52 offen offset:128 nt lds
  s_add_u32 m0, s58, 0
  s_nop 0
  buffer_load_dwordx4 v21, s[8:11], s52 offen offset:2048 nt lds
  v_mfma_f32_16x16x32_bf16 v[60:63], v[188:191], v[168:171], v[60:63]
  ds_read_b128 v[184:187], v1 offset:9216
  v_add_f32 v133, v133, v24
  v_add_f32 v134, v134, v24
  v_add_f32 v135, v135, v24
  v_exp_f32 v12, v128
  s_add_u32 m0, s58, 896
  s_nop 0
  buffer_load_dwordx4 v21, s[8:11], s52 offen offset:2176 nt lds
  s_add_u32 s52, s52, 4096
  s_add_u32 m0, s58, 4096
  s_nop 0
  buffer_load_dwordx4 v20, s[8:11], s52 offen nt lds
  s_waitcnt lgkmcnt(1)
  v_mfma_f32_16x16x32_bf16 v[144:147], v[176:179], v[96:99], v[24:27]
  ds_read_b128 v[188:191], v1 offset:9728
  v_exp_f32 v13, v129
  v_exp_f32 v14, v130
  v_exp_f32 v15, v131
  s_add_u32 m0, s58, 4992
  s_nop 0
  buffer_load_dwordx4 v20, s[8:11], s52 offen offset:128 nt lds
  s_add_u32 m0, s58, 4096
  s_nop 0
  buffer_load_dwordx4 v21, s[8:11], s52 offen offset:2048 nt lds
  v_mfma_f32_16x16x32_bf16 v[144:147], v[180:183], v[100:103], v[144:147]
  ds_read_b128 v[176:179], v1 offset:12288
  v_mul_f32 v32, v32, v16
  v_mul_f32 v33, v33, v16
  v_mul_f32 v34, v34, v16
  v_cvt_pk_bf16_f32 v160, v12, v13
  v_mul_f32 v35, v35, v16
  v_mul_f32 v36, v36, v16
  v_mul_f32 v37, v37, v16
  v_add_f32 v7, v12, v13
  v_mul_f32 v38, v38, v16
  v_mul_f32 v39, v39, v16
  s_add_u32 m0, s58, 4992
  s_nop 0
  buffer_load_dwordx4 v21, s[8:11], s52 offen offset:2176 nt lds
  s_add_u32 s52, s52, 4096
  s_add_u32 m0, s58, 8192
  s_nop 0
  buffer_load_dwordx4 v20, s[8:11], s52 offen nt lds
  s_waitcnt lgkmcnt(1)
  v_mfma_f32_16x16x32_bf16 v[144:147], v[184:187], v[104:107], v[144:147]
  ds_read_b128 v[180:183], v1 offset:12800
  v_cvt_pk_bf16_f32 v224, v32, v33
  v_exp_f32 v12, v132
  v_cvt_pk_bf16_f32 v225, v34, v35
  v_cvt_pk_bf16_f32 v226, v36, v37
  v_cvt_pk_bf16_f32 v227, v38, v39
  v_exp_f32 v13, v133
  v_mul_f32 v40, v40, v16
  v_mul_f32 v41, v41, v16
  s_add_u32 m0, s58, 9088
  s_nop 0
  buffer_load_dwordx4 v20, s[8:11], s52 offen offset:128 nt lds
  s_add_u32 m0, s58, 8192
  s_nop 0
  buffer_load_dwordx4 v21, s[8:11], s52 offen offset:2048 nt lds
  v_mfma_f32_16x16x32_bf16 v[144:147], v[188:191], v[108:111], v[144:147]
  ds_read_b128 v[184:187], v1 offset:13312
  v_mul_f32 v42, v42, v16
  v_cvt_pk_bf16_f32 v161, v14, v15
  v_mul_f32 v43, v43, v16
  v_mul_f32 v44, v44, v16
  v_mul_f32 v45, v45, v16
  v_add_f32 v7, v7, v14
  v_mul_f32 v46, v46, v16
  v_mul_f32 v47, v47, v16
  v_cvt_pk_bf16_f32 v228, v40, v41
  v_add_f32 v7, v7, v15
  s_add_u32 m0, s58, 9088
  s_nop 0
  buffer_load_dwordx4 v21, s[8:11], s52 offen offset:2176 nt lds
  s_add_u32 s52, s52, 4096
  s_add_u32 m0, s58, 12288
  s_nop 0
  buffer_load_dwordx4 v20, s[8:11], s52 offen nt lds
  s_waitcnt lgkmcnt(1)
  v_mfma_f32_16x16x32_bf16 v[148:151], v[176:179], v[96:99], v[24:27]
  ds_read_b128 v[188:191], v1 offset:13824
  v_cvt_pk_bf16_f32 v229, v42, v43
  v_cvt_pk_bf16_f32 v230, v44, v45
  v_cvt_pk_bf16_f32 v231, v46, v47
  v_exp_f32 v14, v134
  v_mul_f32 v48, v48, v16
  v_mul_f32 v49, v49, v16
  v_mul_f32 v50, v50, v16
  v_exp_f32 v15, v135
  v_mul_f32 v51, v51, v16
  s_add_u32 m0, s58, 13184
  s_nop 0
  buffer_load_dwordx4 v20, s[8:11], s52 offen offset:128 nt lds
  s_add_u32 m0, s58, 12288
  s_nop 0
  buffer_load_dwordx4 v21, s[8:11], s52 offen offset:2048 nt lds
  v_mfma_f32_16x16x32_bf16 v[148:151], v[180:183], v[100:103], v[148:151]
  ds_read_b64_tr_b16 v[176:177], v2 offset:24576
  ds_read_b64_tr_b16 v[178:179], v2 offset:28672
  v_mul_f32 v52, v52, v16
  v_mul_f32 v53, v53, v16
  v_cvt_pk_bf16_f32 v162, v12, v13
  v_mul_f32 v54, v54, v16
  v_mul_f32 v55, v55, v16
  v_cvt_pk_bf16_f32 v232, v48, v49
  v_add_f32 v7, v7, v12
  v_cvt_pk_bf16_f32 v233, v50, v51
  v_cvt_pk_bf16_f32 v234, v52, v53
  s_add_u32 m0, s58, 13184
  s_nop 0
  buffer_load_dwordx4 v21, s[8:11], s52 offen offset:2176 nt lds
  s_xor_b32 s70, s53, 128
  s_add_u32 m0, s58, 16384
  s_nop 0
  buffer_load_dwordx4 v22, s[12:15], s53 offen nt lds
  s_waitcnt lgkmcnt(2)
  v_mfma_f32_16x16x32_bf16 v[148:151], v[184:187], v[104:107], v[148:151]
  ds_read_b64_tr_b16 v[180:181], v3 offset:24576
  ds_read_b64_tr_b16 v[182:183], v3 offset:28672
  v_cvt_pk_bf16_f32 v235, v54, v55
  v_add_f32 v7, v7, v13
  v_mul_f32 v56, v56, v16
  v_mul_f32 v57, v57, v16
  v_mul_f32 v58, v58, v16
  v_cvt_pk_bf16_f32 v163, v14, v15
  v_mul_f32 v59, v59, v16
  v_mul_f32 v60, v60, v16
  v_mul_f32 v61, v61, v16
  s_add_u32 m0, s58, 17408
  s_nop 0
  buffer_load_dwordx4 v22, s[12:15], s70 offen nt lds
  s_add_u32 m0, s58, 16384
  s_nop 0
  buffer_load_dwordx4 v22, s[12:15], s53 offen offset:2048 nt lds
  v_mfma_f32_16x16x32_bf16 v[148:151], v[188:191], v[108:111], v[148:151]
  ds_read_b64_tr_b16 v[184:185], v2 offset:25088
  ds_read_b64_tr_b16 v[186:187], v2 offset:29184
  v_add_f32 v7, v7, v14
  v_mul_f32 v62, v62, v16
  v_mul_f32 v63, v63, v16
  v_cvt_pk_bf16_f32 v236, v56, v57
  v_add_f32 v7, v7, v15
  v_cvt_pk_bf16_f32 v237, v58, v59
  v_cvt_pk_bf16_f32 v238, v60, v61
  v_cvt_pk_bf16_f32 v239, v62, v63
  v_mov_b32 v5, v7
  s_add_u32 m0, s58, 17408
  s_nop 0
  buffer_load_dwordx4 v22, s[12:15], s70 offen offset:2048 nt lds
  s_add_u32 s53, s53, 4096
  s_xor_b32 s70, s53, 128
  s_add_u32 m0, s58, 20480
  s_nop 0
  buffer_load_dwordx4 v22, s[12:15], s53 offen nt lds
  s_waitcnt lgkmcnt(2)
  v_mfma_f32_16x16x32_bf16 v[32:35], v[176:179], v[160:163], 0
  ds_read_b64_tr_b16 v[188:189], v3 offset:25088
  ds_read_b64_tr_b16 v[190:191], v3 offset:29184
  v_mov_b32 v56, 0
  v_mov_b32 v57, 0
  v_mov_b32 v58, 0
  v_mov_b32 v59, 0
  v_mov_b32 v60, 0
  v_mov_b32 v61, 0
  v_mov_b32 v62, 0
  v_mov_b32 v63, 0
  s_add_u32 s51, s51, 1
  s_cmp_eq_u32 s51, 3
  s_cselect_b32 s61, s57, s56
  s_cselect_b32 s51, 0, s51
  s_add_u32 s44, s44, 1
  v_add_u32 v1, s61, v1
  s_add_u32 m0, s58, 21504
  s_nop 0
  buffer_load_dwordx4 v22, s[12:15], s70 offen nt lds
  s_add_u32 m0, s58, 20480
  s_nop 0
  buffer_load_dwordx4 v22, s[12:15], s53 offen offset:2048 nt lds
  v_mfma_f32_16x16x32_bf16 v[36:39], v[180:183], v[160:163], 0
  ds_read_b64_tr_b16 v[176:177], v2 offset:25600
  ds_read_b64_tr_b16 v[178:179], v2 offset:29696
  v_exp_f32 v12, v144
  s_add_u32 m0, s58, 21504
  s_nop 0
  buffer_load_dwordx4 v22, s[12:15], s70 offen offset:2048 nt lds
  s_add_u32 s53, s53, 4096
  s_xor_b32 s70, s53, 128
  s_add_u32 m0, s58, 24576
  s_nop 0
  buffer_load_dwordx4 v22, s[12:15], s53 offen nt lds
  s_waitcnt lgkmcnt(2)
  v_mfma_f32_16x16x32_bf16 v[40:43], v[184:187], v[160:163], 0
  ds_read_b64_tr_b16 v[180:181], v3 offset:25600
  ds_read_b64_tr_b16 v[182:183], v3 offset:29696
  v_exp_f32 v13, v145
  s_add_u32 m0, s58, 25600
  s_nop 0
  buffer_load_dwordx4 v22, s[12:15], s70 offen nt lds
  s_add_u32 m0, s58, 24576
  s_nop 0
  buffer_load_dwordx4 v22, s[12:15], s53 offen offset:2048 nt lds
  v_mfma_f32_16x16x32_bf16 v[44:47], v[188:191], v[160:163], 0
  ds_read_b64_tr_b16 v[184:185], v2 offset:26112
  ds_read_b64_tr_b16 v[186:187], v2 offset:30208
  v_exp_f32 v14, v146
  v_exp_f32 v15, v147
  s_add_u32 m0, s58, 25600
  s_nop 0
  buffer_load_dwordx4 v22, s[12:15], s70 offen offset:2048 nt lds
  s_add_u32 s53, s53, 4096
  s_xor_b32 s70, s53, 128
  s_add_u32 m0, s58, 28672
  s_nop 0
  buffer_load_dwordx4 v22, s[12:15], s53 offen nt lds
  s_waitcnt lgkmcnt(2)
  v_mfma_f32_16x16x32_bf16 v[48:51], v[176:179], v[160:163], 0
  ds_read_b64_tr_b16 v[188:189], v3 offset:26112
  ds_read_b64_tr_b16 v[190:191], v3 offset:30208
  v_cvt_pk_bf16_f32 v168, v12, v13
  v_add_f32 v7, v12, v13
  s_add_u32 m0, s58, 29696
  s_nop 0
  buffer_load_dwordx4 v22, s[12:15], s70 offen nt lds
  s_add_u32 m0, s58, 28672
  s_nop 0
  buffer_load_dwordx4 v22, s[12:15], s53 offen offset:2048 nt lds
  v_mfma_f32_16x16x32_bf16 v[52:55], v[180:183], v[160:163], 0
  v_add_u32 v2, s61, v2
  v_add_u32 v3, s61, v3
  v_exp_f32 v12, v148
  s_add_u32 m0, s58, 29696
  s_nop 0
  buffer_load_dwordx4 v22, s[12:15], s70 offen offset:2048 nt lds
  s_add_u32 s52, s52, 4096
  s_add_u32 s53, s53, 4096
  s_add_u32 s58, s58, 32768
  s_cmp_ge_u32 s58, 98304
  s_cselect_b32 s58, 0, s58
  s_waitcnt vmcnt(34) lgkmcnt(0)
  s_branch L_loop1_1
L_f3_1:
  s_barrier
  ds_read_b128 v[176:179], v1 offset:0
  ds_read_b128 v[180:183], v1 offset:512
  v_mfma_f32_16x16x32_bf16 v[56:59], v[184:187], v[160:163], v[56:59]
  v_mov_b32 v96, v192
  v_mov_b32 v97, v193
  v_mov_b32 v98, v194
  v_mov_b32 v99, v195
  v_mfma_f32_16x16x32_bf16 v[60:63], v[188:191], v[160:163], v[60:63]
  ds_read_b128 v[184:187], v1 offset:1024
  v_mov_b32 v100, v196
  v_mov_b32 v101, v197
  v_mov_b32 v102, v198
  v_mov_b32 v103, v199
  s_waitcnt lgkmcnt(1)
  v_mfma_f32_16x16x32_bf16 v[128:131], v[176:179], v[96:99], 0
  ds_read_b128 v[188:191], v1 offset:1536
  v_mov_b32 v104, v200
  v_mov_b32 v105, v201
  v_mov_b32 v106, v202
  v_mov_b32 v107, v203
  v_mfma_f32_16x16x32_bf16 v[128:131], v[180:183], v[100:103], v[128:131]
  ds_read_b128 v[176:179], v1 offset:4096
  v_mov_b32 v108, v204
  v_mov_b32 v109, v205
  v_mov_b32 v110, v206
  v_mov_b32 v111, v207
  s_waitcnt lgkmcnt(1)
  v_mfma_f32_16x16x32_bf16 v[128:131], v[184:187], v[104:107], v[128:131]
  ds_read_b128 v[180:183], v1 offset:4608
  v_exp_f32 v13, v149
  v_cvt_pk_bf16_f32 v169, v14, v15
  v_add_f32 v7, v7, v14
  v_mfma_f32_16x16x32_bf16 v[128:131], v[188:191], v[108:111], v[128:131]
  ds_read_b128 v[184:187], v1 offset:5120
  v_add_f32 v7, v7, v15
  v_exp_f32 v14, v150
  v_exp_f32 v15, v151
  s_waitcnt lgkmcnt(1)
  v_mfma_f32_16x16x32_bf16 v[132:135], v[176:179], v[96:99], 0
  ds_read_b128 v[188:191], v1 offset:5632
  v_cvt_pk_bf16_f32 v170, v12, v13
  v_add_f32 v7, v7, v12
  v_add_f32 v7, v7, v13
  v_mfma_f32_16x16x32_bf16 v[132:135], v[180:183], v[100:103], v[132:135]
  ds_read_b64_tr_b16 v[176:177], v2 offset:16384
  ds_read_b64_tr_b16 v[178:179], v2 offset:20480
  v_cvt_pk_bf16_f32 v171, v14, v15
  v_add_f32 v7, v7, v14
  v_add_f32 v7, v7, v15
  s_waitcnt lgkmcnt(2)
  v_mfma_f32_16x16x32_bf16 v[132:135], v[184:187], v[104:107], v[132:135]
  ds_read_b64_tr_b16 v[180:181], v3 offset:16384
  ds_read_b64_tr_b16 v[182:183], v3 offset:20480
  v_mfma_f32_16x16x32_bf16 v[132:135], v[188:191], v[108:111], v[132:135]
  ds_read_b64_tr_b16 v[184:185], v2 offset:16896
  ds_read_b64_tr_b16 v[186:187], v2 offset:20992
  v_cmp_nge_f32 vcc, s49, v7
  s_nop 0
  s_cbranch_vccnz L_rare_32
L_back_33:
  v_add_f32 v5, v5, v7
  s_waitcnt lgkmcnt(2)
  v_mfma_f32_16x16x32_bf16 v[32:35], v[176:179], v[168:171], v[32:35]
  ds_read_b64_tr_b16 v[188:189], v3 offset:16896
  ds_read_b64_tr_b16 v[190:191], v3 offset:20992
  v_mov_b32 v16, v5
  s_nop 1
  v_permlane16_swap_b32 v5, v16
  v_add_f32 v5, v5, v16
  v_mfma_f32_16x16x32_bf16 v[36:39], v[180:183], v[168:171], v[36:39]
  ds_read_b64_tr_b16 v[176:177], v2 offset:17408
  ds_read_b64_tr_b16 v[178:179], v2 offset:21504
  v_mov_b32 v16, v5
  s_nop 1
  v_permlane32_swap_b32 v5, v16
  v_add_f32 v5, v5, v16
  v_rcp_f32 v16, v5
  s_waitcnt lgkmcnt(2)
  v_mfma_f32_16x16x32_bf16 v[40:43], v[184:187], v[168:171], v[40:43]
  ds_read_b64_tr_b16 v[180:181], v3 offset:17408
  ds_read_b64_tr_b16 v[182:183], v3 offset:21504
  v_max3_f32 v12, v128, v129, v130
  v_max3_f32 v13, v131, v132, v133
  v_max3_f32 v12, v12, v134, v135
  v_mfma_f32_16x16x32_bf16 v[44:47], v[188:191], v[168:171], v[44:47]
  ds_read_b64_tr_b16 v[184:185], v2 offset:17920
  ds_read_b64_tr_b16 v[186:187], v2 offset:22016
  v_max_f32 v12, v12, v13
  v_mov_b32 v13, v12
  s_nop 1
  v_permlane16_swap_b32 v12, v13
  s_waitcnt lgkmcnt(2)
  v_mfma_f32_16x16x32_bf16 v[48:51], v[176:179], v[168:171], v[48:51]
  ds_read_b64_tr_b16 v[188:189], v3 offset:17920
  ds_read_b64_tr_b16 v[190:191], v3 offset:22016
  v_max_f32 v12, v12, v13
  v_mov_b32 v13, v12
  s_nop 1
  v_permlane32_swap_b32 v12, v13
  v_max_f32 v12, v12, v13
  v_mfma_f32_16x16x32_bf16 v[52:55], v[180:183], v[168:171], v[52:55]
  ds_read_b128 v[176:179], v1 offset:8192
  v_sub_f32 v24, 0, v12
  v_sub_f32 v25, 0, v12
  v_sub_f32 v26, 0, v12
  v_sub_f32 v27, 0, v12
  buffer_load_dwordx4 v[64:67], v23, s[76:79], s80 offen
  s_add_u32 s80, s80, s81
  buffer_load_dwordx4 v[68:71], v23, s[76:79], s80 offen
  s_and_b32 s59, s44, s83
  s_cmp_eq_u32 s59, s83
  s_cselect_b32 s59, s82, s81
  s_add_u32 s80, s80, s59
  s_add_u32 m0, s58, 0
  s_nop 0
  buffer_load_dwordx4 v20, s[8:11], s52 offen nt lds
  s_waitcnt lgkmcnt(1)
  v_mfma_f32_16x16x32_bf16 v[56:59], v[184:187], v[168:171], v[56:59]
  ds_read_b128 v[180:183], v1 offset:8704
  v_add_f32 v128, v128, v24
  v_add_f32 v129, v129, v24
  v_add_f32 v130, v130, v24
  v_add_f32 v131, v131, v24
  v_add_f32 v132, v132, v24
  s_add_u32 m0, s58, 896
  s_nop 0
  buffer_load_dwordx4 v20, s[8:11], s52 offen offset:128 nt lds
  s_add_u32 m0, s58, 0
  s_nop 0
  buffer_load_dwordx4 v21, s[8:11], s52 offen offset:2048 nt lds
  v_mfma_f32_16x16x32_bf16 v[60:63], v[188:191], v[168:171], v[60:63]
  ds_read_b128 v[184:187], v1 offset:9216
  v_add_f32 v133, v133, v24
  v_add_f32 v134, v134, v24
  v_add_f32 v135, v135, v24
  v_exp_f32 v12, v128
  s_add_u32 m0, s58, 896
  s_nop 0
  buffer_load_dwordx4 v21, s[8:11], s52 offen offset:2176 nt lds
  s_add_u32 s52, s52, 4096
  s_add_u32 m0, s58, 4096
  s_nop 0
  buffer_load_dwordx4 v20, s[8:11], s52 offen nt lds
  s_waitcnt lgkmcnt(1)
  v_mfma_f32_16x16x32_bf16 v[144:147], v[176:179], v[96:99], v[24:27]
  ds_read_b128 v[188:191], v1 offset:9728
  v_exp_f32 v13, v129
  v_exp_f32 v14, v130
  v_exp_f32 v15, v131
  s_add_u32 m0, s58, 4992
  s_nop 0
  buffer_load_dwordx4 v20, s[8:11], s52 offen offset:128 nt lds
  s_add_u32 m0, s58, 4096
  s_nop 0
  buffer_load_dwordx4 v21, s[8:11], s52 offen offset:2048 nt lds
  v_mfma_f32_16x16x32_bf16 v[144:147], v[180:183], v[100:103], v[144:147]
  ds_read_b128 v[176:179], v1 offset:12288
  v_mul_f32 v32, v32, v16
  v_mul_f32 v33, v33, v16
  v_mul_f32 v34, v34, v16
  v_cvt_pk_bf16_f32 v160, v12, v13
  v_mul_f32 v35, v35, v16
  v_mul_f32 v36, v36, v16
  v_mul_f32 v37, v37, v16
  v_add_f32 v7, v12, v13
  v_mul_f32 v38, v38, v16
  v_mul_f32 v39, v39, v16
  s_add_u32 m0, s58, 4992
  s_nop 0
  buffer_load_dwordx4 v21, s[8:11], s52 offen offset:2176 nt lds
  s_add_u32 s52, s52, 4096
  s_add_u32 m0, s58, 8192
  s_nop 0
  buffer_load_dwordx4 v20, s[8:11], s52 offen nt lds
  s_waitcnt lgkmcnt(1)
  v_mfma_f32_16x16x32_bf16 v[144:147], v[184:187], v[104:107], v[144:147]
  ds_read_b128 v[180:183], v1 offset:12800
  v_cvt_pk_bf16_f32 v192, v32, v33
  v_exp_f32 v12, v132
  v_cvt_pk_bf16_f32 v193, v34, v35
  v_cvt_pk_bf16_f32 v194, v36, v37
  v_cvt_pk_bf16_f32 v195, v38, v39
  v_exp_f32 v13, v133
  v_mul_f32 v40, v40, v16
  v_mul_f32 v41, v41, v16
  s_add_u32 m0, s58, 9088
  s_nop 0
  buffer_load_dwordx4 v20, s[8:11], s52 offen offset:128 nt lds
  s_add_u32 m0, s58, 8192
  s_nop 0
  buffer_load_dwordx4 v21, s[8:11], s52 offen offset:2048 nt lds
  v_mfma_f32_16x16x32_bf16 v[144:147], v[188:191], v[108:111], v[144:147]
  ds_read_b128 v[184:187], v1 offset:13312
  v_mul_f32 v42, v42, v16
  v_cvt_pk_bf16_f32 v161, v14, v15
  v_mul_f32 v43, v43, v16
  v_mul_f32 v44, v44, v16
  v_mul_f32 v45, v45, v16
  v_add_f32 v7, v7, v14
  v_mul_f32 v46, v46, v16
  v_mul_f32 v47, v47, v16
  v_cvt_pk_bf16_f32 v196, v40, v41
  v_add_f32 v7, v7, v15
  s_add_u32 m0, s58, 9088
  s_nop 0
  buffer_load_dwordx4 v21, s[8:11], s52 offen offset:2176 nt lds
  s_add_u32 s52, s52, 4096
  s_add_u32 m0, s58, 12288
  s_nop 0
  buffer_load_dwordx4 v20, s[8:11], s52 offen nt lds
  s_waitcnt lgkmcnt(1)
  v_mfma_f32_16x16x32_bf16 v[148:151], v[176:179], v[96:99], v[24:27]
  ds_read_b128 v[188:191], v1 offset:13824
  v_cvt_pk_bf16_f32 v197, v42, v43
  v_cvt_pk_bf16_f32 v198, v44, v45
  v_cvt_pk_bf16_f32 v199, v46, v47
  v_exp_f32 v14, v134
  v_mul_f32 v48, v48, v16
  v_mul_f32 v49, v49, v16
  v_mul_f32 v50, v50, v16
  v_exp_f32 v15, v135
  v_mul_f32 v51, v51, v16
  s_add_u32 m0, s58, 13184
  s_nop 0
  buffer_load_dwordx4 v20, s[8:11], s52 offen offset:128 nt lds
  s_add_u32 m0, s58, 12288
  s_nop 0
  buffer_load_dwordx4 v21, s[8:11], s52 offen offset:2048 nt lds
  v_mfma_f32_16x16x32_bf16 v[148:151], v[180:183], v[100:103], v[148:151]
  ds_read_b64_tr_b16 v[176:177], v2 offset:24576
  ds_read_b64_tr_b16 v[178:179], v2 offset:28672
  v_mul_f32 v52, v52, v16
  v_mul_f32 v53, v53, v16
  v_cvt_pk_bf16_f32 v162, v12, v13
  v_mul_f32 v54, v54, v16
  v_mul_f32 v55, v55, v16
  v_cvt_pk_bf16_f32 v200, v48, v49
  v_add_f32 v7, v7, v12
  v_cvt_pk_bf16_f32 v201, v50, v51
  v_cvt_pk_bf16_f32 v202, v52, v53
  s_add_u32 m0, s58, 13184
  s_nop 0
  buffer_load_dwordx4 v21, s[8:11], s52 offen offset:2176 nt lds
  s_xor_b32 s70, s53, 128
  s_add_u32 m0, s58, 16384
  s_nop 0
  buffer_load_dwordx4 v22, s[12:15], s53 offen nt lds
  s_waitcnt lgkmcnt(2)
  v_mfma_f32_16x16x32_bf16 v[148:151], v[184:187], v[104:107], v[148:151]
  ds_read_b64_tr_b16 v[180:181], v3 offset:24576
  ds_read_b64_tr_b16 v[182:183], v3 offset:28672
  v_cvt_pk_bf16_f32 v203, v54, v55
  v_add_f32 v7, v7, v13
  v_mul_f32 v56, v56, v16
  v_mul_f32 v57, v57, v16
  v_mul_f32 v58, v58, v16
  v_cvt_pk_bf16_f32 v163, v14, v15
  v_mul_f32 v59, v59, v16
  v_mul_f32 v60, v60, v16
  v_mul_f32 v61, v61, v16
  s_add_u32 m0, s58, 17408
  s_nop 0
  buffer_load_dwordx4 v22, s[12:15], s70 offen nt lds
  s_add_u32 m0, s58, 16384
  s_nop 0
  buffer_load_dwordx4 v22, s[12:15], s53 offen offset:2048 nt lds
  v_mfma_f32_16x16x32_bf16 v[148:151], v[188:191], v[108:111], v[148:151]
  ds_read_b64_tr_b16 v[184:185], v2 offset:25088
  ds_read_b64_tr_b16 v[186:187], v2 offset:29184
  v_add_f32 v7, v7, v14
  v_mul_f32 v62, v62, v16
  v_mul_f32 v63, v63, v16
  v_cvt_pk_bf16_f32 v204, v56, v57
  v_add_f32 v7, v7, v15
  v_cvt_pk_bf16_f32 v205, v58, v59
  v_cvt_pk_bf16_f32 v206, v60, v61
  v_cvt_pk_bf16_f32 v207, v62, v63
  v_mov_b32 v5, v7
  s_add_u32 m0, s58, 17408
  s_nop 0
  buffer_load_dwordx4 v22, s[12:15], s70 offen offset:2048 nt lds
  s_add_u32 s53, s53, 4096
  s_xor_b32 s70, s53, 128
  s_add_u32 m0, s58, 20480
  s_nop 0
  buffer_load_dwordx4 v22, s[12:15], s53 offen nt lds
  s_waitcnt lgkmcnt(2)
  v_mfma_f32_16x16x32_bf16 v[32:35], v[176:179], v[160:163], 0
  ds_read_b64_tr_b16 v[188:189], v3 offset:25088
  ds_read_b64_tr_b16 v[190:191], v3 offset:29184
  v_mov_b32 v56, 0
  v_mov_b32 v57, 0
  v_mov_b32 v58, 0
  v_mov_b32 v59, 0
  v_mov_b32 v60, 0
  v_mov_b32 v61, 0
  v_mov_b32 v62, 0
  v_mov_b32 v63, 0
  s_add_u32 s51, s51, 1
  s_cmp_eq_u32 s51, 3
  s_cselect_b32 s61, s57, s56
  s_cselect_b32 s51, 0, s51
  s_add_u32 s44, s44, 1
  v_add_u32 v1, s61, v1
  s_add_u32 m0, s58, 21504
  s_nop 0
  buffer_load_dwordx4 v22, s[12:15], s70 offen nt lds
  s_add_u32 m0, s58, 20480
  s_nop 0
  buffer_load_dwordx4 v22, s[12:15], s53 offen offset:2048 nt lds
  v_mfma_f32_16x16x32_bf16 v[36:39], v[180:183], v[160:163], 0
  ds_read_b64_tr_b16 v[176:177], v2 offset:25600
  ds_read_b64_tr_b16 v[178:179], v2 offset:29696
  v_exp_f32 v12, v144
  s_add_u32 m0, s58, 21504
  s_nop 0
  buffer_load_dwordx4 v22, s[12:15], s70 offen offset:2048 nt lds
  s_add_u32 s53, s53, 4096
  s_xor_b32 s70, s53, 128
  s_add_u32 m0, s58, 24576
  s_nop 0
  buffer_load_dwordx4 v22, s[12:15], s53 offen nt lds
  s_waitcnt lgkmcnt(2)
  v_mfma_f32_16x16x32_bf16 v[40:43], v[184:187], v[160:163], 0
  ds_read_b64_tr_b16 v[180:181], v3 offset:25600
  ds_read_b64_tr_b16 v[182:183], v3 offset:29696
  v_exp_f32 v13, v145
  s_add_u32 m0, s58, 25600
  s_nop 0
  buffer_load_dwordx4 v22, s[12:15], s70 offen nt lds
  s_add_u32 m0, s58, 24576
  s_nop 0
  buffer_load_dwordx4 v22, s[12:15], s53 offen offset:2048 nt lds
  v_mfma_f32_16x16x32_bf16 v[44:47], v[188:191], v[160:163], 0
  ds_read_b64_tr_b16 v[184:185], v2 offset:26112
  ds_read_b64_tr_b16 v[186:187], v2 offset:30208
  v_exp_f32 v14, v146
  v_exp_f32 v15, v147
  s_add_u32 m0, s58, 25600
  s_nop 0
  buffer_load_dwordx4 v22, s[12:15], s70 offen offset:2048 nt lds
  s_add_u32 s53, s53, 4096
  s_xor_b32 s70, s53, 128
  s_add_u32 m0, s58, 28672
  s_nop 0
  buffer_load_dwordx4 v22, s[12:15], s53 offen nt lds
  s_waitcnt lgkmcnt(2)
  v_mfma_f32_16x16x32_bf16 v[48:51], v[176:179], v[160:163], 0
  ds_read_b64_tr_b16 v[188:189], v3 offset:26112
  ds_read_b64_tr_b16 v[190:191], v3 offset:30208
  v_cvt_pk_bf16_f32 v168, v12, v13
  v_add_f32 v7, v12, v13
  s_add_u32 m0, s58, 29696
  s_nop 0
  buffer_load_dwordx4 v22, s[12:15], s70 offen nt lds
  s_add_u32 m0, s58, 28672
  s_nop 0
  buffer_load_dwordx4 v22, s[12:15], s53 offen offset:2048 nt lds
  v_mfma_f32_16x16x32_bf16 v[52:55], v[180:183], v[160:163], 0
  v_add_u32 v2, s61, v2
  v_add_u32 v3, s61, v3
  v_exp_f32 v12, v148
  s_add_u32 m0, s58, 29696
  s_nop 0
  buffer_load_dwordx4 v22, s[12:15], s70 offen offset:2048 nt lds
  s_add_u32 s52, s52, 4096
  s_add_u32 s53, s53, 4096
  s_add_u32 s58, s58, 32768
  s_cmp_ge_u32 s58, 98304
  s_cselect_b32 s58, 0, s58
  s_waitcnt vmcnt(34) lgkmcnt(0)
  s_branch L_loop1_0
L_tr_1:
  s_barrier
  ds_read_b128 v[176:179], v1 offset:0
  ds_read_b128 v[180:183], v1 offset:512
  v_mfma_f32_16x16x32_bf16 v[56:59], v[184:187], v[160:163], v[56:59]
  v_exp_f32 v13, v149
  s_lshl_b32 s59, s40, 11
  s_add_u32 s59, s59, 98304
  v_add_u32 v18, s59, v4
  ds_write_b128 v18, v[192:195] offset:0
  v_mfma_f32_16x16x32_bf16 v[60:63], v[188:191], v[160:163], v[60:63]
  ds_read_b128 v[184:187], v1 offset:1024
  s_lshl_b32 s59, s40, 11
  s_add_u32 s59, s59, 98304
  v_add_u32 v18, s59, v4
  ds_write_b128 v18, v[196:199] offset:8192
  s_waitcnt lgkmcnt(3)
  v_mfma_f32_16x16x32_bf16 v[128:131], v[176:179], v[96:99], v[24:27]
  ds_read_b128 v[188:191], v1 offset:1536
  v_cvt_pk_bf16_f32 v169, v14, v15
  s_lshl_b32 s59, s40, 11
  s_add_u32 s59, s59, 98304
  v_add_u32 v18, s59, v4
  ds_write_b128 v18, v[200:203] offset:16384
  v_mfma_f32_16x16x32_bf16 v[128:131], v[180:183], v[100:103], v[128:131]
  ds_read_b128 v[176:179], v1 offset:4096
  v_add_f32 v7, v7, v14
  s_lshl_b32 s59, s40, 11
  s_add_u32 s59, s59, 98304
  v_add_u32 v18, s59, v4
  ds_write_b128 v18, v[204:207] offset:24576
  s_waitcnt lgkmcnt(3)
  v_mfma_f32_16x16x32_bf16 v[128:131], v[184:187], v[104:107], v[128:131]
  ds_read_b128 v[180:183], v1 offset:4608
  s_lshl_b32 s59, s40, 13
  s_add_u32 s59, s59, 131072
  v_add_u32 v18, s59, v4
  ds_read_b128 v[192:195], v18 offset:0
  ds_read_b128 v[196:199], v18 offset:1024
  v_mfma_f32_16x16x32_bf16 v[128:131], v[188:191], v[108:111], v[128:131]
  ds_read_b128 v[184:187], v1 offset:5120
  v_add_f32 v7, v7, v15
  ds_read_b128 v[200:203], v18 offset:2048
  ds_read_b128 v[204:207], v18 offset:3072
  s_waitcnt lgkmcnt(5)
  v_mfma_f32_16x16x32_bf16 v[132:135], v[176:179], v[96:99], v[24:27]
  ds_read_b128 v[188:191], v1 offset:5632
  v_exp_f32 v14, v150
  v_exp_f32 v15, v151
  s_waitcnt lgkmcnt(1)
  s_barrier
  v_mfma_f32_16x16x32_bf16 v[132:135], v[180:183], v[100:103], v[132:135]
  ds_read_b64_tr_b16 v[176:177], v2 offset:16384
  ds_read_b64_tr_b16 v[178:179], v2 offset:20480
  v_cvt_pk_bf16_f32 v170, v12, v13
  v_add_f32 v7, v7, v12
  v_add_f32 v7, v7, v13
  v_mfma_f32_16x16x32_bf16 v[132:135], v[184:187], v[104:107], v[132:135]
  ds_read_b64_tr_b16 v[180:181], v3 offset:16384
  ds_read_b64_tr_b16 v[182:183], v3 offset:20480
  v_cvt_pk_bf16_f32 v171, v14, v15
  v_add_f32 v7, v7, v14
  v_add_f32 v7, v7, v15
  s_waitcnt lgkmcnt(2)
  v_mfma_f32_16x16x32_bf16 v[132:135], v[188:191], v[108:111], v[132:135]
  ds_read_b64_tr_b16 v[184:185], v2 offset:16896
  ds_read_b64_tr_b16 v[186:187], v2 offset:20992
  v_cmp_nge_f32 vcc, s49, v7
  s_nop 0
  s_cbranch_vccnz L_rare_34
L_back_35:
  v_add_f32 v5, v5, v7
  v_mfma_f32_16x16x32_bf16 v[32:35], v[176:179], v[168:171], v[32:35]
  ds_read_b64_tr_b16 v[188:189], v3 offset:16896
  ds_read_b64_tr_b16 v[190:191], v3 offset:20992
  s_waitcnt lgkmcnt(2)
  v_mfma_f32_16x16x32_bf16 v[36:39], v[180:183], v[168:171], v[36:39]
  ds_read_b64_tr_b16 v[176:177], v2 offset:17408
  ds_read_b64_tr_b16 v[178:179], v2 offset:21504
  v_exp_f32 v12, v128
  v_mfma_f32_16x16x32_bf16 v[40:43], v[184:187], v[168:171], v[40:43]
  ds_read_b64_tr_b16 v[180:181], v3 offset:17408
  ds_read_b64_tr_b16 v[182:183], v3 offset:21504
  v_exp_f32 v13, v129
  s_waitcnt lgkmcnt(2)
  v_mfma_f32_16x16x32_bf16 v[44:47], v[188:191], v[168:171], v[44:47]
  ds_read_b64_tr_b16 v[184:185], v2 offset:17920
  ds_read_b64_tr_b16 v[186:187], v2 offset:22016
  v_exp_f32 v14, v130
  buffer_load_dwordx4 v[64:67], v23, s[76:79], s80 offen
  s_add_u32 s80, s80, s81
  buffer_load_dwordx4 v[68:71], v23, s[76:79], s80 offen
  s_and_b32 s59, s44, s83
  s_cmp_eq_u32 s59, s83
  s_cselect_b32 s59, s82, s81
  s_add_u32 s80, s80, s59
  s_add_u32 m0, s58, 0
  s_nop 0
  buffer_load_dwordx4 v20, s[8:11], s52 offen nt lds
  v_mfma_f32_16x16x32_bf16 v[48:51], v[176:179], v[168:171], v[48:51]
  ds_read_b64_tr_b16 v[188:189], v3 offset:17920
  ds_read_b64_tr_b16 v[190:191], v3 offset:22016
  v_exp_f32 v15, v131
  s_add_u32 m0, s58, 896
  s_nop 0
  buffer_load_dwordx4 v20, s[8:11], s52 offen offset:128 nt lds
  s_add_u32 m0, s58, 0
  s_nop 0
  buffer_load_dwordx4 v21, s[8:11], s52 offen offset:2048 nt lds
  s_waitcnt lgkmcnt(2)
  v_mfma_f32_16x16x32_bf16 v[52:55], v[180:183], v[168:171], v[52:55]
  ds_read_b128 v[176:179], v1 offset:8192
  v_cvt_pk_bf16_f32 v160, v12, v13
  v_add_f32 v7, v12, v13
  s_add_u32 m0, s58, 896
  s_nop 0
  buffer_load_dwordx4 v21, s[8:11], s52 offen offset:2176 nt lds
  s_add_u32 s52, s52, 4096
  s_add_u32 m0, s58, 4096
  s_nop 0
  buffer_load_dwordx4 v20, s[8:11], s52 offen nt lds
  v_mfma_f32_16x16x32_bf16 v[56:59], v[184:187], v[168:171], v[56:59]
  ds_read_b128 v[180:183], v1 offset:8704
  v_exp_f32 v12, v132
  s_add_u32 m0, s58, 4992
  s_nop 0
  buffer_load_dwordx4 v20, s[8:11], s52 offen offset:128 nt lds
  s_add_u32 m0, s58, 4096
  s_nop 0
  buffer_load_dwordx4 v21, s[8:11], s52 offen offset:2048 nt lds
  s_waitcnt lgkmcnt(1)
  v_mfma_f32_16x16x32_bf16 v[60:63], v[188:191], v[168:171], v[60:63]
  ds_read_b128 v[184:187], v1 offset:9216
  v_exp_f32 v13, v133
  v_cvt_pk_bf16_f32 v161, v14, v15
  s_add_u32 m0, s58, 4992
  s_nop 0
  buffer_load_dwordx4 v21, s[8:11], s52 offen offset:2176 nt lds
  v_mfma_f32_16x16x32_bf16 v[144:147], v[176:179], v[96:99], v[24:27]
  ds_read_b128 v[188:191], v1 offset:9728
  v_add_f32 v7, v7, v14
  v_add_f32 v7, v7, v15
  s_add_u32 s52, s52, 4096
  s_add_u32 m0, s58, 8192
  s_nop 0
  buffer_load_dwordx4 v20, s[8:11], s52 offen nt lds
  s_add_u32 m0, s58, 9088
  s_nop 0
  buffer_load_dwordx4 v20, s[8:11], s52 offen offset:128 nt lds
  s_waitcnt lgkmcnt(1)
  v_mfma_f32_16x16x32_bf16 v[144:147], v[180:183], v[100:103], v[144:147]
  ds_read_b128 v[176:179], v1 offset:12288
  v_exp_f32 v14, v134
  v_exp_f32 v15, v135
  s_add_u32 m0, s58, 8192
  s_nop 0
  buffer_load_dwordx4 v21, s[8:11], s52 offen offset:2048 nt lds
  s_add_u32 m0, s58, 9088
  s_nop 0
  buffer_load_dwordx4 v21, s[8:11], s52 offen offset:2176 nt lds
  v_mfma_f32_16x16x32_bf16 v[144:147], v[184:187], v[104:107], v[144:147]
  ds_read_b128 v[180:183], v1 offset:12800
  v_cvt_pk_bf16_f32 v162, v12, v13
  v_add_f32 v7, v7, v12
  s_add_u32 s52, s52, 4096
  s_add_u32 m0, s58, 12288
  s_nop 0
  buffer_load_dwordx4 v20, s[8:11], s52 offen nt lds
  s_add_u32 m0, s58, 13184
  s_nop 0
  buffer_load_dwordx4 v20, s[8:11], s52 offen offset:128 nt lds
  s_waitcnt lgkmcnt(1)
  v_mfma_f32_16x16x32_bf16 v[144:147], v[188:191], v[108:111], v[144:147]
  ds_read_b128 v[184:187], v1 offset:13312
  v_add_f32 v7, v7, v13
  v_cvt_pk_bf16_f32 v163, v14, v15
  s_add_u32 m0, s58, 12288
  s_nop 0
  buffer_load_dwordx4 v21, s[8:11], s52 offen offset:2048 nt lds
  s_add_u32 m0, s58, 13184
  s_nop 0
  buffer_load_dwordx4 v21, s[8:11], s52 offen offset:2176 nt lds
  v_mfma_f32_16x16x32_bf16 v[148:151], v[176:179], v[96:99], v[24:27]
  ds_read_b128 v[188:191], v1 offset:13824
  v_add_f32 v7, v7, v14
  v_add_f32 v7, v7, v15
  s_xor_b32 s70, s53, 128
  s_add_u32 m0, s58, 16384
  s_nop 0
  buffer_load_dwordx4 v22, s[12:15], s53 offen nt lds
  s_waitcnt lgkmcnt(1)
  v_mfma_f32_16x16x32_bf16 v[148:151], v[180:183], v[100:103], v[148:151]
  ds_read_b64_tr_b16 v[176:177], v2 offset:24576
  ds_read_b64_tr_b16 v[178:179], v2 offset:28672
  s_add_u32 m0, s58, 17408
  s_nop 0
  buffer_load_dwordx4 v22, s[12:15], s70 offen nt lds
  s_add_u32 m0, s58, 16384
  s_nop 0
  buffer_load_dwordx4 v22, s[12:15], s53 offen offset:2048 nt lds
  v_mfma_f32_16x16x32_bf16 v[148:151], v[184:187], v[104:107], v[148:151]
  ds_read_b64_tr_b16 v[180:181], v3 offset:24576
  ds_read_b64_tr_b16 v[182:183], v3 offset:28672
  s_add_u32 m0, s58, 17408
  s_nop 0
  buffer_load_dwordx4 v22, s[12:15], s70 offen offset:2048 nt lds
  s_add_u32 s53, s53, 4096
  s_xor_b32 s70, s53, 128
  s_add_u32 m0, s58, 20480
  s_nop 0
  buffer_load_dwordx4 v22, s[12:15], s53 offen nt lds
  s_waitcnt lgkmcnt(2)
  v_mfma_f32_16x16x32_bf16 v[148:151], v[188:191], v[108:111], v[148:151]
  ds_read_b64_tr_b16 v[184:185], v2 offset:25088
  ds_read_b64_tr_b16 v[186:187], v2 offset:29184
  v_cmp_nge_f32 vcc, s49, v7
  s_nop 0
  s_cbranch_vccnz L_rare_36
L_back_37:
  v_add_f32 v5, v5, v7
  s_add_u32 m0, s58, 21504
  s_nop 0
  buffer_load_dwordx4 v22, s[12:15], s70 offen nt lds
  s_add_u32 m0, s58, 20480
  s_nop 0
  buffer_load_dwordx4 v22, s[12:15], s53 offen offset:2048 nt lds
  v_mfma_f32_16x16x32_bf16 v[32:35], v[176:179], v[160:163], v[32:35]
  ds_read_b64_tr_b16 v[188:189], v3 offset:25088
  ds_read_b64_tr_b16 v[190:191], v3 offset:29184
  s_add_u32 s51, s51, 1
  s_cmp_eq_u32 s51, 3
  s_cselect_b32 s61, s57, s56
  s_cselect_b32 s51, 0, s51
  s_add_u32 s44, s44, 1
  v_add_u32 v1, s61, v1
  s_add_u32 m0, s58, 21504
  s_nop 0
  buffer_load_dwordx4 v22, s[12:15], s70 offen offset:2048 nt lds
  s_add_u32 s53, s53, 4096
  s_xor_b32 s70, s53, 128
  s_add_u32 m0, s58, 24576
  s_nop 0
  buffer_load_dwordx4 v22, s[12:15], s53 offen nt lds
  s_waitcnt lgkmcnt(2)
  v_mfma_f32_16x16x32_bf16 v[36:39], v[180:183], v[160:163], v[36:39]
  ds_read_b64_tr_b16 v[176:177], v2 offset:25600
  ds_read_b64_tr_b16 v[178:179], v2 offset:29696
  v_exp_f32 v12, v144
  s_add_u32 m0, s58, 25600
  s_nop 0
  buffer_load_dwordx4 v22, s[12:15], s70 offen nt lds
  v_mfma_f32_16x16x32_bf16 v[40:43], v[184:187], v[160:163], v[40:43]
  ds_read_b64_tr_b16 v[180:181], v3 offset:25600
  ds_read_b64_tr_b16 v[182:183], v3 offset:29696
  v_exp_f32 v13, v145
  s_add_u32 m0, s58, 24576
  s_nop 0
  buffer_load_dwordx4 v22, s[12:15], s53 offen offset:2048 nt lds
  s_add_u32 m0, s58, 25600
  s_nop 0
  buffer_load_dwordx4 v22, s[12:15], s70 offen offset:2048 nt lds
  s_waitcnt lgkmcnt(2)
  v_mfma_f32_16x16x32_bf16 v[44:47], v[188:191], v[160:163], v[44:47]
  ds_read_b64_tr_b16 v[184:185], v2 offset:26112
  ds_read_b64_tr_b16 v[186:187], v2 offset:30208
  v_exp_f32 v14, v146
  v_exp_f32 v15, v147
  s_add_u32 s53, s53, 4096
  s_xor_b32 s70, s53, 128
  s_add_u32 m0, s58, 28672
  s_nop 0
  buffer_load_dwordx4 v22, s[12:15], s53 offen nt lds
  s_add_u32 m0, s58, 29696
  s_nop 0
  buffer_load_dwordx4 v22, s[12:15], s70 offen nt lds
  v_mfma_f32_16x16x32_bf16 v[48:51], v[176:179], v[160:163], v[48:51]
  ds_read_b64_tr_b16 v[188:189], v3 offset:26112
  ds_read_b64_tr_b16 v[190:191], v3 offset:30208
  v_cvt_pk_bf16_f32 v168, v12, v13
  v_add_f32 v7, v12, v13
  s_add_u32 m0, s58, 28672
  s_nop 0
  buffer_load_dwordx4 v22, s[12:15], s53 offen offset:2048 nt lds
  s_add_u32 m0, s58, 29696
  s_nop 0
  buffer_load_dwordx4 v22, s[12:15], s70 offen offset:2048 nt lds
  s_waitcnt lgkmcnt(2)
  v_mfma_f32_16x16x32_bf16 v[52:55], v[180:183], v[160:163], v[52:55]
  v_add_u32 v2, s61, v2
  v_add_u32 v3, s61, v3
  v_exp_f32 v12, v148
  s_add_u32 s52, s52, 4096
  s_add_u32 s53, s53, 4096
  s_add_u32 s58, s58, 32768
  s_cmp_ge_u32 s58, 98304
  s_cselect_b32 s58, 0, s58
  s_waitcnt vmcnt(34) lgkmcnt(0)
  s_branch L_loop1_1
L_hook1:
  s_cmp_eq_u32 s44, 24
  s_cbranch_scc1 L_hk23_1
  s_cmp_eq_u32 s44, 26
  s_cbranch_scc1 L_hk25_1
  s_cmp_eq_u32 s44, 27
  s_cbranch_scc1 L_hk26_1
  s_cmp_eq_u32 s44, 29
  s_cbranch_scc1 L_hk28_1
L_hk21_1:
  s_lshl_b32 s59, s40, 11
  s_add_u32 s59, s59, 98304
  v_add_u32 v18, s59, v4
  ds_write_b128 v18, v[224:227] offset:0
  s_lshl_b32 s59, s40, 11
  s_add_u32 s59, s59, 98304
  v_add_u32 v18, s59, v4
  ds_write_b128 v18, v[228:231] offset:8192
  s_branch L_hookback1_1
L_hk23_1:
  s_lshl_b32 s59, s40, 11
  s_add_u32 s59, s59, 98304
  v_add_u32 v18, s59, v4
  ds_write_b128 v18, v[232:235] offset:16384
  s_branch L_hookback1_1
L_hk25_1:
  s_lshl_b32 s59, s40, 11
  s_add_u32 s59, s59, 98304
  v_add_u32 v18, s59, v4
  ds_write_b128 v18, v[236:239] offset:24576
  s_lshl_b32 s59, s40, 11
  s_add_u32 s59, s59, 98304
  v_add_u32 v18, s59, v4
  ds_write_b128 v18, v[192:195] offset:0
  s_branch L_hookback1_0
L_hk26_1:
  s_lshl_b32 s59, s40, 11
  s_add_u32 s59, s59, 98304
  v_add_u32 v18, s59, v4
  ds_write_b128 v18, v[196:199] offset:8192
  s_branch L_hookback1_0
L_hk28_1:
  s_lshl_b32 s59, s40, 11
  s_add_u32 s59, s59, 98304
  v_add_u32 v18, s59, v4
  ds_write_b128 v18, v[200:203] offset:16384
  s_lshl_b32 s59, s40, 11
  s_add_u32 s59, s59, 98304
  v_add_u32 v18, s59, v4
  ds_write_b128 v18, v[204:207] offset:24576
  s_branch L_hookback1_0
L_last1:
  s_barrier
  ds_read_b64_tr_b16 v[176:177], v2 offset:16384
  ds_read_b64_tr_b16 v[178:179], v2 offset:20480
  ds_read_b64_tr_b16 v[180:181], v3 offset:16384
  ds_read_b64_tr_b16 v[182:183], v3 offset:20480
  v_mfma_f32_16x16x32_bf16 v[56:59], v[184:187], v[160:163], v[56:59]
  v_exp_f32 v13, v149
  v_cvt_pk_bf16_f32 v169, v14, v15
  v_add_f32 v7, v7, v14
  v_add_f32 v7, v7, v15
  v_exp_f32 v14, v150
  v_exp_f32 v15, v151
  v_mfma_f32_16x16x32_bf16 v[60:63], v[188:191], v[160:163], v[60:63]
  ds_read_b64_tr_b16 v[184:185], v2 offset:16896
  ds_read_b64_tr_b16 v[186:187], v2 offset:20992
  v_cvt_pk_bf16_f32 v170, v12, v13
  v_add_f32 v7, v7, v12
  v_add_f32 v7, v7, v13
  v_cvt_pk_bf16_f32 v171, v14, v15
  v_add_f32 v7, v7, v14
  v_add_f32 v7, v7, v15
  v_cmp_nge_f32 vcc, s49, v7
  s_nop 0
  s_cbranch_vccnz L_rare_38
L_back_39:
  v_add_f32 v5, v5, v7
  s_waitcnt lgkmcnt(2)
  v_mfma_f32_16x16x32_bf16 v[32:35], v[176:179], v[168:171], v[32:35]
  ds_read_b64_tr_b16 v[188:189], v3 offset:16896
  ds_read_b64_tr_b16 v[190:191], v3 offset:20992
  v_mov_b32 v16, v5
  v_mfma_f32_16x16x32_bf16 v[36:39], v[180:183], v[168:171], v[36:39]
  ds_read_b64_tr_b16 v[176:177], v2 offset:17408
  ds_read_b64_tr_b16 v[178:179], v2 offset:21504
  v_permlane16_swap_b32 v5, v16
  s_waitcnt lgkmcnt(2)
  v_mfma_f32_16x16x32_bf16 v[40:43], v[184:187], v[168:171], v[40:43]
  ds_read_b64_tr_b16 v[180:181], v3 offset:17408
  ds_read_b64_tr_b16 v[182:183], v3 offset:21504
  v_add_f32 v5, v5, v16
  v_mfma_f32_16x16x32_bf16 v[44:47], v[188:191], v[168:171], v[44:47]
  ds_read_b64_tr_b16 v[184:185], v2 offset:17920
  ds_read_b64_tr_b16 v[186:187], v2 offset:22016
  v_mov_b32 v16, v5
  s_waitcnt lgkmcnt(2)
  v_mfma_f32_16x16x32_bf16 v[48:51], v[176:179], v[168:171], v[48:51]
  ds_read_b64_tr_b16 v[188:189], v3 offset:17920
  ds_read_b64_tr_b16 v[190:191], v3 offset:22016
  v_permlane32_swap_b32 v5, v16
  v_mfma_f32_16x16x32_bf16 v[52:55], v[180:183], v[168:171], v[52:55]
  v_add_f32 v5, v5, v16
  s_waitcnt lgkmcnt(0)
  v_mfma_f32_16x16x32_bf16 v[56:59], v[184:187], v[168:171], v[56:59]
  v_rcp_f32 v16, v5
  v_mfma_f32_16x16x32_bf16 v[60:63], v[188:191], v[168:171], v[60:63]
  s_lshl_b32 s59, s40, 11
  s_add_u32 s59, s59, 32768
  v_add_u32 v18, s59, v4
  v_mul_f32 v32, v32, v16
  v_mul_f32 v33, v33, v16
  v_mul_f32 v34, v34, v16
  v_mul_f32 v35, v35, v16
  v_mul_f32 v36, v36, v16
  v_mul_f32 v37, v37, v16
  v_mul_f32 v38, v38, v16
  v_mul_f32 v39, v39, v16
  v_cvt_pk_bf16_f32 v224, v32, v33
  v_cvt_pk_bf16_f32 v225, v34, v35
  v_cvt_pk_bf16_f32 v226, v36, v37
  v_cvt_pk_bf16_f32 v227, v38, v39
  ds_write_b128 v18, v[224:227] offset:0
  v_mul_f32 v40, v40, v16
  v_mul_f32 v41, v41, v16
  v_mul_f32 v42, v42, v16
  v_mul_f32 v43, v43, v16
  v_mul_f32 v44, v44, v16
  v_mul_f32 v45, v45, v16
  v_mul_f32 v46, v46, v16
  v_mul_f32 v47, v47, v16
  v_cvt_pk_bf16_f32 v228, v40, v41
  v_cvt_pk_bf16_f32 v229, v42, v43
  v_cvt_pk_bf16_f32 v230, v44, v45
  v_cvt_pk_bf16_f32 v231, v46, v47
  ds_write_b128 v18, v[228:231] offset:8192
  v_mul_f32 v48, v48, v16
  v_mul_f32 v49, v49, v16
  v_mul_f32 v50, v50, v16
  v_mul_f32 v51, v51, v16
  v_mul_f32 v52, v52, v16
  v_mul_f32 v53, v53, v16
  v_mul_f32 v54, v54, v16
  v_mul_f32 v55, v55, v16
  v_cvt_pk_bf16_f32 v232, v48, v49
  v_cvt_pk_bf16_f32 v233, v50, v51
  v_cvt_pk_bf16_f32 v234, v52, v53
  v_cvt_pk_bf16_f32 v235, v54, v55
  ds_write_b128 v18, v[232:235] offset:16384
  v_mul_f32 v56, v56, v16
  v_mul_f32 v57, v57, v16
  v_mul_f32 v58, v58, v16
  v_mul_f32 v59, v59, v16
  v_mul_f32 v60, v60, v16
  v_mul_f32 v61, v61, v16
  v_mul_f32 v62, v62, v16
  v_mul_f32 v63, v63, v16
  v_cvt_pk_bf16_f32 v236, v56, v57
  v_cvt_pk_bf16_f32 v237, v58, v59
  v_cvt_pk_bf16_f32 v238, v60, v61
  v_cvt_pk_bf16_f32 v239, v62, v63
  ds_write_b128 v18, v[236:239] offset:24576
  s_waitcnt vmcnt(0) lgkmcnt(0)
  s_barrier
  s_barrier
  s_branch L_red2
L_rare_4:
  s_nop 15
  v_max3_f32 v12, v144, v145, v146
  v_max3_f32 v13, v147, v148, v149
  v_max3_f32 v12, v12, v150, v151
  v_max3_f32 v12, v12, v13, 0
  v_mov_b32 v13, v12
  s_nop 1
  v_permlane16_swap_b32 v12, v13
  v_max_f32 v12, v12, v13
  v_mov_b32 v13, v12
  s_nop 1
  v_permlane32_swap_b32 v12, v13
  v_max_f32 v12, v12, v13
  v_sub_f32 v24, v24, v12
  v_sub_f32 v25, v25, v12
  v_sub_f32 v26, v26, v12
  v_sub_f32 v27, v27, v12
  v_sub_f32 v144, v144, v12
  v_sub_f32 v145, v145, v12
  v_sub_f32 v146, v146, v12
  v_sub_f32 v147, v147, v12
  v_sub_f32 v148, v148, v12
  v_sub_f32 v149, v149, v12
  v_sub_f32 v150, v150, v12
  v_sub_f32 v151, v151, v12
  v_sub_f32 v128, v128, v12
  v_sub_f32 v129, v129, v12
  v_sub_f32 v130, v130, v12
  v_sub_f32 v131, v131, v12
  v_sub_f32 v132, v132, v12
  v_sub_f32 v133, v133, v12
  v_sub_f32 v134, v134, v12
  v_sub_f32 v135, v135, v12
  v_exp_f32 v13, -v12
  s_nop 0
  v_mul_f32 v5, v5, v13
  v_mul_f32 v32, v32, v13
  v_mul_f32 v33, v33, v13
  v_mul_f32 v34, v34, v13
  v_mul_f32 v35, v35, v13
  v_mul_f32 v36, v36, v13
  v_mul_f32 v37, v37, v13
  v_mul_f32 v38, v38, v13
  v_mul_f32 v39, v39, v13
  v_mul_f32 v40, v40, v13
  v_mul_f32 v41, v41, v13
  v_mul_f32 v42, v42, v13
  v_mul_f32 v43, v43, v13
  v_mul_f32 v44, v44, v13
  v_mul_f32 v45, v45, v13
  v_mul_f32 v46, v46, v13
  v_mul_f32 v47, v47, v13
  v_mul_f32 v48, v48, v13
  v_mul_f32 v49, v49, v13
  v_mul_f32 v50, v50, v13
  v_mul_f32 v51, v51, v13
  v_mul_f32 v52, v52, v13
  v_mul_f32 v53, v53, v13
  v_mul_f32 v54, v54, v13
  v_mul_f32 v55, v55, v13
  v_mul_f32 v56, v56, v13
  v_mul_f32 v57, v57, v13
  v_mul_f32 v58, v58, v13
  v_mul_f32 v59, v59, v13
  v_mul_f32 v60, v60, v13
  v_mul_f32 v61, v61, v13
  v_mul_f32 v62, v62, v13
  v_mul_f32 v63, v63, v13
  v_max3_f32 v14, v152, v153, v154
  v_max3_f32 v15, v155, v156, v157
  v_max3_f32 v14, v14, v158, v159
  v_max3_f32 v14, v14, v15, 0
  v_mov_b32 v15, v14
  s_nop 1
  v_permlane16_swap_b32 v14, v15
  v_max_f32 v14, v14, v15
  v_mov_b32 v15, v14
  s_nop 1
  v_permlane32_swap_b32 v14, v15
  v_max_f32 v14, v14, v15
  v_sub_f32 v28, v28, v14
  v_sub_f32 v29, v29, v14
  v_sub_f32 v30, v30, v14
  v_sub_f32 v31, v31, v14
  v_sub_f32 v152, v152, v14
  v_sub_f32 v153, v153, v14
  v_sub_f32 v154, v154, v14
  v_sub_f32 v155, v155, v14
  v_sub_f32 v156, v156, v14
  v_sub_f32 v157, v157, v14
  v_sub_f32 v158, v158, v14
  v_sub_f32 v159, v159, v14
  v_sub_f32 v136, v136, v14
  v_sub_f32 v137, v137, v14
  v_sub_f32 v138, v138, v14
  v_sub_f32 v139, v139, v14
  v_sub_f32 v140, v140, v14
  v_sub_f32 v141, v141, v14
  v_sub_f32 v142, v142, v14
  v_sub_f32 v143, v143, v14
  v_exp_f32 v15, -v14
  s_nop 0
  v_mul_f32 v6, v6, v15
  v_mul_f32 v64, v64, v15
  v_mul_f32 v65, v65, v15
  v_mul_f32 v66, v66, v15
  v_mul_f32 v67, v67, v15
  v_mul_f32 v68, v68, v15
  v_mul_f32 v69, v69, v15
  v_mul_f32 v70, v70, v15
  v_mul_f32 v71, v71, v15
  v_mul_f32 v72, v72, v15
  v_mul_f32 v73, v73, v15
  v_mul_f32 v74, v74, v15
  v_mul_f32 v75, v75, v15
  v_mul_f32 v76, v76, v15
  v_mul_f32 v77, v77, v15
  v_mul_f32 v78, v78, v15
  v_mul_f32 v79, v79, v15
  v_mul_f32 v80, v80, v15
  v_mul_f32 v81, v81, v15
  v_mul_f32 v82, v82, v15
  v_mul_f32 v83, v83, v15
  v_mul_f32 v84, v84, v15
  v_mul_f32 v85, v85, v15
  v_mul_f32 v86, v86, v15
  v_mul_f32 v87, v87, v15
  v_mul_f32 v88, v88, v15
  v_mul_f32 v89, v89, v15
  v_mul_f32 v90, v90, v15
  v_mul_f32 v91, v91, v15
  v_mul_f32 v92, v92, v15
  v_mul_f32 v93, v93, v15
  v_mul_f32 v94, v94, v15
  v_mul_f32 v95, v95, v15
  v_exp_f32 v12, v144
  v_exp_f32 v13, v145
  v_exp_f32 v14, v152
  v_exp_f32 v15, v153
  v_cvt_pk_bf16_f32 v168, v12, v13
  v_add_f32 v7, v12, v13
  v_exp_f32 v12, v146
  v_exp_f32 v13, v147
  v_cvt_pk_bf16_f32 v172, v14, v15
  v_add_f32 v8, v14, v15
  v_exp_f32 v14, v154
  v_exp_f32 v15, v155
  v_cvt_pk_bf16_f32 v169, v12, v13
  v_add_f32 v7, v7, v12
  v_add_f32 v7, v7, v13
  v_exp_f32 v12, v148
  v_exp_f32 v13, v149
  v_cvt_pk_bf16_f32 v173, v14, v15
  v_add_f32 v8, v8, v14
  v_add_f32 v8, v8, v15
  v_exp_f32 v14, v156
  v_exp_f32 v15, v157
  v_cvt_pk_bf16_f32 v170, v12, v13
  v_add_f32 v7, v7, v12
  v_add_f32 v7, v7, v13
  v_exp_f32 v12, v150
  v_exp_f32 v13, v151
  v_cvt_pk_bf16_f32 v174, v14, v15
  v_add_f32 v8, v8, v14
  v_add_f32 v8, v8, v15
  v_exp_f32 v14, v158
  v_exp_f32 v15, v159
  v_cvt_pk_bf16_f32 v171, v12, v13
  v_add_f32 v7, v7, v12
  v_add_f32 v7, v7, v13
  v_cvt_pk_bf16_f32 v175, v14, v15
  v_add_f32 v8, v8, v14
  v_add_f32 v8, v8, v15
  s_nop 1
  s_branch L_back_5
L_rare_6:
  s_nop 15
  v_max3_f32 v12, v128, v129, v130
  v_max3_f32 v13, v131, v132, v133
  v_max3_f32 v12, v12, v134, v135
  v_max3_f32 v12, v12, v13, 0
  v_mov_b32 v13, v12
  s_nop 1
  v_permlane16_swap_b32 v12, v13
  v_max_f32 v12, v12, v13
  v_mov_b32 v13, v12
  s_nop 1
  v_permlane32_swap_b32 v12, v13
  v_max_f32 v12, v12, v13
  v_sub_f32 v24, v24, v12
  v_sub_f32 v25, v25, v12
  v_sub_f32 v26, v26, v12
  v_sub_f32 v27, v27, v12
  v_sub_f32 v128, v128, v12
  v_sub_f32 v129, v129, v12
  v_sub_f32 v130, v130, v12
  v_sub_f32 v131, v131, v12
  v_sub_f32 v132, v132, v12
  v_sub_f32 v133, v133, v12
  v_sub_f32 v134, v134, v12
  v_sub_f32 v135, v135, v12
  v_sub_f32 v144, v144, v12
  v_sub_f32 v145, v145, v12
  v_sub_f32 v146, v146, v12
  v_sub_f32 v147, v147, v12
  v_sub_f32 v148, v148, v12
  v_sub_f32 v149, v149, v12
  v_sub_f32 v150, v150, v12
  v_sub_f32 v151, v151, v12
  v_exp_f32 v13, -v12
  s_nop 0
  v_mul_f32 v5, v5, v13
  v_mul_f32 v32, v32, v13
  v_mul_f32 v33, v33, v13
  v_mul_f32 v34, v34, v13
  v_mul_f32 v35, v35, v13
  v_mul_f32 v36, v36, v13
  v_mul_f32 v37, v37, v13
  v_mul_f32 v38, v38, v13
  v_mul_f32 v39, v39, v13
  v_mul_f32 v40, v40, v13
  v_mul_f32 v41, v41, v13
  v_mul_f32 v42, v42, v13
  v_mul_f32 v43, v43, v13
  v_mul_f32 v44, v44, v13
  v_mul_f32 v45, v45, v13
  v_mul_f32 v46, v46, v13
  v_mul_f32 v47, v47, v13
  v_mul_f32 v48, v48, v13
  v_mul_f32 v49, v49, v13
  v_mul_f32 v50, v50, v13
  v_mul_f32 v51, v51, v13
  v_mul_f32 v52, v52, v13
  v_mul_f32 v53, v53, v13
  v_mul_f32 v54, v54, v13
  v_mul_f32 v55, v55, v13
  v_mul_f32 v56, v56, v13
  v_mul_f32 v57, v57, v13
  v_mul_f32 v58, v58, v13
  v_mul_f32 v59, v59, v13
  v_mul_f32 v60, v60, v13
  v_mul_f32 v61, v61, v13
  v_mul_f32 v62, v62, v13
  v_mul_f32 v63, v63, v13
  v_max3_f32 v14, v136, v137, v138
  v_max3_f32 v15, v139, v140, v141
  v_max3_f32 v14, v14, v142, v143
  v_max3_f32 v14, v14, v15, 0
  v_mov_b32 v15, v14
  s_nop 1
  v_permlane16_swap_b32 v14, v15
  v_max_f32 v14, v14, v15
  v_mov_b32 v15, v14
  s_nop 1
  v_permlane32_swap_b32 v14, v15
  v_max_f32 v14, v14, v15
  v_sub_f32 v28, v28, v14
  v_sub_f32 v29, v29, v14
  v_sub_f32 v30, v30, v14
  v_sub_f32 v31, v31, v14
  v_sub_f32 v136, v136, v14
  v_sub_f32 v137, v137, v14
  v_sub_f32 v138, v138, v14
  v_sub_f32 v139, v139, v14
  v_sub_f32 v140, v140, v14
  v_sub_f32 v141, v141, v14
  v_sub_f32 v142, v142, v14
  v_sub_f32 v143, v143, v14
  v_sub_f32 v152, v152, v14
  v_sub_f32 v153, v153, v14
  v_sub_f32 v154, v154, v14
  v_sub_f32 v155, v155, v14
  v_sub_f32 v156, v156, v14
  v_sub_f32 v157, v157, v14
  v_sub_f32 v158, v158, v14
  v_sub_f32 v159, v159, v14
  v_exp_f32 v15, -v14
  s_nop 0
  v_mul_f32 v6, v6, v15
  v_mul_f32 v64, v64, v15
  v_mul_f32 v65, v65, v15
  v_mul_f32 v66, v66, v15
  v_mul_f32 v67, v67, v15
  v_mul_f32 v68, v68, v15
  v_mul_f32 v69, v69, v15
  v_mul_f32 v70, v70, v15
  v_mul_f32 v71, v71, v15
  v_mul_f32 v72, v72, v15
  v_mul_f32 v73, v73, v15
  v_mul_f32 v74, v74, v15
  v_mul_f32 v75, v75, v15
  v_mul_f32 v76, v76, v15
  v_mul_f32 v77, v77, v15
  v_mul_f32 v78, v78, v15
  v_mul_f32 v79, v79, v15
  v_mul_f32 v80, v80, v15
  v_mul_f32 v81, v81, v15
  v_mul_f32 v82, v82, v15
  v_mul_f32 v83, v83, v15
  v_mul_f32 v84, v84, v15
  v_mul_f32 v85, v85, v15
  v_mul_f32 v86, v86, v15
  v_mul_f32 v87, v87, v15
  v_mul_f32 v88, v88, v15
  v_mul_f32 v89, v89, v15
  v_mul_f32 v90, v90, v15
  v_mul_f32 v91, v91, v15
  v_mul_f32 v92, v92, v15
  v_mul_f32 v93, v93, v15
  v_mul_f32 v94, v94, v15
  v_mul_f32 v95, v95, v15
  v_exp_f32 v12, v128
  v_exp_f32 v13, v129
  v_exp_f32 v14, v136
  v_exp_f32 v15, v137
  v_cvt_pk_bf16_f32 v160, v12, v13
  v_add_f32 v7, v12, v13
  v_exp_f32 v12, v130
  v_exp_f32 v13, v131
  v_cvt_pk_bf16_f32 v164, v14, v15
  v_add_f32 v8, v14, v15
  v_exp_f32 v14, v138
  v_exp_f32 v15, v139
  v_cvt_pk_bf16_f32 v161, v12, v13
  v_add_f32 v7, v7, v12
  v_add_f32 v7, v7, v13
  v_exp_f32 v12, v132
  v_exp_f32 v13, v133
  v_cvt_pk_bf16_f32 v165, v14, v15
  v_add_f32 v8, v8, v14
  v_add_f32 v8, v8, v15
  v_exp_f32 v14, v140
  v_exp_f32 v15, v141
  v_cvt_pk_bf16_f32 v162, v12, v13
  v_add_f32 v7, v7, v12
  v_add_f32 v7, v7, v13
  v_exp_f32 v12, v134
  v_exp_f32 v13, v135
  v_cvt_pk_bf16_f32 v166, v14, v15
  v_add_f32 v8, v8, v14
  v_add_f32 v8, v8, v15
  v_exp_f32 v14, v142
  v_exp_f32 v15, v143
  v_cvt_pk_bf16_f32 v163, v12, v13
  v_add_f32 v7, v7, v12
  v_add_f32 v7, v7, v13
  v_cvt_pk_bf16_f32 v167, v14, v15
  v_add_f32 v8, v8, v14
  v_add_f32 v8, v8, v15
  s_nop 1
  s_branch L_back_7
L_rare_8:
  s_nop 15
  v_max3_f32 v12, v144, v145, v146
  v_max3_f32 v13, v147, v148, v149
  v_max3_f32 v12, v12, v150, v151
  v_max3_f32 v12, v12, v13, 0
  v_mov_b32 v13, v12
  s_nop 1
  v_permlane16_swap_b32 v12, v13
  v_max_f32 v12, v12, v13
  v_mov_b32 v13, v12
  s_nop 1
  v_permlane32_swap_b32 v12, v13
  v_max_f32 v12, v12, v13
  v_sub_f32 v24, v24, v12
  v_sub_f32 v25, v25, v12
  v_sub_f32 v26, v26, v12
  v_sub_f32 v27, v27, v12
  v_sub_f32 v144, v144, v12
  v_sub_f32 v145, v145, v12
  v_sub_f32 v146, v146, v12
  v_sub_f32 v147, v147, v12
  v_sub_f32 v148, v148, v12
  v_sub_f32 v149, v149, v12
  v_sub_f32 v150, v150, v12
  v_sub_f32 v151, v151, v12
  v_exp_f32 v13, -v12
  s_nop 0
  v_mul_f32 v5, v5, v13
  v_mul_f32 v32, v32, v13
  v_mul_f32 v33, v33, v13
  v_mul_f32 v34, v34, v13
  v_mul_f32 v35, v35, v13
  v_mul_f32 v36, v36, v13
  v_mul_f32 v37, v37, v13
  v_mul_f32 v38, v38, v13
  v_mul_f32 v39, v39, v13
  v_mul_f32 v40, v40, v13
  v_mul_f32 v41, v41, v13
  v_mul_f32 v42, v42, v13
  v_mul_f32 v43, v43, v13
  v_mul_f32 v44, v44, v13
  v_mul_f32 v45, v45, v13
  v_mul_f32 v46, v46, v13
  v_mul_f32 v47, v47, v13
  v_mul_f32 v48, v48, v13
  v_mul_f32 v49, v49, v13
  v_mul_f32 v50, v50, v13
  v_mul_f32 v51, v51, v13
  v_mul_f32 v52, v52, v13
  v_mul_f32 v53, v53, v13
  v_mul_f32 v54, v54, v13
  v_mul_f32 v55, v55, v13
  v_mul_f32 v56, v56, v13
  v_mul_f32 v57, v57, v13
  v_mul_f32 v58, v58, v13
  v_mul_f32 v59, v59, v13
  v_mul_f32 v60, v60, v13
  v_mul_f32 v61, v61, v13
  v_mul_f32 v62, v62, v13
  v_mul_f32 v63, v63, v13
  v_max3_f32 v14, v152, v153, v154
  v_max3_f32 v15, v155, v156, v157
  v_max3_f32 v14, v14, v158, v159
  v_max3_f32 v14, v14, v15, 0
  v_mov_b32 v15, v14
  s_nop 1
  v_permlane16_swap_b32 v14, v15
  v_max_f32 v14, v14, v15
  v_mov_b32 v15, v14
  s_nop 1
  v_permlane32_swap_b32 v14, v15
  v_max_f32 v14, v14, v15
  v_sub_f32 v28, v28, v14
  v_sub_f32 v29, v29, v14
  v_sub_f32 v30, v30, v14
  v_sub_f32 v31, v31, v14
  v_sub_f32 v152, v152, v14
  v_sub_f32 v153, v153, v14
  v_sub_f32 v154, v154, v14
  v_sub_f32 v155, v155, v14
  v_sub_f32 v156, v156, v14
  v_sub_f32 v157, v157, v14
  v_sub_f32 v158, v158, v14
  v_sub_f32 v159, v159, v14
  v_exp_f32 v15, -v14
  s_nop 0
  v_mul_f32 v6, v6, v15
  v_mul_f32 v64, v64, v15
  v_mul_f32 v65, v65, v15
  v_mul_f32 v66, v66, v15
  v_mul_f32 v67, v67, v15
  v_mul_f32 v68, v68, v15
  v_mul_f32 v69, v69, v15
  v_mul_f32 v70, v70, v15
  v_mul_f32 v71, v71, v15
  v_mul_f32 v72, v72, v15
  v_mul_f32 v73, v73, v15
  v_mul_f32 v74, v74, v15
  v_mul_f32 v75, v75, v15
  v_mul_f32 v76, v76, v15
  v_mul_f32 v77, v77, v15
  v_mul_f32 v78, v78, v15
  v_mul_f32 v79, v79, v15
  v_mul_f32 v80, v80, v15
  v_mul_f32 v81, v81, v15
  v_mul_f32 v82, v82, v15
  v_mul_f32 v83, v83, v15
  v_mul_f32 v84, v84, v15
  v_mul_f32 v85, v85, v15
  v_mul_f32 v86, v86, v15
  v_mul_f32 v87, v87, v15
  v_mul_f32 v88, v88, v15
  v_mul_f32 v89, v89, v15
  v_mul_f32 v90, v90, v15
  v_mul_f32 v91, v91, v15
  v_mul_f32 v92, v92, v15
  v_mul_f32 v93, v93, v15
  v_mul_f32 v94, v94, v15
  v_mul_f32 v95, v95, v15
  v_exp_f32 v12, v144
  v_exp_f32 v13, v145
  v_exp_f32 v14, v152
  v_exp_f32 v15, v153
  v_cvt_pk_bf16_f32 v168, v12, v13
  v_add_f32 v7, v12, v13
  v_exp_f32 v12, v146
  v_exp_f32 v13, v147
  v_cvt_pk_bf16_f32 v172, v14, v15
  v_add_f32 v8, v14, v15
  v_exp_f32 v14, v154
  v_exp_f32 v15, v155
  v_cvt_pk_bf16_f32 v169, v12, v13
  v_add_f32 v7, v7, v12
  v_add_f32 v7, v7, v13
  v_exp_f32 v12, v148
  v_exp_f32 v13, v149
  v_cvt_pk_bf16_f32 v173, v14, v15
  v_add_f32 v8, v8, v14
  v_add_f32 v8, v8, v15
  v_exp_f32 v14, v156
  v_exp_f32 v15, v157
  v_cvt_pk_bf16_f32 v170, v12, v13
  v_add_f32 v7, v7, v12
  v_add_f32 v7, v7, v13
  v_exp_f32 v12, v150
  v_exp_f32 v13, v151
  v_cvt_pk_bf16_f32 v174, v14, v15
  v_add_f32 v8, v8, v14
  v_add_f32 v8, v8, v15
  v_exp_f32 v14, v158
  v_exp_f32 v15, v159
  v_cvt_pk_bf16_f32 v171, v12, v13
  v_add_f32 v7, v7, v12
  v_add_f32 v7, v7, v13
  v_cvt_pk_bf16_f32 v175, v14, v15
  v_add_f32 v8, v8, v14
  v_add_f32 v8, v8, v15
  s_nop 1
  s_branch L_back_9
L_rare_10:
  s_nop 15
  v_max3_f32 v12, v144, v145, v146
  v_max3_f32 v13, v147, v148, v149
  v_max3_f32 v12, v12, v150, v151
  v_max3_f32 v12, v12, v13, 0
  v_mov_b32 v13, v12
  s_nop 1
  v_permlane16_swap_b32 v12, v13
  v_max_f32 v12, v12, v13
  v_mov_b32 v13, v12
  s_nop 1
  v_permlane32_swap_b32 v12, v13
  v_max_f32 v12, v12, v13
  v_sub_f32 v24, v24, v12
  v_sub_f32 v25, v25, v12
  v_sub_f32 v26, v26, v12
  v_sub_f32 v27, v27, v12
  v_sub_f32 v144, v144, v12
  v_sub_f32 v145, v145, v12
  v_sub_f32 v146, v146, v12
  v_sub_f32 v147, v147, v12
  v_sub_f32 v148, v148, v12
  v_sub_f32 v149, v149, v12
  v_sub_f32 v150, v150, v12
  v_sub_f32 v151, v151, v12
  v_exp_f32 v13, -v12
  s_nop 0
  v_mul_f32 v5, v5, v13
  v_mul_f32 v32, v32, v13
  v_mul_f32 v33, v33, v13
  v_mul_f32 v34, v34, v13
  v_mul_f32 v35, v35, v13
  v_mul_f32 v36, v36, v13
  v_mul_f32 v37, v37, v13
  v_mul_f32 v38, v38, v13
  v_mul_f32 v39, v39, v13
  v_mul_f32 v40, v40, v13
  v_mul_f32 v41, v41, v13
  v_mul_f32 v42, v42, v13
  v_mul_f32 v43, v43, v13
  v_mul_f32 v44, v44, v13
  v_mul_f32 v45, v45, v13
  v_mul_f32 v46, v46, v13
  v_mul_f32 v47, v47, v13
  v_mul_f32 v48, v48, v13
  v_mul_f32 v49, v49, v13
  v_mul_f32 v50, v50, v13
  v_mul_f32 v51, v51, v13
  v_mul_f32 v52, v52, v13
  v_mul_f32 v53, v53, v13
  v_mul_f32 v54, v54, v13
  v_mul_f32 v55, v55, v13
  v_mul_f32 v56, v56, v13
  v_mul_f32 v57, v57, v13
  v_mul_f32 v58, v58, v13
  v_mul_f32 v59, v59, v13
  v_mul_f32 v60, v60, v13
  v_mul_f32 v61, v61, v13
  v_mul_f32 v62, v62, v13
  v_mul_f32 v63, v63, v13
  v_max3_f32 v14, v152, v153, v154
  v_max3_f32 v15, v155, v156, v157
  v_max3_f32 v14, v14, v158, v159
  v_max3_f32 v14, v14, v15, 0
  v_mov_b32 v15, v14
  s_nop 1
  v_permlane16_swap_b32 v14, v15
  v_max_f32 v14, v14, v15
  v_mov_b32 v15, v14
  s_nop 1
  v_permlane32_swap_b32 v14, v15
  v_max_f32 v14, v14, v15
  v_sub_f32 v28, v28, v14
  v_sub_f32 v29, v29, v14
  v_sub_f32 v30, v30, v14
  v_sub_f32 v31, v31, v14
  v_sub_f32 v152, v152, v14
  v_sub_f32 v153, v153, v14
  v_sub_f32 v154, v154, v14
  v_sub_f32 v155, v155, v14
  v_sub_f32 v156, v156, v14
  v_sub_f32 v157, v157, v14
  v_sub_f32 v158, v158, v14
  v_sub_f32 v159, v159, v14
  v_exp_f32 v15, -v14
  s_nop 0
  v_mul_f32 v6, v6, v15
  v_mul_f32 v64, v64, v15
  v_mul_f32 v65, v65, v15
  v_mul_f32 v66, v66, v15
  v_mul_f32 v67, v67, v15
  v_mul_f32 v68, v68, v15
  v_mul_f32 v69, v69, v15
  v_mul_f32 v70, v70, v15
  v_mul_f32 v71, v71, v15
  v_mul_f32 v72, v72, v15
  v_mul_f32 v73, v73, v15
  v_mul_f32 v74, v74, v15
  v_mul_f32 v75, v75, v15
  v_mul_f32 v76, v76, v15
  v_mul_f32 v77, v77, v15
  v_mul_f32 v78, v78, v15
  v_mul_f32 v79, v79, v15
  v_mul_f32 v80, v80, v15
  v_mul_f32 v81, v81, v15
  v_mul_f32 v82, v82, v15
  v_mul_f32 v83, v83, v15
  v_mul_f32 v84, v84, v15
  v_mul_f32 v85, v85, v15
  v_mul_f32 v86, v86, v15
  v_mul_f32 v87, v87, v15
  v_mul_f32 v88, v88, v15
  v_mul_f32 v89, v89, v15
  v_mul_f32 v90, v90, v15
  v_mul_f32 v91, v91, v15
  v_mul_f32 v92, v92, v15
  v_mul_f32 v93, v93, v15
  v_mul_f32 v94, v94, v15
  v_mul_f32 v95, v95, v15
  v_exp_f32 v12, v144
  v_exp_f32 v13, v145
  v_exp_f32 v14, v152
  v_exp_f32 v15, v153
  v_cvt_pk_bf16_f32 v168, v12, v13
  v_add_f32 v7, v12, v13
  v_exp_f32 v12, v146
  v_exp_f32 v13, v147
  v_cvt_pk_bf16_f32 v172, v14, v15
  v_add_f32 v8, v14, v15
  v_exp_f32 v14, v154
  v_exp_f32 v15, v155
  v_cvt_pk_bf16_f32 v169, v12, v13
  v_add_f32 v7, v7, v12
  v_add_f32 v7, v7, v13
  v_exp_f32 v12, v148
  v_exp_f32 v13, v149
  v_cvt_pk_bf16_f32 v173, v14, v15
  v_add_f32 v8, v8, v14
  v_add_f32 v8, v8, v15
  v_exp_f32 v14, v156
  v_exp_f32 v15, v157
  v_cvt_pk_bf16_f32 v170, v12, v13
  v_add_f32 v7, v7, v12
  v_add_f32 v7, v7, v13
  v_exp_f32 v12, v150
  v_exp_f32 v13, v151
  v_cvt_pk_bf16_f32 v174, v14, v15
  v_add_f32 v8, v8, v14
  v_add_f32 v8, v8, v15
  v_exp_f32 v14, v158
  v_exp_f32 v15, v159
  v_cvt_pk_bf16_f32 v171, v12, v13
  v_add_f32 v7, v7, v12
  v_add_f32 v7, v7, v13
  v_cvt_pk_bf16_f32 v175, v14, v15
  v_add_f32 v8, v8, v14
  v_add_f32 v8, v8, v15
  s_nop 1
  s_branch L_back_11
L_rare_12:
  s_nop 15
  v_max3_f32 v12, v144, v145, v146
  v_max3_f32 v13, v147, v148, v149
  v_max3_f32 v12, v12, v150, v151
  v_max3_f32 v12, v12, v13, 0
  v_mov_b32 v13, v12
  s_nop 1
  v_permlane16_swap_b32 v12, v13
  v_max_f32 v12, v12, v13
  v_mov_b32 v13, v12
  s_nop 1
  v_permlane32_swap_b32 v12, v13
  v_max_f32 v12, v12, v13
  v_sub_f32 v24, v24, v12
  v_sub_f32 v25, v25, v12
  v_sub_f32 v26, v26, v12
  v_sub_f32 v27, v27, v12
  v_sub_f32 v144, v144, v12
  v_sub_f32 v145, v145, v12
  v_sub_f32 v146, v146, v12
  v_sub_f32 v147, v147, v12
  v_sub_f32 v148, v148, v12
  v_sub_f32 v149, v149, v12
  v_sub_f32 v150, v150, v12
  v_sub_f32 v151, v151, v12
  v_exp_f32 v13, -v12
  s_nop 0
  v_mul_f32 v5, v5, v13
  v_mul_f32 v32, v32, v13
  v_mul_f32 v33, v33, v13
  v_mul_f32 v34, v34, v13
  v_mul_f32 v35, v35, v13
  v_mul_f32 v36, v36, v13
  v_mul_f32 v37, v37, v13
  v_mul_f32 v38, v38, v13
  v_mul_f32 v39, v39, v13
  v_mul_f32 v40, v40, v13
  v_mul_f32 v41, v41, v13
  v_mul_f32 v42, v42, v13
  v_mul_f32 v43, v43, v13
  v_mul_f32 v44, v44, v13
  v_mul_f32 v45, v45, v13
  v_mul_f32 v46, v46, v13
  v_mul_f32 v47, v47, v13
  v_mul_f32 v48, v48, v13
  v_mul_f32 v49, v49, v13
  v_mul_f32 v50, v50, v13
  v_mul_f32 v51, v51, v13
  v_mul_f32 v52, v52, v13
  v_mul_f32 v53, v53, v13
  v_mul_f32 v54, v54, v13
  v_mul_f32 v55, v55, v13
  v_mul_f32 v56, v56, v13
  v_mul_f32 v57, v57, v13
  v_mul_f32 v58, v58, v13
  v_mul_f32 v59, v59, v13
  v_mul_f32 v60, v60, v13
  v_mul_f32 v61, v61, v13
  v_mul_f32 v62, v62, v13
  v_mul_f32 v63, v63, v13
  v_max3_f32 v14, v152, v153, v154
  v_max3_f32 v15, v155, v156, v157
  v_max3_f32 v14, v14, v158, v159
  v_max3_f32 v14, v14, v15, 0
  v_mov_b32 v15, v14
  s_nop 1
  v_permlane16_swap_b32 v14, v15
  v_max_f32 v14, v14, v15
  v_mov_b32 v15, v14
  s_nop 1
  v_permlane32_swap_b32 v14, v15
  v_max_f32 v14, v14, v15
  v_sub_f32 v28, v28, v14
  v_sub_f32 v29, v29, v14
  v_sub_f32 v30, v30, v14
  v_sub_f32 v31, v31, v14
  v_sub_f32 v152, v152, v14
  v_sub_f32 v153, v153, v14
  v_sub_f32 v154, v154, v14
  v_sub_f32 v155, v155, v14
  v_sub_f32 v156, v156, v14
  v_sub_f32 v157, v157, v14
  v_sub_f32 v158, v158, v14
  v_sub_f32 v159, v159, v14
  v_exp_f32 v15, -v14
  s_nop 0
  v_mul_f32 v6, v6, v15
  v_mul_f32 v64, v64, v15
  v_mul_f32 v65, v65, v15
  v_mul_f32 v66, v66, v15
  v_mul_f32 v67, v67, v15
  v_mul_f32 v68, v68, v15
  v_mul_f32 v69, v69, v15
  v_mul_f32 v70, v70, v15
  v_mul_f32 v71, v71, v15
  v_mul_f32 v72, v72, v15
  v_mul_f32 v73, v73, v15
  v_mul_f32 v74, v74, v15
  v_mul_f32 v75, v75, v15
  v_mul_f32 v76, v76, v15
  v_mul_f32 v77, v77, v15
  v_mul_f32 v78, v78, v15
  v_mul_f32 v79, v79, v15
  v_mul_f32 v80, v80, v15
  v_mul_f32 v81, v81, v15
  v_mul_f32 v82, v82, v15
  v_mul_f32 v83, v83, v15
  v_mul_f32 v84, v84, v15
  v_mul_f32 v85, v85, v15
  v_mul_f32 v86, v86, v15
  v_mul_f32 v87, v87, v15
  v_mul_f32 v88, v88, v15
  v_mul_f32 v89, v89, v15
  v_mul_f32 v90, v90, v15
  v_mul_f32 v91, v91, v15
  v_mul_f32 v92, v92, v15
  v_mul_f32 v93, v93, v15
  v_mul_f32 v94, v94, v15
  v_mul_f32 v95, v95, v15
  v_exp_f32 v12, v144
  v_exp_f32 v13, v145
  v_exp_f32 v14, v152
  v_exp_f32 v15, v153
  v_cvt_pk_bf16_f32 v168, v12, v13
  v_add_f32 v7, v12, v13
  v_exp_f32 v12, v146
  v_exp_f32 v13, v147
  v_cvt_pk_bf16_f32 v172, v14, v15
  v_add_f32 v8, v14, v15
  v_exp_f32 v14, v154
  v_exp_f32 v15, v155
  v_cvt_pk_bf16_f32 v169, v12, v13
  v_add_f32 v7, v7, v12
  v_add_f32 v7, v7, v13
  v_exp_f32 v12, v148
  v_exp_f32 v13, v149
  v_cvt_pk_bf16_f32 v173, v14, v15
  v_add_f32 v8, v8, v14
  v_add_f32 v8, v8, v15
  v_exp_f32 v14, v156
  v_exp_f32 v15, v157
  v_cvt_pk_bf16_f32 v170, v12, v13
  v_add_f32 v7, v7, v12
  v_add_f32 v7, v7, v13
  v_exp_f32 v12, v150
  v_exp_f32 v13, v151
  v_cvt_pk_bf16_f32 v174, v14, v15
  v_add_f32 v8, v8, v14
  v_add_f32 v8, v8, v15
  v_exp_f32 v14, v158
  v_exp_f32 v15, v159
  v_cvt_pk_bf16_f32 v171, v12, v13
  v_add_f32 v7, v7, v12
  v_add_f32 v7, v7, v13
  v_cvt_pk_bf16_f32 v175, v14, v15
  v_add_f32 v8, v8, v14
  v_add_f32 v8, v8, v15
  s_nop 1
  s_branch L_back_13
L_rare_14:
  s_nop 15
  v_max3_f32 v12, v144, v145, v146
  v_max3_f32 v13, v147, v148, v149
  v_max3_f32 v12, v12, v150, v151
  v_max3_f32 v12, v12, v13, 0
  v_mov_b32 v13, v12
  s_nop 1
  v_permlane16_swap_b32 v12, v13
  v_max_f32 v12, v12, v13
  v_mov_b32 v13, v12
  s_nop 1
  v_permlane32_swap_b32 v12, v13
  v_max_f32 v12, v12, v13
  v_sub_f32 v24, v24, v12
  v_sub_f32 v25, v25, v12
  v_sub_f32 v26, v26, v12
  v_sub_f32 v27, v27, v12
  v_sub_f32 v144, v144, v12
  v_sub_f32 v145, v145, v12
  v_sub_f32 v146, v146, v12
  v_sub_f32 v147, v147, v12
  v_sub_f32 v148, v148, v12
  v_sub_f32 v149, v149, v12
  v_sub_f32 v150, v150, v12
  v_sub_f32 v151, v151, v12
  v_sub_f32 v128, v128, v12
  v_sub_f32 v129, v129, v12
  v_sub_f32 v130, v130, v12
  v_sub_f32 v131, v131, v12
  v_sub_f32 v132, v132, v12
  v_sub_f32 v133, v133, v12
  v_sub_f32 v134, v134, v12
  v_sub_f32 v135, v135, v12
  v_exp_f32 v13, -v12
  s_nop 0
  v_mul_f32 v5, v5, v13
  v_mul_f32 v32, v32, v13
  v_mul_f32 v33, v33, v13
  v_mul_f32 v34, v34, v13
  v_mul_f32 v35, v35, v13
  v_mul_f32 v36, v36, v13
  v_mul_f32 v37, v37, v13
  v_mul_f32 v38, v38, v13
  v_mul_f32 v39, v39, v13
  v_mul_f32 v40, v40, v13
  v_mul_f32 v41, v41, v13
  v_mul_f32 v42, v42, v13
  v_mul_f32 v43, v43, v13
  v_mul_f32 v44, v44, v13
  v_mul_f32 v45, v45, v13
  v_mul_f32 v46, v46, v13
  v_mul_f32 v47, v47, v13
  v_mul_f32 v48, v48, v13
  v_mul_f32 v49, v49, v13
  v_mul_f32 v50, v50, v13
  v_mul_f32 v51, v51, v13
  v_mul_f32 v52, v52, v13
  v_mul_f32 v53, v53, v13
  v_mul_f32 v54, v54, v13
  v_mul_f32 v55, v55, v13
  v_mul_f32 v56, v56, v13
  v_mul_f32 v57, v57, v13
  v_mul_f32 v58, v58, v13
  v_mul_f32 v59, v59, v13
  v_mul_f32 v60, v60, v13
  v_mul_f32 v61, v61, v13
  v_mul_f32 v62, v62, v13
  v_mul_f32 v63, v63, v13
  v_max3_f32 v14, v152, v153, v154
  v_max3_f32 v15, v155, v156, v157
  v_max3_f32 v14, v14, v158, v159
  v_max3_f32 v14, v14, v15, 0
  v_mov_b32 v15, v14
  s_nop 1
  v_permlane16_swap_b32 v14, v15
  v_max_f32 v14, v14, v15
  v_mov_b32 v15, v14
  s_nop 1
  v_permlane32_swap_b32 v14, v15
  v_max_f32 v14, v14, v15
  v_sub_f32 v28, v28, v14
  v_sub_f32 v29, v29, v14
  v_sub_f32 v30, v30, v14
  v_sub_f32 v31, v31, v14
  v_sub_f32 v152, v152, v14
  v_sub_f32 v153, v153, v14
  v_sub_f32 v154, v154, v14
  v_sub_f32 v155, v155, v14
  v_sub_f32 v156, v156, v14
  v_sub_f32 v157, v157, v14
  v_sub_f32 v158, v158, v14
  v_sub_f32 v159, v159, v14
  v_sub_f32 v136, v136, v14
  v_sub_f32 v137, v137, v14
  v_sub_f32 v138, v138, v14
  v_sub_f32 v139, v139, v14
  v_sub_f32 v140, v140, v14
  v_sub_f32 v141, v141, v14
  v_sub_f32 v142, v142, v14
  v_sub_f32 v143, v143, v14
  v_exp_f32 v15, -v14
  s_nop 0
  v_mul_f32 v6, v6, v15
  v_mul_f32 v64, v64, v15
  v_mul_f32 v65, v65, v15
  v_mul_f32 v66, v66, v15
  v_mul_f32 v67, v67, v15
  v_mul_f32 v68, v68, v15
  v_mul_f32 v69, v69, v15
  v_mul_f32 v70, v70, v15
  v_mul_f32 v71, v71, v15
  v_mul_f32 v72, v72, v15
  v_mul_f32 v73, v73, v15
  v_mul_f32 v74, v74, v15
  v_mul_f32 v75, v75, v15
  v_mul_f32 v76, v76, v15
  v_mul_f32 v77, v77, v15
  v_mul_f32 v78, v78, v15
  v_mul_f32 v79, v79, v15
  v_mul_f32 v80, v80, v15
  v_mul_f32 v81, v81, v15
  v_mul_f32 v82, v82, v15
  v_mul_f32 v83, v83, v15
  v_mul_f32 v84, v84, v15
  v_mul_f32 v85, v85, v15
  v_mul_f32 v86, v86, v15
  v_mul_f32 v87, v87, v15
  v_mul_f32 v88, v88, v15
  v_mul_f32 v89, v89, v15
  v_mul_f32 v90, v90, v15
  v_mul_f32 v91, v91, v15
  v_mul_f32 v92, v92, v15
  v_mul_f32 v93, v93, v15
  v_mul_f32 v94, v94, v15
  v_mul_f32 v95, v95, v15
  v_exp_f32 v12, v144
  v_exp_f32 v13, v145
  v_exp_f32 v14, v152
  v_exp_f32 v15, v153
  v_cvt_pk_bf16_f32 v168, v12, v13
  v_add_f32 v7, v12, v13
  v_exp_f32 v12, v146
  v_exp_f32 v13, v147
  v_cvt_pk_bf16_f32 v172, v14, v15
  v_add_f32 v8, v14, v15
  v_exp_f32 v14, v154
  v_exp_f32 v15, v155
  v_cvt_pk_bf16_f32 v169, v12, v13
  v_add_f32 v7, v7, v12
  v_add_f32 v7, v7, v13
  v_exp_f32 v12, v148
  v_exp_f32 v13, v149
  v_cvt_pk_bf16_f32 v173, v14, v15
  v_add_f32 v8, v8, v14
  v_add_f32 v8, v8, v15
  v_exp_f32 v14, v156
  v_exp_f32 v15, v157
  v_cvt_pk_bf16_f32 v170, v12, v13
  v_add_f32 v7, v7, v12
  v_add_f32 v7, v7, v13
  v_exp_f32 v12, v150
  v_exp_f32 v13, v151
  v_cvt_pk_bf16_f32 v174, v14, v15
  v_add_f32 v8, v8, v14
  v_add_f32 v8, v8, v15
  v_exp_f32 v14, v158
  v_exp_f32 v15, v159
  v_cvt_pk_bf16_f32 v171, v12, v13
  v_add_f32 v7, v7, v12
  v_add_f32 v7, v7, v13
  v_cvt_pk_bf16_f32 v175, v14, v15
  v_add_f32 v8, v8, v14
  v_add_f32 v8, v8, v15
  s_nop 1
  s_branch L_back_15
L_rare_16:
  s_nop 15
  v_max3_f32 v12, v128, v129, v130
  v_max3_f32 v13, v131, v132, v133
  v_max3_f32 v12, v12, v134, v135
  v_max3_f32 v12, v12, v13, 0
  v_mov_b32 v13, v12
  s_nop 1
  v_permlane16_swap_b32 v12, v13
  v_max_f32 v12, v12, v13
  v_mov_b32 v13, v12
  s_nop 1
  v_permlane32_swap_b32 v12, v13
  v_max_f32 v12, v12, v13
  v_sub_f32 v24, v24, v12
  v_sub_f32 v25, v25, v12
  v_sub_f32 v26, v26, v12
  v_sub_f32 v27, v27, v12
  v_sub_f32 v128, v128, v12
  v_sub_f32 v129, v129, v12
  v_sub_f32 v130, v130, v12
  v_sub_f32 v131, v131, v12
  v_sub_f32 v132, v132, v12
  v_sub_f32 v133, v133, v12
  v_sub_f32 v134, v134, v12
  v_sub_f32 v135, v135, v12
  v_sub_f32 v144, v144, v12
  v_sub_f32 v145, v145, v12
  v_sub_f32 v146, v146, v12
  v_sub_f32 v147, v147, v12
  v_sub_f32 v148, v148, v12
  v_sub_f32 v149, v149, v12
  v_sub_f32 v150, v150, v12
  v_sub_f32 v151, v151, v12
  v_exp_f32 v13, -v12
  s_nop 0
  v_mul_f32 v5, v5, v13
  v_mul_f32 v32, v32, v13
  v_mul_f32 v33, v33, v13
  v_mul_f32 v34, v34, v13
  v_mul_f32 v35, v35, v13
  v_mul_f32 v36, v36, v13
  v_mul_f32 v37, v37, v13
  v_mul_f32 v38, v38, v13
  v_mul_f32 v39, v39, v13
  v_mul_f32 v40, v40, v13
  v_mul_f32 v41, v41, v13
  v_mul_f32 v42, v42, v13
  v_mul_f32 v43, v43, v13
  v_mul_f32 v44, v44, v13
  v_mul_f32 v45, v45, v13
  v_mul_f32 v46, v46, v13
  v_mul_f32 v47, v47, v13
  v_mul_f32 v48, v48, v13
  v_mul_f32 v49, v49, v13
  v_mul_f32 v50, v50, v13
  v_mul_f32 v51, v51, v13
  v_mul_f32 v52, v52, v13
  v_mul_f32 v53, v53, v13
  v_mul_f32 v54, v54, v13
  v_mul_f32 v55, v55, v13
  v_mul_f32 v56, v56, v13
  v_mul_f32 v57, v57, v13
  v_mul_f32 v58, v58, v13
  v_mul_f32 v59, v59, v13
  v_mul_f32 v60, v60, v13
  v_mul_f32 v61, v61, v13
  v_mul_f32 v62, v62, v13
  v_mul_f32 v63, v63, v13
  v_max3_f32 v14, v136, v137, v138
  v_max3_f32 v15, v139, v140, v141
  v_max3_f32 v14, v14, v142, v143
  v_max3_f32 v14, v14, v15, 0
  v_mov_b32 v15, v14
  s_nop 1
  v_permlane16_swap_b32 v14, v15
  v_max_f32 v14, v14, v15
  v_mov_b32 v15, v14
  s_nop 1
  v_permlane32_swap_b32 v14, v15
  v_max_f32 v14, v14, v15
  v_sub_f32 v28, v28, v14
  v_sub_f32 v29, v29, v14
  v_sub_f32 v30, v30, v14
  v_sub_f32 v31, v31, v14
  v_sub_f32 v136, v136, v14
  v_sub_f32 v137, v137, v14
  v_sub_f32 v138, v138, v14
  v_sub_f32 v139, v139, v14
  v_sub_f32 v140, v140, v14
  v_sub_f32 v141, v141, v14
  v_sub_f32 v142, v142, v14
  v_sub_f32 v143, v143, v14
  v_sub_f32 v152, v152, v14
  v_sub_f32 v153, v153, v14
  v_sub_f32 v154, v154, v14
  v_sub_f32 v155, v155, v14
  v_sub_f32 v156, v156, v14
  v_sub_f32 v157, v157, v14
  v_sub_f32 v158, v158, v14
  v_sub_f32 v159, v159, v14
  v_exp_f32 v15, -v14
  s_nop 0
  v_mul_f32 v6, v6, v15
  v_mul_f32 v64, v64, v15
  v_mul_f32 v65, v65, v15
  v_mul_f32 v66, v66, v15
  v_mul_f32 v67, v67, v15
  v_mul_f32 v68, v68, v15
  v_mul_f32 v69, v69, v15
  v_mul_f32 v70, v70, v15
  v_mul_f32 v71, v71, v15
  v_mul_f32 v72, v72, v15
  v_mul_f32 v73, v73, v15
  v_mul_f32 v74, v74, v15
  v_mul_f32 v75, v75, v15
  v_mul_f32 v76, v76, v15
  v_mul_f32 v77, v77, v15
  v_mul_f32 v78, v78, v15
  v_mul_f32 v79, v79, v15
  v_mul_f32 v80, v80, v15
  v_mul_f32 v81, v81, v15
  v_mul_f32 v82, v82, v15
  v_mul_f32 v83, v83, v15
  v_mul_f32 v84, v84, v15
  v_mul_f32 v85, v85, v15
  v_mul_f32 v86, v86, v15
  v_mul_f32 v87, v87, v15
  v_mul_f32 v88, v88, v15
  v_mul_f32 v89, v89, v15
  v_mul_f32 v90, v90, v15
  v_mul_f32 v91, v91, v15
  v_mul_f32 v92, v92, v15
  v_mul_f32 v93, v93, v15
  v_mul_f32 v94, v94, v15
  v_mul_f32 v95, v95, v15
  v_exp_f32 v12, v128
  v_exp_f32 v13, v129
  v_exp_f32 v14, v136
  v_exp_f32 v15, v137
  v_cvt_pk_bf16_f32 v160, v12, v13
  v_add_f32 v7, v12, v13
  v_exp_f32 v12, v130
  v_exp_f32 v13, v131
  v_cvt_pk_bf16_f32 v164, v14, v15
  v_add_f32 v8, v14, v15
  v_exp_f32 v14, v138
  v_exp_f32 v15, v139
  v_cvt_pk_bf16_f32 v161, v12, v13
  v_add_f32 v7, v7, v12
  v_add_f32 v7, v7, v13
  v_exp_f32 v12, v132
  v_exp_f32 v13, v133
  v_cvt_pk_bf16_f32 v165, v14, v15
  v_add_f32 v8, v8, v14
  v_add_f32 v8, v8, v15
  v_exp_f32 v14, v140
  v_exp_f32 v15, v141
  v_cvt_pk_bf16_f32 v162, v12, v13
  v_add_f32 v7, v7, v12
  v_add_f32 v7, v7, v13
  v_exp_f32 v12, v134
  v_exp_f32 v13, v135
  v_cvt_pk_bf16_f32 v166, v14, v15
  v_add_f32 v8, v8, v14
  v_add_f32 v8, v8, v15
  v_exp_f32 v14, v142
  v_exp_f32 v15, v143
  v_cvt_pk_bf16_f32 v163, v12, v13
  v_add_f32 v7, v7, v12
  v_add_f32 v7, v7, v13
  v_cvt_pk_bf16_f32 v167, v14, v15
  v_add_f32 v8, v8, v14
  v_add_f32 v8, v8, v15
  s_nop 1
  s_branch L_back_17
L_rare_18:
  s_nop 15
  v_max3_f32 v12, v144, v145, v146
  v_max3_f32 v13, v147, v148, v149
  v_max3_f32 v12, v12, v150, v151
  v_max3_f32 v12, v12, v13, 0
  v_mov_b32 v13, v12
  s_nop 1
  v_permlane16_swap_b32 v12, v13
  v_max_f32 v12, v12, v13
  v_mov_b32 v13, v12
  s_nop 1
  v_permlane32_swap_b32 v12, v13
  v_max_f32 v12, v12, v13
  v_sub_f32 v24, v24, v12
  v_sub_f32 v25, v25, v12
  v_sub_f32 v26, v26, v12
  v_sub_f32 v27, v27, v12
  v_sub_f32 v144, v144, v12
  v_sub_f32 v145, v145, v12
  v_sub_f32 v146, v146, v12
  v_sub_f32 v147, v147, v12
  v_sub_f32 v148, v148, v12
  v_sub_f32 v149, v149, v12
  v_sub_f32 v150, v150, v12
  v_sub_f32 v151, v151, v12
  v_exp_f32 v13, -v12
  s_nop 0
  v_mul_f32 v5, v5, v13
  v_mul_f32 v32, v32, v13
  v_mul_f32 v33, v33, v13
  v_mul_f32 v34, v34, v13
  v_mul_f32 v35, v35, v13
  v_mul_f32 v36, v36, v13
  v_mul_f32 v37, v37, v13
  v_mul_f32 v38, v38, v13
  v_mul_f32 v39, v39, v13
  v_mul_f32 v40, v40, v13
  v_mul_f32 v41, v41, v13
  v_mul_f32 v42, v42, v13
  v_mul_f32 v43, v43, v13
  v_mul_f32 v44, v44, v13
  v_mul_f32 v45, v45, v13
  v_mul_f32 v46, v46, v13
  v_mul_f32 v47, v47, v13
  v_mul_f32 v48, v48, v13
  v_mul_f32 v49, v49, v13
  v_mul_f32 v50, v50, v13
  v_mul_f32 v51, v51, v13
  v_mul_f32 v52, v52, v13
  v_mul_f32 v53, v53, v13
  v_mul_f32 v54, v54, v13
  v_mul_f32 v55, v55, v13
  v_mul_f32 v56, v56, v13
  v_mul_f32 v57, v57, v13
  v_mul_f32 v58, v58, v13
  v_mul_f32 v59, v59, v13
  v_mul_f32 v60, v60, v13
  v_mul_f32 v61, v61, v13
  v_mul_f32 v62, v62, v13
  v_mul_f32 v63, v63, v13
  v_max3_f32 v14, v152, v153, v154
  v_max3_f32 v15, v155, v156, v157
  v_max3_f32 v14, v14, v158, v159
  v_max3_f32 v14, v14, v15, 0
  v_mov_b32 v15, v14
  s_nop 1
  v_permlane16_swap_b32 v14, v15
  v_max_f32 v14, v14, v15
  v_mov_b32 v15, v14
  s_nop 1
  v_permlane32_swap_b32 v14, v15
  v_max_f32 v14, v14, v15
  v_sub_f32 v28, v28, v14
  v_sub_f32 v29, v29, v14
  v_sub_f32 v30, v30, v14
  v_sub_f32 v31, v31, v14
  v_sub_f32 v152, v152, v14
  v_sub_f32 v153, v153, v14
  v_sub_f32 v154, v154, v14
  v_sub_f32 v155, v155, v14
  v_sub_f32 v156, v156, v14
  v_sub_f32 v157, v157, v14
  v_sub_f32 v158, v158, v14
  v_sub_f32 v159, v159, v14
  v_exp_f32 v15, -v14
  s_nop 0
  v_mul_f32 v6, v6, v15
  v_mul_f32 v64, v64, v15
  v_mul_f32 v65, v65, v15
  v_mul_f32 v66, v66, v15
  v_mul_f32 v67, v67, v15
  v_mul_f32 v68, v68, v15
  v_mul_f32 v69, v69, v15
  v_mul_f32 v70, v70, v15
  v_mul_f32 v71, v71, v15
  v_mul_f32 v72, v72, v15
  v_mul_f32 v73, v73, v15
  v_mul_f32 v74, v74, v15
  v_mul_f32 v75, v75, v15
  v_mul_f32 v76, v76, v15
  v_mul_f32 v77, v77, v15
  v_mul_f32 v78, v78, v15
  v_mul_f32 v79, v79, v15
  v_mul_f32 v80, v80, v15
  v_mul_f32 v81, v81, v15
  v_mul_f32 v82, v82, v15
  v_mul_f32 v83, v83, v15
  v_mul_f32 v84, v84, v15
  v_mul_f32 v85, v85, v15
  v_mul_f32 v86, v86, v15
  v_mul_f32 v87, v87, v15
  v_mul_f32 v88, v88, v15
  v_mul_f32 v89, v89, v15
  v_mul_f32 v90, v90, v15
  v_mul_f32 v91, v91, v15
  v_mul_f32 v92, v92, v15
  v_mul_f32 v93, v93, v15
  v_mul_f32 v94, v94, v15
  v_mul_f32 v95, v95, v15
  v_exp_f32 v12, v144
  v_exp_f32 v13, v145
  v_exp_f32 v14, v152
  v_exp_f32 v15, v153
  v_cvt_pk_bf16_f32 v168, v12, v13
  v_add_f32 v7, v12, v13
  v_exp_f32 v12, v146
  v_exp_f32 v13, v147
  v_cvt_pk_bf16_f32 v172, v14, v15
  v_add_f32 v8, v14, v15
  v_exp_f32 v14, v154
  v_exp_f32 v15, v155
  v_cvt_pk_bf16_f32 v169, v12, v13
  v_add_f32 v7, v7, v12
  v_add_f32 v7, v7, v13
  v_exp_f32 v12, v148
  v_exp_f32 v13, v149
  v_cvt_pk_bf16_f32 v173, v14, v15
  v_add_f32 v8, v8, v14
  v_add_f32 v8, v8, v15
  v_exp_f32 v14, v156
  v_exp_f32 v15, v157
  v_cvt_pk_bf16_f32 v170, v12, v13
  v_add_f32 v7, v7, v12
  v_add_f32 v7, v7, v13
  v_exp_f32 v12, v150
  v_exp_f32 v13, v151
  v_cvt_pk_bf16_f32 v174, v14, v15
  v_add_f32 v8, v8, v14
  v_add_f32 v8, v8, v15
  v_exp_f32 v14, v158
  v_exp_f32 v15, v159
  v_cvt_pk_bf16_f32 v171, v12, v13
  v_add_f32 v7, v7, v12
  v_add_f32 v7, v7, v13
  v_cvt_pk_bf16_f32 v175, v14, v15
  v_add_f32 v8, v8, v14
  v_add_f32 v8, v8, v15
  s_nop 1
  s_branch L_back_19
L_rare_20:
  s_nop 15
  v_max3_f32 v12, v144, v145, v146
  v_max3_f32 v13, v147, v148, v149
  v_max3_f32 v12, v12, v150, v151
  v_max3_f32 v12, v12, v13, 0
  v_mov_b32 v13, v12
  s_nop 1
  v_permlane16_swap_b32 v12, v13
  v_max_f32 v12, v12, v13
  v_mov_b32 v13, v12
  s_nop 1
  v_permlane32_swap_b32 v12, v13
  v_max_f32 v12, v12, v13
  v_sub_f32 v24, v24, v12
  v_sub_f32 v25, v25, v12
  v_sub_f32 v26, v26, v12
  v_sub_f32 v27, v27, v12
  v_sub_f32 v144, v144, v12
  v_sub_f32 v145, v145, v12
  v_sub_f32 v146, v146, v12
  v_sub_f32 v147, v147, v12
  v_sub_f32 v148, v148, v12
  v_sub_f32 v149, v149, v12
  v_sub_f32 v150, v150, v12
  v_sub_f32 v151, v151, v12
  v_sub_f32 v128, v128, v12
  v_sub_f32 v129, v129, v12
  v_sub_f32 v130, v130, v12
  v_sub_f32 v131, v131, v12
  v_sub_f32 v132, v132, v12
  v_sub_f32 v133, v133, v12
  v_sub_f32 v134, v134, v12
  v_sub_f32 v135, v135, v12
  v_exp_f32 v13, -v12
  s_nop 0
  v_mul_f32 v5, v5, v13
  v_mul_f32 v32, v32, v13
  v_mul_f32 v33, v33, v13
  v_mul_f32 v34, v34, v13
  v_mul_f32 v35, v35, v13
  v_mul_f32 v36, v36, v13
  v_mul_f32 v37, v37, v13
  v_mul_f32 v38, v38, v13
  v_mul_f32 v39, v39, v13
  v_mul_f32 v40, v40, v13
  v_mul_f32 v41, v41, v13
  v_mul_f32 v42, v42, v13
  v_mul_f32 v43, v43, v13
  v_mul_f32 v44, v44, v13
  v_mul_f32 v45, v45, v13
  v_mul_f32 v46, v46, v13
  v_mul_f32 v47, v47, v13
  v_mul_f32 v48, v48, v13
  v_mul_f32 v49, v49, v13
  v_mul_f32 v50, v50, v13
  v_mul_f32 v51, v51, v13
  v_mul_f32 v52, v52, v13
  v_mul_f32 v53, v53, v13
  v_mul_f32 v54, v54, v13
  v_mul_f32 v55, v55, v13
  v_mul_f32 v56, v56, v13
  v_mul_f32 v57, v57, v13
  v_mul_f32 v58, v58, v13
  v_mul_f32 v59, v59, v13
  v_mul_f32 v60, v60, v13
  v_mul_f32 v61, v61, v13
  v_mul_f32 v62, v62, v13
  v_mul_f32 v63, v63, v13
  v_exp_f32 v12, v144
  v_exp_f32 v13, v145
  v_exp_f32 v14, v146
  v_exp_f32 v15, v147
  v_cvt_pk_bf16_f32 v168, v12, v13
  v_add_f32 v7, v12, v13
  v_exp_f32 v12, v148
  v_exp_f32 v13, v149
  v_cvt_pk_bf16_f32 v169, v14, v15
  v_add_f32 v7, v7, v14
  v_add_f32 v7, v7, v15
  v_exp_f32 v14, v150
  v_exp_f32 v15, v151
  v_cvt_pk_bf16_f32 v170, v12, v13
  v_add_f32 v7, v7, v12
  v_add_f32 v7, v7, v13
  v_cvt_pk_bf16_f32 v171, v14, v15
  v_add_f32 v7, v7, v14
  v_add_f32 v7, v7, v15
  s_nop 1
  s_branch L_back_21
L_rare_22:
  s_nop 15
  v_max3_f32 v12, v128, v129, v130
  v_max3_f32 v13, v131, v132, v133
  v_max3_f32 v12, v12, v134, v135
  v_max3_f32 v12, v12, v13, 0
  v_mov_b32 v13, v12
  s_nop 1
  v_permlane16_swap_b32 v12, v13
  v_max_f32 v12, v12, v13
  v_mov_b32 v13, v12
  s_nop 1
  v_permlane32_swap_b32 v12, v13
  v_max_f32 v12, v12, v13
  v_sub_f32 v24, v24, v12
  v_sub_f32 v25, v25, v12
  v_sub_f32 v26, v26, v12
  v_sub_f32 v27, v27, v12
  v_sub_f32 v128, v128, v12
  v_sub_f32 v129, v129, v12
  v_sub_f32 v130, v130, v12
  v_sub_f32 v131, v131, v12
  v_sub_f32 v132, v132, v12
  v_sub_f32 v133, v133, v12
  v_sub_f32 v134, v134, v12
  v_sub_f32 v135, v135, v12
  v_sub_f32 v144, v144, v12
  v_sub_f32 v145, v145, v12
  v_sub_f32 v146, v146, v12
  v_sub_f32 v147, v147, v12
  v_sub_f32 v148, v148, v12
  v_sub_f32 v149, v149, v12
  v_sub_f32 v150, v150, v12
  v_sub_f32 v151, v151, v12
  v_exp_f32 v13, -v12
  s_nop 0
  v_mul_f32 v5, v5, v13
  v_mul_f32 v32, v32, v13
  v_mul_f32 v33, v33, v13
  v_mul_f32 v34, v34, v13
  v_mul_f32 v35, v35, v13
  v_mul_f32 v36, v36, v13
  v_mul_f32 v37, v37, v13
  v_mul_f32 v38, v38, v13
  v_mul_f32 v39, v39, v13
  v_mul_f32 v40, v40, v13
  v_mul_f32 v41, v41, v13
  v_mul_f32 v42, v42, v13
  v_mul_f32 v43, v43, v13
  v_mul_f32 v44, v44, v13
  v_mul_f32 v45, v45, v13
  v_mul_f32 v46, v46, v13
  v_mul_f32 v47, v47, v13
  v_mul_f32 v48, v48, v13
  v_mul_f32 v49, v49, v13
  v_mul_f32 v50, v50, v13
  v_mul_f32 v51, v51, v13
  v_mul_f32 v52, v52, v13
  v_mul_f32 v53, v53, v13
  v_mul_f32 v54, v54, v13
  v_mul_f32 v55, v55, v13
  v_mul_f32 v56, v56, v13
  v_mul_f32 v57, v57, v13
  v_mul_f32 v58, v58, v13
  v_mul_f32 v59, v59, v13
  v_mul_f32 v60, v60, v13
  v_mul_f32 v61, v61, v13
  v_mul_f32 v62, v62, v13
  v_mul_f32 v63, v63, v13
  v_exp_f32 v12, v128
  v_exp_f32 v13, v129
  v_exp_f32 v14, v130
  v_exp_f32 v15, v131
  v_cvt_pk_bf16_f32 v160, v12, v13
  v_add_f32 v7, v12, v13
  v_exp_f32 v12, v132
  v_exp_f32 v13, v133
  v_cvt_pk_bf16_f32 v161, v14, v15
  v_add_f32 v7, v7, v14
  v_add_f32 v7, v7, v15
  v_exp_f32 v14, v134
  v_exp_f32 v15, v135
  v_cvt_pk_bf16_f32 v162, v12, v13
  v_add_f32 v7, v7, v12
  v_add_f32 v7, v7, v13
  v_cvt_pk_bf16_f32 v163, v14, v15
  v_add_f32 v7, v7, v14
  v_add_f32 v7, v7, v15
  s_nop 1
  s_branch L_back_23
L_rare_24:
  s_nop 15
  v_max3_f32 v12, v144, v145, v146
  v_max3_f32 v13, v147, v148, v149
  v_max3_f32 v12, v12, v150, v151
  v_max3_f32 v12, v12, v13, 0
  v_mov_b32 v13, v12
  s_nop 1
  v_permlane16_swap_b32 v12, v13
  v_max_f32 v12, v12, v13
  v_mov_b32 v13, v12
  s_nop 1
  v_permlane32_swap_b32 v12, v13
  v_max_f32 v12, v12, v13
  v_sub_f32 v24, v24, v12
  v_sub_f32 v25, v25, v12
  v_sub_f32 v26, v26, v12
  v_sub_f32 v27, v27, v12
  v_sub_f32 v144, v144, v12
  v_sub_f32 v145, v145, v12
  v_sub_f32 v146, v146, v12
  v_sub_f32 v147, v147, v12
  v_sub_f32 v148, v148, v12
  v_sub_f32 v149, v149, v12
  v_sub_f32 v150, v150, v12
  v_sub_f32 v151, v151, v12
  v_sub_f32 v128, v128, v12
  v_sub_f32 v129, v129, v12
  v_sub_f32 v130, v130, v12
  v_sub_f32 v131, v131, v12
  v_sub_f32 v132, v132, v12
  v_sub_f32 v133, v133, v12
  v_sub_f32 v134, v134, v12
  v_sub_f32 v135, v135, v12
  v_exp_f32 v13, -v12
  s_nop 0
  v_mul_f32 v5, v5, v13
  v_mul_f32 v32, v32, v13
  v_mul_f32 v33, v33, v13
  v_mul_f32 v34, v34, v13
  v_mul_f32 v35, v35, v13
  v_mul_f32 v36, v36, v13
  v_mul_f32 v37, v37, v13
  v_mul_f32 v38, v38, v13
  v_mul_f32 v39, v39, v13
  v_mul_f32 v40, v40, v13
  v_mul_f32 v41, v41, v13
  v_mul_f32 v42, v42, v13
  v_mul_f32 v43, v43, v13
  v_mul_f32 v44, v44, v13
  v_mul_f32 v45, v45, v13
  v_mul_f32 v46, v46, v13
  v_mul_f32 v47, v47, v13
  v_mul_f32 v48, v48, v13
  v_mul_f32 v49, v49, v13
  v_mul_f32 v50, v50, v13
  v_mul_f32 v51, v51, v13
  v_mul_f32 v52, v52, v13
  v_mul_f32 v53, v53, v13
  v_mul_f32 v54, v54, v13
  v_mul_f32 v55, v55, v13
  v_mul_f32 v56, v56, v13
  v_mul_f32 v57, v57, v13
  v_mul_f32 v58, v58, v13
  v_mul_f32 v59, v59, v13
  v_mul_f32 v60, v60, v13
  v_mul_f32 v61, v61, v13
  v_mul_f32 v62, v62, v13
  v_mul_f32 v63, v63, v13
  v_exp_f32 v12, v144
  v_exp_f32 v13, v145
  v_exp_f32 v14, v146
  v_exp_f32 v15, v147
  v_cvt_pk_bf16_f32 v168, v12, v13
  v_add_f32 v7, v12, v13
  v_exp_f32 v12, v148
  v_exp_f32 v13, v149
  v_cvt_pk_bf16_f32 v169, v14, v15
  v_add_f32 v7, v7, v14
  v_add_f32 v7, v7, v15
  v_exp_f32 v14, v150
  v_exp_f32 v15, v151
  v_cvt_pk_bf16_f32 v170, v12, v13
  v_add_f32 v7, v7, v12
  v_add_f32 v7, v7, v13
  v_cvt_pk_bf16_f32 v171, v14, v15
  v_add_f32 v7, v7, v14
  v_add_f32 v7, v7, v15
  s_nop 1
  s_branch L_back_25
L_rare_26:
  s_nop 15
  v_max3_f32 v12, v128, v129, v130
  v_max3_f32 v13, v131, v132, v133
  v_max3_f32 v12, v12, v134, v135
  v_max3_f32 v12, v12, v13, 0
  v_mov_b32 v13, v12
  s_nop 1
  v_permlane16_swap_b32 v12, v13
  v_max_f32 v12, v12, v13
  v_mov_b32 v13, v12
  s_nop 1
  v_permlane32_swap_b32 v12, v13
  v_max_f32 v12, v12, v13
  v_sub_f32 v24, v24, v12
  v_sub_f32 v25, v25, v12
  v_sub_f32 v26, v26, v12
  v_sub_f32 v27, v27, v12
  v_sub_f32 v128, v128, v12
  v_sub_f32 v129, v129, v12
  v_sub_f32 v130, v130, v12
  v_sub_f32 v131, v131, v12
  v_sub_f32 v132, v132, v12
  v_sub_f32 v133, v133, v12
  v_sub_f32 v134, v134, v12
  v_sub_f32 v135, v135, v12
  v_sub_f32 v144, v144, v12
  v_sub_f32 v145, v145, v12
  v_sub_f32 v146, v146, v12
  v_sub_f32 v147, v147, v12
  v_sub_f32 v148, v148, v12
  v_sub_f32 v149, v149, v12
  v_sub_f32 v150, v150, v12
  v_sub_f32 v151, v151, v12
  v_exp_f32 v13, -v12
  s_nop 0
  v_mul_f32 v5, v5, v13
  v_mul_f32 v32, v32, v13
  v_mul_f32 v33, v33, v13
  v_mul_f32 v34, v34, v13
  v_mul_f32 v35, v35, v13
  v_mul_f32 v36, v36, v13
  v_mul_f32 v37, v37, v13
  v_mul_f32 v38, v38, v13
  v_mul_f32 v39, v39, v13
  v_mul_f32 v40, v40, v13
  v_mul_f32 v41, v41, v13
  v_mul_f32 v42, v42, v13
  v_mul_f32 v43, v43, v13
  v_mul_f32 v44, v44, v13
  v_mul_f32 v45, v45, v13
  v_mul_f32 v46, v46, v13
  v_mul_f32 v47, v47, v13
  v_mul_f32 v48, v48, v13
  v_mul_f32 v49, v49, v13
  v_mul_f32 v50, v50, v13
  v_mul_f32 v51, v51, v13
  v_mul_f32 v52, v52, v13
  v_mul_f32 v53, v53, v13
  v_mul_f32 v54, v54, v13
  v_mul_f32 v55, v55, v13
  v_mul_f32 v56, v56, v13
  v_mul_f32 v57, v57, v13
  v_mul_f32 v58, v58, v13
  v_mul_f32 v59, v59, v13
  v_mul_f32 v60, v60, v13
  v_mul_f32 v61, v61, v13
  v_mul_f32 v62, v62, v13
  v_mul_f32 v63, v63, v13
  v_exp_f32 v12, v128
  v_exp_f32 v13, v129
  v_exp_f32 v14, v130
  v_exp_f32 v15, v131
  v_cvt_pk_bf16_f32 v160, v12, v13
  v_add_f32 v7, v12, v13
  v_exp_f32 v12, v132
  v_exp_f32 v13, v133
  v_cvt_pk_bf16_f32 v161, v14, v15
  v_add_f32 v7, v7, v14
  v_add_f32 v7, v7, v15
  v_exp_f32 v14, v134
  v_exp_f32 v15, v135
  v_cvt_pk_bf16_f32 v162, v12, v13
  v_add_f32 v7, v7, v12
  v_add_f32 v7, v7, v13
  v_cvt_pk_bf16_f32 v163, v14, v15
  v_add_f32 v7, v7, v14
  v_add_f32 v7, v7, v15
  s_nop 1
  s_branch L_back_27
L_rare_28:
  s_nop 15
  v_max3_f32 v12, v144, v145, v146
  v_max3_f32 v13, v147, v148, v149
  v_max3_f32 v12, v12, v150, v151
  v_max3_f32 v12, v12, v13, 0
  v_mov_b32 v13, v12
  s_nop 1
  v_permlane16_swap_b32 v12, v13
  v_max_f32 v12, v12, v13
  v_mov_b32 v13, v12
  s_nop 1
  v_permlane32_swap_b32 v12, v13
  v_max_f32 v12, v12, v13
  v_sub_f32 v24, v24, v12
  v_sub_f32 v25, v25, v12
  v_sub_f32 v26, v26, v12
  v_sub_f32 v27, v27, v12
  v_sub_f32 v144, v144, v12
  v_sub_f32 v145, v145, v12
  v_sub_f32 v146, v146, v12
  v_sub_f32 v147, v147, v12
  v_sub_f32 v148, v148, v12
  v_sub_f32 v149, v149, v12
  v_sub_f32 v150, v150, v12
  v_sub_f32 v151, v151, v12
  v_exp_f32 v13, -v12
  s_nop 0
  v_mul_f32 v5, v5, v13
  v_mul_f32 v32, v32, v13
  v_mul_f32 v33, v33, v13
  v_mul_f32 v34, v34, v13
  v_mul_f32 v35, v35, v13
  v_mul_f32 v36, v36, v13
  v_mul_f32 v37, v37, v13
  v_mul_f32 v38, v38, v13
  v_mul_f32 v39, v39, v13
  v_mul_f32 v40, v40, v13
  v_mul_f32 v41, v41, v13
  v_mul_f32 v42, v42, v13
  v_mul_f32 v43, v43, v13
  v_mul_f32 v44, v44, v13
  v_mul_f32 v45, v45, v13
  v_mul_f32 v46, v46, v13
  v_mul_f32 v47, v47, v13
  v_mul_f32 v48, v48, v13
  v_mul_f32 v49, v49, v13
  v_mul_f32 v50, v50, v13
  v_mul_f32 v51, v51, v13
  v_mul_f32 v52, v52, v13
  v_mul_f32 v53, v53, v13
  v_mul_f32 v54, v54, v13
  v_mul_f32 v55, v55, v13
  v_mul_f32 v56, v56, v13
  v_mul_f32 v57, v57, v13
  v_mul_f32 v58, v58, v13
  v_mul_f32 v59, v59, v13
  v_mul_f32 v60, v60, v13
  v_mul_f32 v61, v61, v13
  v_mul_f32 v62, v62, v13
  v_mul_f32 v63, v63, v13
  v_exp_f32 v12, v144
  v_exp_f32 v13, v145
  v_exp_f32 v14, v146
  v_exp_f32 v15, v147
  v_cvt_pk_bf16_f32 v168, v12, v13
  v_add_f32 v7, v12, v13
  v_exp_f32 v12, v148
  v_exp_f32 v13, v149
  v_cvt_pk_bf16_f32 v169, v14, v15
  v_add_f32 v7, v7, v14
  v_add_f32 v7, v7, v15
  v_exp_f32 v14, v150
  v_exp_f32 v15, v151
  v_cvt_pk_bf16_f32 v170, v12, v13
  v_add_f32 v7, v7, v12
  v_add_f32 v7, v7, v13
  v_cvt_pk_bf16_f32 v171, v14, v15
  v_add_f32 v7, v7, v14
  v_add_f32 v7, v7, v15
  s_nop 1
  s_branch L_back_29
L_rare_30:
  s_nop 15
  v_max3_f32 v12, v144, v145, v146
  v_max3_f32 v13, v147, v148, v149
  v_max3_f32 v12, v12, v150, v151
  v_max3_f32 v12, v12, v13, 0
  v_mov_b32 v13, v12
  s_nop 1
  v_permlane16_swap_b32 v12, v13
  v_max_f32 v12, v12, v13
  v_mov_b32 v13, v12
  s_nop 1
  v_permlane32_swap_b32 v12, v13
  v_max_f32 v12, v12, v13
  v_sub_f32 v24, v24, v12
  v_sub_f32 v25, v25, v12
  v_sub_f32 v26, v26, v12
  v_sub_f32 v27, v27, v12
  v_sub_f32 v144, v144, v12
  v_sub_f32 v145, v145, v12
  v_sub_f32 v146, v146, v12
  v_sub_f32 v147, v147, v12
  v_sub_f32 v148, v148, v12
  v_sub_f32 v149, v149, v12
  v_sub_f32 v150, v150, v12
  v_sub_f32 v151, v151, v12
  v_exp_f32 v13, -v12
  s_nop 0
  v_mul_f32 v5, v5, v13
  v_mul_f32 v32, v32, v13
  v_mul_f32 v33, v33, v13
  v_mul_f32 v34, v34, v13
  v_mul_f32 v35, v35, v13
  v_mul_f32 v36, v36, v13
  v_mul_f32 v37, v37, v13
  v_mul_f32 v38, v38, v13
  v_mul_f32 v39, v39, v13
  v_mul_f32 v40, v40, v13
  v_mul_f32 v41, v41, v13
  v_mul_f32 v42, v42, v13
  v_mul_f32 v43, v43, v13
  v_mul_f32 v44, v44, v13
  v_mul_f32 v45, v45, v13
  v_mul_f32 v46, v46, v13
  v_mul_f32 v47, v47, v13
  v_mul_f32 v48, v48, v13
  v_mul_f32 v49, v49, v13
  v_mul_f32 v50, v50, v13
  v_mul_f32 v51, v51, v13
  v_mul_f32 v52, v52, v13
  v_mul_f32 v53, v53, v13
  v_mul_f32 v54, v54, v13
  v_mul_f32 v55, v55, v13
  v_mul_f32 v56, v56, v13
  v_mul_f32 v57, v57, v13
  v_mul_f32 v58, v58, v13
  v_mul_f32 v59, v59, v13
  v_mul_f32 v60, v60, v13
  v_mul_f32 v61, v61, v13
  v_mul_f32 v62, v62, v13
  v_mul_f32 v63, v63, v13
  v_exp_f32 v12, v144
  v_exp_f32 v13, v145
  v_exp_f32 v14, v146
  v_exp_f32 v15, v147
  v_cvt_pk_bf16_f32 v168, v12, v13
  v_add_f32 v7, v12, v13
  v_exp_f32 v12, v148
  v_exp_f32 v13, v149
  v_cvt_pk_bf16_f32 v169, v14, v15
  v_add_f32 v7, v7, v14
  v_add_f32 v7, v7, v15
  v_exp_f32 v14, v150
  v_exp_f32 v15, v151
  v_cvt_pk_bf16_f32 v170, v12, v13
  v_add_f32 v7, v7, v12
  v_add_f32 v7, v7, v13
  v_cvt_pk_bf16_f32 v171, v14, v15
  v_add_f32 v7, v7, v14
  v_add_f32 v7, v7, v15
  s_nop 1
  s_branch L_back_31
L_rare_32:
  s_nop 15
  v_max3_f32 v12, v144, v145, v146
  v_max3_f32 v13, v147, v148, v149
  v_max3_f32 v12, v12, v150, v151
  v_max3_f32 v12, v12, v13, 0
  v_mov_b32 v13, v12
  s_nop 1
  v_permlane16_swap_b32 v12, v13
  v_max_f32 v12, v12, v13
  v_mov_b32 v13, v12
  s_nop 1
  v_permlane32_swap_b32 v12, v13
  v_max_f32 v12, v12, v13
  v_sub_f32 v24, v24, v12
  v_sub_f32 v25, v25, v12
  v_sub_f32 v26, v26, v12
  v_sub_f32 v27, v27, v12
  v_sub_f32 v144, v144, v12
  v_sub_f32 v145, v145, v12
  v_sub_f32 v146, v146, v12
  v_sub_f32 v147, v147, v12
  v_sub_f32 v148, v148, v12
  v_sub_f32 v149, v149, v12
  v_sub_f32 v150, v150, v12
  v_sub_f32 v151, v151, v12
  v_exp_f32 v13, -v12
  s_nop 0
  v_mul_f32 v5, v5, v13
  v_mul_f32 v32, v32, v13
  v_mul_f32 v33, v33, v13
  v_mul_f32 v34, v34, v13
  v_mul_f32 v35, v35, v13
  v_mul_f32 v36, v36, v13
  v_mul_f32 v37, v37, v13
  v_mul_f32 v38, v38, v13
  v_mul_f32 v39, v39, v13
  v_mul_f32 v40, v40, v13
  v_mul_f32 v41, v41, v13
  v_mul_f32 v42, v42, v13
  v_mul_f32 v43, v43, v13
  v_mul_f32 v44, v44, v13
  v_mul_f32 v45, v45, v13
  v_mul_f32 v46, v46, v13
  v_mul_f32 v47, v47, v13
  v_mul_f32 v48, v48, v13
  v_mul_f32 v49, v49, v13
  v_mul_f32 v50, v50, v13
  v_mul_f32 v51, v51, v13
  v_mul_f32 v52, v52, v13
  v_mul_f32 v53, v53, v13
  v_mul_f32 v54, v54, v13
  v_mul_f32 v55, v55, v13
  v_mul_f32 v56, v56, v13
  v_mul_f32 v57, v57, v13
  v_mul_f32 v58, v58, v13
  v_mul_f32 v59, v59, v13
  v_mul_f32 v60, v60, v13
  v_mul_f32 v61, v61, v13
  v_mul_f32 v62, v62, v13
  v_mul_f32 v63, v63, v13
  v_exp_f32 v12, v144
  v_exp_f32 v13, v145
  v_exp_f32 v14, v146
  v_exp_f32 v15, v147
  v_cvt_pk_bf16_f32 v168, v12, v13
  v_add_f32 v7, v12, v13
  v_exp_f32 v12, v148
  v_exp_f32 v13, v149
  v_cvt_pk_bf16_f32 v169, v14, v15
  v_add_f32 v7, v7, v14
  v_add_f32 v7, v7, v15
  v_exp_f32 v14, v150
  v_exp_f32 v15, v151
  v_cvt_pk_bf16_f32 v170, v12, v13
  v_add_f32 v7, v7, v12
  v_add_f32 v7, v7, v13
  v_cvt_pk_bf16_f32 v171, v14, v15
  v_add_f32 v7, v7, v14
  v_add_f32 v7, v7, v15
  s_nop 1
  s_branch L_back_33
L_rare_34:
  s_nop 15
  v_max3_f32 v12, v144, v145, v146
  v_max3_f32 v13, v147, v148, v149
  v_max3_f32 v12, v12, v150, v151
  v_max3_f32 v12, v12, v13, 0
  v_mov_b32 v13, v12
  s_nop 1
  v_permlane16_swap_b32 v12, v13
  v_max_f32 v12, v12, v13
  v_mov_b32 v13, v12
  s_nop 1
  v_permlane32_swap_b32 v12, v13
  v_max_f32 v12, v12, v13
  v_sub_f32 v24, v24, v12
  v_sub_f32 v25, v25, v12
  v_sub_f32 v26, v26, v12
  v_sub_f32 v27, v27, v12
  v_sub_f32 v144, v144, v12
  v_sub_f32 v145, v145, v12
  v_sub_f32 v146, v146, v12
  v_sub_f32 v147, v147, v12
  v_sub_f32 v148, v148, v12
  v_sub_f32 v149, v149, v12
  v_sub_f32 v150, v150, v12
  v_sub_f32 v151, v151, v12
  v_sub_f32 v128, v128, v12
  v_sub_f32 v129, v129, v12
  v_sub_f32 v130, v130, v12
  v_sub_f32 v131, v131, v12
  v_sub_f32 v132, v132, v12
  v_sub_f32 v133, v133, v12
  v_sub_f32 v134, v134, v12
  v_sub_f32 v135, v135, v12
  v_exp_f32 v13, -v12
  s_nop 0
  v_mul_f32 v5, v5, v13
  v_mul_f32 v32, v32, v13
  v_mul_f32 v33, v33, v13
  v_mul_f32 v34, v34, v13
  v_mul_f32 v35, v35, v13
  v_mul_f32 v36, v36, v13
  v_mul_f32 v37, v37, v13
  v_mul_f32 v38, v38, v13
  v_mul_f32 v39, v39, v13
  v_mul_f32 v40, v40, v13
  v_mul_f32 v41, v41, v13
  v_mul_f32 v42, v42, v13
  v_mul_f32 v43, v43, v13
  v_mul_f32 v44, v44, v13
  v_mul_f32 v45, v45, v13
  v_mul_f32 v46, v46, v13
  v_mul_f32 v47, v47, v13
  v_mul_f32 v48, v48, v13
  v_mul_f32 v49, v49, v13
  v_mul_f32 v50, v50, v13
  v_mul_f32 v51, v51, v13
  v_mul_f32 v52, v52, v13
  v_mul_f32 v53, v53, v13
  v_mul_f32 v54, v54, v13
  v_mul_f32 v55, v55, v13
  v_mul_f32 v56, v56, v13
  v_mul_f32 v57, v57, v13
  v_mul_f32 v58, v58, v13
  v_mul_f32 v59, v59, v13
  v_mul_f32 v60, v60, v13
  v_mul_f32 v61, v61, v13
  v_mul_f32 v62, v62, v13
  v_mul_f32 v63, v63, v13
  v_exp_f32 v12, v144
  v_exp_f32 v13, v145
  v_exp_f32 v14, v146
  v_exp_f32 v15, v147
  v_cvt_pk_bf16_f32 v168, v12, v13
  v_add_f32 v7, v12, v13
  v_exp_f32 v12, v148
  v_exp_f32 v13, v149
  v_cvt_pk_bf16_f32 v169, v14, v15
  v_add_f32 v7, v7, v14
  v_add_f32 v7, v7, v15
  v_exp_f32 v14, v150
  v_exp_f32 v15, v151
  v_cvt_pk_bf16_f32 v170, v12, v13
  v_add_f32 v7, v7, v12
  v_add_f32 v7, v7, v13
  v_cvt_pk_bf16_f32 v171, v14, v15
  v_add_f32 v7, v7, v14
  v_add_f32 v7, v7, v15
  s_nop 1
  s_branch L_back_35
L_rare_36:
  s_nop 15
  v_max3_f32 v12, v128, v129, v130
  v_max3_f32 v13, v131, v132, v133
  v_max3_f32 v12, v12, v134, v135
  v_max3_f32 v12, v12, v13, 0
  v_mov_b32 v13, v12
  s_nop 1
  v_permlane16_swap_b32 v12, v13
  v_max_f32 v12, v12, v13
  v_mov_b32 v13, v12
  s_nop 1
  v_permlane32_swap_b32 v12, v13
  v_max_f32 v12, v12, v13
  v_sub_f32 v24, v24, v12
  v_sub_f32 v25, v25, v12
  v_sub_f32 v26, v26, v12
  v_sub_f32 v27, v27, v12
  v_sub_f32 v128, v128, v12
  v_sub_f32 v129, v129, v12
  v_sub_f32 v130, v130, v12
  v_sub_f32 v131, v131, v12
  v_sub_f32 v132, v132, v12
  v_sub_f32 v133, v133, v12
  v_sub_f32 v134, v134, v12
  v_sub_f32 v135, v135, v12
  v_sub_f32 v144, v144, v12
  v_sub_f32 v145, v145, v12
  v_sub_f32 v146, v146, v12
  v_sub_f32 v147, v147, v12
  v_sub_f32 v148, v148, v12
  v_sub_f32 v149, v149, v12
  v_sub_f32 v150, v150, v12
  v_sub_f32 v151, v151, v12
  v_exp_f32 v13, -v12
  s_nop 0
  v_mul_f32 v5, v5, v13
  v_mul_f32 v32, v32, v13
  v_mul_f32 v33, v33, v13
  v_mul_f32 v34, v34, v13
  v_mul_f32 v35, v35, v13
  v_mul_f32 v36, v36, v13
  v_mul_f32 v37, v37, v13
  v_mul_f32 v38, v38, v13
  v_mul_f32 v39, v39, v13
  v_mul_f32 v40, v40, v13
  v_mul_f32 v41, v41, v13
  v_mul_f32 v42, v42, v13
  v_mul_f32 v43, v43, v13
  v_mul_f32 v44, v44, v13
  v_mul_f32 v45, v45, v13
  v_mul_f32 v46, v46, v13
  v_mul_f32 v47, v47, v13
  v_mul_f32 v48, v48, v13
  v_mul_f32 v49, v49, v13
  v_mul_f32 v50, v50, v13
  v_mul_f32 v51, v51, v13
  v_mul_f32 v52, v52, v13
  v_mul_f32 v53, v53, v13
  v_mul_f32 v54, v54, v13
  v_mul_f32 v55, v55, v13
  v_mul_f32 v56, v56, v13
  v_mul_f32 v57, v57, v13
  v_mul_f32 v58, v58, v13
  v_mul_f32 v59, v59, v13
  v_mul_f32 v60, v60, v13
  v_mul_f32 v61, v61, v13
  v_mul_f32 v62, v62, v13
  v_mul_f32 v63, v63, v13
  v_exp_f32 v12, v128
  v_exp_f32 v13, v129
  v_exp_f32 v14, v130
  v_exp_f32 v15, v131
  v_cvt_pk_bf16_f32 v160, v12, v13
  v_add_f32 v7, v12, v13
  v_exp_f32 v12, v132
  v_exp_f32 v13, v133
  v_cvt_pk_bf16_f32 v161, v14, v15
  v_add_f32 v7, v7, v14
  v_add_f32 v7, v7, v15
  v_exp_f32 v14, v134
  v_exp_f32 v15, v135
  v_cvt_pk_bf16_f32 v162, v12, v13
  v_add_f32 v7, v7, v12
  v_add_f32 v7, v7, v13
  v_cvt_pk_bf16_f32 v163, v14, v15
  v_add_f32 v7, v7, v14
  v_add_f32 v7, v7, v15
  s_nop 1
  s_branch L_back_37
L_rare_38:
  s_nop 15
  v_max3_f32 v12, v144, v145, v146
  v_max3_f32 v13, v147, v148, v149
  v_max3_f32 v12, v12, v150, v151
  v_max3_f32 v12, v12, v13, 0
  v_mov_b32 v13, v12
  s_nop 1
  v_permlane16_swap_b32 v12, v13
  v_max_f32 v12, v12, v13
  v_mov_b32 v13, v12
  s_nop 1
  v_permlane32_swap_b32 v12, v13
  v_max_f32 v12, v12, v13
  v_sub_f32 v24, v24, v12
  v_sub_f32 v25, v25, v12
  v_sub_f32 v26, v26, v12
  v_sub_f32 v27, v27, v12
  v_sub_f32 v144, v144, v12
  v_sub_f32 v145, v145, v12
  v_sub_f32 v146, v146, v12
  v_sub_f32 v147, v147, v12
  v_sub_f32 v148, v148, v12
  v_sub_f32 v149, v149, v12
  v_sub_f32 v150, v150, v12
  v_sub_f32 v151, v151, v12
  v_exp_f32 v13, -v12
  s_nop 0
  v_mul_f32 v5, v5, v13
  v_mul_f32 v32, v32, v13
  v_mul_f32 v33, v33, v13
  v_mul_f32 v34, v34, v13
  v_mul_f32 v35, v35, v13
  v_mul_f32 v36, v36, v13
  v_mul_f32 v37, v37, v13
  v_mul_f32 v38, v38, v13
  v_mul_f32 v39, v39, v13
  v_mul_f32 v40, v40, v13
  v_mul_f32 v41, v41, v13
  v_mul_f32 v42, v42, v13
  v_mul_f32 v43, v43, v13
  v_mul_f32 v44, v44, v13
  v_mul_f32 v45, v45, v13
  v_mul_f32 v46, v46, v13
  v_mul_f32 v47, v47, v13
  v_mul_f32 v48, v48, v13
  v_mul_f32 v49, v49, v13
  v_mul_f32 v50, v50, v13
  v_mul_f32 v51, v51, v13
  v_mul_f32 v52, v52, v13
  v_mul_f32 v53, v53, v13
  v_mul_f32 v54, v54, v13
  v_mul_f32 v55, v55, v13
  v_mul_f32 v56, v56, v13
  v_mul_f32 v57, v57, v13
  v_mul_f32 v58, v58, v13
  v_mul_f32 v59, v59, v13
  v_mul_f32 v60, v60, v13
  v_mul_f32 v61, v61, v13
  v_mul_f32 v62, v62, v13
  v_mul_f32 v63, v63, v13
  v_exp_f32 v12, v144
  v_exp_f32 v13, v145
  v_exp_f32 v14, v146
  v_exp_f32 v15, v147
  v_cvt_pk_bf16_f32 v168, v12, v13
  v_add_f32 v7, v12, v13
  v_exp_f32 v12, v148
  v_exp_f32 v13, v149
  v_cvt_pk_bf16_f32 v169, v14, v15
  v_add_f32 v7, v7, v14
  v_add_f32 v7, v7, v15
  v_exp_f32 v14, v150
  v_exp_f32 v15, v151
  v_cvt_pk_bf16_f32 v170, v12, v13
  v_add_f32 v7, v7, v12
  v_add_f32 v7, v7, v13
  v_cvt_pk_bf16_f32 v171, v14, v15
  v_add_f32 v7, v7, v14
  v_add_f32 v7, v7, v15
  s_nop 1
  s_branch L_back_39
L_h2:
  s_barrier
  ds_read_b64_tr_b16 v[16:17], v9 offset:0
  ds_read_b64_tr_b16 v[18:19], v9 offset:4096
  ds_read_b64_tr_b16 v[20:21], v10 offset:0
  ds_read_b64_tr_b16 v[22:23], v10 offset:4096
  ds_read_b64_tr_b16 v[24:25], v9 offset:512
  ds_read_b64_tr_b16 v[26:27], v9 offset:4608
  s_add_u32 s59, s45, 1
  s_and_b32 s59, s59, 7
  s_lshl_b32 s59, s59, 19
  s_add_u32 s59, s59, s54
  s_add_u32 s59, s59, 262400
  s_add_u32 m0, s55, 131072
  s_nop 0
  buffer_load_dwordx4 v8, s[16:19], s59 offen lds
  s_add_u32 m0, s55, 131968
  s_nop 0
  buffer_load_dwordx4 v8, s[16:19], s59 offen offset:128 lds
  s_add_u32 s59, s45, 2
  s_and_b32 s59, s59, 7
  s_lshl_b32 s59, s59, 19
  s_add_u32 s59, s59, s54
  s_add_u32 s59, s59, 256
  s_add_u32 m0, s55, 139264
  s_nop 0
  buffer_load_dwordx4 v8, s[16:19], s59 offen lds
  s_add_u32 m0, s55, 140160
  s_nop 0
  buffer_load_dwordx4 v8, s[16:19], s59 offen offset:128 lds
  s_add_u32 s59, s45, 2
  s_and_b32 s59, s59, 7
  s_lshl_b32 s59, s59, 19
  s_add_u32 s59, s59, s54
  s_add_u32 s59, s59, 262400
  s_add_u32 m0, s55, 147456
  s_nop 0
  buffer_load_dwordx4 v8, s[16:19], s59 offen lds
  s_add_u32 m0, s55, 148352
  s_nop 0
  buffer_load_dwordx4 v8, s[16:19], s59 offen offset:128 lds
  s_waitcnt lgkmcnt(2)
  v_mfma_f32_16x16x32_bf16 v[64:67], v[16:19], v[128:131], 0
  ds_read_b64_tr_b16 v[28:29], v10 offset:512
  ds_read_b64_tr_b16 v[30:31], v10 offset:4608
  v_mfma_f32_16x16x32_bf16 v[96:99], v[16:19], v[192:195], 0
  v_mfma_f32_16x16x32_bf16 v[68:71], v[20:23], v[128:131], 0
  ds_read_b64_tr_b16 v[16:17], v9 offset:1024
  ds_read_b64_tr_b16 v[18:19], v9 offset:5120
  v_mfma_f32_16x16x32_bf16 v[100:103], v[20:23], v[192:195], 0
  s_waitcnt lgkmcnt(2)
  v_mfma_f32_16x16x32_bf16 v[72:75], v[24:27], v[128:131], 0
  ds_read_b64_tr_b16 v[20:21], v10 offset:1024
  ds_read_b64_tr_b16 v[22:23], v10 offset:5120
  v_mfma_f32_16x16x32_bf16 v[104:107], v[24:27], v[192:195], 0
  v_mfma_f32_16x16x32_bf16 v[76:79], v[28:31], v[128:131], 0
  ds_read_b64_tr_b16 v[24:25], v9 offset:1536
  ds_read_b64_tr_b16 v[26:27], v9 offset:5632
  v_mfma_f32_16x16x32_bf16 v[108:111], v[28:31], v[192:195], 0
  s_barrier
  s_waitcnt lgkmcnt(2)
  v_mfma_f32_16x16x32_bf16 v[80:83], v[16:19], v[128:131], 0
  ds_read_b64_tr_b16 v[28:29], v10 offset:1536
  ds_read_b64_tr_b16 v[30:31], v10 offset:5632
  v_mfma_f32_16x16x32_bf16 v[112:115], v[16:19], v[192:195], 0
  v_mfma_f32_16x16x32_bf16 v[84:87], v[20:23], v[128:131], 0
  ds_read_b64_tr_b16 v[16:17], v9 offset:8192
  ds_read_b64_tr_b16 v[18:19], v9 offset:12288
  v_mfma_f32_16x16x32_bf16 v[116:119], v[20:23], v[192:195], 0
  s_waitcnt lgkmcnt(2)
  v_mfma_f32_16x16x32_bf16 v[88:91], v[24:27], v[128:131], 0
  ds_read_b64_tr_b16 v[20:21], v10 offset:8192
  ds_read_b64_tr_b16 v[22:23], v10 offset:12288
  v_mfma_f32_16x16x32_bf16 v[120:123], v[24:27], v[192:195], 0
  v_mfma_f32_16x16x32_bf16 v[92:95], v[28:31], v[128:131], 0
  ds_read_b64_tr_b16 v[24:25], v9 offset:8704
  ds_read_b64_tr_b16 v[26:27], v9 offset:12800
  v_mfma_f32_16x16x32_bf16 v[124:127], v[28:31], v[192:195], 0
  s_waitcnt lgkmcnt(2)
  v_mfma_f32_16x16x32_bf16 v[64:67], v[16:19], v[132:135], v[64:67]
  ds_read_b64_tr_b16 v[28:29], v10 offset:8704
  ds_read_b64_tr_b16 v[30:31], v10 offset:12800
  v_mfma_f32_16x16x32_bf16 v[96:99], v[16:19], v[196:199], v[96:99]
  v_mfma_f32_16x16x32_bf16 v[68:71], v[20:23], v[132:135], v[68:71]
  ds_read_b64_tr_b16 v[16:17], v9 offset:9216
  ds_read_b64_tr_b16 v[18:19], v9 offset:13312
  v_mfma_f32_16x16x32_bf16 v[100:103], v[20:23], v[196:199], v[100:103]
  s_waitcnt lgkmcnt(2)
  v_mfma_f32_16x16x32_bf16 v[72:75], v[24:27], v[132:135], v[72:75]
  ds_read_b64_tr_b16 v[20:21], v10 offset:9216
  ds_read_b64_tr_b16 v[22:23], v10 offset:13312
  v_mfma_f32_16x16x32_bf16 v[104:107], v[24:27], v[196:199], v[104:107]
  v_mfma_f32_16x16x32_bf16 v[76:79], v[28:31], v[132:135], v[76:79]
  ds_read_b64_tr_b16 v[24:25], v9 offset:9728
  ds_read_b64_tr_b16 v[26:27], v9 offset:13824
  v_mfma_f32_16x16x32_bf16 v[108:111], v[28:31], v[196:199], v[108:111]
  s_waitcnt lgkmcnt(2)
  v_mfma_f32_16x16x32_bf16 v[80:83], v[16:19], v[132:135], v[80:83]
  ds_read_b64_tr_b16 v[28:29], v10 offset:9728
  ds_read_b64_tr_b16 v[30:31], v10 offset:13824
  v_mfma_f32_16x16x32_bf16 v[112:115], v[16:19], v[196:199], v[112:115]
  v_mfma_f32_16x16x32_bf16 v[84:87], v[20:23], v[132:135], v[84:87]
  ds_read_b64_tr_b16 v[16:17], v9 offset:16384
  ds_read_b64_tr_b16 v[18:19], v9 offset:20480
  v_mfma_f32_16x16x32_bf16 v[116:119], v[20:23], v[196:199], v[116:119]
  s_waitcnt lgkmcnt(2)
  v_mfma_f32_16x16x32_bf16 v[88:91], v[24:27], v[132:135], v[88:91]
  ds_read_b64_tr_b16 v[20:21], v10 offset:16384
  ds_read_b64_tr_b16 v[22:23], v10 offset:20480
  v_mfma_f32_16x16x32_bf16 v[120:123], v[24:27], v[196:199], v[120:123]
  v_mfma_f32_16x16x32_bf16 v[92:95], v[28:31], v[132:135], v[92:95]
  ds_read_b64_tr_b16 v[24:25], v9 offset:16896
  ds_read_b64_tr_b16 v[26:27], v9 offset:20992
  v_mfma_f32_16x16x32_bf16 v[124:127], v[28:31], v[196:199], v[124:127]
  s_waitcnt lgkmcnt(2)
  v_mfma_f32_16x16x32_bf16 v[64:67], v[16:19], v[136:139], v[64:67]
  ds_read_b64_tr_b16 v[28:29], v10 offset:16896
  ds_read_b64_tr_b16 v[30:31], v10 offset:20992
  v_mfma_f32_16x16x32_bf16 v[96:99], v[16:19], v[200:203], v[96:99]
  v_mfma_f32_16x16x32_bf16 v[68:71], v[20:23], v[136:139], v[68:71]
  ds_read_b64_tr_b16 v[16:17], v9 offset:17408
  ds_read_b64_tr_b16 v[18:19], v9 offset:21504
  v_mfma_f32_16x16x32_bf16 v[100:103], v[20:23], v[200:203], v[100:103]
  s_waitcnt lgkmcnt(2)
  v_mfma_f32_16x16x32_bf16 v[72:75], v[24:27], v[136:139], v[72:75]
  ds_read_b64_tr_b16 v[20:21], v10 offset:17408
  ds_read_b64_tr_b16 v[22:23], v10 offset:21504
  v_mfma_f32_16x16x32_bf16 v[104:107], v[24:27], v[200:203], v[104:107]
  v_mfma_f32_16x16x32_bf16 v[76:79], v[28:31], v[136:139], v[76:79]
  ds_read_b64_tr_b16 v[24:25], v9 offset:17920
  ds_read_b64_tr_b16 v[26:27], v9 offset:22016
  v_mfma_f32_16x16x32_bf16 v[108:111], v[28:31], v[200:203], v[108:111]
  s_waitcnt lgkmcnt(2)
  v_mfma_f32_16x16x32_bf16 v[80:83], v[16:19], v[136:139], v[80:83]
  ds_read_b64_tr_b16 v[28:29], v10 offset:17920
  ds_read_b64_tr_b16 v[30:31], v10 offset:22016
  v_mfma_f32_16x16x32_bf16 v[112:115], v[16:19], v[200:203], v[112:115]
  v_mfma_f32_16x16x32_bf16 v[84:87], v[20:23], v[136:139], v[84:87]
  v_mfma_f32_16x16x32_bf16 v[116:119], v[20:23], v[200:203], v[116:119]
  s_waitcnt lgkmcnt(0)
  v_mfma_f32_16x16x32_bf16 v[88:91], v[24:27], v[136:139], v[88:91]
  v_mfma_f32_16x16x32_bf16 v[120:123], v[24:27], v[200:203], v[120:123]
  v_mfma_f32_16x16x32_bf16 v[92:95], v[28:31], v[136:139], v[92:95]
  v_mfma_f32_16x16x32_bf16 v[124:127], v[28:31], v[200:203], v[124:127]
  s_waitcnt vmcnt(0)
  s_waitcnt lgkmcnt(0)
  s_barrier
  ds_read_b64_tr_b16 v[16:17], v9 offset:32768
  ds_read_b64_tr_b16 v[18:19], v9 offset:36864
  ds_read_b64_tr_b16 v[20:21], v10 offset:32768
  ds_read_b64_tr_b16 v[22:23], v10 offset:36864
  ds_read_b64_tr_b16 v[24:25], v9 offset:33280
  ds_read_b64_tr_b16 v[26:27], v9 offset:37376
  s_add_u32 s59, s45, 3
  s_and_b32 s59, s59, 7
  s_lshl_b32 s59, s59, 19
  s_add_u32 s59, s59, s54
  s_add_u32 s59, s59, 256
  s_add_u32 m0, s55, 155648
  s_nop 0
  buffer_load_dwordx4 v8, s[16:19], s59 offen lds
  s_add_u32 m0, s55, 156544
  s_nop 0
  buffer_load_dwordx4 v8, s[16:19], s59 offen offset:128 lds
  s_add_u32 s59, s45, 3
  s_and_b32 s59, s59, 7
  s_lshl_b32 s59, s59, 19
  s_add_u32 s59, s59, s54
  s_add_u32 s59, s59, 262400
  s_add_u32 m0, s55, 98304
  s_nop 0
  buffer_load_dwordx4 v8, s[16:19], s59 offen lds
  s_add_u32 m0, s55, 99200
  s_nop 0
  buffer_load_dwordx4 v8, s[16:19], s59 offen offset:128 lds
  s_add_u32 s59, s45, 4
  s_and_b32 s59, s59, 7
  s_lshl_b32 s59, s59, 19
  s_add_u32 s59, s59, s54
  s_add_u32 s59, s59, 256
  s_add_u32 m0, s55, 106496
  s_nop 0
  buffer_load_dwordx4 v8, s[16:19], s59 offen lds
  s_add_u32 m0, s55, 107392
  s_nop 0
  buffer_load_dwordx4 v8, s[16:19], s59 offen offset:128 lds
  s_waitcnt lgkmcnt(2)
  v_mfma_f32_16x16x32_bf16 v[64:67], v[16:19], v[140:143], v[64:67]
  ds_read_b64_tr_b16 v[28:29], v10 offset:33280
  ds_read_b64_tr_b16 v[30:31], v10 offset:37376
  v_mfma_f32_16x16x32_bf16 v[96:99], v[16:19], v[204:207], v[96:99]
  v_mfma_f32_16x16x32_bf16 v[68:71], v[20:23], v[140:143], v[68:71]
  ds_read_b64_tr_b16 v[16:17], v9 offset:33792
  ds_read_b64_tr_b16 v[18:19], v9 offset:37888
  v_mfma_f32_16x16x32_bf16 v[100:103], v[20:23], v[204:207], v[100:103]
  s_waitcnt lgkmcnt(2)
  v_mfma_f32_16x16x32_bf16 v[72:75], v[24:27], v[140:143], v[72:75]
  ds_read_b64_tr_b16 v[20:21], v10 offset:33792
  ds_read_b64_tr_b16 v[22:23], v10 offset:37888
  v_mfma_f32_16x16x32_bf16 v[104:107], v[24:27], v[204:207], v[104:107]
  v_mfma_f32_16x16x32_bf16 v[76:79], v[28:31], v[140:143], v[76:79]
  ds_read_b64_tr_b16 v[24:25], v9 offset:34304
  ds_read_b64_tr_b16 v[26:27], v9 offset:38400
  v_mfma_f32_16x16x32_bf16 v[108:111], v[28:31], v[204:207], v[108:111]
  s_waitcnt lgkmcnt(2)
  v_mfma_f32_16x16x32_bf16 v[80:83], v[16:19], v[140:143], v[80:83]
  ds_read_b64_tr_b16 v[28:29], v10 offset:34304
  ds_read_b64_tr_b16 v[30:31], v10 offset:38400
  v_mfma_f32_16x16x32_bf16 v[112:115], v[16:19], v[204:207], v[112:115]
  v_mfma_f32_16x16x32_bf16 v[84:87], v[20:23], v[140:143], v[84:87]
  ds_read_b64_tr_b16 v[16:17], v9 offset:40960
  ds_read_b64_tr_b16 v[18:19], v9 offset:45056
  v_mfma_f32_16x16x32_bf16 v[116:119], v[20:23], v[204:207], v[116:119]
  s_waitcnt lgkmcnt(2)
  v_mfma_f32_16x16x32_bf16 v[88:91], v[24:27], v[140:143], v[88:91]
  ds_read_b64_tr_b16 v[20:21], v10 offset:40960
  ds_read_b64_tr_b16 v[22:23], v10 offset:45056
  v_mfma_f32_16x16x32_bf16 v[120:123], v[24:27], v[204:207], v[120:123]
  v_mfma_f32_16x16x32_bf16 v[92:95], v[28:31], v[140:143], v[92:95]
  ds_read_b64_tr_b16 v[24:25], v9 offset:41472
  ds_read_b64_tr_b16 v[26:27], v9 offset:45568
  v_mfma_f32_16x16x32_bf16 v[124:127], v[28:31], v[204:207], v[124:127]
  s_waitcnt lgkmcnt(2)
  v_mfma_f32_16x16x32_bf16 v[64:67], v[16:19], v[144:147], v[64:67]
  ds_read_b64_tr_b16 v[28:29], v10 offset:41472
  ds_read_b64_tr_b16 v[30:31], v10 offset:45568
  v_mfma_f32_16x16x32_bf16 v[96:99], v[16:19], v[208:211], v[96:99]
  v_mfma_f32_16x16x32_bf16 v[68:71], v[20:23], v[144:147], v[68:71]
  ds_read_b64_tr_b16 v[16:17], v9 offset:41984
  ds_read_b64_tr_b16 v[18:19], v9 offset:46080
  v_mfma_f32_16x16x32_bf16 v[100:103], v[20:23], v[208:211], v[100:103]
  s_waitcnt lgkmcnt(2)
  v_mfma_f32_16x16x32_bf16 v[72:75], v[24:27], v[144:147], v[72:75]
  ds_read_b64_tr_b16 v[20:21], v10 offset:41984
  ds_read_b64_tr_b16 v[22:23], v10 offset:46080
  v_mfma_f32_16x16x32_bf16 v[104:107], v[24:27], v[208:211], v[104:107]
  v_mfma_f32_16x16x32_bf16 v[76:79], v[28:31], v[144:147], v[76:79]
  ds_read_b64_tr_b16 v[24:25], v9 offset:42496
  ds_read_b64_tr_b16 v[26:27], v9 offset:46592
  v_mfma_f32_16x16x32_bf16 v[108:111], v[28:31], v[208:211], v[108:111]
  s_waitcnt lgkmcnt(2)
  v_mfma_f32_16x16x32_bf16 v[80:83], v[16:19], v[144:147], v[80:83]
  ds_read_b64_tr_b16 v[28:29], v10 offset:42496
  ds_read_b64_tr_b16 v[30:31], v10 offset:46592
  v_mfma_f32_16x16x32_bf16 v[112:115], v[16:19], v[208:211], v[112:115]
  v_mfma_f32_16x16x32_bf16 v[84:87], v[20:23], v[144:147], v[84:87]
  ds_read_b64_tr_b16 v[16:17], v9 offset:49152
  ds_read_b64_tr_b16 v[18:19], v9 offset:53248
  v_mfma_f32_16x16x32_bf16 v[116:119], v[20:23], v[208:211], v[116:119]
  s_waitcnt lgkmcnt(2)
  v_mfma_f32_16x16x32_bf16 v[88:91], v[24:27], v[144:147], v[88:91]
  ds_read_b64_tr_b16 v[20:21], v10 offset:49152
  ds_read_b64_tr_b16 v[22:23], v10 offset:53248
  v_mfma_f32_16x16x32_bf16 v[120:123], v[24:27], v[208:211], v[120:123]
  v_mfma_f32_16x16x32_bf16 v[92:95], v[28:31], v[144:147], v[92:95]
  ds_read_b64_tr_b16 v[24:25], v9 offset:49664
  ds_read_b64_tr_b16 v[26:27], v9 offset:53760
  v_mfma_f32_16x16x32_bf16 v[124:127], v[28:31], v[208:211], v[124:127]
  s_waitcnt lgkmcnt(2)
  v_mfma_f32_16x16x32_bf16 v[64:67], v[16:19], v[148:151], v[64:67]
  ds_read_b64_tr_b16 v[28:29], v10 offset:49664
  ds_read_b64_tr_b16 v[30:31], v10 offset:53760
  v_mfma_f32_16x16x32_bf16 v[96:99], v[16:19], v[212:215], v[96:99]
  v_mfma_f32_16x16x32_bf16 v[68:71], v[20:23], v[148:151], v[68:71]
  ds_read_b64_tr_b16 v[16:17], v9 offset:50176
  ds_read_b64_tr_b16 v[18:19], v9 offset:54272
  v_mfma_f32_16x16x32_bf16 v[100:103], v[20:23], v[212:215], v[100:103]
  s_waitcnt lgkmcnt(2)
  v_mfma_f32_16x16x32_bf16 v[72:75], v[24:27], v[148:151], v[72:75]
  ds_read_b64_tr_b16 v[20:21], v10 offset:50176
  ds_read_b64_tr_b16 v[22:23], v10 offset:54272
  v_mfma_f32_16x16x32_bf16 v[104:107], v[24:27], v[212:215], v[104:107]
  v_mfma_f32_16x16x32_bf16 v[76:79], v[28:31], v[148:151], v[76:79]
  ds_read_b64_tr_b16 v[24:25], v9 offset:50688
  ds_read_b64_tr_b16 v[26:27], v9 offset:54784
  v_mfma_f32_16x16x32_bf16 v[108:111], v[28:31], v[212:215], v[108:111]
  s_waitcnt lgkmcnt(2)
  v_mfma_f32_16x16x32_bf16 v[80:83], v[16:19], v[148:151], v[80:83]
  ds_read_b64_tr_b16 v[28:29], v10 offset:50688
  ds_read_b64_tr_b16 v[30:31], v10 offset:54784
  v_mfma_f32_16x16x32_bf16 v[112:115], v[16:19], v[212:215], v[112:115]
  v_mfma_f32_16x16x32_bf16 v[84:87], v[20:23], v[148:151], v[84:87]
  v_mfma_f32_16x16x32_bf16 v[116:119], v[20:23], v[212:215], v[116:119]
  s_waitcnt lgkmcnt(0)
  v_mfma_f32_16x16x32_bf16 v[88:91], v[24:27], v[148:151], v[88:91]
  v_mfma_f32_16x16x32_bf16 v[120:123], v[24:27], v[212:215], v[120:123]
  v_mfma_f32_16x16x32_bf16 v[92:95], v[28:31], v[148:151], v[92:95]
  v_mfma_f32_16x16x32_bf16 v[124:127], v[28:31], v[212:215], v[124:127]
  s_waitcnt vmcnt(0)
  s_waitcnt lgkmcnt(0)
  s_barrier
  ds_read_b64_tr_b16 v[16:17], v9 offset:57344
  ds_read_b64_tr_b16 v[18:19], v9 offset:61440
  ds_read_b64_tr_b16 v[20:21], v10 offset:57344
  ds_read_b64_tr_b16 v[22:23], v10 offset:61440
  ds_read_b64_tr_b16 v[24:25], v9 offset:57856
  ds_read_b64_tr_b16 v[26:27], v9 offset:61952
  s_add_u32 s59, s45, 4
  s_and_b32 s59, s59, 7
  s_lshl_b32 s59, s59, 19
  s_add_u32 s59, s59, s54
  s_add_u32 s59, s59, 262400
  s_add_u32 m0, s55, 131072
  s_nop 0
  buffer_load_dwordx4 v8, s[16:19], s59 offen lds
  s_add_u32 m0, s55, 131968
  s_nop 0
  buffer_load_dwordx4 v8, s[16:19], s59 offen offset:128 lds
  s_add_u32 s59, s45, 5
  s_and_b32 s59, s59, 7
  s_lshl_b32 s59, s59, 19
  s_add_u32 s59, s59, s54
  s_add_u32 s59, s59, 256
  s_add_u32 m0, s55, 139264
  s_nop 0
  buffer_load_dwordx4 v8, s[16:19], s59 offen lds
  s_add_u32 m0, s55, 140160
  s_nop 0
  buffer_load_dwordx4 v8, s[16:19], s59 offen offset:128 lds
  s_add_u32 s59, s45, 5
  s_and_b32 s59, s59, 7
  s_lshl_b32 s59, s59, 19
  s_add_u32 s59, s59, s54
  s_add_u32 s59, s59, 262400
  s_add_u32 m0, s55, 147456
  s_nop 0
  buffer_load_dwordx4 v8, s[16:19], s59 offen lds
  s_add_u32 m0, s55, 148352
  s_nop 0
  buffer_load_dwordx4 v8, s[16:19], s59 offen offset:128 lds
  s_waitcnt lgkmcnt(2)
  v_mfma_f32_16x16x32_bf16 v[64:67], v[16:19], v[152:155], v[64:67]
  ds_read_b64_tr_b16 v[28:29], v10 offset:57856
  ds_read_b64_tr_b16 v[30:31], v10 offset:61952
  v_mfma_f32_16x16x32_bf16 v[96:99], v[16:19], v[216:219], v[96:99]
  v_mfma_f32_16x16x32_bf16 v[68:71], v[20:23], v[152:155], v[68:71]
  ds_read_b64_tr_b16 v[16:17], v9 offset:58368
  ds_read_b64_tr_b16 v[18:19], v9 offset:62464
  v_mfma_f32_16x16x32_bf16 v[100:103], v[20:23], v[216:219], v[100:103]
  s_waitcnt lgkmcnt(2)
  v_mfma_f32_16x16x32_bf16 v[72:75], v[24:27], v[152:155], v[72:75]
  ds_read_b64_tr_b16 v[20:21], v10 offset:58368
  ds_read_b64_tr_b16 v[22:23], v10 offset:62464
  v_mfma_f32_16x16x32_bf16 v[104:107], v[24:27], v[216:219], v[104:107]
  v_mfma_f32_16x16x32_bf16 v[76:79], v[28:31], v[152:155], v[76:79]
  ds_read_b64_tr_b16 v[24:25], v9 offset:58880
  ds_read_b64_tr_b16 v[26:27], v9 offset:62976
  v_mfma_f32_16x16x32_bf16 v[108:111], v[28:31], v[216:219], v[108:111]
  s_waitcnt lgkmcnt(2)
  v_mfma_f32_16x16x32_bf16 v[80:83], v[16:19], v[152:155], v[80:83]
  ds_read_b64_tr_b16 v[28:29], v10 offset:58880
  ds_read_b64_tr_b16 v[30:31], v10 offset:62976
  v_mfma_f32_16x16x32_bf16 v[112:115], v[16:19], v[216:219], v[112:115]
  v_mfma_f32_16x16x32_bf16 v[84:87], v[20:23], v[152:155], v[84:87]
  ds_read_b64_tr_b16 v[16:17], v9 offset:0
  ds_read_b64_tr_b16 v[18:19], v9 offset:4096
  v_mfma_f32_16x16x32_bf16 v[116:119], v[20:23], v[216:219], v[116:119]
  s_waitcnt lgkmcnt(2)
  v_mfma_f32_16x16x32_bf16 v[88:91], v[24:27], v[152:155], v[88:91]
  ds_read_b64_tr_b16 v[20:21], v10 offset:0
  ds_read_b64_tr_b16 v[22:23], v10 offset:4096
  v_mfma_f32_16x16x32_bf16 v[120:123], v[24:27], v[216:219], v[120:123]
  v_mfma_f32_16x16x32_bf16 v[92:95], v[28:31], v[152:155], v[92:95]
  ds_read_b64_tr_b16 v[24:25], v9 offset:512
  ds_read_b64_tr_b16 v[26:27], v9 offset:4608
  v_mfma_f32_16x16x32_bf16 v[124:127], v[28:31], v[216:219], v[124:127]
  s_waitcnt lgkmcnt(2)
  v_mfma_f32_16x16x32_bf16 v[64:67], v[16:19], v[156:159], v[64:67]
  ds_read_b64_tr_b16 v[28:29], v10 offset:512
  ds_read_b64_tr_b16 v[30:31], v10 offset:4608
  v_mfma_f32_16x16x32_bf16 v[96:99], v[16:19], v[220:223], v[96:99]
  v_mfma_f32_16x16x32_bf16 v[68:71], v[20:23], v[156:159], v[68:71]
  ds_read_b64_tr_b16 v[16:17], v9 offset:1024
  ds_read_b64_tr_b16 v[18:19], v9 offset:5120
  v_mfma_f32_16x16x32_bf16 v[100:103], v[20:23], v[220:223], v[100:103]
  s_waitcnt lgkmcnt(2)
  v_mfma_f32_16x16x32_bf16 v[72:75], v[24:27], v[156:159], v[72:75]
  ds_read_b64_tr_b16 v[20:21], v10 offset:1024
  ds_read_b64_tr_b16 v[22:23], v10 offset:5120
  v_mfma_f32_16x16x32_bf16 v[104:107], v[24:27], v[220:223], v[104:107]
  v_mfma_f32_16x16x32_bf16 v[76:79], v[28:31], v[156:159], v[76:79]
  ds_read_b64_tr_b16 v[24:25], v9 offset:1536
  ds_read_b64_tr_b16 v[26:27], v9 offset:5632
  v_mfma_f32_16x16x32_bf16 v[108:111], v[28:31], v[220:223], v[108:111]
  s_waitcnt lgkmcnt(2)
  v_mfma_f32_16x16x32_bf16 v[80:83], v[16:19], v[156:159], v[80:83]
  ds_read_b64_tr_b16 v[28:29], v10 offset:1536
  ds_read_b64_tr_b16 v[30:31], v10 offset:5632
  v_mfma_f32_16x16x32_bf16 v[112:115], v[16:19], v[220:223], v[112:115]
  v_mfma_f32_16x16x32_bf16 v[84:87], v[20:23], v[156:159], v[84:87]
  ds_read_b64_tr_b16 v[16:17], v9 offset:8192
  ds_read_b64_tr_b16 v[18:19], v9 offset:12288
  v_mfma_f32_16x16x32_bf16 v[116:119], v[20:23], v[220:223], v[116:119]
  s_waitcnt lgkmcnt(2)
  v_mfma_f32_16x16x32_bf16 v[88:91], v[24:27], v[156:159], v[88:91]
  ds_read_b64_tr_b16 v[20:21], v10 offset:8192
  ds_read_b64_tr_b16 v[22:23], v10 offset:12288
  v_mfma_f32_16x16x32_bf16 v[120:123], v[24:27], v[220:223], v[120:123]
  v_mfma_f32_16x16x32_bf16 v[92:95], v[28:31], v[156:159], v[92:95]
  ds_read_b64_tr_b16 v[24:25], v9 offset:8704
  ds_read_b64_tr_b16 v[26:27], v9 offset:12800
  v_mfma_f32_16x16x32_bf16 v[124:127], v[28:31], v[220:223], v[124:127]
  s_waitcnt lgkmcnt(2)
  v_mfma_f32_16x16x32_bf16 v[64:67], v[16:19], v[160:163], v[64:67]
  ds_read_b64_tr_b16 v[28:29], v10 offset:8704
  ds_read_b64_tr_b16 v[30:31], v10 offset:12800
  v_mfma_f32_16x16x32_bf16 v[96:99], v[16:19], v[224:227], v[96:99]
  v_mfma_f32_16x16x32_bf16 v[68:71], v[20:23], v[160:163], v[68:71]
  ds_read_b64_tr_b16 v[16:17], v9 offset:9216
  ds_read_b64_tr_b16 v[18:19], v9 offset:13312
  v_mfma_f32_16x16x32_bf16 v[100:103], v[20:23], v[224:227], v[100:103]
  s_waitcnt lgkmcnt(2)
  v_mfma_f32_16x16x32_bf16 v[72:75], v[24:27], v[160:163], v[72:75]
  ds_read_b64_tr_b16 v[20:21], v10 offset:9216
  ds_read_b64_tr_b16 v[22:23], v10 offset:13312
  v_mfma_f32_16x16x32_bf16 v[104:107], v[24:27], v[224:227], v[104:107]
  v_mfma_f32_16x16x32_bf16 v[76:79], v[28:31], v[160:163], v[76:79]
  ds_read_b64_tr_b16 v[24:25], v9 offset:9728
  ds_read_b64_tr_b16 v[26:27], v9 offset:13824
  v_mfma_f32_16x16x32_bf16 v[108:111], v[28:31], v[224:227], v[108:111]
  s_waitcnt lgkmcnt(2)
  v_mfma_f32_16x16x32_bf16 v[80:83], v[16:19], v[160:163], v[80:83]
  ds_read_b64_tr_b16 v[28:29], v10 offset:9728
  ds_read_b64_tr_b16 v[30:31], v10 offset:13824
  v_mfma_f32_16x16x32_bf16 v[112:115], v[16:19], v[224:227], v[112:115]
  v_mfma_f32_16x16x32_bf16 v[84:87], v[20:23], v[160:163], v[84:87]
  v_mfma_f32_16x16x32_bf16 v[116:119], v[20:23], v[224:227], v[116:119]
  s_waitcnt lgkmcnt(0)
  v_mfma_f32_16x16x32_bf16 v[88:91], v[24:27], v[160:163], v[88:91]
  v_mfma_f32_16x16x32_bf16 v[120:123], v[24:27], v[224:227], v[120:123]
  v_mfma_f32_16x16x32_bf16 v[92:95], v[28:31], v[160:163], v[92:95]
  v_mfma_f32_16x16x32_bf16 v[124:127], v[28:31], v[224:227], v[124:127]
  s_waitcnt vmcnt(0)
  s_waitcnt lgkmcnt(0)
  s_barrier
  ds_read_b64_tr_b16 v[16:17], v9 offset:32768
  ds_read_b64_tr_b16 v[18:19], v9 offset:36864
  ds_read_b64_tr_b16 v[20:21], v10 offset:32768
  ds_read_b64_tr_b16 v[22:23], v10 offset:36864
  ds_read_b64_tr_b16 v[24:25], v9 offset:33280
  ds_read_b64_tr_b16 v[26:27], v9 offset:37376
  s_add_u32 s59, s45, 6
  s_and_b32 s59, s59, 7
  s_lshl_b32 s59, s59, 19
  s_add_u32 s59, s59, s54
  s_add_u32 s59, s59, 256
  s_add_u32 m0, s55, 155648
  s_nop 0
  buffer_load_dwordx4 v8, s[16:19], s59 offen lds
  s_add_u32 m0, s55, 156544
  s_nop 0
  buffer_load_dwordx4 v8, s[16:19], s59 offen offset:128 lds
  s_add_u32 s59, s45, 6
  s_and_b32 s59, s59, 7
  s_lshl_b32 s59, s59, 19
  s_add_u32 s59, s59, s54
  s_add_u32 s59, s59, 262400
  s_add_u32 m0, s55, 98304
  s_nop 0
  buffer_load_dwordx4 v8, s[16:19], s59 offen lds
  s_add_u32 m0, s55, 99200
  s_nop 0
  buffer_load_dwordx4 v8, s[16:19], s59 offen offset:128 lds
  s_add_u32 s59, s45, 7
  s_and_b32 s59, s59, 7
  s_lshl_b32 s59, s59, 19
  s_add_u32 s59, s59, s54
  s_add_u32 s59, s59, 256
  s_add_u32 m0, s55, 106496
  s_nop 0
  buffer_load_dwordx4 v8, s[16:19], s59 offen lds
  s_add_u32 m0, s55, 107392
  s_nop 0
  buffer_load_dwordx4 v8, s[16:19], s59 offen offset:128 lds
  s_waitcnt lgkmcnt(2)
  v_mfma_f32_16x16x32_bf16 v[64:67], v[16:19], v[164:167], v[64:67]
  ds_read_b64_tr_b16 v[28:29], v10 offset:33280
  ds_read_b64_tr_b16 v[30:31], v10 offset:37376
  v_mfma_f32_16x16x32_bf16 v[96:99], v[16:19], v[228:231], v[96:99]
  v_mfma_f32_16x16x32_bf16 v[68:71], v[20:23], v[164:167], v[68:71]
  ds_read_b64_tr_b16 v[16:17], v9 offset:33792
  ds_read_b64_tr_b16 v[18:19], v9 offset:37888
  v_mfma_f32_16x16x32_bf16 v[100:103], v[20:23], v[228:231], v[100:103]
  s_waitcnt lgkmcnt(2)
  v_mfma_f32_16x16x32_bf16 v[72:75], v[24:27], v[164:167], v[72:75]
  ds_read_b64_tr_b16 v[20:21], v10 offset:33792
  ds_read_b64_tr_b16 v[22:23], v10 offset:37888
  v_mfma_f32_16x16x32_bf16 v[104:107], v[24:27], v[228:231], v[104:107]
  v_mfma_f32_16x16x32_bf16 v[76:79], v[28:31], v[164:167], v[76:79]
  ds_read_b64_tr_b16 v[24:25], v9 offset:34304
  ds_read_b64_tr_b16 v[26:27], v9 offset:38400
  v_mfma_f32_16x16x32_bf16 v[108:111], v[28:31], v[228:231], v[108:111]
  s_waitcnt lgkmcnt(2)
  v_mfma_f32_16x16x32_bf16 v[80:83], v[16:19], v[164:167], v[80:83]
  ds_read_b64_tr_b16 v[28:29], v10 offset:34304
  ds_read_b64_tr_b16 v[30:31], v10 offset:38400
  v_mfma_f32_16x16x32_bf16 v[112:115], v[16:19], v[228:231], v[112:115]
  v_mfma_f32_16x16x32_bf16 v[84:87], v[20:23], v[164:167], v[84:87]
  ds_read_b64_tr_b16 v[16:17], v9 offset:40960
  ds_read_b64_tr_b16 v[18:19], v9 offset:45056
  v_mfma_f32_16x16x32_bf16 v[116:119], v[20:23], v[228:231], v[116:119]
  s_waitcnt lgkmcnt(2)
  v_mfma_f32_16x16x32_bf16 v[88:91], v[24:27], v[164:167], v[88:91]
  ds_read_b64_tr_b16 v[20:21], v10 offset:40960
  ds_read_b64_tr_b16 v[22:23], v10 offset:45056
  v_mfma_f32_16x16x32_bf16 v[120:123], v[24:27], v[228:231], v[120:123]
  v_mfma_f32_16x16x32_bf16 v[92:95], v[28:31], v[164:167], v[92:95]
  ds_read_b64_tr_b16 v[24:25], v9 offset:41472
  ds_read_b64_tr_b16 v[26:27], v9 offset:45568
  v_mfma_f32_16x16x32_bf16 v[124:127], v[28:31], v[228:231], v[124:127]
  s_waitcnt lgkmcnt(2)
  v_mfma_f32_16x16x32_bf16 v[64:67], v[16:19], v[168:171], v[64:67]
  ds_read_b64_tr_b16 v[28:29], v10 offset:41472
  ds_read_b64_tr_b16 v[30:31], v10 offset:45568
  v_mfma_f32_16x16x32_bf16 v[96:99], v[16:19], v[232:235], v[96:99]
  v_mfma_f32_16x16x32_bf16 v[68:71], v[20:23], v[168:171], v[68:71]
  ds_read_b64_tr_b16 v[16:17], v9 offset:41984
  ds_read_b64_tr_b16 v[18:19], v9 offset:46080
  v_mfma_f32_16x16x32_bf16 v[100:103], v[20:23], v[232:235], v[100:103]
  s_waitcnt lgkmcnt(2)
  v_mfma_f32_16x16x32_bf16 v[72:75], v[24:27], v[168:171], v[72:75]
  ds_read_b64_tr_b16 v[20:21], v10 offset:41984
  ds_read_b64_tr_b16 v[22:23], v10 offset:46080
  v_mfma_f32_16x16x32_bf16 v[104:107], v[24:27], v[232:235], v[104:107]
  v_mfma_f32_16x16x32_bf16 v[76:79], v[28:31], v[168:171], v[76:79]
  ds_read_b64_tr_b16 v[24:25], v9 offset:42496
  ds_read_b64_tr_b16 v[26:27], v9 offset:46592
  v_mfma_f32_16x16x32_bf16 v[108:111], v[28:31], v[232:235], v[108:111]
  s_waitcnt lgkmcnt(2)
  v_mfma_f32_16x16x32_bf16 v[80:83], v[16:19], v[168:171], v[80:83]
  ds_read_b64_tr_b16 v[28:29], v10 offset:42496
  ds_read_b64_tr_b16 v[30:31], v10 offset:46592
  v_mfma_f32_16x16x32_bf16 v[112:115], v[16:19], v[232:235], v[112:115]
  v_mfma_f32_16x16x32_bf16 v[84:87], v[20:23], v[168:171], v[84:87]
  ds_read_b64_tr_b16 v[16:17], v9 offset:49152
  ds_read_b64_tr_b16 v[18:19], v9 offset:53248
  v_mfma_f32_16x16x32_bf16 v[116:119], v[20:23], v[232:235], v[116:119]
  s_waitcnt lgkmcnt(2)
  v_mfma_f32_16x16x32_bf16 v[88:91], v[24:27], v[168:171], v[88:91]
  ds_read_b64_tr_b16 v[20:21], v10 offset:49152
  ds_read_b64_tr_b16 v[22:23], v10 offset:53248
  v_mfma_f32_16x16x32_bf16 v[120:123], v[24:27], v[232:235], v[120:123]
  v_mfma_f32_16x16x32_bf16 v[92:95], v[28:31], v[168:171], v[92:95]
  ds_read_b64_tr_b16 v[24:25], v9 offset:49664
  ds_read_b64_tr_b16 v[26:27], v9 offset:53760
  v_mfma_f32_16x16x32_bf16 v[124:127], v[28:31], v[232:235], v[124:127]
  s_waitcnt lgkmcnt(2)
  v_mfma_f32_16x16x32_bf16 v[64:67], v[16:19], v[172:175], v[64:67]
  ds_read_b64_tr_b16 v[28:29], v10 offset:49664
  ds_read_b64_tr_b16 v[30:31], v10 offset:53760
  v_mfma_f32_16x16x32_bf16 v[96:99], v[16:19], v[236:239], v[96:99]
  v_mfma_f32_16x16x32_bf16 v[68:71], v[20:23], v[172:175], v[68:71]
  ds_read_b64_tr_b16 v[16:17], v9 offset:50176
  ds_read_b64_tr_b16 v[18:19], v9 offset:54272
  v_mfma_f32_16x16x32_bf16 v[100:103], v[20:23], v[236:239], v[100:103]
  s_waitcnt lgkmcnt(2)
  v_mfma_f32_16x16x32_bf16 v[72:75], v[24:27], v[172:175], v[72:75]
  ds_read_b64_tr_b16 v[20:21], v10 offset:50176
  ds_read_b64_tr_b16 v[22:23], v10 offset:54272
  v_mfma_f32_16x16x32_bf16 v[104:107], v[24:27], v[236:239], v[104:107]
  v_mfma_f32_16x16x32_bf16 v[76:79], v[28:31], v[172:175], v[76:79]
  ds_read_b64_tr_b16 v[24:25], v9 offset:50688
  ds_read_b64_tr_b16 v[26:27], v9 offset:54784
  v_mfma_f32_16x16x32_bf16 v[108:111], v[28:31], v[236:239], v[108:111]
  s_waitcnt lgkmcnt(2)
  v_mfma_f32_16x16x32_bf16 v[80:83], v[16:19], v[172:175], v[80:83]
  ds_read_b64_tr_b16 v[28:29], v10 offset:50688
  ds_read_b64_tr_b16 v[30:31], v10 offset:54784
  v_mfma_f32_16x16x32_bf16 v[112:115], v[16:19], v[236:239], v[112:115]
  v_mfma_f32_16x16x32_bf16 v[84:87], v[20:23], v[172:175], v[84:87]
  v_mfma_f32_16x16x32_bf16 v[116:119], v[20:23], v[236:239], v[116:119]
  s_waitcnt lgkmcnt(0)
  v_mfma_f32_16x16x32_bf16 v[88:91], v[24:27], v[172:175], v[88:91]
  v_mfma_f32_16x16x32_bf16 v[120:123], v[24:27], v[236:239], v[120:123]
  v_mfma_f32_16x16x32_bf16 v[92:95], v[28:31], v[172:175], v[92:95]
  v_mfma_f32_16x16x32_bf16 v[124:127], v[28:31], v[236:239], v[124:127]
  s_waitcnt vmcnt(0)
  s_waitcnt lgkmcnt(0)
  s_barrier
  ds_read_b64_tr_b16 v[16:17], v9 offset:57344
  ds_read_b64_tr_b16 v[18:19], v9 offset:61440
  ds_read_b64_tr_b16 v[20:21], v10 offset:57344
  ds_read_b64_tr_b16 v[22:23], v10 offset:61440
  ds_read_b64_tr_b16 v[24:25], v9 offset:57856
  ds_read_b64_tr_b16 v[26:27], v9 offset:61952
  s_add_u32 s59, s45, 7
  s_and_b32 s59, s59, 7
  s_lshl_b32 s59, s59, 19
  s_add_u32 s59, s59, s54
  s_add_u32 s59, s59, 262400
  s_add_u32 m0, s55, 131072
  s_nop 0
  buffer_load_dwordx4 v8, s[16:19], s59 offen lds
  s_add_u32 m0, s55, 131968
  s_nop 0
  buffer_load_dwordx4 v8, s[16:19], s59 offen offset:128 lds
  s_add_u32 s59, s45, 0
  s_and_b32 s59, s59, 7
  s_lshl_b32 s59, s59, 19
  s_add_u32 s59, s59, s54
  s_add_u32 s59, s59, 512
  s_add_u32 m0, s55, 139264
  s_nop 0
  buffer_load_dwordx4 v8, s[16:19], s59 offen lds
  s_add_u32 m0, s55, 140160
  s_nop 0
  buffer_load_dwordx4 v8, s[16:19], s59 offen offset:128 lds
  s_add_u32 s59, s45, 0
  s_and_b32 s59, s59, 7
  s_lshl_b32 s59, s59, 19
  s_add_u32 s59, s59, s54
  s_add_u32 s59, s59, 262656
  s_add_u32 m0, s55, 147456
  s_nop 0
  buffer_load_dwordx4 v8, s[16:19], s59 offen lds
  s_add_u32 m0, s55, 148352
  s_nop 0
  buffer_load_dwordx4 v8, s[16:19], s59 offen offset:128 lds
  s_waitcnt lgkmcnt(2)
  v_mfma_f32_16x16x32_bf16 v[64:67], v[16:19], v[176:179], v[64:67]
  ds_read_b64_tr_b16 v[28:29], v10 offset:57856
  ds_read_b64_tr_b16 v[30:31], v10 offset:61952
  v_mfma_f32_16x16x32_bf16 v[96:99], v[16:19], v[240:243], v[96:99]
  v_mfma_f32_16x16x32_bf16 v[68:71], v[20:23], v[176:179], v[68:71]
  ds_read_b64_tr_b16 v[16:17], v9 offset:58368
  ds_read_b64_tr_b16 v[18:19], v9 offset:62464
  v_mfma_f32_16x16x32_bf16 v[100:103], v[20:23], v[240:243], v[100:103]
  s_waitcnt lgkmcnt(2)
  v_mfma_f32_16x16x32_bf16 v[72:75], v[24:27], v[176:179], v[72:75]
  ds_read_b64_tr_b16 v[20:21], v10 offset:58368
  ds_read_b64_tr_b16 v[22:23], v10 offset:62464
  v_mfma_f32_16x16x32_bf16 v[104:107], v[24:27], v[240:243], v[104:107]
  v_mfma_f32_16x16x32_bf16 v[76:79], v[28:31], v[176:179], v[76:79]
  ds_read_b64_tr_b16 v[24:25], v9 offset:58880
  ds_read_b64_tr_b16 v[26:27], v9 offset:62976
  v_mfma_f32_16x16x32_bf16 v[108:111], v[28:31], v[240:243], v[108:111]
  s_waitcnt lgkmcnt(2)
  v_mfma_f32_16x16x32_bf16 v[80:83], v[16:19], v[176:179], v[80:83]
  ds_read_b64_tr_b16 v[28:29], v10 offset:58880
  ds_read_b64_tr_b16 v[30:31], v10 offset:62976
  v_mfma_f32_16x16x32_bf16 v[112:115], v[16:19], v[240:243], v[112:115]
  v_mfma_f32_16x16x32_bf16 v[84:87], v[20:23], v[176:179], v[84:87]
  ds_read_b64_tr_b16 v[16:17], v9 offset:0
  ds_read_b64_tr_b16 v[18:19], v9 offset:4096
  v_mfma_f32_16x16x32_bf16 v[116:119], v[20:23], v[240:243], v[116:119]
  s_waitcnt lgkmcnt(2)
  v_mfma_f32_16x16x32_bf16 v[88:91], v[24:27], v[176:179], v[88:91]
  ds_read_b64_tr_b16 v[20:21], v10 offset:0
  ds_read_b64_tr_b16 v[22:23], v10 offset:4096
  v_mfma_f32_16x16x32_bf16 v[120:123], v[24:27], v[240:243], v[120:123]
  v_mfma_f32_16x16x32_bf16 v[92:95], v[28:31], v[176:179], v[92:95]
  ds_read_b64_tr_b16 v[24:25], v9 offset:512
  ds_read_b64_tr_b16 v[26:27], v9 offset:4608
  v_mfma_f32_16x16x32_bf16 v[124:127], v[28:31], v[240:243], v[124:127]
  s_waitcnt lgkmcnt(2)
  v_mfma_f32_16x16x32_bf16 v[64:67], v[16:19], v[180:183], v[64:67]
  ds_read_b64_tr_b16 v[28:29], v10 offset:512
  ds_read_b64_tr_b16 v[30:31], v10 offset:4608
  v_mfma_f32_16x16x32_bf16 v[96:99], v[16:19], v[244:247], v[96:99]
  v_mfma_f32_16x16x32_bf16 v[68:71], v[20:23], v[180:183], v[68:71]
  ds_read_b64_tr_b16 v[16:17], v9 offset:1024
  ds_read_b64_tr_b16 v[18:19], v9 offset:5120
  v_mfma_f32_16x16x32_bf16 v[100:103], v[20:23], v[244:247], v[100:103]
  s_waitcnt lgkmcnt(2)
  v_mfma_f32_16x16x32_bf16 v[72:75], v[24:27], v[180:183], v[72:75]
  ds_read_b64_tr_b16 v[20:21], v10 offset:1024
  ds_read_b64_tr_b16 v[22:23], v10 offset:5120
  v_mfma_f32_16x16x32_bf16 v[104:107], v[24:27], v[244:247], v[104:107]
  v_mfma_f32_16x16x32_bf16 v[76:79], v[28:31], v[180:183], v[76:79]
  ds_read_b64_tr_b16 v[24:25], v9 offset:1536
  ds_read_b64_tr_b16 v[26:27], v9 offset:5632
  v_mfma_f32_16x16x32_bf16 v[108:111], v[28:31], v[244:247], v[108:111]
  s_waitcnt lgkmcnt(2)
  v_mfma_f32_16x16x32_bf16 v[80:83], v[16:19], v[180:183], v[80:83]
  ds_read_b64_tr_b16 v[28:29], v10 offset:1536
  ds_read_b64_tr_b16 v[30:31], v10 offset:5632
  v_mfma_f32_16x16x32_bf16 v[112:115], v[16:19], v[244:247], v[112:115]
  v_mfma_f32_16x16x32_bf16 v[84:87], v[20:23], v[180:183], v[84:87]
  ds_read_b64_tr_b16 v[16:17], v9 offset:8192
  ds_read_b64_tr_b16 v[18:19], v9 offset:12288
  v_mfma_f32_16x16x32_bf16 v[116:119], v[20:23], v[244:247], v[116:119]
  s_waitcnt lgkmcnt(2)
  v_mfma_f32_16x16x32_bf16 v[88:91], v[24:27], v[180:183], v[88:91]
  ds_read_b64_tr_b16 v[20:21], v10 offset:8192
  ds_read_b64_tr_b16 v[22:23], v10 offset:12288
  v_mfma_f32_16x16x32_bf16 v[120:123], v[24:27], v[244:247], v[120:123]
  v_mfma_f32_16x16x32_bf16 v[92:95], v[28:31], v[180:183], v[92:95]
  ds_read_b64_tr_b16 v[24:25], v9 offset:8704
  ds_read_b64_tr_b16 v[26:27], v9 offset:12800
  v_mfma_f32_16x16x32_bf16 v[124:127], v[28:31], v[244:247], v[124:127]
  s_waitcnt lgkmcnt(2)
  v_mfma_f32_16x16x32_bf16 v[64:67], v[16:19], v[184:187], v[64:67]
  ds_read_b64_tr_b16 v[28:29], v10 offset:8704
  ds_read_b64_tr_b16 v[30:31], v10 offset:12800
  v_mfma_f32_16x16x32_bf16 v[96:99], v[16:19], v[248:251], v[96:99]
  v_mfma_f32_16x16x32_bf16 v[68:71], v[20:23], v[184:187], v[68:71]
  ds_read_b64_tr_b16 v[16:17], v9 offset:9216
  ds_read_b64_tr_b16 v[18:19], v9 offset:13312
  v_mfma_f32_16x16x32_bf16 v[100:103], v[20:23], v[248:251], v[100:103]
  s_waitcnt lgkmcnt(2)
  v_mfma_f32_16x16x32_bf16 v[72:75], v[24:27], v[184:187], v[72:75]
  ds_read_b64_tr_b16 v[20:21], v10 offset:9216
  ds_read_b64_tr_b16 v[22:23], v10 offset:13312
  v_mfma_f32_16x16x32_bf16 v[104:107], v[24:27], v[248:251], v[104:107]
  v_mfma_f32_16x16x32_bf16 v[76:79], v[28:31], v[184:187], v[76:79]
  ds_read_b64_tr_b16 v[24:25], v9 offset:9728
  ds_read_b64_tr_b16 v[26:27], v9 offset:13824
  v_mfma_f32_16x16x32_bf16 v[108:111], v[28:31], v[248:251], v[108:111]
  s_waitcnt lgkmcnt(2)
  v_mfma_f32_16x16x32_bf16 v[80:83], v[16:19], v[184:187], v[80:83]
  ds_read_b64_tr_b16 v[28:29], v10 offset:9728
  ds_read_b64_tr_b16 v[30:31], v10 offset:13824
  v_mfma_f32_16x16x32_bf16 v[112:115], v[16:19], v[248:251], v[112:115]
  v_mfma_f32_16x16x32_bf16 v[84:87], v[20:23], v[184:187], v[84:87]
  v_mfma_f32_16x16x32_bf16 v[116:119], v[20:23], v[248:251], v[116:119]
  s_waitcnt lgkmcnt(0)
  v_mfma_f32_16x16x32_bf16 v[88:91], v[24:27], v[184:187], v[88:91]
  v_mfma_f32_16x16x32_bf16 v[120:123], v[24:27], v[248:251], v[120:123]
  v_mfma_f32_16x16x32_bf16 v[92:95], v[28:31], v[184:187], v[92:95]
  v_mfma_f32_16x16x32_bf16 v[124:127], v[28:31], v[248:251], v[124:127]
  s_waitcnt vmcnt(0)
  s_waitcnt lgkmcnt(0)
  s_barrier
  ds_read_b64_tr_b16 v[16:17], v9 offset:32768
  ds_read_b64_tr_b16 v[18:19], v9 offset:36864
  ds_read_b64_tr_b16 v[20:21], v10 offset:32768
  ds_read_b64_tr_b16 v[22:23], v10 offset:36864
  ds_read_b64_tr_b16 v[24:25], v9 offset:33280
  ds_read_b64_tr_b16 v[26:27], v9 offset:37376
  s_add_u32 s59, s45, 1
  s_and_b32 s59, s59, 7
  s_lshl_b32 s59, s59, 19
  s_add_u32 s59, s59, s54
  s_add_u32 s59, s59, 512
  s_add_u32 m0, s55, 155648
  s_nop 0
  buffer_load_dwordx4 v8, s[16:19], s59 offen lds
  s_add_u32 m0, s55, 156544
  s_nop 0
  buffer_load_dwordx4 v8, s[16:19], s59 offen offset:128 lds
  s_add_u32 s59, s45, 1
  s_and_b32 s59, s59, 7
  s_lshl_b32 s59, s59, 19
  s_add_u32 s59, s59, s54
  s_add_u32 s59, s59, 262656
  s_add_u32 m0, s55, 98304
  s_nop 0
  buffer_load_dwordx4 v8, s[16:19], s59 offen lds
  s_add_u32 m0, s55, 99200
  s_nop 0
  buffer_load_dwordx4 v8, s[16:19], s59 offen offset:128 lds
  s_add_u32 s59, s45, 2
  s_and_b32 s59, s59, 7
  s_lshl_b32 s59, s59, 19
  s_add_u32 s59, s59, s54
  s_add_u32 s59, s59, 512
  s_add_u32 m0, s55, 106496
  s_nop 0
  buffer_load_dwordx4 v8, s[16:19], s59 offen lds
  s_add_u32 m0, s55, 107392
  s_nop 0
  buffer_load_dwordx4 v8, s[16:19], s59 offen offset:128 lds
  s_waitcnt lgkmcnt(2)
  v_mfma_f32_16x16x32_bf16 v[64:67], v[16:19], v[188:191], v[64:67]
  ds_read_b64_tr_b16 v[28:29], v10 offset:33280
  ds_read_b64_tr_b16 v[30:31], v10 offset:37376
  v_mfma_f32_16x16x32_bf16 v[96:99], v[16:19], v[252:255], v[96:99]
  v_mfma_f32_16x16x32_bf16 v[68:71], v[20:23], v[188:191], v[68:71]
  ds_read_b64_tr_b16 v[16:17], v9 offset:33792
  ds_read_b64_tr_b16 v[18:19], v9 offset:37888
  v_mfma_f32_16x16x32_bf16 v[100:103], v[20:23], v[252:255], v[100:103]
  s_waitcnt lgkmcnt(2)
  v_mfma_f32_16x16x32_bf16 v[72:75], v[24:27], v[188:191], v[72:75]
  ds_read_b64_tr_b16 v[20:21], v10 offset:33792
  ds_read_b64_tr_b16 v[22:23], v10 offset:37888
  v_mfma_f32_16x16x32_bf16 v[104:107], v[24:27], v[252:255], v[104:107]
  v_mfma_f32_16x16x32_bf16 v[76:79], v[28:31], v[188:191], v[76:79]
  ds_read_b64_tr_b16 v[24:25], v9 offset:34304
  ds_read_b64_tr_b16 v[26:27], v9 offset:38400
  v_mfma_f32_16x16x32_bf16 v[108:111], v[28:31], v[252:255], v[108:111]
  s_waitcnt lgkmcnt(2)
  v_mfma_f32_16x16x32_bf16 v[80:83], v[16:19], v[188:191], v[80:83]
  ds_read_b64_tr_b16 v[28:29], v10 offset:34304
  ds_read_b64_tr_b16 v[30:31], v10 offset:38400
  v_mfma_f32_16x16x32_bf16 v[112:115], v[16:19], v[252:255], v[112:115]
  v_mfma_f32_16x16x32_bf16 v[84:87], v[20:23], v[188:191], v[84:87]
  ds_read_b64_tr_b16 v[16:17], v9 offset:40960
  ds_read_b64_tr_b16 v[18:19], v9 offset:45056
  v_mfma_f32_16x16x32_bf16 v[116:119], v[20:23], v[252:255], v[116:119]
  s_waitcnt lgkmcnt(2)
  v_mfma_f32_16x16x32_bf16 v[88:91], v[24:27], v[188:191], v[88:91]
  ds_read_b64_tr_b16 v[20:21], v10 offset:40960
  ds_read_b64_tr_b16 v[22:23], v10 offset:45056
  v_mfma_f32_16x16x32_bf16 v[120:123], v[24:27], v[252:255], v[120:123]
  v_mfma_f32_16x16x32_bf16 v[92:95], v[28:31], v[188:191], v[92:95]
  ds_read_b64_tr_b16 v[24:25], v9 offset:41472
  ds_read_b64_tr_b16 v[26:27], v9 offset:45568
  v_mfma_f32_16x16x32_bf16 v[124:127], v[28:31], v[252:255], v[124:127]
  v_mul_f32 v64, s50, v64
  v_mul_f32 v65, s50, v65
  v_mul_f32 v66, s50, v66
  v_mul_f32 v67, s50, v67
  v_cvt_pk_bf16_f32 v32, v64, v65
  v_cvt_pk_bf16_f32 v33, v66, v67
  v_mul_f32 v96, s50, v96
  v_mul_f32 v97, s50, v97
  v_mul_f32 v98, s50, v98
  v_mul_f32 v99, s50, v99
  v_cvt_pk_bf16_f32 v48, v96, v97
  v_cvt_pk_bf16_f32 v49, v98, v99
  s_waitcnt lgkmcnt(2)
  v_mfma_f32_16x16x32_bf16 v[64:67], v[16:19], v[128:131], 0
  ds_read_b64_tr_b16 v[28:29], v10 offset:41472
  ds_read_b64_tr_b16 v[30:31], v10 offset:45568
  v_mfma_f32_16x16x32_bf16 v[96:99], v[16:19], v[192:195], 0
  v_mul_f32 v68, s50, v68
  v_mul_f32 v69, s50, v69
  v_mul_f32 v70, s50, v70
  v_mul_f32 v71, s50, v71
  v_cvt_pk_bf16_f32 v34, v68, v69
  v_cvt_pk_bf16_f32 v35, v70, v71
  v_mul_f32 v100, s50, v100
  v_mul_f32 v101, s50, v101
  v_mul_f32 v102, s50, v102
  v_mul_f32 v103, s50, v103
  v_cvt_pk_bf16_f32 v50, v100, v101
  v_cvt_pk_bf16_f32 v51, v102, v103
  v_permlane16_swap_b32 v32, v34
  v_permlane16_swap_b32 v33, v35
  v_permlane16_swap_b32 v48, v50
  v_permlane16_swap_b32 v49, v51
  v_mfma_f32_16x16x32_bf16 v[68:71], v[20:23], v[128:131], 0
  ds_read_b64_tr_b16 v[16:17], v9 offset:41984
  ds_read_b64_tr_b16 v[18:19], v9 offset:46080
  v_mfma_f32_16x16x32_bf16 v[100:103], v[20:23], v[192:195], 0
  v_mul_f32 v72, s50, v72
  v_mul_f32 v73, s50, v73
  v_mul_f32 v74, s50, v74
  v_mul_f32 v75, s50, v75
  v_cvt_pk_bf16_f32 v36, v72, v73
  v_cvt_pk_bf16_f32 v37, v74, v75
  v_mul_f32 v104, s50, v104
  v_mul_f32 v105, s50, v105
  v_mul_f32 v106, s50, v106
  v_mul_f32 v107, s50, v107
  v_cvt_pk_bf16_f32 v52, v104, v105
  v_cvt_pk_bf16_f32 v53, v106, v107
  s_waitcnt lgkmcnt(2)
  v_mfma_f32_16x16x32_bf16 v[72:75], v[24:27], v[128:131], 0
  ds_read_b64_tr_b16 v[20:21], v10 offset:41984
  ds_read_b64_tr_b16 v[22:23], v10 offset:46080
  v_mfma_f32_16x16x32_bf16 v[104:107], v[24:27], v[192:195], 0
  v_mul_f32 v76, s50, v76
  v_mul_f32 v77, s50, v77
  v_mul_f32 v78, s50, v78
  v_mul_f32 v79, s50, v79
  v_cvt_pk_bf16_f32 v38, v76, v77
  v_cvt_pk_bf16_f32 v39, v78, v79
  v_mul_f32 v108, s50, v108
  v_mul_f32 v109, s50, v109
  v_mul_f32 v110, s50, v110
  v_mul_f32 v111, s50, v111
  v_cvt_pk_bf16_f32 v54, v108, v109
  v_cvt_pk_bf16_f32 v55, v110, v111
  v_permlane16_swap_b32 v36, v38
  v_permlane16_swap_b32 v37, v39
  v_permlane16_swap_b32 v52, v54
  v_permlane16_swap_b32 v53, v55
  v_mfma_f32_16x16x32_bf16 v[76:79], v[28:31], v[128:131], 0
  ds_read_b64_tr_b16 v[24:25], v9 offset:42496
  ds_read_b64_tr_b16 v[26:27], v9 offset:46592
  v_mfma_f32_16x16x32_bf16 v[108:111], v[28:31], v[192:195], 0
  v_mul_f32 v80, s50, v80
  v_mul_f32 v81, s50, v81
  v_mul_f32 v82, s50, v82
  v_mul_f32 v83, s50, v83
  v_cvt_pk_bf16_f32 v40, v80, v81
  v_cvt_pk_bf16_f32 v41, v82, v83
  v_mul_f32 v112, s50, v112
  v_mul_f32 v113, s50, v113
  v_mul_f32 v114, s50, v114
  v_mul_f32 v115, s50, v115
  v_cvt_pk_bf16_f32 v56, v112, v113
  v_cvt_pk_bf16_f32 v57, v114, v115
  s_waitcnt lgkmcnt(2)
  v_mfma_f32_16x16x32_bf16 v[80:83], v[16:19], v[128:131], 0
  ds_read_b64_tr_b16 v[28:29], v10 offset:42496
  ds_read_b64_tr_b16 v[30:31], v10 offset:46592
  v_mfma_f32_16x16x32_bf16 v[112:115], v[16:19], v[192:195], 0
  v_mul_f32 v84, s50, v84
  v_mul_f32 v85, s50, v85
  v_mul_f32 v86, s50, v86
  v_mul_f32 v87, s50, v87
  v_cvt_pk_bf16_f32 v42, v84, v85
  v_cvt_pk_bf16_f32 v43, v86, v87
  v_mul_f32 v116, s50, v116
  v_mul_f32 v117, s50, v117
  v_mul_f32 v118, s50, v118
  v_mul_f32 v119, s50, v119
  v_cvt_pk_bf16_f32 v58, v116, v117
  v_cvt_pk_bf16_f32 v59, v118, v119
  v_permlane16_swap_b32 v40, v42
  v_permlane16_swap_b32 v41, v43
  v_permlane16_swap_b32 v56, v58
  v_permlane16_swap_b32 v57, v59
  v_mfma_f32_16x16x32_bf16 v[84:87], v[20:23], v[128:131], 0
  ds_read_b64_tr_b16 v[16:17], v9 offset:49152
  ds_read_b64_tr_b16 v[18:19], v9 offset:53248
  v_mfma_f32_16x16x32_bf16 v[116:119], v[20:23], v[192:195], 0
  v_mul_f32 v88, s50, v88
  v_mul_f32 v89, s50, v89
  v_mul_f32 v90, s50, v90
  v_mul_f32 v91, s50, v91
  v_cvt_pk_bf16_f32 v44, v88, v89
  v_cvt_pk_bf16_f32 v45, v90, v91
  v_mul_f32 v120, s50, v120
  v_mul_f32 v121, s50, v121
  v_mul_f32 v122, s50, v122
  v_mul_f32 v123, s50, v123
  v_cvt_pk_bf16_f32 v60, v120, v121
  v_cvt_pk_bf16_f32 v61, v122, v123
  s_waitcnt lgkmcnt(2)
  v_mfma_f32_16x16x32_bf16 v[88:91], v[24:27], v[128:131], 0
  ds_read_b64_tr_b16 v[20:21], v10 offset:49152
  ds_read_b64_tr_b16 v[22:23], v10 offset:53248
  v_mfma_f32_16x16x32_bf16 v[120:123], v[24:27], v[192:195], 0
  v_mul_f32 v92, s50, v92
  v_mul_f32 v93, s50, v93
  v_mul_f32 v94, s50, v94
  v_mul_f32 v95, s50, v95
  v_cvt_pk_bf16_f32 v46, v92, v93
  v_cvt_pk_bf16_f32 v47, v94, v95
  v_mul_f32 v124, s50, v124
  v_mul_f32 v125, s50, v125
  v_mul_f32 v126, s50, v126
  v_mul_f32 v127, s50, v127
  v_cvt_pk_bf16_f32 v62, v124, v125
  v_cvt_pk_bf16_f32 v63, v126, v127
  v_permlane16_swap_b32 v44, v46
  v_permlane16_swap_b32 v45, v47
  v_permlane16_swap_b32 v60, v62
  v_permlane16_swap_b32 v61, v63
  v_mfma_f32_16x16x32_bf16 v[92:95], v[28:31], v[128:131], 0
  ds_read_b64_tr_b16 v[24:25], v9 offset:49664
  ds_read_b64_tr_b16 v[26:27], v9 offset:53760
  v_mfma_f32_16x16x32_bf16 v[124:127], v[28:31], v[192:195], 0
  s_waitcnt lgkmcnt(2)
  v_mfma_f32_16x16x32_bf16 v[64:67], v[16:19], v[132:135], v[64:67]
  ds_read_b64_tr_b16 v[28:29], v10 offset:49664
  ds_read_b64_tr_b16 v[30:31], v10 offset:53760
  v_mfma_f32_16x16x32_bf16 v[96:99], v[16:19], v[196:199], v[96:99]
  v_mfma_f32_16x16x32_bf16 v[68:71], v[20:23], v[132:135], v[68:71]
  ds_read_b64_tr_b16 v[16:17], v9 offset:50176
  ds_read_b64_tr_b16 v[18:19], v9 offset:54272
  v_mfma_f32_16x16x32_bf16 v[100:103], v[20:23], v[196:199], v[100:103]
  s_waitcnt lgkmcnt(2)
  v_mfma_f32_16x16x32_bf16 v[72:75], v[24:27], v[132:135], v[72:75]
  ds_read_b64_tr_b16 v[20:21], v10 offset:50176
  ds_read_b64_tr_b16 v[22:23], v10 offset:54272
  v_mfma_f32_16x16x32_bf16 v[104:107], v[24:27], v[196:199], v[104:107]
  v_mfma_f32_16x16x32_bf16 v[76:79], v[28:31], v[132:135], v[76:79]
  ds_read_b64_tr_b16 v[24:25], v9 offset:50688
  ds_read_b64_tr_b16 v[26:27], v9 offset:54784
  v_mfma_f32_16x16x32_bf16 v[108:111], v[28:31], v[196:199], v[108:111]
  s_waitcnt lgkmcnt(2)
  v_mfma_f32_16x16x32_bf16 v[80:83], v[16:19], v[132:135], v[80:83]
  ds_read_b64_tr_b16 v[28:29], v10 offset:50688
  ds_read_b64_tr_b16 v[30:31], v10 offset:54784
  v_mfma_f32_16x16x32_bf16 v[112:115], v[16:19], v[196:199], v[112:115]
  v_mfma_f32_16x16x32_bf16 v[84:87], v[20:23], v[132:135], v[84:87]
  v_mfma_f32_16x16x32_bf16 v[116:119], v[20:23], v[196:199], v[116:119]
  s_waitcnt lgkmcnt(0)
  v_mfma_f32_16x16x32_bf16 v[88:91], v[24:27], v[132:135], v[88:91]
  v_mfma_f32_16x16x32_bf16 v[120:123], v[24:27], v[196:199], v[120:123]
  v_mfma_f32_16x16x32_bf16 v[92:95], v[28:31], v[132:135], v[92:95]
  v_mfma_f32_16x16x32_bf16 v[124:127], v[28:31], v[196:199], v[124:127]
  s_waitcnt vmcnt(0)
  s_waitcnt lgkmcnt(0)
  s_barrier
  ds_read_b64_tr_b16 v[16:17], v9 offset:57344
  ds_read_b64_tr_b16 v[18:19], v9 offset:61440
  ds_read_b64_tr_b16 v[20:21], v10 offset:57344
  ds_read_b64_tr_b16 v[22:23], v10 offset:61440
  ds_read_b64_tr_b16 v[24:25], v9 offset:57856
  ds_read_b64_tr_b16 v[26:27], v9 offset:61952
  s_add_u32 s59, s45, 2
  s_and_b32 s59, s59, 7
  s_lshl_b32 s59, s59, 19
  s_add_u32 s59, s59, s54
  s_add_u32 s59, s59, 262656
  s_add_u32 m0, s55, 114688
  s_nop 0
  buffer_load_dwordx4 v8, s[16:19], s59 offen lds
  s_add_u32 m0, s55, 115584
  s_nop 0
  buffer_load_dwordx4 v8, s[16:19], s59 offen offset:128 lds
  s_add_u32 s59, s45, 3
  s_and_b32 s59, s59, 7
  s_lshl_b32 s59, s59, 19
  s_add_u32 s59, s59, s54
  s_add_u32 s59, s59, 512
  s_add_u32 m0, s55, 122880
  s_nop 0
  buffer_load_dwordx4 v8, s[16:19], s59 offen lds
  s_add_u32 m0, s55, 123776
  s_nop 0
  buffer_load_dwordx4 v8, s[16:19], s59 offen offset:128 lds
  s_waitcnt lgkmcnt(2)
  v_mfma_f32_16x16x32_bf16 v[64:67], v[16:19], v[136:139], v[64:67]
  ds_read_b64_tr_b16 v[28:29], v10 offset:57856
  ds_read_b64_tr_b16 v[30:31], v10 offset:61952
  v_mfma_f32_16x16x32_bf16 v[96:99], v[16:19], v[200:203], v[96:99]
  v_mfma_f32_16x16x32_bf16 v[68:71], v[20:23], v[136:139], v[68:71]
  ds_read_b64_tr_b16 v[16:17], v9 offset:58368
  ds_read_b64_tr_b16 v[18:19], v9 offset:62464
  v_mfma_f32_16x16x32_bf16 v[100:103], v[20:23], v[200:203], v[100:103]
  s_waitcnt lgkmcnt(2)
  v_mfma_f32_16x16x32_bf16 v[72:75], v[24:27], v[136:139], v[72:75]
  ds_read_b64_tr_b16 v[20:21], v10 offset:58368
  ds_read_b64_tr_b16 v[22:23], v10 offset:62464
  v_mfma_f32_16x16x32_bf16 v[104:107], v[24:27], v[200:203], v[104:107]
  v_mfma_f32_16x16x32_bf16 v[76:79], v[28:31], v[136:139], v[76:79]
  ds_read_b64_tr_b16 v[24:25], v9 offset:58880
  ds_read_b64_tr_b16 v[26:27], v9 offset:62976
  v_mfma_f32_16x16x32_bf16 v[108:111], v[28:31], v[200:203], v[108:111]
  s_waitcnt lgkmcnt(2)
  v_mfma_f32_16x16x32_bf16 v[80:83], v[16:19], v[136:139], v[80:83]
  ds_read_b64_tr_b16 v[28:29], v10 offset:58880
  ds_read_b64_tr_b16 v[30:31], v10 offset:62976
  v_mfma_f32_16x16x32_bf16 v[112:115], v[16:19], v[200:203], v[112:115]
  v_mfma_f32_16x16x32_bf16 v[84:87], v[20:23], v[136:139], v[84:87]
  ds_read_b64_tr_b16 v[16:17], v9 offset:0
  ds_read_b64_tr_b16 v[18:19], v9 offset:4096
  v_mfma_f32_16x16x32_bf16 v[116:119], v[20:23], v[200:203], v[116:119]
  s_waitcnt lgkmcnt(2)
  v_mfma_f32_16x16x32_bf16 v[88:91], v[24:27], v[136:139], v[88:91]
  ds_read_b64_tr_b16 v[20:21], v10 offset:0
  ds_read_b64_tr_b16 v[22:23], v10 offset:4096
  v_mfma_f32_16x16x32_bf16 v[120:123], v[24:27], v[200:203], v[120:123]
  v_mfma_f32_16x16x32_bf16 v[92:95], v[28:31], v[136:139], v[92:95]
  ds_read_b64_tr_b16 v[24:25], v9 offset:512
  ds_read_b64_tr_b16 v[26:27], v9 offset:4608
  v_mfma_f32_16x16x32_bf16 v[124:127], v[28:31], v[200:203], v[124:127]
  s_waitcnt lgkmcnt(2)
  v_mfma_f32_16x16x32_bf16 v[64:67], v[16:19], v[140:143], v[64:67]
  ds_read_b64_tr_b16 v[28:29], v10 offset:512
  ds_read_b64_tr_b16 v[30:31], v10 offset:4608
  v_mfma_f32_16x16x32_bf16 v[96:99], v[16:19], v[204:207], v[96:99]
  v_mfma_f32_16x16x32_bf16 v[68:71], v[20:23], v[140:143], v[68:71]
  ds_read_b64_tr_b16 v[16:17], v9 offset:1024
  ds_read_b64_tr_b16 v[18:19], v9 offset:5120
  v_mfma_f32_16x16x32_bf16 v[100:103], v[20:23], v[204:207], v[100:103]
  s_waitcnt lgkmcnt(2)
  v_mfma_f32_16x16x32_bf16 v[72:75], v[24:27], v[140:143], v[72:75]
  ds_read_b64_tr_b16 v[20:21], v10 offset:1024
  ds_read_b64_tr_b16 v[22:23], v10 offset:5120
  v_mfma_f32_16x16x32_bf16 v[104:107], v[24:27], v[204:207], v[104:107]
  v_mfma_f32_16x16x32_bf16 v[76:79], v[28:31], v[140:143], v[76:79]
  ds_read_b64_tr_b16 v[24:25], v9 offset:1536
  ds_read_b64_tr_b16 v[26:27], v9 offset:5632
  v_mfma_f32_16x16x32_bf16 v[108:111], v[28:31], v[204:207], v[108:111]
  s_waitcnt lgkmcnt(2)
  v_mfma_f32_16x16x32_bf16 v[80:83], v[16:19], v[140:143], v[80:83]
  ds_read_b64_tr_b16 v[28:29], v10 offset:1536
  ds_read_b64_tr_b16 v[30:31], v10 offset:5632
  v_mfma_f32_16x16x32_bf16 v[112:115], v[16:19], v[204:207], v[112:115]
  v_mfma_f32_16x16x32_bf16 v[84:87], v[20:23], v[140:143], v[84:87]
  ds_read_b64_tr_b16 v[16:17], v9 offset:8192
  ds_read_b64_tr_b16 v[18:19], v9 offset:12288
  v_mfma_f32_16x16x32_bf16 v[116:119], v[20:23], v[204:207], v[116:119]
  s_waitcnt lgkmcnt(2)
  v_mfma_f32_16x16x32_bf16 v[88:91], v[24:27], v[140:143], v[88:91]
  ds_read_b64_tr_b16 v[20:21], v10 offset:8192
  ds_read_b64_tr_b16 v[22:23], v10 offset:12288
  v_mfma_f32_16x16x32_bf16 v[120:123], v[24:27], v[204:207], v[120:123]
  v_mfma_f32_16x16x32_bf16 v[92:95], v[28:31], v[140:143], v[92:95]
  ds_read_b64_tr_b16 v[24:25], v9 offset:8704
  ds_read_b64_tr_b16 v[26:27], v9 offset:12800
  v_mfma_f32_16x16x32_bf16 v[124:127], v[28:31], v[204:207], v[124:127]
  s_waitcnt lgkmcnt(2)
  v_mfma_f32_16x16x32_bf16 v[64:67], v[16:19], v[144:147], v[64:67]
  ds_read_b64_tr_b16 v[28:29], v10 offset:8704
  ds_read_b64_tr_b16 v[30:31], v10 offset:12800
  v_mfma_f32_16x16x32_bf16 v[96:99], v[16:19], v[208:211], v[96:99]
  v_mfma_f32_16x16x32_bf16 v[68:71], v[20:23], v[144:147], v[68:71]
  ds_read_b64_tr_b16 v[16:17], v9 offset:9216
  ds_read_b64_tr_b16 v[18:19], v9 offset:13312
  v_mfma_f32_16x16x32_bf16 v[100:103], v[20:23], v[208:211], v[100:103]
  s_waitcnt lgkmcnt(2)
  v_mfma_f32_16x16x32_bf16 v[72:75], v[24:27], v[144:147], v[72:75]
  ds_read_b64_tr_b16 v[20:21], v10 offset:9216
  ds_read_b64_tr_b16 v[22:23], v10 offset:13312
  v_mfma_f32_16x16x32_bf16 v[104:107], v[24:27], v[208:211], v[104:107]
  v_mfma_f32_16x16x32_bf16 v[76:79], v[28:31], v[144:147], v[76:79]
  ds_read_b64_tr_b16 v[24:25], v9 offset:9728
  ds_read_b64_tr_b16 v[26:27], v9 offset:13824
  v_mfma_f32_16x16x32_bf16 v[108:111], v[28:31], v[208:211], v[108:111]
  s_waitcnt lgkmcnt(2)
  v_mfma_f32_16x16x32_bf16 v[80:83], v[16:19], v[144:147], v[80:83]
  ds_read_b64_tr_b16 v[28:29], v10 offset:9728
  ds_read_b64_tr_b16 v[30:31], v10 offset:13824
  v_mfma_f32_16x16x32_bf16 v[112:115], v[16:19], v[208:211], v[112:115]
  v_mfma_f32_16x16x32_bf16 v[84:87], v[20:23], v[144:147], v[84:87]
  v_mfma_f32_16x16x32_bf16 v[116:119], v[20:23], v[208:211], v[116:119]
  s_waitcnt lgkmcnt(0)
  v_mfma_f32_16x16x32_bf16 v[88:91], v[24:27], v[144:147], v[88:91]
  v_mfma_f32_16x16x32_bf16 v[120:123], v[24:27], v[208:211], v[120:123]
  v_mfma_f32_16x16x32_bf16 v[92:95], v[28:31], v[144:147], v[92:95]
  v_mfma_f32_16x16x32_bf16 v[124:127], v[28:31], v[208:211], v[124:127]
  s_waitcnt vmcnt(0)
  s_waitcnt lgkmcnt(0)
  s_barrier
  ds_read_b64_tr_b16 v[16:17], v9 offset:16384
  ds_read_b64_tr_b16 v[18:19], v9 offset:20480
  ds_read_b64_tr_b16 v[20:21], v10 offset:16384
  ds_read_b64_tr_b16 v[22:23], v10 offset:20480
  ds_read_b64_tr_b16 v[24:25], v9 offset:16896
  ds_read_b64_tr_b16 v[26:27], v9 offset:20992
  s_add_u32 s59, s45, 3
  s_and_b32 s59, s59, 7
  s_lshl_b32 s59, s59, 19
  s_add_u32 s59, s59, s54
  s_add_u32 s59, s59, 262656
  s_add_u32 m0, s55, 98304
  s_nop 0
  buffer_load_dwordx4 v8, s[16:19], s59 offen lds
  s_add_u32 m0, s55, 99200
  s_nop 0
  buffer_load_dwordx4 v8, s[16:19], s59 offen offset:128 lds
  s_add_u32 s59, s45, 4
  s_and_b32 s59, s59, 7
  s_lshl_b32 s59, s59, 19
  s_add_u32 s59, s59, s54
  s_add_u32 s59, s59, 512
  s_add_u32 m0, s55, 106496
  s_nop 0
  buffer_load_dwordx4 v8, s[16:19], s59 offen lds
  s_add_u32 m0, s55, 107392
  s_nop 0
  buffer_load_dwordx4 v8, s[16:19], s59 offen offset:128 lds
  s_waitcnt lgkmcnt(2)
  v_mfma_f32_16x16x32_bf16 v[64:67], v[16:19], v[148:151], v[64:67]
  ds_read_b64_tr_b16 v[28:29], v10 offset:16896
  ds_read_b64_tr_b16 v[30:31], v10 offset:20992
  v_mfma_f32_16x16x32_bf16 v[96:99], v[16:19], v[212:215], v[96:99]
  v_add_u32 v13, 131072, v11
  ds_write_b128 v13, v[32:35] offset:0
  v_mfma_f32_16x16x32_bf16 v[68:71], v[20:23], v[148:151], v[68:71]
  ds_read_b64_tr_b16 v[16:17], v9 offset:17408
  ds_read_b64_tr_b16 v[18:19], v9 offset:21504
  v_mfma_f32_16x16x32_bf16 v[100:103], v[20:23], v[212:215], v[100:103]
  s_waitcnt lgkmcnt(3)
  v_mfma_f32_16x16x32_bf16 v[72:75], v[24:27], v[148:151], v[72:75]
  ds_read_b64_tr_b16 v[20:21], v10 offset:17408
  ds_read_b64_tr_b16 v[22:23], v10 offset:21504
  v_mfma_f32_16x16x32_bf16 v[104:107], v[24:27], v[212:215], v[104:107]
  ds_write_b128 v13, v[48:51] offset:4096
  v_mfma_f32_16x16x32_bf16 v[76:79], v[28:31], v[148:151], v[76:79]
  ds_read_b64_tr_b16 v[24:25], v9 offset:17920
  ds_read_b64_tr_b16 v[26:27], v9 offset:22016
  v_mfma_f32_16x16x32_bf16 v[108:111], v[28:31], v[212:215], v[108:111]
  s_waitcnt lgkmcnt(3)
  v_mfma_f32_16x16x32_bf16 v[80:83], v[16:19], v[148:151], v[80:83]
  ds_read_b64_tr_b16 v[28:29], v10 offset:17920
  ds_read_b64_tr_b16 v[30:31], v10 offset:22016
  v_mfma_f32_16x16x32_bf16 v[112:115], v[16:19], v[212:215], v[112:115]
  ds_write_b128 v13, v[36:39] offset:1024
  v_mfma_f32_16x16x32_bf16 v[84:87], v[20:23], v[148:151], v[84:87]
  ds_read_b64_tr_b16 v[16:17], v9 offset:24576
  ds_read_b64_tr_b16 v[18:19], v9 offset:28672
  v_mfma_f32_16x16x32_bf16 v[116:119], v[20:23], v[212:215], v[116:119]
  s_waitcnt lgkmcnt(3)
  v_mfma_f32_16x16x32_bf16 v[88:91], v[24:27], v[148:151], v[88:91]
  ds_read_b64_tr_b16 v[20:21], v10 offset:24576
  ds_read_b64_tr_b16 v[22:23], v10 offset:28672
  v_mfma_f32_16x16x32_bf16 v[120:123], v[24:27], v[212:215], v[120:123]
  ds_write_b128 v13, v[52:55] offset:5120
  v_mfma_f32_16x16x32_bf16 v[92:95], v[28:31], v[148:151], v[92:95]
  ds_read_b64_tr_b16 v[24:25], v9 offset:25088
  ds_read_b64_tr_b16 v[26:27], v9 offset:29184
  v_mfma_f32_16x16x32_bf16 v[124:127], v[28:31], v[212:215], v[124:127]
  s_waitcnt lgkmcnt(3)
  v_mfma_f32_16x16x32_bf16 v[64:67], v[16:19], v[152:155], v[64:67]
  ds_read_b64_tr_b16 v[28:29], v10 offset:25088
  ds_read_b64_tr_b16 v[30:31], v10 offset:29184
  v_mfma_f32_16x16x32_bf16 v[96:99], v[16:19], v[216:219], v[96:99]
  ds_write_b128 v13, v[40:43] offset:2048
  v_mfma_f32_16x16x32_bf16 v[68:71], v[20:23], v[152:155], v[68:71]
  ds_read_b64_tr_b16 v[16:17], v9 offset:25600
  ds_read_b64_tr_b16 v[18:19], v9 offset:29696
  v_mfma_f32_16x16x32_bf16 v[100:103], v[20:23], v[216:219], v[100:103]
  s_waitcnt lgkmcnt(3)
  v_mfma_f32_16x16x32_bf16 v[72:75], v[24:27], v[152:155], v[72:75]
  ds_read_b64_tr_b16 v[20:21], v10 offset:25600
  ds_read_b64_tr_b16 v[22:23], v10 offset:29696
  v_mfma_f32_16x16x32_bf16 v[104:107], v[24:27], v[216:219], v[104:107]
  ds_write_b128 v13, v[56:59] offset:6144
  v_mfma_f32_16x16x32_bf16 v[76:79], v[28:31], v[152:155], v[76:79]
  ds_read_b64_tr_b16 v[24:25], v9 offset:26112
  ds_read_b64_tr_b16 v[26:27], v9 offset:30208
  v_mfma_f32_16x16x32_bf16 v[108:111], v[28:31], v[216:219], v[108:111]
  s_waitcnt lgkmcnt(3)
  v_mfma_f32_16x16x32_bf16 v[80:83], v[16:19], v[152:155], v[80:83]
  ds_read_b64_tr_b16 v[28:29], v10 offset:26112
  ds_read_b64_tr_b16 v[30:31], v10 offset:30208
  v_mfma_f32_16x16x32_bf16 v[112:115], v[16:19], v[216:219], v[112:115]
  ds_write_b128 v13, v[44:47] offset:3072
  v_mfma_f32_16x16x32_bf16 v[84:87], v[20:23], v[152:155], v[84:87]
  v_mfma_f32_16x16x32_bf16 v[116:119], v[20:23], v[216:219], v[116:119]
  s_waitcnt lgkmcnt(1)
  v_mfma_f32_16x16x32_bf16 v[88:91], v[24:27], v[152:155], v[88:91]
  v_mfma_f32_16x16x32_bf16 v[120:123], v[24:27], v[216:219], v[120:123]
  ds_write_b128 v13, v[60:63] offset:7168
  v_mfma_f32_16x16x32_bf16 v[92:95], v[28:31], v[152:155], v[92:95]
  v_mfma_f32_16x16x32_bf16 v[124:127], v[28:31], v[216:219], v[124:127]
  s_waitcnt vmcnt(0)
  s_waitcnt lgkmcnt(0)
  s_barrier
  ds_read_b64_tr_b16 v[16:17], v9 offset:0
  ds_read_b64_tr_b16 v[18:19], v9 offset:4096
  ds_read_b64_tr_b16 v[20:21], v10 offset:0
  ds_read_b64_tr_b16 v[22:23], v10 offset:4096
  ds_read_b64_tr_b16 v[24:25], v9 offset:512
  ds_read_b64_tr_b16 v[26:27], v9 offset:4608
  s_add_u32 s59, s45, 4
  s_and_b32 s59, s59, 7
  s_lshl_b32 s59, s59, 19
  s_add_u32 s59, s59, s54
  s_add_u32 s59, s59, 262656
  s_add_u32 m0, s55, 114688
  s_nop 0
  buffer_load_dwordx4 v8, s[16:19], s59 offen lds
  s_add_u32 m0, s55, 115584
  s_nop 0
  buffer_load_dwordx4 v8, s[16:19], s59 offen offset:128 lds
  s_add_u32 s59, s45, 5
  s_and_b32 s59, s59, 7
  s_lshl_b32 s59, s59, 19
  s_add_u32 s59, s59, s54
  s_add_u32 s59, s59, 512
  s_add_u32 m0, s55, 122880
  s_nop 0
  buffer_load_dwordx4 v8, s[16:19], s59 offen lds
  s_add_u32 m0, s55, 123776
  s_nop 0
  buffer_load_dwordx4 v8, s[16:19], s59 offen offset:128 lds
  s_waitcnt lgkmcnt(2)
  v_mfma_f32_16x16x32_bf16 v[64:67], v[16:19], v[156:159], v[64:67]
  ds_read_b64_tr_b16 v[28:29], v10 offset:512
  ds_read_b64_tr_b16 v[30:31], v10 offset:4608
  v_mfma_f32_16x16x32_bf16 v[96:99], v[16:19], v[220:223], v[96:99]
  v_mfma_f32_16x16x32_bf16 v[68:71], v[20:23], v[156:159], v[68:71]
  ds_read_b64_tr_b16 v[16:17], v9 offset:1024
  ds_read_b64_tr_b16 v[18:19], v9 offset:5120
  v_mfma_f32_16x16x32_bf16 v[100:103], v[20:23], v[220:223], v[100:103]
  s_waitcnt lgkmcnt(2)
  v_mfma_f32_16x16x32_bf16 v[72:75], v[24:27], v[156:159], v[72:75]
  ds_read_b64_tr_b16 v[20:21], v10 offset:1024
  ds_read_b64_tr_b16 v[22:23], v10 offset:5120
  v_mfma_f32_16x16x32_bf16 v[104:107], v[24:27], v[220:223], v[104:107]
  v_mfma_f32_16x16x32_bf16 v[76:79], v[28:31], v[156:159], v[76:79]
  ds_read_b64_tr_b16 v[24:25], v9 offset:1536
  ds_read_b64_tr_b16 v[26:27], v9 offset:5632
  v_mfma_f32_16x16x32_bf16 v[108:111], v[28:31], v[220:223], v[108:111]
  s_waitcnt lgkmcnt(2)
  v_mfma_f32_16x16x32_bf16 v[80:83], v[16:19], v[156:159], v[80:83]
  ds_read_b64_tr_b16 v[28:29], v10 offset:1536
  ds_read_b64_tr_b16 v[30:31], v10 offset:5632
  v_mfma_f32_16x16x32_bf16 v[112:115], v[16:19], v[220:223], v[112:115]
  v_mfma_f32_16x16x32_bf16 v[84:87], v[20:23], v[156:159], v[84:87]
  ds_read_b64_tr_b16 v[16:17], v9 offset:8192
  ds_read_b64_tr_b16 v[18:19], v9 offset:12288
  v_mfma_f32_16x16x32_bf16 v[116:119], v[20:23], v[220:223], v[116:119]
  s_waitcnt lgkmcnt(2)
  v_mfma_f32_16x16x32_bf16 v[88:91], v[24:27], v[156:159], v[88:91]
  ds_read_b64_tr_b16 v[20:21], v10 offset:8192
  ds_read_b64_tr_b16 v[22:23], v10 offset:12288
  v_mfma_f32_16x16x32_bf16 v[120:123], v[24:27], v[220:223], v[120:123]
  v_mfma_f32_16x16x32_bf16 v[92:95], v[28:31], v[156:159], v[92:95]
  ds_read_b64_tr_b16 v[24:25], v9 offset:8704
  ds_read_b64_tr_b16 v[26:27], v9 offset:12800
  v_mfma_f32_16x16x32_bf16 v[124:127], v[28:31], v[220:223], v[124:127]
  s_waitcnt lgkmcnt(2)
  v_mfma_f32_16x16x32_bf16 v[64:67], v[16:19], v[160:163], v[64:67]
  ds_read_b64_tr_b16 v[28:29], v10 offset:8704
  ds_read_b64_tr_b16 v[30:31], v10 offset:12800
  v_mfma_f32_16x16x32_bf16 v[96:99], v[16:19], v[224:227], v[96:99]
  v_mfma_f32_16x16x32_bf16 v[68:71], v[20:23], v[160:163], v[68:71]
  ds_read_b64_tr_b16 v[16:17], v9 offset:9216
  ds_read_b64_tr_b16 v[18:19], v9 offset:13312
  v_mfma_f32_16x16x32_bf16 v[100:103], v[20:23], v[224:227], v[100:103]
  s_waitcnt lgkmcnt(2)
  v_mfma_f32_16x16x32_bf16 v[72:75], v[24:27], v[160:163], v[72:75]
  ds_read_b64_tr_b16 v[20:21], v10 offset:9216
  ds_read_b64_tr_b16 v[22:23], v10 offset:13312
  v_mfma_f32_16x16x32_bf16 v[104:107], v[24:27], v[224:227], v[104:107]
  v_mfma_f32_16x16x32_bf16 v[76:79], v[28:31], v[160:163], v[76:79]
  ds_read_b64_tr_b16 v[24:25], v9 offset:9728
  ds_read_b64_tr_b16 v[26:27], v9 offset:13824
  v_mfma_f32_16x16x32_bf16 v[108:111], v[28:31], v[224:227], v[108:111]
  s_waitcnt lgkmcnt(2)
  v_mfma_f32_16x16x32_bf16 v[80:83], v[16:19], v[160:163], v[80:83]
  ds_read_b64_tr_b16 v[28:29], v10 offset:9728
  ds_read_b64_tr_b16 v[30:31], v10 offset:13824
  v_mfma_f32_16x16x32_bf16 v[112:115], v[16:19], v[224:227], v[112:115]
  v_mfma_f32_16x16x32_bf16 v[84:87], v[20:23], v[160:163], v[84:87]
  v_mfma_f32_16x16x32_bf16 v[116:119], v[20:23], v[224:227], v[116:119]
  s_waitcnt lgkmcnt(0)
  v_mfma_f32_16x16x32_bf16 v[88:91], v[24:27], v[160:163], v[88:91]
  v_mfma_f32_16x16x32_bf16 v[120:123], v[24:27], v[224:227], v[120:123]
  v_mfma_f32_16x16x32_bf16 v[92:95], v[28:31], v[160:163], v[92:95]
  v_mfma_f32_16x16x32_bf16 v[124:127], v[28:31], v[224:227], v[124:127]
  s_waitcnt vmcnt(0)
  s_waitcnt lgkmcnt(0)
  s_barrier
  ds_read_b64_tr_b16 v[16:17], v9 offset:16384
  ds_read_b64_tr_b16 v[18:19], v9 offset:20480
  ds_read_b64_tr_b16 v[20:21], v10 offset:16384
  ds_read_b64_tr_b16 v[22:23], v10 offset:20480
  ds_read_b64_tr_b16 v[24:25], v9 offset:16896
  ds_read_b64_tr_b16 v[26:27], v9 offset:20992
  s_add_u32 s59, s45, 5
  s_and_b32 s59, s59, 7
  s_lshl_b32 s59, s59, 19
  s_add_u32 s59, s59, s54
  s_add_u32 s59, s59, 262656
  s_add_u32 m0, s55, 131072
  s_nop 0
  buffer_load_dwordx4 v8, s[16:19], s59 offen lds
  s_add_u32 m0, s55, 131968
  s_nop 0
  buffer_load_dwordx4 v8, s[16:19], s59 offen offset:128 lds
  s_add_u32 s59, s45, 6
  s_and_b32 s59, s59, 7
  s_lshl_b32 s59, s59, 19
  s_add_u32 s59, s59, s54
  s_add_u32 s59, s59, 512
  s_add_u32 m0, s55, 139264
  s_nop 0
  buffer_load_dwordx4 v8, s[16:19], s59 offen lds
  s_add_u32 m0, s55, 140160
  s_nop 0
  buffer_load_dwordx4 v8, s[16:19], s59 offen offset:128 lds
  s_add_u32 s59, s45, 6
  s_and_b32 s59, s59, 7
  s_lshl_b32 s59, s59, 19
  s_add_u32 s59, s59, s54
  s_add_u32 s59, s59, 262656
  s_add_u32 m0, s55, 147456
  s_nop 0
  buffer_load_dwordx4 v8, s[16:19], s59 offen lds
  s_add_u32 m0, s55, 148352
  s_nop 0
  buffer_load_dwordx4 v8, s[16:19], s59 offen offset:128 lds
  s_waitcnt lgkmcnt(2)
  v_mfma_f32_16x16x32_bf16 v[64:67], v[16:19], v[164:167], v[64:67]
  ds_read_b64_tr_b16 v[28:29], v10 offset:16896
  ds_read_b64_tr_b16 v[30:31], v10 offset:20992
  v_mfma_f32_16x16x32_bf16 v[96:99], v[16:19], v[228:231], v[96:99]
  v_mfma_f32_16x16x32_bf16 v[68:71], v[20:23], v[164:167], v[68:71]
  ds_read_b64_tr_b16 v[16:17], v9 offset:17408
  ds_read_b64_tr_b16 v[18:19], v9 offset:21504
  v_mfma_f32_16x16x32_bf16 v[100:103], v[20:23], v[228:231], v[100:103]
  s_waitcnt lgkmcnt(2)
  v_mfma_f32_16x16x32_bf16 v[72:75], v[24:27], v[164:167], v[72:75]
  ds_read_b64_tr_b16 v[20:21], v10 offset:17408
  ds_read_b64_tr_b16 v[22:23], v10 offset:21504
  v_mfma_f32_16x16x32_bf16 v[104:107], v[24:27], v[228:231], v[104:107]
  v_mfma_f32_16x16x32_bf16 v[76:79], v[28:31], v[164:167], v[76:79]
  ds_read_b64_tr_b16 v[24:25], v9 offset:17920
  ds_read_b64_tr_b16 v[26:27], v9 offset:22016
  v_mfma_f32_16x16x32_bf16 v[108:111], v[28:31], v[228:231], v[108:111]
  s_waitcnt lgkmcnt(2)
  v_mfma_f32_16x16x32_bf16 v[80:83], v[16:19], v[164:167], v[80:83]
  ds_read_b64_tr_b16 v[28:29], v10 offset:17920
  ds_read_b64_tr_b16 v[30:31], v10 offset:22016
  v_mfma_f32_16x16x32_bf16 v[112:115], v[16:19], v[228:231], v[112:115]
  v_mfma_f32_16x16x32_bf16 v[84:87], v[20:23], v[164:167], v[84:87]
  ds_read_b64_tr_b16 v[16:17], v9 offset:24576
  ds_read_b64_tr_b16 v[18:19], v9 offset:28672
  v_mfma_f32_16x16x32_bf16 v[116:119], v[20:23], v[228:231], v[116:119]
  s_waitcnt lgkmcnt(2)
  v_mfma_f32_16x16x32_bf16 v[88:91], v[24:27], v[164:167], v[88:91]
  ds_read_b64_tr_b16 v[20:21], v10 offset:24576
  ds_read_b64_tr_b16 v[22:23], v10 offset:28672
  v_mfma_f32_16x16x32_bf16 v[120:123], v[24:27], v[228:231], v[120:123]
  v_mfma_f32_16x16x32_bf16 v[92:95], v[28:31], v[164:167], v[92:95]
  ds_read_b64_tr_b16 v[24:25], v9 offset:25088
  ds_read_b64_tr_b16 v[26:27], v9 offset:29184
  v_mfma_f32_16x16x32_bf16 v[124:127], v[28:31], v[228:231], v[124:127]
  s_waitcnt lgkmcnt(2)
  v_mfma_f32_16x16x32_bf16 v[64:67], v[16:19], v[168:171], v[64:67]
  ds_read_b64_tr_b16 v[28:29], v10 offset:25088
  ds_read_b64_tr_b16 v[30:31], v10 offset:29184
  v_mfma_f32_16x16x32_bf16 v[96:99], v[16:19], v[232:235], v[96:99]
  v_mfma_f32_16x16x32_bf16 v[68:71], v[20:23], v[168:171], v[68:71]
  ds_read_b64_tr_b16 v[16:17], v9 offset:25600
  ds_read_b64_tr_b16 v[18:19], v9 offset:29696
  v_mfma_f32_16x16x32_bf16 v[100:103], v[20:23], v[232:235], v[100:103]
  s_waitcnt lgkmcnt(2)
  v_mfma_f32_16x16x32_bf16 v[72:75], v[24:27], v[168:171], v[72:75]
  ds_read_b64_tr_b16 v[20:21], v10 offset:25600
  ds_read_b64_tr_b16 v[22:23], v10 offset:29696
  v_mfma_f32_16x16x32_bf16 v[104:107], v[24:27], v[232:235], v[104:107]
  v_mfma_f32_16x16x32_bf16 v[76:79], v[28:31], v[168:171], v[76:79]
  ds_read_b64_tr_b16 v[24:25], v9 offset:26112
  ds_read_b64_tr_b16 v[26:27], v9 offset:30208
  v_mfma_f32_16x16x32_bf16 v[108:111], v[28:31], v[232:235], v[108:111]
  s_waitcnt lgkmcnt(2)
  v_mfma_f32_16x16x32_bf16 v[80:83], v[16:19], v[168:171], v[80:83]
  ds_read_b64_tr_b16 v[28:29], v10 offset:26112
  ds_read_b64_tr_b16 v[30:31], v10 offset:30208
  v_mfma_f32_16x16x32_bf16 v[112:115], v[16:19], v[232:235], v[112:115]
  v_mfma_f32_16x16x32_bf16 v[84:87], v[20:23], v[168:171], v[84:87]
  v_mfma_f32_16x16x32_bf16 v[116:119], v[20:23], v[232:235], v[116:119]
  s_waitcnt lgkmcnt(0)
  v_mfma_f32_16x16x32_bf16 v[88:91], v[24:27], v[168:171], v[88:91]
  v_mfma_f32_16x16x32_bf16 v[120:123], v[24:27], v[232:235], v[120:123]
  v_mfma_f32_16x16x32_bf16 v[92:95], v[28:31], v[168:171], v[92:95]
  v_mfma_f32_16x16x32_bf16 v[124:127], v[28:31], v[232:235], v[124:127]
  s_waitcnt vmcnt(0)
  s_waitcnt lgkmcnt(0)
  s_barrier
  ds_read_b64_tr_b16 v[16:17], v9 offset:32768
  ds_read_b64_tr_b16 v[18:19], v9 offset:36864
  ds_read_b64_tr_b16 v[20:21], v10 offset:32768
  ds_read_b64_tr_b16 v[22:23], v10 offset:36864
  ds_read_b64_tr_b16 v[24:25], v9 offset:33280
  ds_read_b64_tr_b16 v[26:27], v9 offset:37376
  s_add_u32 s59, s45, 7
  s_and_b32 s59, s59, 7
  s_lshl_b32 s59, s59, 19
  s_add_u32 s59, s59, s54
  s_add_u32 s59, s59, 512
  s_add_u32 m0, s55, 155648
  s_nop 0
  buffer_load_dwordx4 v8, s[16:19], s59 offen lds
  s_add_u32 m0, s55, 156544
  s_nop 0
  buffer_load_dwordx4 v8, s[16:19], s59 offen offset:128 lds
  s_add_u32 s59, s45, 7
  s_and_b32 s59, s59, 7
  s_lshl_b32 s59, s59, 19
  s_add_u32 s59, s59, s54
  s_add_u32 s59, s59, 262656
  s_add_u32 m0, s55, 98304
  s_nop 0
  buffer_load_dwordx4 v8, s[16:19], s59 offen lds
  s_add_u32 m0, s55, 99200
  s_nop 0
  buffer_load_dwordx4 v8, s[16:19], s59 offen offset:128 lds
  s_add_u32 s59, s45, 0
  s_and_b32 s59, s59, 7
  s_lshl_b32 s59, s59, 19
  s_add_u32 s59, s59, s54
  s_add_u32 s59, s59, 768
  s_add_u32 m0, s55, 106496
  s_nop 0
  buffer_load_dwordx4 v8, s[16:19], s59 offen lds
  s_add_u32 m0, s55, 107392
  s_nop 0
  buffer_load_dwordx4 v8, s[16:19], s59 offen offset:128 lds
  s_waitcnt lgkmcnt(2)
  v_mfma_f32_16x16x32_bf16 v[64:67], v[16:19], v[172:175], v[64:67]
  ds_read_b64_tr_b16 v[28:29], v10 offset:33280
  ds_read_b64_tr_b16 v[30:31], v10 offset:37376
  v_mfma_f32_16x16x32_bf16 v[96:99], v[16:19], v[236:239], v[96:99]
  v_mfma_f32_16x16x32_bf16 v[68:71], v[20:23], v[172:175], v[68:71]
  ds_read_b64_tr_b16 v[16:17], v9 offset:33792
  ds_read_b64_tr_b16 v[18:19], v9 offset:37888
  v_mfma_f32_16x16x32_bf16 v[100:103], v[20:23], v[236:239], v[100:103]
  s_waitcnt lgkmcnt(2)
  v_mfma_f32_16x16x32_bf16 v[72:75], v[24:27], v[172:175], v[72:75]
  ds_read_b64_tr_b16 v[20:21], v10 offset:33792
  ds_read_b64_tr_b16 v[22:23], v10 offset:37888
  v_mfma_f32_16x16x32_bf16 v[104:107], v[24:27], v[236:239], v[104:107]
  v_mfma_f32_16x16x32_bf16 v[76:79], v[28:31], v[172:175], v[76:79]
  ds_read_b64_tr_b16 v[24:25], v9 offset:34304
  ds_read_b64_tr_b16 v[26:27], v9 offset:38400
  v_mfma_f32_16x16x32_bf16 v[108:111], v[28:31], v[236:239], v[108:111]
  s_waitcnt lgkmcnt(2)
  v_mfma_f32_16x16x32_bf16 v[80:83], v[16:19], v[172:175], v[80:83]
  ds_read_b64_tr_b16 v[28:29], v10 offset:34304
  ds_read_b64_tr_b16 v[30:31], v10 offset:38400
  v_mfma_f32_16x16x32_bf16 v[112:115], v[16:19], v[236:239], v[112:115]
  v_mfma_f32_16x16x32_bf16 v[84:87], v[20:23], v[172:175], v[84:87]
  ds_read_b64_tr_b16 v[16:17], v9 offset:40960
  ds_read_b64_tr_b16 v[18:19], v9 offset:45056
  v_mfma_f32_16x16x32_bf16 v[116:119], v[20:23], v[236:239], v[116:119]
  s_waitcnt lgkmcnt(2)
  v_mfma_f32_16x16x32_bf16 v[88:91], v[24:27], v[172:175], v[88:91]
  ds_read_b64_tr_b16 v[20:21], v10 offset:40960
  ds_read_b64_tr_b16 v[22:23], v10 offset:45056
  v_mfma_f32_16x16x32_bf16 v[120:123], v[24:27], v[236:239], v[120:123]
  v_mfma_f32_16x16x32_bf16 v[92:95], v[28:31], v[172:175], v[92:95]
  ds_read_b64_tr_b16 v[24:25], v9 offset:41472
  ds_read_b64_tr_b16 v[26:27], v9 offset:45568
  v_mfma_f32_16x16x32_bf16 v[124:127], v[28:31], v[236:239], v[124:127]
  s_waitcnt lgkmcnt(2)
  v_mfma_f32_16x16x32_bf16 v[64:67], v[16:19], v[176:179], v[64:67]
  ds_read_b64_tr_b16 v[28:29], v10 offset:41472
  ds_read_b64_tr_b16 v[30:31], v10 offset:45568
  v_mfma_f32_16x16x32_bf16 v[96:99], v[16:19], v[240:243], v[96:99]
  v_mfma_f32_16x16x32_bf16 v[68:71], v[20:23], v[176:179], v[68:71]
  ds_read_b64_tr_b16 v[16:17], v9 offset:41984
  ds_read_b64_tr_b16 v[18:19], v9 offset:46080
  v_mfma_f32_16x16x32_bf16 v[100:103], v[20:23], v[240:243], v[100:103]
  s_waitcnt lgkmcnt(2)
  v_mfma_f32_16x16x32_bf16 v[72:75], v[24:27], v[176:179], v[72:75]
  ds_read_b64_tr_b16 v[20:21], v10 offset:41984
  ds_read_b64_tr_b16 v[22:23], v10 offset:46080
  v_mfma_f32_16x16x32_bf16 v[104:107], v[24:27], v[240:243], v[104:107]
  v_mfma_f32_16x16x32_bf16 v[76:79], v[28:31], v[176:179], v[76:79]
  ds_read_b64_tr_b16 v[24:25], v9 offset:42496
  ds_read_b64_tr_b16 v[26:27], v9 offset:46592
  v_mfma_f32_16x16x32_bf16 v[108:111], v[28:31], v[240:243], v[108:111]
  s_waitcnt lgkmcnt(2)
  v_mfma_f32_16x16x32_bf16 v[80:83], v[16:19], v[176:179], v[80:83]
  ds_read_b64_tr_b16 v[28:29], v10 offset:42496
  ds_read_b64_tr_b16 v[30:31], v10 offset:46592
  v_mfma_f32_16x16x32_bf16 v[112:115], v[16:19], v[240:243], v[112:115]
  v_mfma_f32_16x16x32_bf16 v[84:87], v[20:23], v[176:179], v[84:87]
  ds_read_b64_tr_b16 v[16:17], v9 offset:49152
  ds_read_b64_tr_b16 v[18:19], v9 offset:53248
  v_mfma_f32_16x16x32_bf16 v[116:119], v[20:23], v[240:243], v[116:119]
  s_waitcnt lgkmcnt(2)
  v_mfma_f32_16x16x32_bf16 v[88:91], v[24:27], v[176:179], v[88:91]
  ds_read_b64_tr_b16 v[20:21], v10 offset:49152
  ds_read_b64_tr_b16 v[22:23], v10 offset:53248
  v_mfma_f32_16x16x32_bf16 v[120:123], v[24:27], v[240:243], v[120:123]
  v_mfma_f32_16x16x32_bf16 v[92:95], v[28:31], v[176:179], v[92:95]
  ds_read_b64_tr_b16 v[24:25], v9 offset:49664
  ds_read_b64_tr_b16 v[26:27], v9 offset:53760
  v_mfma_f32_16x16x32_bf16 v[124:127], v[28:31], v[240:243], v[124:127]
  s_waitcnt lgkmcnt(2)
  v_mfma_f32_16x16x32_bf16 v[64:67], v[16:19], v[180:183], v[64:67]
  ds_read_b64_tr_b16 v[28:29], v10 offset:49664
  ds_read_b64_tr_b16 v[30:31], v10 offset:53760
  v_mfma_f32_16x16x32_bf16 v[96:99], v[16:19], v[244:247], v[96:99]
  v_mfma_f32_16x16x32_bf16 v[68:71], v[20:23], v[180:183], v[68:71]
  ds_read_b64_tr_b16 v[16:17], v9 offset:50176
  ds_read_b64_tr_b16 v[18:19], v9 offset:54272
  v_mfma_f32_16x16x32_bf16 v[100:103], v[20:23], v[244:247], v[100:103]
  s_waitcnt lgkmcnt(2)
  v_mfma_f32_16x16x32_bf16 v[72:75], v[24:27], v[180:183], v[72:75]
  ds_read_b64_tr_b16 v[20:21], v10 offset:50176
  ds_read_b64_tr_b16 v[22:23], v10 offset:54272
  v_mfma_f32_16x16x32_bf16 v[104:107], v[24:27], v[244:247], v[104:107]
  v_mfma_f32_16x16x32_bf16 v[76:79], v[28:31], v[180:183], v[76:79]
  ds_read_b64_tr_b16 v[24:25], v9 offset:50688
  ds_read_b64_tr_b16 v[26:27], v9 offset:54784
  v_mfma_f32_16x16x32_bf16 v[108:111], v[28:31], v[244:247], v[108:111]
  s_waitcnt lgkmcnt(2)
  v_mfma_f32_16x16x32_bf16 v[80:83], v[16:19], v[180:183], v[80:83]
  ds_read_b64_tr_b16 v[28:29], v10 offset:50688
  ds_read_b64_tr_b16 v[30:31], v10 offset:54784
  v_mfma_f32_16x16x32_bf16 v[112:115], v[16:19], v[244:247], v[112:115]
  v_mfma_f32_16x16x32_bf16 v[84:87], v[20:23], v[180:183], v[84:87]
  v_mfma_f32_16x16x32_bf16 v[116:119], v[20:23], v[244:247], v[116:119]
  s_waitcnt lgkmcnt(0)
  v_mfma_f32_16x16x32_bf16 v[88:91], v[24:27], v[180:183], v[88:91]
  v_mfma_f32_16x16x32_bf16 v[120:123], v[24:27], v[244:247], v[120:123]
  v_mfma_f32_16x16x32_bf16 v[92:95], v[28:31], v[180:183], v[92:95]
  v_mfma_f32_16x16x32_bf16 v[124:127], v[28:31], v[244:247], v[124:127]
  s_waitcnt vmcnt(0)
  s_waitcnt lgkmcnt(0)
  s_barrier
  ds_read_b64_tr_b16 v[16:17], v9 offset:57344
  ds_read_b64_tr_b16 v[18:19], v9 offset:61440
  ds_read_b64_tr_b16 v[20:21], v10 offset:57344
  ds_read_b64_tr_b16 v[22:23], v10 offset:61440
  ds_read_b64_tr_b16 v[24:25], v9 offset:57856
  ds_read_b64_tr_b16 v[26:27], v9 offset:61952
  s_add_u32 s59, s45, 0
  s_and_b32 s59, s59, 7
  s_lshl_b32 s59, s59, 19
  s_add_u32 s59, s59, s54
  s_add_u32 s59, s59, 262912
  s_add_u32 m0, s55, 131072
  s_nop 0
  buffer_load_dwordx4 v8, s[16:19], s59 offen lds
  s_add_u32 m0, s55, 131968
  s_nop 0
  buffer_load_dwordx4 v8, s[16:19], s59 offen offset:128 lds
  s_add_u32 s59, s45, 1
  s_and_b32 s59, s59, 7
  s_lshl_b32 s59, s59, 19
  s_add_u32 s59, s59, s54
  s_add_u32 s59, s59, 768
  s_add_u32 m0, s55, 139264
  s_nop 0
  buffer_load_dwordx4 v8, s[16:19], s59 offen lds
  s_add_u32 m0, s55, 140160
  s_nop 0
  buffer_load_dwordx4 v8, s[16:19], s59 offen offset:128 lds
  s_add_u32 s59, s45, 1
  s_and_b32 s59, s59, 7
  s_lshl_b32 s59, s59, 19
  s_add_u32 s59, s59, s54
  s_add_u32 s59, s59, 262912
  s_add_u32 m0, s55, 147456
  s_nop 0
  buffer_load_dwordx4 v8, s[16:19], s59 offen lds
  s_add_u32 m0, s55, 148352
  s_nop 0
  buffer_load_dwordx4 v8, s[16:19], s59 offen offset:128 lds
  s_waitcnt lgkmcnt(2)
  v_mfma_f32_16x16x32_bf16 v[64:67], v[16:19], v[184:187], v[64:67]
  ds_read_b64_tr_b16 v[28:29], v10 offset:57856
  ds_read_b64_tr_b16 v[30:31], v10 offset:61952
  v_mfma_f32_16x16x32_bf16 v[96:99], v[16:19], v[248:251], v[96:99]
  v_mfma_f32_16x16x32_bf16 v[68:71], v[20:23], v[184:187], v[68:71]
  ds_read_b64_tr_b16 v[16:17], v9 offset:58368
  ds_read_b64_tr_b16 v[18:19], v9 offset:62464
  v_mfma_f32_16x16x32_bf16 v[100:103], v[20:23], v[248:251], v[100:103]
  s_waitcnt lgkmcnt(2)
  v_mfma_f32_16x16x32_bf16 v[72:75], v[24:27], v[184:187], v[72:75]
  ds_read_b64_tr_b16 v[20:21], v10 offset:58368
  ds_read_b64_tr_b16 v[22:23], v10 offset:62464
  v_mfma_f32_16x16x32_bf16 v[104:107], v[24:27], v[248:251], v[104:107]
  v_mfma_f32_16x16x32_bf16 v[76:79], v[28:31], v[184:187], v[76:79]
  ds_read_b64_tr_b16 v[24:25], v9 offset:58880
  ds_read_b64_tr_b16 v[26:27], v9 offset:62976
  v_mfma_f32_16x16x32_bf16 v[108:111], v[28:31], v[248:251], v[108:111]
  s_waitcnt lgkmcnt(2)
  v_mfma_f32_16x16x32_bf16 v[80:83], v[16:19], v[184:187], v[80:83]
  ds_read_b64_tr_b16 v[28:29], v10 offset:58880
  ds_read_b64_tr_b16 v[30:31], v10 offset:62976
  v_mfma_f32_16x16x32_bf16 v[112:115], v[16:19], v[248:251], v[112:115]
  v_mfma_f32_16x16x32_bf16 v[84:87], v[20:23], v[184:187], v[84:87]
  ds_read_b64_tr_b16 v[16:17], v9 offset:0
  ds_read_b64_tr_b16 v[18:19], v9 offset:4096
  v_mfma_f32_16x16x32_bf16 v[116:119], v[20:23], v[248:251], v[116:119]
  s_waitcnt lgkmcnt(2)
  v_mfma_f32_16x16x32_bf16 v[88:91], v[24:27], v[184:187], v[88:91]
  ds_read_b64_tr_b16 v[20:21], v10 offset:0
  ds_read_b64_tr_b16 v[22:23], v10 offset:4096
  v_mfma_f32_16x16x32_bf16 v[120:123], v[24:27], v[248:251], v[120:123]
  v_mfma_f32_16x16x32_bf16 v[92:95], v[28:31], v[184:187], v[92:95]
  ds_read_b64_tr_b16 v[24:25], v9 offset:512
  ds_read_b64_tr_b16 v[26:27], v9 offset:4608
  v_mfma_f32_16x16x32_bf16 v[124:127], v[28:31], v[248:251], v[124:127]
  s_waitcnt lgkmcnt(2)
  v_mfma_f32_16x16x32_bf16 v[64:67], v[16:19], v[188:191], v[64:67]
  ds_read_b64_tr_b16 v[28:29], v10 offset:512
  ds_read_b64_tr_b16 v[30:31], v10 offset:4608
  v_mfma_f32_16x16x32_bf16 v[96:99], v[16:19], v[252:255], v[96:99]
  v_mfma_f32_16x16x32_bf16 v[68:71], v[20:23], v[188:191], v[68:71]
  ds_read_b64_tr_b16 v[16:17], v9 offset:1024
  ds_read_b64_tr_b16 v[18:19], v9 offset:5120
  v_mfma_f32_16x16x32_bf16 v[100:103], v[20:23], v[252:255], v[100:103]
  s_waitcnt lgkmcnt(2)
  v_mfma_f32_16x16x32_bf16 v[72:75], v[24:27], v[188:191], v[72:75]
  ds_read_b64_tr_b16 v[20:21], v10 offset:1024
  ds_read_b64_tr_b16 v[22:23], v10 offset:5120
  v_mfma_f32_16x16x32_bf16 v[104:107], v[24:27], v[252:255], v[104:107]
  v_mfma_f32_16x16x32_bf16 v[76:79], v[28:31], v[188:191], v[76:79]
  ds_read_b64_tr_b16 v[24:25], v9 offset:1536
  ds_read_b64_tr_b16 v[26:27], v9 offset:5632
  v_mfma_f32_16x16x32_bf16 v[108:111], v[28:31], v[252:255], v[108:111]
  s_waitcnt lgkmcnt(2)
  v_mfma_f32_16x16x32_bf16 v[80:83], v[16:19], v[188:191], v[80:83]
  ds_read_b64_tr_b16 v[28:29], v10 offset:1536
  ds_read_b64_tr_b16 v[30:31], v10 offset:5632
  v_mfma_f32_16x16x32_bf16 v[112:115], v[16:19], v[252:255], v[112:115]
  v_mfma_f32_16x16x32_bf16 v[84:87], v[20:23], v[188:191], v[84:87]
  ds_read_b64_tr_b16 v[16:17], v9 offset:8192
  ds_read_b64_tr_b16 v[18:19], v9 offset:12288
  v_mfma_f32_16x16x32_bf16 v[116:119], v[20:23], v[252:255], v[116:119]
  s_waitcnt lgkmcnt(2)
  v_mfma_f32_16x16x32_bf16 v[88:91], v[24:27], v[188:191], v[88:91]
  ds_read_b64_tr_b16 v[20:21], v10 offset:8192
  ds_read_b64_tr_b16 v[22:23], v10 offset:12288
  v_mfma_f32_16x16x32_bf16 v[120:123], v[24:27], v[252:255], v[120:123]
  v_mfma_f32_16x16x32_bf16 v[92:95], v[28:31], v[188:191], v[92:95]
  ds_read_b64_tr_b16 v[24:25], v9 offset:8704
  ds_read_b64_tr_b16 v[26:27], v9 offset:12800
  v_mfma_f32_16x16x32_bf16 v[124:127], v[28:31], v[252:255], v[124:127]
  v_mul_f32 v64, s50, v64
  v_mul_f32 v65, s50, v65
  v_mul_f32 v66, s50, v66
  v_mul_f32 v67, s50, v67
  v_cvt_pk_bf16_f32 v32, v64, v65
  v_cvt_pk_bf16_f32 v33, v66, v67
  v_mul_f32 v96, s50, v96
  v_mul_f32 v97, s50, v97
  v_mul_f32 v98, s50, v98
  v_mul_f32 v99, s50, v99
  v_cvt_pk_bf16_f32 v48, v96, v97
  v_cvt_pk_bf16_f32 v49, v98, v99
  s_waitcnt lgkmcnt(2)
  v_mfma_f32_16x16x32_bf16 v[64:67], v[16:19], v[128:131], 0
  ds_read_b64_tr_b16 v[28:29], v10 offset:8704
  ds_read_b64_tr_b16 v[30:31], v10 offset:12800
  v_mfma_f32_16x16x32_bf16 v[96:99], v[16:19], v[192:195], 0
  v_mul_f32 v68, s50, v68
  v_mul_f32 v69, s50, v69
  v_mul_f32 v70, s50, v70
  v_mul_f32 v71, s50, v71
  v_cvt_pk_bf16_f32 v34, v68, v69
  v_cvt_pk_bf16_f32 v35, v70, v71
  v_mul_f32 v100, s50, v100
  v_mul_f32 v101, s50, v101
  v_mul_f32 v102, s50, v102
  v_mul_f32 v103, s50, v103
  v_cvt_pk_bf16_f32 v50, v100, v101
  v_cvt_pk_bf16_f32 v51, v102, v103
  v_permlane16_swap_b32 v32, v34
  v_permlane16_swap_b32 v33, v35
  v_permlane16_swap_b32 v48, v50
  v_permlane16_swap_b32 v49, v51
  v_mfma_f32_16x16x32_bf16 v[68:71], v[20:23], v[128:131], 0
  ds_read_b64_tr_b16 v[16:17], v9 offset:9216
  ds_read_b64_tr_b16 v[18:19], v9 offset:13312
  v_mfma_f32_16x16x32_bf16 v[100:103], v[20:23], v[192:195], 0
  v_mul_f32 v72, s50, v72
  v_mul_f32 v73, s50, v73
  v_mul_f32 v74, s50, v74
  v_mul_f32 v75, s50, v75
  v_cvt_pk_bf16_f32 v36, v72, v73
  v_cvt_pk_bf16_f32 v37, v74, v75
  v_mul_f32 v104, s50, v104
  v_mul_f32 v105, s50, v105
  v_mul_f32 v106, s50, v106
  v_mul_f32 v107, s50, v107
  v_cvt_pk_bf16_f32 v52, v104, v105
  v_cvt_pk_bf16_f32 v53, v106, v107
  s_waitcnt lgkmcnt(2)
  v_mfma_f32_16x16x32_bf16 v[72:75], v[24:27], v[128:131], 0
  ds_read_b64_tr_b16 v[20:21], v10 offset:9216
  ds_read_b64_tr_b16 v[22:23], v10 offset:13312
  v_mfma_f32_16x16x32_bf16 v[104:107], v[24:27], v[192:195], 0
  v_mul_f32 v76, s50, v76
  v_mul_f32 v77, s50, v77
  v_mul_f32 v78, s50, v78
  v_mul_f32 v79, s50, v79
  v_cvt_pk_bf16_f32 v38, v76, v77
  v_cvt_pk_bf16_f32 v39, v78, v79
  v_mul_f32 v108, s50, v108
  v_mul_f32 v109, s50, v109
  v_mul_f32 v110, s50, v110
  v_mul_f32 v111, s50, v111
  v_cvt_pk_bf16_f32 v54, v108, v109
  v_cvt_pk_bf16_f32 v55, v110, v111
  v_permlane16_swap_b32 v36, v38
  v_permlane16_swap_b32 v37, v39
  v_permlane16_swap_b32 v52, v54
  v_permlane16_swap_b32 v53, v55
  v_mfma_f32_16x16x32_bf16 v[76:79], v[28:31], v[128:131], 0
  ds_read_b64_tr_b16 v[24:25], v9 offset:9728
  ds_read_b64_tr_b16 v[26:27], v9 offset:13824
  v_mfma_f32_16x16x32_bf16 v[108:111], v[28:31], v[192:195], 0
  v_mul_f32 v80, s50, v80
  v_mul_f32 v81, s50, v81
  v_mul_f32 v82, s50, v82
  v_mul_f32 v83, s50, v83
  v_cvt_pk_bf16_f32 v40, v80, v81
  v_cvt_pk_bf16_f32 v41, v82, v83
  v_mul_f32 v112, s50, v112
  v_mul_f32 v113, s50, v113
  v_mul_f32 v114, s50, v114
  v_mul_f32 v115, s50, v115
  v_cvt_pk_bf16_f32 v56, v112, v113
  v_cvt_pk_bf16_f32 v57, v114, v115
  s_waitcnt lgkmcnt(2)
  v_mfma_f32_16x16x32_bf16 v[80:83], v[16:19], v[128:131], 0
  ds_read_b64_tr_b16 v[28:29], v10 offset:9728
  ds_read_b64_tr_b16 v[30:31], v10 offset:13824
  v_mfma_f32_16x16x32_bf16 v[112:115], v[16:19], v[192:195], 0
  v_mul_f32 v84, s50, v84
  v_mul_f32 v85, s50, v85
  v_mul_f32 v86, s50, v86
  v_mul_f32 v87, s50, v87
  v_cvt_pk_bf16_f32 v42, v84, v85
  v_cvt_pk_bf16_f32 v43, v86, v87
  v_mul_f32 v116, s50, v116
  v_mul_f32 v117, s50, v117
  v_mul_f32 v118, s50, v118
  v_mul_f32 v119, s50, v119
  v_cvt_pk_bf16_f32 v58, v116, v117
  v_cvt_pk_bf16_f32 v59, v118, v119
  v_permlane16_swap_b32 v40, v42
  v_permlane16_swap_b32 v41, v43
  v_permlane16_swap_b32 v56, v58
  v_permlane16_swap_b32 v57, v59
  v_mfma_f32_16x16x32_bf16 v[84:87], v[20:23], v[128:131], 0
  v_mfma_f32_16x16x32_bf16 v[116:119], v[20:23], v[192:195], 0
  v_mul_f32 v88, s50, v88
  v_mul_f32 v89, s50, v89
  v_mul_f32 v90, s50, v90
  v_mul_f32 v91, s50, v91
  v_cvt_pk_bf16_f32 v44, v88, v89
  v_cvt_pk_bf16_f32 v45, v90, v91
  v_mul_f32 v120, s50, v120
  v_mul_f32 v121, s50, v121
  v_mul_f32 v122, s50, v122
  v_mul_f32 v123, s50, v123
  v_cvt_pk_bf16_f32 v60, v120, v121
  v_cvt_pk_bf16_f32 v61, v122, v123
  s_waitcnt lgkmcnt(0)
  v_mfma_f32_16x16x32_bf16 v[88:91], v[24:27], v[128:131], 0
  v_mfma_f32_16x16x32_bf16 v[120:123], v[24:27], v[192:195], 0
  v_mul_f32 v92, s50, v92
  v_mul_f32 v93, s50, v93
  v_mul_f32 v94, s50, v94
  v_mul_f32 v95, s50, v95
  v_cvt_pk_bf16_f32 v46, v92, v93
  v_cvt_pk_bf16_f32 v47, v94, v95
  v_mul_f32 v124, s50, v124
  v_mul_f32 v125, s50, v125
  v_mul_f32 v126, s50, v126
  v_mul_f32 v127, s50, v127
  v_cvt_pk_bf16_f32 v62, v124, v125
  v_cvt_pk_bf16_f32 v63, v126, v127
  v_permlane16_swap_b32 v44, v46
  v_permlane16_swap_b32 v45, v47
  v_permlane16_swap_b32 v60, v62
  v_permlane16_swap_b32 v61, v63
  v_mfma_f32_16x16x32_bf16 v[92:95], v[28:31], v[128:131], 0
  v_mfma_f32_16x16x32_bf16 v[124:127], v[28:31], v[192:195], 0
  s_waitcnt vmcnt(0)
  s_waitcnt lgkmcnt(0)
  s_barrier
  ds_read_b64_tr_b16 v[16:17], v9 offset:32768
  ds_read_b64_tr_b16 v[18:19], v9 offset:36864
  ds_read_b64_tr_b16 v[20:21], v10 offset:32768
  ds_read_b64_tr_b16 v[22:23], v10 offset:36864
  ds_read_b64_tr_b16 v[24:25], v9 offset:33280
  ds_read_b64_tr_b16 v[26:27], v9 offset:37376
  s_add_u32 s59, s45, 2
  s_and_b32 s59, s59, 7
  s_lshl_b32 s59, s59, 19
  s_add_u32 s59, s59, s54
  s_add_u32 s59, s59, 768
  s_add_u32 m0, s55, 155648
  s_nop 0
  buffer_load_dwordx4 v8, s[16:19], s59 offen lds
  s_add_u32 m0, s55, 156544
  s_nop 0
  buffer_load_dwordx4 v8, s[16:19], s59 offen offset:128 lds
  s_add_u32 s59, s45, 2
  s_and_b32 s59, s59, 7
  s_lshl_b32 s59, s59, 19
  s_add_u32 s59, s59, s54
  s_add_u32 s59, s59, 262912
  s_add_u32 m0, s55, 98304
  s_nop 0
  buffer_load_dwordx4 v8, s[16:19], s59 offen lds
  s_add_u32 m0, s55, 99200
  s_nop 0
  buffer_load_dwordx4 v8, s[16:19], s59 offen offset:128 lds
  s_add_u32 s59, s45, 3
  s_and_b32 s59, s59, 7
  s_lshl_b32 s59, s59, 19
  s_add_u32 s59, s59, s54
  s_add_u32 s59, s59, 768
  s_add_u32 m0, s55, 106496
  s_nop 0
  buffer_load_dwordx4 v8, s[16:19], s59 offen lds
  s_add_u32 m0, s55, 107392
  s_nop 0
  buffer_load_dwordx4 v8, s[16:19], s59 offen offset:128 lds
  s_waitcnt lgkmcnt(2)
  v_mfma_f32_16x16x32_bf16 v[64:67], v[16:19], v[132:135], v[64:67]
  ds_read_b64_tr_b16 v[28:29], v10 offset:33280
  ds_read_b64_tr_b16 v[30:31], v10 offset:37376
  v_mfma_f32_16x16x32_bf16 v[96:99], v[16:19], v[196:199], v[96:99]
  v_mfma_f32_16x16x32_bf16 v[68:71], v[20:23], v[132:135], v[68:71]
  ds_read_b64_tr_b16 v[16:17], v9 offset:33792
  ds_read_b64_tr_b16 v[18:19], v9 offset:37888
  v_mfma_f32_16x16x32_bf16 v[100:103], v[20:23], v[196:199], v[100:103]
  s_waitcnt lgkmcnt(2)
  v_mfma_f32_16x16x32_bf16 v[72:75], v[24:27], v[132:135], v[72:75]
  ds_read_b64_tr_b16 v[20:21], v10 offset:33792
  ds_read_b64_tr_b16 v[22:23], v10 offset:37888
  v_mfma_f32_16x16x32_bf16 v[104:107], v[24:27], v[196:199], v[104:107]
  v_mfma_f32_16x16x32_bf16 v[76:79], v[28:31], v[132:135], v[76:79]
  ds_read_b64_tr_b16 v[24:25], v9 offset:34304
  ds_read_b64_tr_b16 v[26:27], v9 offset:38400
  v_mfma_f32_16x16x32_bf16 v[108:111], v[28:31], v[196:199], v[108:111]
  s_waitcnt lgkmcnt(2)
  v_mfma_f32_16x16x32_bf16 v[80:83], v[16:19], v[132:135], v[80:83]
  ds_read_b64_tr_b16 v[28:29], v10 offset:34304
  ds_read_b64_tr_b16 v[30:31], v10 offset:38400
  v_mfma_f32_16x16x32_bf16 v[112:115], v[16:19], v[196:199], v[112:115]
  v_mfma_f32_16x16x32_bf16 v[84:87], v[20:23], v[132:135], v[84:87]
  ds_read_b64_tr_b16 v[16:17], v9 offset:40960
  ds_read_b64_tr_b16 v[18:19], v9 offset:45056
  v_mfma_f32_16x16x32_bf16 v[116:119], v[20:23], v[196:199], v[116:119]
  s_waitcnt lgkmcnt(2)
  v_mfma_f32_16x16x32_bf16 v[88:91], v[24:27], v[132:135], v[88:91]
  ds_read_b64_tr_b16 v[20:21], v10 offset:40960
  ds_read_b64_tr_b16 v[22:23], v10 offset:45056
  v_mfma_f32_16x16x32_bf16 v[120:123], v[24:27], v[196:199], v[120:123]
  v_mfma_f32_16x16x32_bf16 v[92:95], v[28:31], v[132:135], v[92:95]
  ds_read_b64_tr_b16 v[24:25], v9 offset:41472
  ds_read_b64_tr_b16 v[26:27], v9 offset:45568
  v_mfma_f32_16x16x32_bf16 v[124:127], v[28:31], v[196:199], v[124:127]
  s_waitcnt lgkmcnt(2)
  v_mfma_f32_16x16x32_bf16 v[64:67], v[16:19], v[136:139], v[64:67]
  ds_read_b64_tr_b16 v[28:29], v10 offset:41472
  ds_read_b64_tr_b16 v[30:31], v10 offset:45568
  v_mfma_f32_16x16x32_bf16 v[96:99], v[16:19], v[200:203], v[96:99]
  v_mfma_f32_16x16x32_bf16 v[68:71], v[20:23], v[136:139], v[68:71]
  ds_read_b64_tr_b16 v[16:17], v9 offset:41984
  ds_read_b64_tr_b16 v[18:19], v9 offset:46080
  v_mfma_f32_16x16x32_bf16 v[100:103], v[20:23], v[200:203], v[100:103]
  s_waitcnt lgkmcnt(2)
  v_mfma_f32_16x16x32_bf16 v[72:75], v[24:27], v[136:139], v[72:75]
  ds_read_b64_tr_b16 v[20:21], v10 offset:41984
  ds_read_b64_tr_b16 v[22:23], v10 offset:46080
  v_mfma_f32_16x16x32_bf16 v[104:107], v[24:27], v[200:203], v[104:107]
  v_mfma_f32_16x16x32_bf16 v[76:79], v[28:31], v[136:139], v[76:79]
  ds_read_b64_tr_b16 v[24:25], v9 offset:42496
  ds_read_b64_tr_b16 v[26:27], v9 offset:46592
  v_mfma_f32_16x16x32_bf16 v[108:111], v[28:31], v[200:203], v[108:111]
  s_waitcnt lgkmcnt(2)
  v_mfma_f32_16x16x32_bf16 v[80:83], v[16:19], v[136:139], v[80:83]
  ds_read_b64_tr_b16 v[28:29], v10 offset:42496
  ds_read_b64_tr_b16 v[30:31], v10 offset:46592
  v_mfma_f32_16x16x32_bf16 v[112:115], v[16:19], v[200:203], v[112:115]
  v_mfma_f32_16x16x32_bf16 v[84:87], v[20:23], v[136:139], v[84:87]
  ds_read_b64_tr_b16 v[16:17], v9 offset:49152
  ds_read_b64_tr_b16 v[18:19], v9 offset:53248
  v_mfma_f32_16x16x32_bf16 v[116:119], v[20:23], v[200:203], v[116:119]
  s_waitcnt lgkmcnt(2)
  v_mfma_f32_16x16x32_bf16 v[88:91], v[24:27], v[136:139], v[88:91]
  ds_read_b64_tr_b16 v[20:21], v10 offset:49152
  ds_read_b64_tr_b16 v[22:23], v10 offset:53248
  v_mfma_f32_16x16x32_bf16 v[120:123], v[24:27], v[200:203], v[120:123]
  v_mfma_f32_16x16x32_bf16 v[92:95], v[28:31], v[136:139], v[92:95]
  ds_read_b64_tr_b16 v[24:25], v9 offset:49664
  ds_read_b64_tr_b16 v[26:27], v9 offset:53760
  v_mfma_f32_16x16x32_bf16 v[124:127], v[28:31], v[200:203], v[124:127]
  s_waitcnt lgkmcnt(2)
  v_mfma_f32_16x16x32_bf16 v[64:67], v[16:19], v[140:143], v[64:67]
  ds_read_b64_tr_b16 v[28:29], v10 offset:49664
  ds_read_b64_tr_b16 v[30:31], v10 offset:53760
  v_mfma_f32_16x16x32_bf16 v[96:99], v[16:19], v[204:207], v[96:99]
  v_mfma_f32_16x16x32_bf16 v[68:71], v[20:23], v[140:143], v[68:71]
  ds_read_b64_tr_b16 v[16:17], v9 offset:50176
  ds_read_b64_tr_b16 v[18:19], v9 offset:54272
  v_mfma_f32_16x16x32_bf16 v[100:103], v[20:23], v[204:207], v[100:103]
  s_waitcnt lgkmcnt(2)
  v_mfma_f32_16x16x32_bf16 v[72:75], v[24:27], v[140:143], v[72:75]
  ds_read_b64_tr_b16 v[20:21], v10 offset:50176
  ds_read_b64_tr_b16 v[22:23], v10 offset:54272
  v_mfma_f32_16x16x32_bf16 v[104:107], v[24:27], v[204:207], v[104:107]
  v_mfma_f32_16x16x32_bf16 v[76:79], v[28:31], v[140:143], v[76:79]
  ds_read_b64_tr_b16 v[24:25], v9 offset:50688
  ds_read_b64_tr_b16 v[26:27], v9 offset:54784
  v_mfma_f32_16x16x32_bf16 v[108:111], v[28:31], v[204:207], v[108:111]
  s_waitcnt lgkmcnt(2)
  v_mfma_f32_16x16x32_bf16 v[80:83], v[16:19], v[140:143], v[80:83]
  ds_read_b64_tr_b16 v[28:29], v10 offset:50688
  ds_read_b64_tr_b16 v[30:31], v10 offset:54784
  v_mfma_f32_16x16x32_bf16 v[112:115], v[16:19], v[204:207], v[112:115]
  v_mfma_f32_16x16x32_bf16 v[84:87], v[20:23], v[140:143], v[84:87]
  v_mfma_f32_16x16x32_bf16 v[116:119], v[20:23], v[204:207], v[116:119]
  s_waitcnt lgkmcnt(0)
  v_mfma_f32_16x16x32_bf16 v[88:91], v[24:27], v[140:143], v[88:91]
  v_mfma_f32_16x16x32_bf16 v[120:123], v[24:27], v[204:207], v[120:123]
  v_mfma_f32_16x16x32_bf16 v[92:95], v[28:31], v[140:143], v[92:95]
  v_mfma_f32_16x16x32_bf16 v[124:127], v[28:31], v[204:207], v[124:127]
  s_waitcnt vmcnt(0)
  s_waitcnt lgkmcnt(0)
  s_barrier
  ds_read_b64_tr_b16 v[16:17], v9 offset:57344
  ds_read_b64_tr_b16 v[18:19], v9 offset:61440
  ds_read_b64_tr_b16 v[20:21], v10 offset:57344
  ds_read_b64_tr_b16 v[22:23], v10 offset:61440
  ds_read_b64_tr_b16 v[24:25], v9 offset:57856
  ds_read_b64_tr_b16 v[26:27], v9 offset:61952
  s_add_u32 s59, s45, 3
  s_and_b32 s59, s59, 7
  s_lshl_b32 s59, s59, 19
  s_add_u32 s59, s59, s54
  s_add_u32 s59, s59, 262912
  s_add_u32 m0, s55, 131072
  s_nop 0
  buffer_load_dwordx4 v8, s[16:19], s59 offen lds
  s_add_u32 m0, s55, 131968
  s_nop 0
  buffer_load_dwordx4 v8, s[16:19], s59 offen offset:128 lds
  s_add_u32 s59, s45, 4
  s_and_b32 s59, s59, 7
  s_lshl_b32 s59, s59, 19
  s_add_u32 s59, s59, s54
  s_add_u32 s59, s59, 768
  s_add_u32 m0, s55, 139264
  s_nop 0
  buffer_load_dwordx4 v8, s[16:19], s59 offen lds
  s_add_u32 m0, s55, 140160
  s_nop 0
  buffer_load_dwordx4 v8, s[16:19], s59 offen offset:128 lds
  s_add_u32 s59, s45, 4
  s_and_b32 s59, s59, 7
  s_lshl_b32 s59, s59, 19
  s_add_u32 s59, s59, s54
  s_add_u32 s59, s59, 262912
  s_add_u32 m0, s55, 147456
  s_nop 0
  buffer_load_dwordx4 v8, s[16:19], s59 offen lds
  s_add_u32 m0, s55, 148352
  s_nop 0
  buffer_load_dwordx4 v8, s[16:19], s59 offen offset:128 lds
  s_waitcnt lgkmcnt(2)
  v_mfma_f32_16x16x32_bf16 v[64:67], v[16:19], v[144:147], v[64:67]
  ds_read_b64_tr_b16 v[28:29], v10 offset:57856
  ds_read_b64_tr_b16 v[30:31], v10 offset:61952
  v_mfma_f32_16x16x32_bf16 v[96:99], v[16:19], v[208:211], v[96:99]
  v_mfma_f32_16x16x32_bf16 v[68:71], v[20:23], v[144:147], v[68:71]
  ds_read_b64_tr_b16 v[16:17], v9 offset:58368
  ds_read_b64_tr_b16 v[18:19], v9 offset:62464
  v_mfma_f32_16x16x32_bf16 v[100:103], v[20:23], v[208:211], v[100:103]
  s_waitcnt lgkmcnt(2)
  v_mfma_f32_16x16x32_bf16 v[72:75], v[24:27], v[144:147], v[72:75]
  ds_read_b64_tr_b16 v[20:21], v10 offset:58368
  ds_read_b64_tr_b16 v[22:23], v10 offset:62464
  v_mfma_f32_16x16x32_bf16 v[104:107], v[24:27], v[208:211], v[104:107]
  v_mfma_f32_16x16x32_bf16 v[76:79], v[28:31], v[144:147], v[76:79]
  ds_read_b64_tr_b16 v[24:25], v9 offset:58880
  ds_read_b64_tr_b16 v[26:27], v9 offset:62976
  v_mfma_f32_16x16x32_bf16 v[108:111], v[28:31], v[208:211], v[108:111]
  s_waitcnt lgkmcnt(2)
  v_mfma_f32_16x16x32_bf16 v[80:83], v[16:19], v[144:147], v[80:83]
  ds_read_b64_tr_b16 v[28:29], v10 offset:58880
  ds_read_b64_tr_b16 v[30:31], v10 offset:62976
  v_mfma_f32_16x16x32_bf16 v[112:115], v[16:19], v[208:211], v[112:115]
  v_mfma_f32_16x16x32_bf16 v[84:87], v[20:23], v[144:147], v[84:87]
  ds_read_b64_tr_b16 v[16:17], v9 offset:0
  ds_read_b64_tr_b16 v[18:19], v9 offset:4096
  v_mfma_f32_16x16x32_bf16 v[116:119], v[20:23], v[208:211], v[116:119]
  s_waitcnt lgkmcnt(2)
  v_mfma_f32_16x16x32_bf16 v[88:91], v[24:27], v[144:147], v[88:91]
  ds_read_b64_tr_b16 v[20:21], v10 offset:0
  ds_read_b64_tr_b16 v[22:23], v10 offset:4096
  v_mfma_f32_16x16x32_bf16 v[120:123], v[24:27], v[208:211], v[120:123]
  v_mfma_f32_16x16x32_bf16 v[92:95], v[28:31], v[144:147], v[92:95]
  ds_read_b64_tr_b16 v[24:25], v9 offset:512
  ds_read_b64_tr_b16 v[26:27], v9 offset:4608
  v_mfma_f32_16x16x32_bf16 v[124:127], v[28:31], v[208:211], v[124:127]
  s_waitcnt lgkmcnt(2)
  v_mfma_f32_16x16x32_bf16 v[64:67], v[16:19], v[148:151], v[64:67]
  ds_read_b64_tr_b16 v[28:29], v10 offset:512
  ds_read_b64_tr_b16 v[30:31], v10 offset:4608
  v_mfma_f32_16x16x32_bf16 v[96:99], v[16:19], v[212:215], v[96:99]
  v_mfma_f32_16x16x32_bf16 v[68:71], v[20:23], v[148:151], v[68:71]
  ds_read_b64_tr_b16 v[16:17], v9 offset:1024
  ds_read_b64_tr_b16 v[18:19], v9 offset:5120
  v_mfma_f32_16x16x32_bf16 v[100:103], v[20:23], v[212:215], v[100:103]
  s_waitcnt lgkmcnt(2)
  v_mfma_f32_16x16x32_bf16 v[72:75], v[24:27], v[148:151], v[72:75]
  ds_read_b64_tr_b16 v[20:21], v10 offset:1024
  ds_read_b64_tr_b16 v[22:23], v10 offset:5120
  v_mfma_f32_16x16x32_bf16 v[104:107], v[24:27], v[212:215], v[104:107]
  v_mfma_f32_16x16x32_bf16 v[76:79], v[28:31], v[148:151], v[76:79]
  ds_read_b64_tr_b16 v[24:25], v9 offset:1536
  ds_read_b64_tr_b16 v[26:27], v9 offset:5632
  v_mfma_f32_16x16x32_bf16 v[108:111], v[28:31], v[212:215], v[108:111]
  s_waitcnt lgkmcnt(2)
  v_mfma_f32_16x16x32_bf16 v[80:83], v[16:19], v[148:151], v[80:83]
  ds_read_b64_tr_b16 v[28:29], v10 offset:1536
  ds_read_b64_tr_b16 v[30:31], v10 offset:5632
  v_mfma_f32_16x16x32_bf16 v[112:115], v[16:19], v[212:215], v[112:115]
  v_mfma_f32_16x16x32_bf16 v[84:87], v[20:23], v[148:151], v[84:87]
  ds_read_b64_tr_b16 v[16:17], v9 offset:8192
  ds_read_b64_tr_b16 v[18:19], v9 offset:12288
  v_mfma_f32_16x16x32_bf16 v[116:119], v[20:23], v[212:215], v[116:119]
  s_waitcnt lgkmcnt(2)
  v_mfma_f32_16x16x32_bf16 v[88:91], v[24:27], v[148:151], v[88:91]
  ds_read_b64_tr_b16 v[20:21], v10 offset:8192
  ds_read_b64_tr_b16 v[22:23], v10 offset:12288
  v_mfma_f32_16x16x32_bf16 v[120:123], v[24:27], v[212:215], v[120:123]
  v_mfma_f32_16x16x32_bf16 v[92:95], v[28:31], v[148:151], v[92:95]
  ds_read_b64_tr_b16 v[24:25], v9 offset:8704
  ds_read_b64_tr_b16 v[26:27], v9 offset:12800
  v_mfma_f32_16x16x32_bf16 v[124:127], v[28:31], v[212:215], v[124:127]
  s_waitcnt lgkmcnt(2)
  v_mfma_f32_16x16x32_bf16 v[64:67], v[16:19], v[152:155], v[64:67]
  ds_read_b64_tr_b16 v[28:29], v10 offset:8704
  ds_read_b64_tr_b16 v[30:31], v10 offset:12800
  v_mfma_f32_16x16x32_bf16 v[96:99], v[16:19], v[216:219], v[96:99]
  v_mfma_f32_16x16x32_bf16 v[68:71], v[20:23], v[152:155], v[68:71]
  ds_read_b64_tr_b16 v[16:17], v9 offset:9216
  ds_read_b64_tr_b16 v[18:19], v9 offset:13312
  v_mfma_f32_16x16x32_bf16 v[100:103], v[20:23], v[216:219], v[100:103]
  s_waitcnt lgkmcnt(2)
  v_mfma_f32_16x16x32_bf16 v[72:75], v[24:27], v[152:155], v[72:75]
  ds_read_b64_tr_b16 v[20:21], v10 offset:9216
  ds_read_b64_tr_b16 v[22:23], v10 offset:13312
  v_mfma_f32_16x16x32_bf16 v[104:107], v[24:27], v[216:219], v[104:107]
  v_mfma_f32_16x16x32_bf16 v[76:79], v[28:31], v[152:155], v[76:79]
  ds_read_b64_tr_b16 v[24:25], v9 offset:9728
  ds_read_b64_tr_b16 v[26:27], v9 offset:13824
  v_mfma_f32_16x16x32_bf16 v[108:111], v[28:31], v[216:219], v[108:111]
  s_waitcnt lgkmcnt(2)
  v_mfma_f32_16x16x32_bf16 v[80:83], v[16:19], v[152:155], v[80:83]
  ds_read_b64_tr_b16 v[28:29], v10 offset:9728
  ds_read_b64_tr_b16 v[30:31], v10 offset:13824
  v_mfma_f32_16x16x32_bf16 v[112:115], v[16:19], v[216:219], v[112:115]
  v_mfma_f32_16x16x32_bf16 v[84:87], v[20:23], v[152:155], v[84:87]
  v_mfma_f32_16x16x32_bf16 v[116:119], v[20:23], v[216:219], v[116:119]
  s_waitcnt lgkmcnt(0)
  v_mfma_f32_16x16x32_bf16 v[88:91], v[24:27], v[152:155], v[88:91]
  v_mfma_f32_16x16x32_bf16 v[120:123], v[24:27], v[216:219], v[120:123]
  v_mfma_f32_16x16x32_bf16 v[92:95], v[28:31], v[152:155], v[92:95]
  v_mfma_f32_16x16x32_bf16 v[124:127], v[28:31], v[216:219], v[124:127]
  s_waitcnt vmcnt(0)
  s_waitcnt lgkmcnt(0)
  s_barrier
  ds_read_b64_tr_b16 v[16:17], v9 offset:32768
  ds_read_b64_tr_b16 v[18:19], v9 offset:36864
  ds_read_b64_tr_b16 v[20:21], v10 offset:32768
  ds_read_b64_tr_b16 v[22:23], v10 offset:36864
  ds_read_b64_tr_b16 v[24:25], v9 offset:33280
  ds_read_b64_tr_b16 v[26:27], v9 offset:37376
  s_add_u32 s59, s45, 5
  s_and_b32 s59, s59, 7
  s_lshl_b32 s59, s59, 19
  s_add_u32 s59, s59, s54
  s_add_u32 s59, s59, 768
  s_add_u32 m0, s55, 98304
  s_nop 0
  buffer_load_dwordx4 v8, s[16:19], s59 offen lds
  s_add_u32 m0, s55, 99200
  s_nop 0
  buffer_load_dwordx4 v8, s[16:19], s59 offen offset:128 lds
  s_add_u32 s59, s45, 5
  s_and_b32 s59, s59, 7
  s_lshl_b32 s59, s59, 19
  s_add_u32 s59, s59, s54
  s_add_u32 s59, s59, 262912
  s_add_u32 m0, s55, 106496
  s_nop 0
  buffer_load_dwordx4 v8, s[16:19], s59 offen lds
  s_add_u32 m0, s55, 107392
  s_nop 0
  buffer_load_dwordx4 v8, s[16:19], s59 offen offset:128 lds
  s_waitcnt lgkmcnt(2)
  v_mfma_f32_16x16x32_bf16 v[64:67], v[16:19], v[156:159], v[64:67]
  ds_read_b64_tr_b16 v[28:29], v10 offset:33280
  ds_read_b64_tr_b16 v[30:31], v10 offset:37376
  v_mfma_f32_16x16x32_bf16 v[96:99], v[16:19], v[220:223], v[96:99]
  v_mfma_f32_16x16x32_bf16 v[68:71], v[20:23], v[156:159], v[68:71]
  ds_read_b64_tr_b16 v[16:17], v9 offset:33792
  ds_read_b64_tr_b16 v[18:19], v9 offset:37888
  v_mfma_f32_16x16x32_bf16 v[100:103], v[20:23], v[220:223], v[100:103]
  s_waitcnt lgkmcnt(2)
  v_mfma_f32_16x16x32_bf16 v[72:75], v[24:27], v[156:159], v[72:75]
  ds_read_b64_tr_b16 v[20:21], v10 offset:33792
  ds_read_b64_tr_b16 v[22:23], v10 offset:37888
  v_mfma_f32_16x16x32_bf16 v[104:107], v[24:27], v[220:223], v[104:107]
  v_mfma_f32_16x16x32_bf16 v[76:79], v[28:31], v[156:159], v[76:79]
  ds_read_b64_tr_b16 v[24:25], v9 offset:34304
  ds_read_b64_tr_b16 v[26:27], v9 offset:38400
  v_mfma_f32_16x16x32_bf16 v[108:111], v[28:31], v[220:223], v[108:111]
  s_waitcnt lgkmcnt(2)
  v_mfma_f32_16x16x32_bf16 v[80:83], v[16:19], v[156:159], v[80:83]
  ds_read_b64_tr_b16 v[28:29], v10 offset:34304
  ds_read_b64_tr_b16 v[30:31], v10 offset:38400
  v_mfma_f32_16x16x32_bf16 v[112:115], v[16:19], v[220:223], v[112:115]
  v_mfma_f32_16x16x32_bf16 v[84:87], v[20:23], v[156:159], v[84:87]
  ds_read_b64_tr_b16 v[16:17], v9 offset:40960
  ds_read_b64_tr_b16 v[18:19], v9 offset:45056
  v_mfma_f32_16x16x32_bf16 v[116:119], v[20:23], v[220:223], v[116:119]
  s_waitcnt lgkmcnt(2)
  v_mfma_f32_16x16x32_bf16 v[88:91], v[24:27], v[156:159], v[88:91]
  ds_read_b64_tr_b16 v[20:21], v10 offset:40960
  ds_read_b64_tr_b16 v[22:23], v10 offset:45056
  v_mfma_f32_16x16x32_bf16 v[120:123], v[24:27], v[220:223], v[120:123]
  s_lshr_b32 s59, s2, 3
  s_lshl2_add_u32 s59, s59, s40
  s_lshl_b32 s59, s59, 8
  s_add_u32 s59, s59, L_h16-concat_heads__mha_block_cached__gqa_block_cached__near_ridge_kernel
  v_and_b32 v1, 0xf0, v7
  buffer_load_dword v1, v1, s[92:95], s59 offen
  v_mfma_f32_16x16x32_bf16 v[92:95], v[28:31], v[156:159], v[92:95]
  ds_read_b64_tr_b16 v[24:25], v9 offset:41472
  ds_read_b64_tr_b16 v[26:27], v9 offset:45568
  v_mfma_f32_16x16x32_bf16 v[124:127], v[28:31], v[220:223], v[124:127]
  s_waitcnt lgkmcnt(2)
  v_mfma_f32_16x16x32_bf16 v[64:67], v[16:19], v[160:163], v[64:67]
  ds_read_b64_tr_b16 v[28:29], v10 offset:41472
  ds_read_b64_tr_b16 v[30:31], v10 offset:45568
  v_mfma_f32_16x16x32_bf16 v[96:99], v[16:19], v[224:227], v[96:99]
  v_mfma_f32_16x16x32_bf16 v[68:71], v[20:23], v[160:163], v[68:71]
  ds_read_b64_tr_b16 v[16:17], v9 offset:41984
  ds_read_b64_tr_b16 v[18:19], v9 offset:46080
  v_mfma_f32_16x16x32_bf16 v[100:103], v[20:23], v[224:227], v[100:103]
  s_waitcnt lgkmcnt(2)
  v_mfma_f32_16x16x32_bf16 v[72:75], v[24:27], v[160:163], v[72:75]
  ds_read_b64_tr_b16 v[20:21], v10 offset:41984
  ds_read_b64_tr_b16 v[22:23], v10 offset:46080
  v_mfma_f32_16x16x32_bf16 v[104:107], v[24:27], v[224:227], v[104:107]
  v_mfma_f32_16x16x32_bf16 v[76:79], v[28:31], v[160:163], v[76:79]
  ds_read_b64_tr_b16 v[24:25], v9 offset:42496
  ds_read_b64_tr_b16 v[26:27], v9 offset:46592
  v_mfma_f32_16x16x32_bf16 v[108:111], v[28:31], v[224:227], v[108:111]
  s_waitcnt lgkmcnt(2)
  v_mfma_f32_16x16x32_bf16 v[80:83], v[16:19], v[160:163], v[80:83]
  ds_read_b64_tr_b16 v[28:29], v10 offset:42496
  ds_read_b64_tr_b16 v[30:31], v10 offset:46592
  v_mfma_f32_16x16x32_bf16 v[112:115], v[16:19], v[224:227], v[112:115]
  v_mfma_f32_16x16x32_bf16 v[84:87], v[20:23], v[160:163], v[84:87]
  ds_read_b64_tr_b16 v[16:17], v9 offset:49152
  ds_read_b64_tr_b16 v[18:19], v9 offset:53248
  v_mfma_f32_16x16x32_bf16 v[116:119], v[20:23], v[224:227], v[116:119]
  s_waitcnt lgkmcnt(2)
  v_mfma_f32_16x16x32_bf16 v[88:91], v[24:27], v[160:163], v[88:91]
  ds_read_b64_tr_b16 v[20:21], v10 offset:49152
  ds_read_b64_tr_b16 v[22:23], v10 offset:53248
  v_mfma_f32_16x16x32_bf16 v[120:123], v[24:27], v[224:227], v[120:123]
  v_mfma_f32_16x16x32_bf16 v[92:95], v[28:31], v[160:163], v[92:95]
  ds_read_b64_tr_b16 v[24:25], v9 offset:49664
  ds_read_b64_tr_b16 v[26:27], v9 offset:53760
  v_mfma_f32_16x16x32_bf16 v[124:127], v[28:31], v[224:227], v[124:127]
  s_waitcnt lgkmcnt(2)
  v_mfma_f32_16x16x32_bf16 v[64:67], v[16:19], v[164:167], v[64:67]
  ds_read_b64_tr_b16 v[28:29], v10 offset:49664
  ds_read_b64_tr_b16 v[30:31], v10 offset:53760
  v_mfma_f32_16x16x32_bf16 v[96:99], v[16:19], v[228:231], v[96:99]
  v_mfma_f32_16x16x32_bf16 v[68:71], v[20:23], v[164:167], v[68:71]
  ds_read_b64_tr_b16 v[16:17], v9 offset:50176
  ds_read_b64_tr_b16 v[18:19], v9 offset:54272
  v_mfma_f32_16x16x32_bf16 v[100:103], v[20:23], v[228:231], v[100:103]
  s_waitcnt lgkmcnt(2)
  v_mfma_f32_16x16x32_bf16 v[72:75], v[24:27], v[164:167], v[72:75]
  ds_read_b64_tr_b16 v[20:21], v10 offset:50176
  ds_read_b64_tr_b16 v[22:23], v10 offset:54272
  v_mfma_f32_16x16x32_bf16 v[104:107], v[24:27], v[228:231], v[104:107]
  v_mfma_f32_16x16x32_bf16 v[76:79], v[28:31], v[164:167], v[76:79]
  ds_read_b64_tr_b16 v[24:25], v9 offset:50688
  ds_read_b64_tr_b16 v[26:27], v9 offset:54784
  v_mfma_f32_16x16x32_bf16 v[108:111], v[28:31], v[228:231], v[108:111]
  s_waitcnt lgkmcnt(2)
  v_mfma_f32_16x16x32_bf16 v[80:83], v[16:19], v[164:167], v[80:83]
  ds_read_b64_tr_b16 v[28:29], v10 offset:50688
  ds_read_b64_tr_b16 v[30:31], v10 offset:54784
  v_mfma_f32_16x16x32_bf16 v[112:115], v[16:19], v[228:231], v[112:115]
  v_mfma_f32_16x16x32_bf16 v[84:87], v[20:23], v[164:167], v[84:87]
  v_mfma_f32_16x16x32_bf16 v[116:119], v[20:23], v[228:231], v[116:119]
  s_waitcnt lgkmcnt(0)
  v_mfma_f32_16x16x32_bf16 v[88:91], v[24:27], v[164:167], v[88:91]
  v_mfma_f32_16x16x32_bf16 v[120:123], v[24:27], v[228:231], v[120:123]
  v_mfma_f32_16x16x32_bf16 v[92:95], v[28:31], v[164:167], v[92:95]
  v_mfma_f32_16x16x32_bf16 v[124:127], v[28:31], v[228:231], v[124:127]
  s_waitcnt vmcnt(1)
  s_waitcnt lgkmcnt(0)
  s_barrier
  ds_read_b64_tr_b16 v[16:17], v9 offset:0
  ds_read_b64_tr_b16 v[18:19], v9 offset:4096
  ds_read_b64_tr_b16 v[20:21], v10 offset:0
  ds_read_b64_tr_b16 v[22:23], v10 offset:4096
  ds_read_b64_tr_b16 v[24:25], v9 offset:512
  ds_read_b64_tr_b16 v[26:27], v9 offset:4608
  s_add_u32 s59, s45, 6
  s_and_b32 s59, s59, 7
  s_lshl_b32 s59, s59, 19
  s_add_u32 s59, s59, s54
  s_add_u32 s59, s59, 768
  s_add_u32 m0, s55, 114688
  s_nop 0
  buffer_load_dwordx4 v8, s[16:19], s59 offen lds
  s_add_u32 m0, s55, 115584
  s_nop 0
  buffer_load_dwordx4 v8, s[16:19], s59 offen offset:128 lds
  s_add_u32 s59, s45, 6
  s_and_b32 s59, s59, 7
  s_lshl_b32 s59, s59, 19
  s_add_u32 s59, s59, s54
  s_add_u32 s59, s59, 262912
  s_add_u32 m0, s55, 122880
  s_nop 0
  buffer_load_dwordx4 v8, s[16:19], s59 offen lds
  s_add_u32 m0, s55, 123776
  s_nop 0
  buffer_load_dwordx4 v8, s[16:19], s59 offen offset:128 lds
  s_waitcnt lgkmcnt(2)
  v_mfma_f32_16x16x32_bf16 v[64:67], v[16:19], v[168:171], v[64:67]
  ds_read_b64_tr_b16 v[28:29], v10 offset:512
  ds_read_b64_tr_b16 v[30:31], v10 offset:4608
  v_mfma_f32_16x16x32_bf16 v[96:99], v[16:19], v[232:235], v[96:99]
  v_add_u32 v13, 131072, v11
  ds_write_b128 v13, v[32:35] offset:0
  v_mfma_f32_16x16x32_bf16 v[68:71], v[20:23], v[168:171], v[68:71]
  ds_read_b64_tr_b16 v[16:17], v9 offset:1024
  ds_read_b64_tr_b16 v[18:19], v9 offset:5120
  v_mfma_f32_16x16x32_bf16 v[100:103], v[20:23], v[232:235], v[100:103]
  s_waitcnt lgkmcnt(3)
  v_mfma_f32_16x16x32_bf16 v[72:75], v[24:27], v[168:171], v[72:75]
  ds_read_b64_tr_b16 v[20:21], v10 offset:1024
  ds_read_b64_tr_b16 v[22:23], v10 offset:5120
  v_mfma_f32_16x16x32_bf16 v[104:107], v[24:27], v[232:235], v[104:107]
  ds_write_b128 v13, v[48:51] offset:4096
  v_mfma_f32_16x16x32_bf16 v[76:79], v[28:31], v[168:171], v[76:79]
  ds_read_b64_tr_b16 v[24:25], v9 offset:1536
  ds_read_b64_tr_b16 v[26:27], v9 offset:5632
  v_mfma_f32_16x16x32_bf16 v[108:111], v[28:31], v[232:235], v[108:111]
  s_waitcnt lgkmcnt(3)
  v_mfma_f32_16x16x32_bf16 v[80:83], v[16:19], v[168:171], v[80:83]
  ds_read_b64_tr_b16 v[28:29], v10 offset:1536
  ds_read_b64_tr_b16 v[30:31], v10 offset:5632
  v_mfma_f32_16x16x32_bf16 v[112:115], v[16:19], v[232:235], v[112:115]
  ds_write_b128 v13, v[36:39] offset:1024
  v_mfma_f32_16x16x32_bf16 v[84:87], v[20:23], v[168:171], v[84:87]
  ds_read_b64_tr_b16 v[16:17], v9 offset:8192
  ds_read_b64_tr_b16 v[18:19], v9 offset:12288
  v_mfma_f32_16x16x32_bf16 v[116:119], v[20:23], v[232:235], v[116:119]
  s_waitcnt lgkmcnt(3)
  v_mfma_f32_16x16x32_bf16 v[88:91], v[24:27], v[168:171], v[88:91]
  ds_read_b64_tr_b16 v[20:21], v10 offset:8192
  ds_read_b64_tr_b16 v[22:23], v10 offset:12288
  v_mfma_f32_16x16x32_bf16 v[120:123], v[24:27], v[232:235], v[120:123]
  ds_write_b128 v13, v[52:55] offset:5120
  v_mfma_f32_16x16x32_bf16 v[92:95], v[28:31], v[168:171], v[92:95]
  ds_read_b64_tr_b16 v[24:25], v9 offset:8704
  ds_read_b64_tr_b16 v[26:27], v9 offset:12800
  v_mfma_f32_16x16x32_bf16 v[124:127], v[28:31], v[232:235], v[124:127]
  s_waitcnt lgkmcnt(3)
  v_mfma_f32_16x16x32_bf16 v[64:67], v[16:19], v[172:175], v[64:67]
  ds_read_b64_tr_b16 v[28:29], v10 offset:8704
  ds_read_b64_tr_b16 v[30:31], v10 offset:12800
  v_mfma_f32_16x16x32_bf16 v[96:99], v[16:19], v[236:239], v[96:99]
  ds_write_b128 v13, v[40:43] offset:2048
  v_mfma_f32_16x16x32_bf16 v[68:71], v[20:23], v[172:175], v[68:71]
  ds_read_b64_tr_b16 v[16:17], v9 offset:9216
  ds_read_b64_tr_b16 v[18:19], v9 offset:13312
  v_mfma_f32_16x16x32_bf16 v[100:103], v[20:23], v[236:239], v[100:103]
  s_waitcnt lgkmcnt(3)
  v_mfma_f32_16x16x32_bf16 v[72:75], v[24:27], v[172:175], v[72:75]
  ds_read_b64_tr_b16 v[20:21], v10 offset:9216
  ds_read_b64_tr_b16 v[22:23], v10 offset:13312
  v_mfma_f32_16x16x32_bf16 v[104:107], v[24:27], v[236:239], v[104:107]
  ds_write_b128 v13, v[56:59] offset:6144
  v_mfma_f32_16x16x32_bf16 v[76:79], v[28:31], v[172:175], v[76:79]
  ds_read_b64_tr_b16 v[24:25], v9 offset:9728
  ds_read_b64_tr_b16 v[26:27], v9 offset:13824
  v_mfma_f32_16x16x32_bf16 v[108:111], v[28:31], v[236:239], v[108:111]
  s_waitcnt lgkmcnt(3)
  v_mfma_f32_16x16x32_bf16 v[80:83], v[16:19], v[172:175], v[80:83]
  ds_read_b64_tr_b16 v[28:29], v10 offset:9728
  ds_read_b64_tr_b16 v[30:31], v10 offset:13824
  v_mfma_f32_16x16x32_bf16 v[112:115], v[16:19], v[236:239], v[112:115]
  ds_write_b128 v13, v[44:47] offset:3072
  v_mfma_f32_16x16x32_bf16 v[84:87], v[20:23], v[172:175], v[84:87]
  v_mfma_f32_16x16x32_bf16 v[116:119], v[20:23], v[236:239], v[116:119]
  s_waitcnt lgkmcnt(1)
  v_mfma_f32_16x16x32_bf16 v[88:91], v[24:27], v[172:175], v[88:91]
  v_mfma_f32_16x16x32_bf16 v[120:123], v[24:27], v[236:239], v[120:123]
  ds_write_b128 v13, v[60:63] offset:7168
  v_mfma_f32_16x16x32_bf16 v[92:95], v[28:31], v[172:175], v[92:95]
  v_mfma_f32_16x16x32_bf16 v[124:127], v[28:31], v[236:239], v[124:127]
  s_waitcnt vmcnt(0)
  s_waitcnt lgkmcnt(0)
  s_barrier
  ds_read_b64_tr_b16 v[16:17], v9 offset:16384
  ds_read_b64_tr_b16 v[18:19], v9 offset:20480
  ds_read_b64_tr_b16 v[20:21], v10 offset:16384
  ds_read_b64_tr_b16 v[22:23], v10 offset:20480
  ds_read_b64_tr_b16 v[24:25], v9 offset:16896
  ds_read_b64_tr_b16 v[26:27], v9 offset:20992
  s_add_u32 s59, s45, 7
  s_and_b32 s59, s59, 7
  s_lshl_b32 s59, s59, 19
  s_add_u32 s59, s59, s54
  s_add_u32 s59, s59, 768
  s_add_u32 m0, s55, 98304
  s_nop 0
  buffer_load_dwordx4 v8, s[16:19], s59 offen lds
  s_add_u32 m0, s55, 99200
  s_nop 0
  buffer_load_dwordx4 v8, s[16:19], s59 offen offset:128 lds
  s_add_u32 s59, s45, 7
  s_and_b32 s59, s59, 7
  s_lshl_b32 s59, s59, 19
  s_add_u32 s59, s59, s54
  s_add_u32 s59, s59, 262912
  s_add_u32 m0, s55, 106496
  s_nop 0
  buffer_load_dwordx4 v8, s[16:19], s59 offen lds
  s_add_u32 m0, s55, 107392
  s_nop 0
  buffer_load_dwordx4 v8, s[16:19], s59 offen offset:128 lds
  s_waitcnt lgkmcnt(2)
  v_mfma_f32_16x16x32_bf16 v[64:67], v[16:19], v[176:179], v[64:67]
  ds_read_b64_tr_b16 v[28:29], v10 offset:16896
  ds_read_b64_tr_b16 v[30:31], v10 offset:20992
  v_mfma_f32_16x16x32_bf16 v[96:99], v[16:19], v[240:243], v[96:99]
  v_mfma_f32_16x16x32_bf16 v[68:71], v[20:23], v[176:179], v[68:71]
  ds_read_b64_tr_b16 v[16:17], v9 offset:17408
  ds_read_b64_tr_b16 v[18:19], v9 offset:21504
  v_mfma_f32_16x16x32_bf16 v[100:103], v[20:23], v[240:243], v[100:103]
  s_waitcnt lgkmcnt(2)
  v_mfma_f32_16x16x32_bf16 v[72:75], v[24:27], v[176:179], v[72:75]
  ds_read_b64_tr_b16 v[20:21], v10 offset:17408
  ds_read_b64_tr_b16 v[22:23], v10 offset:21504
  v_mfma_f32_16x16x32_bf16 v[104:107], v[24:27], v[240:243], v[104:107]
  v_mfma_f32_16x16x32_bf16 v[76:79], v[28:31], v[176:179], v[76:79]
  ds_read_b64_tr_b16 v[24:25], v9 offset:17920
  ds_read_b64_tr_b16 v[26:27], v9 offset:22016
  v_mfma_f32_16x16x32_bf16 v[108:111], v[28:31], v[240:243], v[108:111]
  s_waitcnt lgkmcnt(2)
  v_mfma_f32_16x16x32_bf16 v[80:83], v[16:19], v[176:179], v[80:83]
  ds_read_b64_tr_b16 v[28:29], v10 offset:17920
  ds_read_b64_tr_b16 v[30:31], v10 offset:22016
  v_mfma_f32_16x16x32_bf16 v[112:115], v[16:19], v[240:243], v[112:115]
  v_mfma_f32_16x16x32_bf16 v[84:87], v[20:23], v[176:179], v[84:87]
  ds_read_b64_tr_b16 v[16:17], v9 offset:24576
  ds_read_b64_tr_b16 v[18:19], v9 offset:28672
  v_mfma_f32_16x16x32_bf16 v[116:119], v[20:23], v[240:243], v[116:119]
  s_waitcnt lgkmcnt(2)
  v_mfma_f32_16x16x32_bf16 v[88:91], v[24:27], v[176:179], v[88:91]
  ds_read_b64_tr_b16 v[20:21], v10 offset:24576
  ds_read_b64_tr_b16 v[22:23], v10 offset:28672
  v_mfma_f32_16x16x32_bf16 v[120:123], v[24:27], v[240:243], v[120:123]
  v_mfma_f32_16x16x32_bf16 v[92:95], v[28:31], v[176:179], v[92:95]
  ds_read_b64_tr_b16 v[24:25], v9 offset:25088
  ds_read_b64_tr_b16 v[26:27], v9 offset:29184
  v_mfma_f32_16x16x32_bf16 v[124:127], v[28:31], v[240:243], v[124:127]
  s_waitcnt lgkmcnt(2)
  v_mfma_f32_16x16x32_bf16 v[64:67], v[16:19], v[180:183], v[64:67]
  ds_read_b64_tr_b16 v[28:29], v10 offset:25088
  ds_read_b64_tr_b16 v[30:31], v10 offset:29184
  v_mfma_f32_16x16x32_bf16 v[96:99], v[16:19], v[244:247], v[96:99]
  v_mfma_f32_16x16x32_bf16 v[68:71], v[20:23], v[180:183], v[68:71]
  ds_read_b64_tr_b16 v[16:17], v9 offset:25600
  ds_read_b64_tr_b16 v[18:19], v9 offset:29696
  v_mfma_f32_16x16x32_bf16 v[100:103], v[20:23], v[244:247], v[100:103]
  s_waitcnt lgkmcnt(2)
  v_mfma_f32_16x16x32_bf16 v[72:75], v[24:27], v[180:183], v[72:75]
  ds_read_b64_tr_b16 v[20:21], v10 offset:25600
  ds_read_b64_tr_b16 v[22:23], v10 offset:29696
  v_mfma_f32_16x16x32_bf16 v[104:107], v[24:27], v[244:247], v[104:107]
  v_mfma_f32_16x16x32_bf16 v[76:79], v[28:31], v[180:183], v[76:79]
  ds_read_b64_tr_b16 v[24:25], v9 offset:26112
  ds_read_b64_tr_b16 v[26:27], v9 offset:30208
  v_mfma_f32_16x16x32_bf16 v[108:111], v[28:31], v[244:247], v[108:111]
  s_waitcnt lgkmcnt(2)
  v_mfma_f32_16x16x32_bf16 v[80:83], v[16:19], v[180:183], v[80:83]
  ds_read_b64_tr_b16 v[28:29], v10 offset:26112
  ds_read_b64_tr_b16 v[30:31], v10 offset:30208
  v_mfma_f32_16x16x32_bf16 v[112:115], v[16:19], v[244:247], v[112:115]
  v_mfma_f32_16x16x32_bf16 v[84:87], v[20:23], v[180:183], v[84:87]
  v_mfma_f32_16x16x32_bf16 v[116:119], v[20:23], v[244:247], v[116:119]
  s_waitcnt lgkmcnt(0)
  v_mfma_f32_16x16x32_bf16 v[88:91], v[24:27], v[180:183], v[88:91]
  v_mfma_f32_16x16x32_bf16 v[120:123], v[24:27], v[244:247], v[120:123]
  v_mfma_f32_16x16x32_bf16 v[92:95], v[28:31], v[180:183], v[92:95]
  v_mfma_f32_16x16x32_bf16 v[124:127], v[28:31], v[244:247], v[124:127]
  s_waitcnt vmcnt(0)
  s_waitcnt lgkmcnt(0)
  s_barrier
  ds_read_b64_tr_b16 v[16:17], v9 offset:0
  ds_read_b64_tr_b16 v[18:19], v9 offset:4096
  ds_read_b64_tr_b16 v[20:21], v10 offset:0
  ds_read_b64_tr_b16 v[22:23], v10 offset:4096
  ds_read_b64_tr_b16 v[24:25], v9 offset:512
  ds_read_b64_tr_b16 v[26:27], v9 offset:4608
  s_waitcnt lgkmcnt(2)
  v_mfma_f32_16x16x32_bf16 v[64:67], v[16:19], v[184:187], v[64:67]
  ds_read_b64_tr_b16 v[28:29], v10 offset:512
  ds_read_b64_tr_b16 v[30:31], v10 offset:4608
  v_mfma_f32_16x16x32_bf16 v[96:99], v[16:19], v[248:251], v[96:99]
  v_mfma_f32_16x16x32_bf16 v[68:71], v[20:23], v[184:187], v[68:71]
  ds_read_b64_tr_b16 v[16:17], v9 offset:1024
  ds_read_b64_tr_b16 v[18:19], v9 offset:5120
  v_mfma_f32_16x16x32_bf16 v[100:103], v[20:23], v[248:251], v[100:103]
  s_waitcnt lgkmcnt(2)
  v_mfma_f32_16x16x32_bf16 v[72:75], v[24:27], v[184:187], v[72:75]
  ds_read_b64_tr_b16 v[20:21], v10 offset:1024
  ds_read_b64_tr_b16 v[22:23], v10 offset:5120
  v_mfma_f32_16x16x32_bf16 v[104:107], v[24:27], v[248:251], v[104:107]
  v_mfma_f32_16x16x32_bf16 v[76:79], v[28:31], v[184:187], v[76:79]
  ds_read_b64_tr_b16 v[24:25], v9 offset:1536
  ds_read_b64_tr_b16 v[26:27], v9 offset:5632
  v_mfma_f32_16x16x32_bf16 v[108:111], v[28:31], v[248:251], v[108:111]
  s_waitcnt lgkmcnt(2)
  v_mfma_f32_16x16x32_bf16 v[80:83], v[16:19], v[184:187], v[80:83]
  ds_read_b64_tr_b16 v[28:29], v10 offset:1536
  ds_read_b64_tr_b16 v[30:31], v10 offset:5632
  v_mfma_f32_16x16x32_bf16 v[112:115], v[16:19], v[248:251], v[112:115]
  v_mfma_f32_16x16x32_bf16 v[84:87], v[20:23], v[184:187], v[84:87]
  ds_read_b64_tr_b16 v[16:17], v9 offset:8192
  ds_read_b64_tr_b16 v[18:19], v9 offset:12288
  v_mfma_f32_16x16x32_bf16 v[116:119], v[20:23], v[248:251], v[116:119]
  s_waitcnt lgkmcnt(2)
  v_mfma_f32_16x16x32_bf16 v[88:91], v[24:27], v[184:187], v[88:91]
  ds_read_b64_tr_b16 v[20:21], v10 offset:8192
  ds_read_b64_tr_b16 v[22:23], v10 offset:12288
  v_mfma_f32_16x16x32_bf16 v[120:123], v[24:27], v[248:251], v[120:123]
  v_mfma_f32_16x16x32_bf16 v[92:95], v[28:31], v[184:187], v[92:95]
  ds_read_b64_tr_b16 v[24:25], v9 offset:8704
  ds_read_b64_tr_b16 v[26:27], v9 offset:12800
  v_mfma_f32_16x16x32_bf16 v[124:127], v[28:31], v[248:251], v[124:127]
  s_waitcnt lgkmcnt(2)
  v_mfma_f32_16x16x32_bf16 v[64:67], v[16:19], v[188:191], v[64:67]
  ds_read_b64_tr_b16 v[28:29], v10 offset:8704
  ds_read_b64_tr_b16 v[30:31], v10 offset:12800
  v_mfma_f32_16x16x32_bf16 v[96:99], v[16:19], v[252:255], v[96:99]
  v_mfma_f32_16x16x32_bf16 v[68:71], v[20:23], v[188:191], v[68:71]
  ds_read_b64_tr_b16 v[16:17], v9 offset:9216
  ds_read_b64_tr_b16 v[18:19], v9 offset:13312
  v_mfma_f32_16x16x32_bf16 v[100:103], v[20:23], v[252:255], v[100:103]
  s_waitcnt lgkmcnt(2)
  v_mfma_f32_16x16x32_bf16 v[72:75], v[24:27], v[188:191], v[72:75]
  ds_read_b64_tr_b16 v[20:21], v10 offset:9216
  ds_read_b64_tr_b16 v[22:23], v10 offset:13312
  v_mfma_f32_16x16x32_bf16 v[104:107], v[24:27], v[252:255], v[104:107]
  v_mul_f32 v64, s50, v64
  v_mul_f32 v65, s50, v65
  v_mul_f32 v66, s50, v66
  v_mul_f32 v67, s50, v67
  v_cvt_pk_bf16_f32 v32, v64, v65
  v_cvt_pk_bf16_f32 v33, v66, v67
  v_mul_f32 v96, s50, v96
  v_mul_f32 v97, s50, v97
  v_mul_f32 v98, s50, v98
  v_mul_f32 v99, s50, v99
  v_cvt_pk_bf16_f32 v48, v96, v97
  v_cvt_pk_bf16_f32 v49, v98, v99
  v_mfma_f32_16x16x32_bf16 v[76:79], v[28:31], v[188:191], v[76:79]
  ds_read_b64_tr_b16 v[24:25], v9 offset:9728
  ds_read_b64_tr_b16 v[26:27], v9 offset:13824
  v_mfma_f32_16x16x32_bf16 v[108:111], v[28:31], v[252:255], v[108:111]
  v_mul_f32 v68, s50, v68
  v_mul_f32 v69, s50, v69
  v_mul_f32 v70, s50, v70
  v_mul_f32 v71, s50, v71
  v_cvt_pk_bf16_f32 v34, v68, v69
  v_cvt_pk_bf16_f32 v35, v70, v71
  v_mul_f32 v100, s50, v100
  v_mul_f32 v101, s50, v101
  v_mul_f32 v102, s50, v102
  v_mul_f32 v103, s50, v103
  v_cvt_pk_bf16_f32 v50, v100, v101
  v_cvt_pk_bf16_f32 v51, v102, v103
  v_permlane16_swap_b32 v32, v34
  v_permlane16_swap_b32 v33, v35
  v_permlane16_swap_b32 v48, v50
  v_permlane16_swap_b32 v49, v51
  v_add_u32 v13, 131072, v11
  ds_write_b128 v13, v[32:35] offset:0
  ds_write_b128 v13, v[48:51] offset:4096
  s_waitcnt lgkmcnt(4)
  v_mfma_f32_16x16x32_bf16 v[80:83], v[16:19], v[188:191], v[80:83]
  ds_read_b64_tr_b16 v[28:29], v10 offset:9728
  ds_read_b64_tr_b16 v[30:31], v10 offset:13824
  v_mfma_f32_16x16x32_bf16 v[112:115], v[16:19], v[252:255], v[112:115]
  v_mul_f32 v72, s50, v72
  v_mul_f32 v73, s50, v73
  v_mul_f32 v74, s50, v74
  v_mul_f32 v75, s50, v75
  v_cvt_pk_bf16_f32 v36, v72, v73
  v_cvt_pk_bf16_f32 v37, v74, v75
  v_mul_f32 v104, s50, v104
  v_mul_f32 v105, s50, v105
  v_mul_f32 v106, s50, v106
  v_mul_f32 v107, s50, v107
  v_cvt_pk_bf16_f32 v52, v104, v105
  v_cvt_pk_bf16_f32 v53, v106, v107
  v_mfma_f32_16x16x32_bf16 v[84:87], v[20:23], v[188:191], v[84:87]
  v_mfma_f32_16x16x32_bf16 v[116:119], v[20:23], v[252:255], v[116:119]
  v_mul_f32 v76, s50, v76
  v_mul_f32 v77, s50, v77
  v_mul_f32 v78, s50, v78
  v_mul_f32 v79, s50, v79
  v_cvt_pk_bf16_f32 v38, v76, v77
  v_cvt_pk_bf16_f32 v39, v78, v79
  v_mul_f32 v108, s50, v108
  v_mul_f32 v109, s50, v109
  v_mul_f32 v110, s50, v110
  v_mul_f32 v111, s50, v111
  v_cvt_pk_bf16_f32 v54, v108, v109
  v_cvt_pk_bf16_f32 v55, v110, v111
  v_permlane16_swap_b32 v36, v38
  v_permlane16_swap_b32 v37, v39
  v_permlane16_swap_b32 v52, v54
  v_permlane16_swap_b32 v53, v55
  ds_write_b128 v13, v[36:39] offset:1024
  ds_write_b128 v13, v[52:55] offset:5120
  s_waitcnt lgkmcnt(2)
  v_mfma_f32_16x16x32_bf16 v[88:91], v[24:27], v[188:191], v[88:91]
  v_mfma_f32_16x16x32_bf16 v[120:123], v[24:27], v[252:255], v[120:123]
  v_mul_f32 v80, s50, v80
  v_mul_f32 v81, s50, v81
  v_mul_f32 v82, s50, v82
  v_mul_f32 v83, s50, v83
  v_cvt_pk_bf16_f32 v40, v80, v81
  v_cvt_pk_bf16_f32 v41, v82, v83
  v_mul_f32 v112, s50, v112
  v_mul_f32 v113, s50, v113
  v_mul_f32 v114, s50, v114
  v_mul_f32 v115, s50, v115
  v_cvt_pk_bf16_f32 v56, v112, v113
  v_cvt_pk_bf16_f32 v57, v114, v115
  v_mfma_f32_16x16x32_bf16 v[92:95], v[28:31], v[188:191], v[92:95]
  v_mfma_f32_16x16x32_bf16 v[124:127], v[28:31], v[252:255], v[124:127]
  v_mul_f32 v84, s50, v84
  v_mul_f32 v85, s50, v85
  v_mul_f32 v86, s50, v86
  v_mul_f32 v87, s50, v87
  v_cvt_pk_bf16_f32 v42, v84, v85
  v_cvt_pk_bf16_f32 v43, v86, v87
  v_mul_f32 v116, s50, v116
  v_mul_f32 v117, s50, v117
  v_mul_f32 v118, s50, v118
  v_mul_f32 v119, s50, v119
  v_cvt_pk_bf16_f32 v58, v116, v117
  v_cvt_pk_bf16_f32 v59, v118, v119
  v_permlane16_swap_b32 v40, v42
  v_permlane16_swap_b32 v41, v43
  v_permlane16_swap_b32 v56, v58
  v_permlane16_swap_b32 v57, v59
  ds_write_b128 v13, v[40:43] offset:2048
  ds_write_b128 v13, v[56:59] offset:6144
  v_mul_f32 v88, s50, v88
  v_mul_f32 v89, s50, v89
  v_mul_f32 v90, s50, v90
  v_mul_f32 v91, s50, v91
  v_cvt_pk_bf16_f32 v44, v88, v89
  v_cvt_pk_bf16_f32 v45, v90, v91
  v_mul_f32 v120, s50, v120
  v_mul_f32 v121, s50, v121
  v_mul_f32 v122, s50, v122
  v_mul_f32 v123, s50, v123
  v_cvt_pk_bf16_f32 v60, v120, v121
  v_cvt_pk_bf16_f32 v61, v122, v123
  v_mul_f32 v92, s50, v92
  v_mul_f32 v93, s50, v93
  v_mul_f32 v94, s50, v94
  v_mul_f32 v95, s50, v95
  v_cvt_pk_bf16_f32 v46, v92, v93
  v_cvt_pk_bf16_f32 v47, v94, v95
  v_mul_f32 v124, s50, v124
  v_mul_f32 v125, s50, v125
  v_mul_f32 v126, s50, v126
  v_mul_f32 v127, s50, v127
  v_cvt_pk_bf16_f32 v62, v124, v125
  v_cvt_pk_bf16_f32 v63, v126, v127
  v_permlane16_swap_b32 v44, v46
  v_permlane16_swap_b32 v45, v47
  v_permlane16_swap_b32 v60, v62
  v_permlane16_swap_b32 v61, v63
  ds_write_b128 v13, v[44:47] offset:3072
  ds_write_b128 v13, v[60:63] offset:7168
  s_waitcnt lgkmcnt(0)
  s_branch L_h16
L_h1:
  s_barrier
  ds_read_b64_tr_b16 v[16:17], v9 offset:0
  ds_read_b64_tr_b16 v[18:19], v9 offset:4096
  ds_read_b64_tr_b16 v[20:21], v10 offset:0
  ds_read_b64_tr_b16 v[22:23], v10 offset:4096
  ds_read_b64_tr_b16 v[24:25], v9 offset:512
  ds_read_b64_tr_b16 v[26:27], v9 offset:4608
  s_add_u32 s59, s45, 1
  s_and_b32 s59, s59, 7
  s_lshl_b32 s59, s59, 19
  s_add_u32 s59, s59, s54
  s_add_u32 s59, s59, 262400
  s_add_u32 m0, s55, 131072
  s_nop 0
  buffer_load_dwordx4 v8, s[16:19], s59 offen lds
  s_add_u32 m0, s55, 131968
  s_nop 0
  buffer_load_dwordx4 v8, s[16:19], s59 offen offset:128 lds
  s_add_u32 s59, s45, 2
  s_and_b32 s59, s59, 7
  s_lshl_b32 s59, s59, 19
  s_add_u32 s59, s59, s54
  s_add_u32 s59, s59, 256
  s_add_u32 m0, s55, 139264
  s_nop 0
  buffer_load_dwordx4 v8, s[16:19], s59 offen lds
  s_add_u32 m0, s55, 140160
  s_nop 0
  buffer_load_dwordx4 v8, s[16:19], s59 offen offset:128 lds
  s_add_u32 s59, s45, 2
  s_and_b32 s59, s59, 7
  s_lshl_b32 s59, s59, 19
  s_add_u32 s59, s59, s54
  s_add_u32 s59, s59, 262400
  s_add_u32 m0, s55, 147456
  s_nop 0
  buffer_load_dwordx4 v8, s[16:19], s59 offen lds
  s_add_u32 m0, s55, 148352
  s_nop 0
  buffer_load_dwordx4 v8, s[16:19], s59 offen offset:128 lds
  s_waitcnt lgkmcnt(2)
  v_mfma_f32_16x16x32_bf16 v[64:67], v[16:19], v[128:131], 0
  ds_read_b64_tr_b16 v[28:29], v10 offset:512
  ds_read_b64_tr_b16 v[30:31], v10 offset:4608
  v_mfma_f32_16x16x32_bf16 v[68:71], v[20:23], v[128:131], 0
  ds_read_b64_tr_b16 v[16:17], v9 offset:1024
  ds_read_b64_tr_b16 v[18:19], v9 offset:5120
  s_waitcnt lgkmcnt(2)
  v_mfma_f32_16x16x32_bf16 v[72:75], v[24:27], v[128:131], 0
  ds_read_b64_tr_b16 v[20:21], v10 offset:1024
  ds_read_b64_tr_b16 v[22:23], v10 offset:5120
  v_mfma_f32_16x16x32_bf16 v[76:79], v[28:31], v[128:131], 0
  ds_read_b64_tr_b16 v[24:25], v9 offset:1536
  ds_read_b64_tr_b16 v[26:27], v9 offset:5632
  s_barrier
  s_waitcnt lgkmcnt(2)
  v_mfma_f32_16x16x32_bf16 v[80:83], v[16:19], v[128:131], 0
  ds_read_b64_tr_b16 v[28:29], v10 offset:1536
  ds_read_b64_tr_b16 v[30:31], v10 offset:5632
  v_mfma_f32_16x16x32_bf16 v[84:87], v[20:23], v[128:131], 0
  ds_read_b64_tr_b16 v[16:17], v9 offset:8192
  ds_read_b64_tr_b16 v[18:19], v9 offset:12288
  s_waitcnt lgkmcnt(2)
  v_mfma_f32_16x16x32_bf16 v[88:91], v[24:27], v[128:131], 0
  ds_read_b64_tr_b16 v[20:21], v10 offset:8192
  ds_read_b64_tr_b16 v[22:23], v10 offset:12288
  v_mfma_f32_16x16x32_bf16 v[92:95], v[28:31], v[128:131], 0
  ds_read_b64_tr_b16 v[24:25], v9 offset:8704
  ds_read_b64_tr_b16 v[26:27], v9 offset:12800
  s_waitcnt lgkmcnt(2)
  v_mfma_f32_16x16x32_bf16 v[64:67], v[16:19], v[132:135], v[64:67]
  ds_read_b64_tr_b16 v[28:29], v10 offset:8704
  ds_read_b64_tr_b16 v[30:31], v10 offset:12800
  v_mfma_f32_16x16x32_bf16 v[68:71], v[20:23], v[132:135], v[68:71]
  ds_read_b64_tr_b16 v[16:17], v9 offset:9216
  ds_read_b64_tr_b16 v[18:19], v9 offset:13312
  s_waitcnt lgkmcnt(2)
  v_mfma_f32_16x16x32_bf16 v[72:75], v[24:27], v[132:135], v[72:75]
  ds_read_b64_tr_b16 v[20:21], v10 offset:9216
  ds_read_b64_tr_b16 v[22:23], v10 offset:13312
  v_mfma_f32_16x16x32_bf16 v[76:79], v[28:31], v[132:135], v[76:79]
  ds_read_b64_tr_b16 v[24:25], v9 offset:9728
  ds_read_b64_tr_b16 v[26:27], v9 offset:13824
  s_waitcnt lgkmcnt(2)
  v_mfma_f32_16x16x32_bf16 v[80:83], v[16:19], v[132:135], v[80:83]
  ds_read_b64_tr_b16 v[28:29], v10 offset:9728
  ds_read_b64_tr_b16 v[30:31], v10 offset:13824
  v_mfma_f32_16x16x32_bf16 v[84:87], v[20:23], v[132:135], v[84:87]
  ds_read_b64_tr_b16 v[16:17], v9 offset:16384
  ds_read_b64_tr_b16 v[18:19], v9 offset:20480
  s_waitcnt lgkmcnt(2)
  v_mfma_f32_16x16x32_bf16 v[88:91], v[24:27], v[132:135], v[88:91]
  ds_read_b64_tr_b16 v[20:21], v10 offset:16384
  ds_read_b64_tr_b16 v[22:23], v10 offset:20480
  v_mfma_f32_16x16x32_bf16 v[92:95], v[28:31], v[132:135], v[92:95]
  ds_read_b64_tr_b16 v[24:25], v9 offset:16896
  ds_read_b64_tr_b16 v[26:27], v9 offset:20992
  s_waitcnt lgkmcnt(2)
  v_mfma_f32_16x16x32_bf16 v[64:67], v[16:19], v[136:139], v[64:67]
  ds_read_b64_tr_b16 v[28:29], v10 offset:16896
  ds_read_b64_tr_b16 v[30:31], v10 offset:20992
  v_mfma_f32_16x16x32_bf16 v[68:71], v[20:23], v[136:139], v[68:71]
  ds_read_b64_tr_b16 v[16:17], v9 offset:17408
  ds_read_b64_tr_b16 v[18:19], v9 offset:21504
  s_waitcnt lgkmcnt(2)
  v_mfma_f32_16x16x32_bf16 v[72:75], v[24:27], v[136:139], v[72:75]
  ds_read_b64_tr_b16 v[20:21], v10 offset:17408
  ds_read_b64_tr_b16 v[22:23], v10 offset:21504
  v_mfma_f32_16x16x32_bf16 v[76:79], v[28:31], v[136:139], v[76:79]
  ds_read_b64_tr_b16 v[24:25], v9 offset:17920
  ds_read_b64_tr_b16 v[26:27], v9 offset:22016
  s_waitcnt lgkmcnt(2)
  v_mfma_f32_16x16x32_bf16 v[80:83], v[16:19], v[136:139], v[80:83]
  ds_read_b64_tr_b16 v[28:29], v10 offset:17920
  ds_read_b64_tr_b16 v[30:31], v10 offset:22016
  v_mfma_f32_16x16x32_bf16 v[84:87], v[20:23], v[136:139], v[84:87]
  s_waitcnt lgkmcnt(0)
  v_mfma_f32_16x16x32_bf16 v[88:91], v[24:27], v[136:139], v[88:91]
  v_mfma_f32_16x16x32_bf16 v[92:95], v[28:31], v[136:139], v[92:95]
  s_waitcnt vmcnt(0)
  s_waitcnt lgkmcnt(0)
  s_barrier
  ds_read_b64_tr_b16 v[16:17], v9 offset:32768
  ds_read_b64_tr_b16 v[18:19], v9 offset:36864
  ds_read_b64_tr_b16 v[20:21], v10 offset:32768
  ds_read_b64_tr_b16 v[22:23], v10 offset:36864
  ds_read_b64_tr_b16 v[24:25], v9 offset:33280
  ds_read_b64_tr_b16 v[26:27], v9 offset:37376
  s_add_u32 s59, s45, 3
  s_and_b32 s59, s59, 7
  s_lshl_b32 s59, s59, 19
  s_add_u32 s59, s59, s54
  s_add_u32 s59, s59, 256
  s_add_u32 m0, s55, 155648
  s_nop 0
  buffer_load_dwordx4 v8, s[16:19], s59 offen lds
  s_add_u32 m0, s55, 156544
  s_nop 0
  buffer_load_dwordx4 v8, s[16:19], s59 offen offset:128 lds
  s_add_u32 s59, s45, 3
  s_and_b32 s59, s59, 7
  s_lshl_b32 s59, s59, 19
  s_add_u32 s59, s59, s54
  s_add_u32 s59, s59, 262400
  s_add_u32 m0, s55, 98304
  s_nop 0
  buffer_load_dwordx4 v8, s[16:19], s59 offen lds
  s_add_u32 m0, s55, 99200
  s_nop 0
  buffer_load_dwordx4 v8, s[16:19], s59 offen offset:128 lds
  s_add_u32 s59, s45, 4
  s_and_b32 s59, s59, 7
  s_lshl_b32 s59, s59, 19
  s_add_u32 s59, s59, s54
  s_add_u32 s59, s59, 256
  s_add_u32 m0, s55, 106496
  s_nop 0
  buffer_load_dwordx4 v8, s[16:19], s59 offen lds
  s_add_u32 m0, s55, 107392
  s_nop 0
  buffer_load_dwordx4 v8, s[16:19], s59 offen offset:128 lds
  s_waitcnt lgkmcnt(2)
  v_mfma_f32_16x16x32_bf16 v[64:67], v[16:19], v[140:143], v[64:67]
  ds_read_b64_tr_b16 v[28:29], v10 offset:33280
  ds_read_b64_tr_b16 v[30:31], v10 offset:37376
  v_mfma_f32_16x16x32_bf16 v[68:71], v[20:23], v[140:143], v[68:71]
  ds_read_b64_tr_b16 v[16:17], v9 offset:33792
  ds_read_b64_tr_b16 v[18:19], v9 offset:37888
  s_waitcnt lgkmcnt(2)
  v_mfma_f32_16x16x32_bf16 v[72:75], v[24:27], v[140:143], v[72:75]
  ds_read_b64_tr_b16 v[20:21], v10 offset:33792
  ds_read_b64_tr_b16 v[22:23], v10 offset:37888
  v_mfma_f32_16x16x32_bf16 v[76:79], v[28:31], v[140:143], v[76:79]
  ds_read_b64_tr_b16 v[24:25], v9 offset:34304
  ds_read_b64_tr_b16 v[26:27], v9 offset:38400
  s_waitcnt lgkmcnt(2)
  v_mfma_f32_16x16x32_bf16 v[80:83], v[16:19], v[140:143], v[80:83]
  ds_read_b64_tr_b16 v[28:29], v10 offset:34304
  ds_read_b64_tr_b16 v[30:31], v10 offset:38400
  v_mfma_f32_16x16x32_bf16 v[84:87], v[20:23], v[140:143], v[84:87]
  ds_read_b64_tr_b16 v[16:17], v9 offset:40960
  ds_read_b64_tr_b16 v[18:19], v9 offset:45056
  s_waitcnt lgkmcnt(2)
  v_mfma_f32_16x16x32_bf16 v[88:91], v[24:27], v[140:143], v[88:91]
  ds_read_b64_tr_b16 v[20:21], v10 offset:40960
  ds_read_b64_tr_b16 v[22:23], v10 offset:45056
  v_mfma_f32_16x16x32_bf16 v[92:95], v[28:31], v[140:143], v[92:95]
  ds_read_b64_tr_b16 v[24:25], v9 offset:41472
  ds_read_b64_tr_b16 v[26:27], v9 offset:45568
  s_waitcnt lgkmcnt(2)
  v_mfma_f32_16x16x32_bf16 v[64:67], v[16:19], v[144:147], v[64:67]
  ds_read_b64_tr_b16 v[28:29], v10 offset:41472
  ds_read_b64_tr_b16 v[30:31], v10 offset:45568
  v_mfma_f32_16x16x32_bf16 v[68:71], v[20:23], v[144:147], v[68:71]
  ds_read_b64_tr_b16 v[16:17], v9 offset:41984
  ds_read_b64_tr_b16 v[18:19], v9 offset:46080
  s_waitcnt lgkmcnt(2)
  v_mfma_f32_16x16x32_bf16 v[72:75], v[24:27], v[144:147], v[72:75]
  ds_read_b64_tr_b16 v[20:21], v10 offset:41984
  ds_read_b64_tr_b16 v[22:23], v10 offset:46080
  v_mfma_f32_16x16x32_bf16 v[76:79], v[28:31], v[144:147], v[76:79]
  ds_read_b64_tr_b16 v[24:25], v9 offset:42496
  ds_read_b64_tr_b16 v[26:27], v9 offset:46592
  s_waitcnt lgkmcnt(2)
  v_mfma_f32_16x16x32_bf16 v[80:83], v[16:19], v[144:147], v[80:83]
  ds_read_b64_tr_b16 v[28:29], v10 offset:42496
  ds_read_b64_tr_b16 v[30:31], v10 offset:46592
  v_mfma_f32_16x16x32_bf16 v[84:87], v[20:23], v[144:147], v[84:87]
  ds_read_b64_tr_b16 v[16:17], v9 offset:49152
  ds_read_b64_tr_b16 v[18:19], v9 offset:53248
  s_waitcnt lgkmcnt(2)
  v_mfma_f32_16x16x32_bf16 v[88:91], v[24:27], v[144:147], v[88:91]
  ds_read_b64_tr_b16 v[20:21], v10 offset:49152
  ds_read_b64_tr_b16 v[22:23], v10 offset:53248
  v_mfma_f32_16x16x32_bf16 v[92:95], v[28:31], v[144:147], v[92:95]
  ds_read_b64_tr_b16 v[24:25], v9 offset:49664
  ds_read_b64_tr_b16 v[26:27], v9 offset:53760
  s_waitcnt lgkmcnt(2)
  v_mfma_f32_16x16x32_bf16 v[64:67], v[16:19], v[148:151], v[64:67]
  ds_read_b64_tr_b16 v[28:29], v10 offset:49664
  ds_read_b64_tr_b16 v[30:31], v10 offset:53760
  v_mfma_f32_16x16x32_bf16 v[68:71], v[20:23], v[148:151], v[68:71]
  ds_read_b64_tr_b16 v[16:17], v9 offset:50176
  ds_read_b64_tr_b16 v[18:19], v9 offset:54272
  s_waitcnt lgkmcnt(2)
  v_mfma_f32_16x16x32_bf16 v[72:75], v[24:27], v[148:151], v[72:75]
  ds_read_b64_tr_b16 v[20:21], v10 offset:50176
  ds_read_b64_tr_b16 v[22:23], v10 offset:54272
  v_mfma_f32_16x16x32_bf16 v[76:79], v[28:31], v[148:151], v[76:79]
  ds_read_b64_tr_b16 v[24:25], v9 offset:50688
  ds_read_b64_tr_b16 v[26:27], v9 offset:54784
  s_waitcnt lgkmcnt(2)
  v_mfma_f32_16x16x32_bf16 v[80:83], v[16:19], v[148:151], v[80:83]
  ds_read_b64_tr_b16 v[28:29], v10 offset:50688
  ds_read_b64_tr_b16 v[30:31], v10 offset:54784
  v_mfma_f32_16x16x32_bf16 v[84:87], v[20:23], v[148:151], v[84:87]
  s_waitcnt lgkmcnt(0)
  v_mfma_f32_16x16x32_bf16 v[88:91], v[24:27], v[148:151], v[88:91]
  v_mfma_f32_16x16x32_bf16 v[92:95], v[28:31], v[148:151], v[92:95]
  s_waitcnt vmcnt(0)
  s_waitcnt lgkmcnt(0)
  s_barrier
  ds_read_b64_tr_b16 v[16:17], v9 offset:57344
  ds_read_b64_tr_b16 v[18:19], v9 offset:61440
  ds_read_b64_tr_b16 v[20:21], v10 offset:57344
  ds_read_b64_tr_b16 v[22:23], v10 offset:61440
  ds_read_b64_tr_b16 v[24:25], v9 offset:57856
  ds_read_b64_tr_b16 v[26:27], v9 offset:61952
  s_add_u32 s59, s45, 4
  s_and_b32 s59, s59, 7
  s_lshl_b32 s59, s59, 19
  s_add_u32 s59, s59, s54
  s_add_u32 s59, s59, 262400
  s_add_u32 m0, s55, 131072
  s_nop 0
  buffer_load_dwordx4 v8, s[16:19], s59 offen lds
  s_add_u32 m0, s55, 131968
  s_nop 0
  buffer_load_dwordx4 v8, s[16:19], s59 offen offset:128 lds
  s_add_u32 s59, s45, 5
  s_and_b32 s59, s59, 7
  s_lshl_b32 s59, s59, 19
  s_add_u32 s59, s59, s54
  s_add_u32 s59, s59, 256
  s_add_u32 m0, s55, 139264
  s_nop 0
  buffer_load_dwordx4 v8, s[16:19], s59 offen lds
  s_add_u32 m0, s55, 140160
  s_nop 0
  buffer_load_dwordx4 v8, s[16:19], s59 offen offset:128 lds
  s_add_u32 s59, s45, 5
  s_and_b32 s59, s59, 7
  s_lshl_b32 s59, s59, 19
  s_add_u32 s59, s59, s54
  s_add_u32 s59, s59, 262400
  s_add_u32 m0, s55, 147456
  s_nop 0
  buffer_load_dwordx4 v8, s[16:19], s59 offen lds
  s_add_u32 m0, s55, 148352
  s_nop 0
  buffer_load_dwordx4 v8, s[16:19], s59 offen offset:128 lds
  s_waitcnt lgkmcnt(2)
  v_mfma_f32_16x16x32_bf16 v[64:67], v[16:19], v[152:155], v[64:67]
  ds_read_b64_tr_b16 v[28:29], v10 offset:57856
  ds_read_b64_tr_b16 v[30:31], v10 offset:61952
  v_mfma_f32_16x16x32_bf16 v[68:71], v[20:23], v[152:155], v[68:71]
  ds_read_b64_tr_b16 v[16:17], v9 offset:58368
  ds_read_b64_tr_b16 v[18:19], v9 offset:62464
  s_waitcnt lgkmcnt(2)
  v_mfma_f32_16x16x32_bf16 v[72:75], v[24:27], v[152:155], v[72:75]
  ds_read_b64_tr_b16 v[20:21], v10 offset:58368
  ds_read_b64_tr_b16 v[22:23], v10 offset:62464
  v_mfma_f32_16x16x32_bf16 v[76:79], v[28:31], v[152:155], v[76:79]
  ds_read_b64_tr_b16 v[24:25], v9 offset:58880
  ds_read_b64_tr_b16 v[26:27], v9 offset:62976
  s_waitcnt lgkmcnt(2)
  v_mfma_f32_16x16x32_bf16 v[80:83], v[16:19], v[152:155], v[80:83]
  ds_read_b64_tr_b16 v[28:29], v10 offset:58880
  ds_read_b64_tr_b16 v[30:31], v10 offset:62976
  v_mfma_f32_16x16x32_bf16 v[84:87], v[20:23], v[152:155], v[84:87]
  ds_read_b64_tr_b16 v[16:17], v9 offset:0
  ds_read_b64_tr_b16 v[18:19], v9 offset:4096
  s_waitcnt lgkmcnt(2)
  v_mfma_f32_16x16x32_bf16 v[88:91], v[24:27], v[152:155], v[88:91]
  ds_read_b64_tr_b16 v[20:21], v10 offset:0
  ds_read_b64_tr_b16 v[22:23], v10 offset:4096
  v_mfma_f32_16x16x32_bf16 v[92:95], v[28:31], v[152:155], v[92:95]
  ds_read_b64_tr_b16 v[24:25], v9 offset:512
  ds_read_b64_tr_b16 v[26:27], v9 offset:4608
  s_waitcnt lgkmcnt(2)
  v_mfma_f32_16x16x32_bf16 v[64:67], v[16:19], v[156:159], v[64:67]
  ds_read_b64_tr_b16 v[28:29], v10 offset:512
  ds_read_b64_tr_b16 v[30:31], v10 offset:4608
  v_mfma_f32_16x16x32_bf16 v[68:71], v[20:23], v[156:159], v[68:71]
  ds_read_b64_tr_b16 v[16:17], v9 offset:1024
  ds_read_b64_tr_b16 v[18:19], v9 offset:5120
  s_waitcnt lgkmcnt(2)
  v_mfma_f32_16x16x32_bf16 v[72:75], v[24:27], v[156:159], v[72:75]
  ds_read_b64_tr_b16 v[20:21], v10 offset:1024
  ds_read_b64_tr_b16 v[22:23], v10 offset:5120
  v_mfma_f32_16x16x32_bf16 v[76:79], v[28:31], v[156:159], v[76:79]
  ds_read_b64_tr_b16 v[24:25], v9 offset:1536
  ds_read_b64_tr_b16 v[26:27], v9 offset:5632
  s_waitcnt lgkmcnt(2)
  v_mfma_f32_16x16x32_bf16 v[80:83], v[16:19], v[156:159], v[80:83]
  ds_read_b64_tr_b16 v[28:29], v10 offset:1536
  ds_read_b64_tr_b16 v[30:31], v10 offset:5632
  v_mfma_f32_16x16x32_bf16 v[84:87], v[20:23], v[156:159], v[84:87]
  ds_read_b64_tr_b16 v[16:17], v9 offset:8192
  ds_read_b64_tr_b16 v[18:19], v9 offset:12288
  s_waitcnt lgkmcnt(2)
  v_mfma_f32_16x16x32_bf16 v[88:91], v[24:27], v[156:159], v[88:91]
  ds_read_b64_tr_b16 v[20:21], v10 offset:8192
  ds_read_b64_tr_b16 v[22:23], v10 offset:12288
  v_mfma_f32_16x16x32_bf16 v[92:95], v[28:31], v[156:159], v[92:95]
  ds_read_b64_tr_b16 v[24:25], v9 offset:8704
  ds_read_b64_tr_b16 v[26:27], v9 offset:12800
  s_waitcnt lgkmcnt(2)
  v_mfma_f32_16x16x32_bf16 v[64:67], v[16:19], v[160:163], v[64:67]
  ds_read_b64_tr_b16 v[28:29], v10 offset:8704
  ds_read_b64_tr_b16 v[30:31], v10 offset:12800
  v_mfma_f32_16x16x32_bf16 v[68:71], v[20:23], v[160:163], v[68:71]
  ds_read_b64_tr_b16 v[16:17], v9 offset:9216
  ds_read_b64_tr_b16 v[18:19], v9 offset:13312
  s_waitcnt lgkmcnt(2)
  v_mfma_f32_16x16x32_bf16 v[72:75], v[24:27], v[160:163], v[72:75]
  ds_read_b64_tr_b16 v[20:21], v10 offset:9216
  ds_read_b64_tr_b16 v[22:23], v10 offset:13312
  v_mfma_f32_16x16x32_bf16 v[76:79], v[28:31], v[160:163], v[76:79]
  ds_read_b64_tr_b16 v[24:25], v9 offset:9728
  ds_read_b64_tr_b16 v[26:27], v9 offset:13824
  s_waitcnt lgkmcnt(2)
  v_mfma_f32_16x16x32_bf16 v[80:83], v[16:19], v[160:163], v[80:83]
  ds_read_b64_tr_b16 v[28:29], v10 offset:9728
  ds_read_b64_tr_b16 v[30:31], v10 offset:13824
  v_mfma_f32_16x16x32_bf16 v[84:87], v[20:23], v[160:163], v[84:87]
  s_waitcnt lgkmcnt(0)
  v_mfma_f32_16x16x32_bf16 v[88:91], v[24:27], v[160:163], v[88:91]
  v_mfma_f32_16x16x32_bf16 v[92:95], v[28:31], v[160:163], v[92:95]
  s_waitcnt vmcnt(0)
  s_waitcnt lgkmcnt(0)
  s_barrier
  ds_read_b64_tr_b16 v[16:17], v9 offset:32768
  ds_read_b64_tr_b16 v[18:19], v9 offset:36864
  ds_read_b64_tr_b16 v[20:21], v10 offset:32768
  ds_read_b64_tr_b16 v[22:23], v10 offset:36864
  ds_read_b64_tr_b16 v[24:25], v9 offset:33280
  ds_read_b64_tr_b16 v[26:27], v9 offset:37376
  s_add_u32 s59, s45, 6
  s_and_b32 s59, s59, 7
  s_lshl_b32 s59, s59, 19
  s_add_u32 s59, s59, s54
  s_add_u32 s59, s59, 256
  s_add_u32 m0, s55, 155648
  s_nop 0
  buffer_load_dwordx4 v8, s[16:19], s59 offen lds
  s_add_u32 m0, s55, 156544
  s_nop 0
  buffer_load_dwordx4 v8, s[16:19], s59 offen offset:128 lds
  s_add_u32 s59, s45, 6
  s_and_b32 s59, s59, 7
  s_lshl_b32 s59, s59, 19
  s_add_u32 s59, s59, s54
  s_add_u32 s59, s59, 262400
  s_add_u32 m0, s55, 98304
  s_nop 0
  buffer_load_dwordx4 v8, s[16:19], s59 offen lds
  s_add_u32 m0, s55, 99200
  s_nop 0
  buffer_load_dwordx4 v8, s[16:19], s59 offen offset:128 lds
  s_add_u32 s59, s45, 7
  s_and_b32 s59, s59, 7
  s_lshl_b32 s59, s59, 19
  s_add_u32 s59, s59, s54
  s_add_u32 s59, s59, 256
  s_add_u32 m0, s55, 106496
  s_nop 0
  buffer_load_dwordx4 v8, s[16:19], s59 offen lds
  s_add_u32 m0, s55, 107392
  s_nop 0
  buffer_load_dwordx4 v8, s[16:19], s59 offen offset:128 lds
  s_waitcnt lgkmcnt(2)
  v_mfma_f32_16x16x32_bf16 v[64:67], v[16:19], v[164:167], v[64:67]
  ds_read_b64_tr_b16 v[28:29], v10 offset:33280
  ds_read_b64_tr_b16 v[30:31], v10 offset:37376
  v_mfma_f32_16x16x32_bf16 v[68:71], v[20:23], v[164:167], v[68:71]
  ds_read_b64_tr_b16 v[16:17], v9 offset:33792
  ds_read_b64_tr_b16 v[18:19], v9 offset:37888
  s_waitcnt lgkmcnt(2)
  v_mfma_f32_16x16x32_bf16 v[72:75], v[24:27], v[164:167], v[72:75]
  ds_read_b64_tr_b16 v[20:21], v10 offset:33792
  ds_read_b64_tr_b16 v[22:23], v10 offset:37888
  v_mfma_f32_16x16x32_bf16 v[76:79], v[28:31], v[164:167], v[76:79]
  ds_read_b64_tr_b16 v[24:25], v9 offset:34304
  ds_read_b64_tr_b16 v[26:27], v9 offset:38400
  s_waitcnt lgkmcnt(2)
  v_mfma_f32_16x16x32_bf16 v[80:83], v[16:19], v[164:167], v[80:83]
  ds_read_b64_tr_b16 v[28:29], v10 offset:34304
  ds_read_b64_tr_b16 v[30:31], v10 offset:38400
  v_mfma_f32_16x16x32_bf16 v[84:87], v[20:23], v[164:167], v[84:87]
  ds_read_b64_tr_b16 v[16:17], v9 offset:40960
  ds_read_b64_tr_b16 v[18:19], v9 offset:45056
  s_waitcnt lgkmcnt(2)
  v_mfma_f32_16x16x32_bf16 v[88:91], v[24:27], v[164:167], v[88:91]
  ds_read_b64_tr_b16 v[20:21], v10 offset:40960
  ds_read_b64_tr_b16 v[22:23], v10 offset:45056
  v_mfma_f32_16x16x32_bf16 v[92:95], v[28:31], v[164:167], v[92:95]
  ds_read_b64_tr_b16 v[24:25], v9 offset:41472
  ds_read_b64_tr_b16 v[26:27], v9 offset:45568
  s_waitcnt lgkmcnt(2)
  v_mfma_f32_16x16x32_bf16 v[64:67], v[16:19], v[168:171], v[64:67]
  ds_read_b64_tr_b16 v[28:29], v10 offset:41472
  ds_read_b64_tr_b16 v[30:31], v10 offset:45568
  v_mfma_f32_16x16x32_bf16 v[68:71], v[20:23], v[168:171], v[68:71]
  ds_read_b64_tr_b16 v[16:17], v9 offset:41984
  ds_read_b64_tr_b16 v[18:19], v9 offset:46080
  s_waitcnt lgkmcnt(2)
  v_mfma_f32_16x16x32_bf16 v[72:75], v[24:27], v[168:171], v[72:75]
  ds_read_b64_tr_b16 v[20:21], v10 offset:41984
  ds_read_b64_tr_b16 v[22:23], v10 offset:46080
  v_mfma_f32_16x16x32_bf16 v[76:79], v[28:31], v[168:171], v[76:79]
  ds_read_b64_tr_b16 v[24:25], v9 offset:42496
  ds_read_b64_tr_b16 v[26:27], v9 offset:46592
  s_waitcnt lgkmcnt(2)
  v_mfma_f32_16x16x32_bf16 v[80:83], v[16:19], v[168:171], v[80:83]
  ds_read_b64_tr_b16 v[28:29], v10 offset:42496
  ds_read_b64_tr_b16 v[30:31], v10 offset:46592
  v_mfma_f32_16x16x32_bf16 v[84:87], v[20:23], v[168:171], v[84:87]
  ds_read_b64_tr_b16 v[16:17], v9 offset:49152
  ds_read_b64_tr_b16 v[18:19], v9 offset:53248
  s_waitcnt lgkmcnt(2)
  v_mfma_f32_16x16x32_bf16 v[88:91], v[24:27], v[168:171], v[88:91]
  ds_read_b64_tr_b16 v[20:21], v10 offset:49152
  ds_read_b64_tr_b16 v[22:23], v10 offset:53248
  v_mfma_f32_16x16x32_bf16 v[92:95], v[28:31], v[168:171], v[92:95]
  ds_read_b64_tr_b16 v[24:25], v9 offset:49664
  ds_read_b64_tr_b16 v[26:27], v9 offset:53760
  s_waitcnt lgkmcnt(2)
  v_mfma_f32_16x16x32_bf16 v[64:67], v[16:19], v[172:175], v[64:67]
  ds_read_b64_tr_b16 v[28:29], v10 offset:49664
  ds_read_b64_tr_b16 v[30:31], v10 offset:53760
  v_mfma_f32_16x16x32_bf16 v[68:71], v[20:23], v[172:175], v[68:71]
  ds_read_b64_tr_b16 v[16:17], v9 offset:50176
  ds_read_b64_tr_b16 v[18:19], v9 offset:54272
  s_waitcnt lgkmcnt(2)
  v_mfma_f32_16x16x32_bf16 v[72:75], v[24:27], v[172:175], v[72:75]
  ds_read_b64_tr_b16 v[20:21], v10 offset:50176
  ds_read_b64_tr_b16 v[22:23], v10 offset:54272
  v_mfma_f32_16x16x32_bf16 v[76:79], v[28:31], v[172:175], v[76:79]
  ds_read_b64_tr_b16 v[24:25], v9 offset:50688
  ds_read_b64_tr_b16 v[26:27], v9 offset:54784
  s_waitcnt lgkmcnt(2)
  v_mfma_f32_16x16x32_bf16 v[80:83], v[16:19], v[172:175], v[80:83]
  ds_read_b64_tr_b16 v[28:29], v10 offset:50688
  ds_read_b64_tr_b16 v[30:31], v10 offset:54784
  v_mfma_f32_16x16x32_bf16 v[84:87], v[20:23], v[172:175], v[84:87]
  s_waitcnt lgkmcnt(0)
  v_mfma_f32_16x16x32_bf16 v[88:91], v[24:27], v[172:175], v[88:91]
  v_mfma_f32_16x16x32_bf16 v[92:95], v[28:31], v[172:175], v[92:95]
  s_waitcnt vmcnt(0)
  s_waitcnt lgkmcnt(0)
  s_barrier
  ds_read_b64_tr_b16 v[16:17], v9 offset:57344
  ds_read_b64_tr_b16 v[18:19], v9 offset:61440
  ds_read_b64_tr_b16 v[20:21], v10 offset:57344
  ds_read_b64_tr_b16 v[22:23], v10 offset:61440
  ds_read_b64_tr_b16 v[24:25], v9 offset:57856
  ds_read_b64_tr_b16 v[26:27], v9 offset:61952
  s_add_u32 s59, s45, 7
  s_and_b32 s59, s59, 7
  s_lshl_b32 s59, s59, 19
  s_add_u32 s59, s59, s54
  s_add_u32 s59, s59, 262400
  s_add_u32 m0, s55, 131072
  s_nop 0
  buffer_load_dwordx4 v8, s[16:19], s59 offen lds
  s_add_u32 m0, s55, 131968
  s_nop 0
  buffer_load_dwordx4 v8, s[16:19], s59 offen offset:128 lds
  s_add_u32 s59, s45, 0
  s_and_b32 s59, s59, 7
  s_lshl_b32 s59, s59, 19
  s_add_u32 s59, s59, s54
  s_add_u32 s59, s59, 512
  s_add_u32 m0, s55, 139264
  s_nop 0
  buffer_load_dwordx4 v8, s[16:19], s59 offen lds
  s_add_u32 m0, s55, 140160
  s_nop 0
  buffer_load_dwordx4 v8, s[16:19], s59 offen offset:128 lds
  s_add_u32 s59, s45, 0
  s_and_b32 s59, s59, 7
  s_lshl_b32 s59, s59, 19
  s_add_u32 s59, s59, s54
  s_add_u32 s59, s59, 262656
  s_add_u32 m0, s55, 147456
  s_nop 0
  buffer_load_dwordx4 v8, s[16:19], s59 offen lds
  s_add_u32 m0, s55, 148352
  s_nop 0
  buffer_load_dwordx4 v8, s[16:19], s59 offen offset:128 lds
  s_waitcnt lgkmcnt(2)
  v_mfma_f32_16x16x32_bf16 v[64:67], v[16:19], v[176:179], v[64:67]
  ds_read_b64_tr_b16 v[28:29], v10 offset:57856
  ds_read_b64_tr_b16 v[30:31], v10 offset:61952
  v_mfma_f32_16x16x32_bf16 v[68:71], v[20:23], v[176:179], v[68:71]
  ds_read_b64_tr_b16 v[16:17], v9 offset:58368
  ds_read_b64_tr_b16 v[18:19], v9 offset:62464
  s_waitcnt lgkmcnt(2)
  v_mfma_f32_16x16x32_bf16 v[72:75], v[24:27], v[176:179], v[72:75]
  ds_read_b64_tr_b16 v[20:21], v10 offset:58368
  ds_read_b64_tr_b16 v[22:23], v10 offset:62464
  v_mfma_f32_16x16x32_bf16 v[76:79], v[28:31], v[176:179], v[76:79]
  ds_read_b64_tr_b16 v[24:25], v9 offset:58880
  ds_read_b64_tr_b16 v[26:27], v9 offset:62976
  s_waitcnt lgkmcnt(2)
  v_mfma_f32_16x16x32_bf16 v[80:83], v[16:19], v[176:179], v[80:83]
  ds_read_b64_tr_b16 v[28:29], v10 offset:58880
  ds_read_b64_tr_b16 v[30:31], v10 offset:62976
  v_mfma_f32_16x16x32_bf16 v[84:87], v[20:23], v[176:179], v[84:87]
  ds_read_b64_tr_b16 v[16:17], v9 offset:0
  ds_read_b64_tr_b16 v[18:19], v9 offset:4096
  s_waitcnt lgkmcnt(2)
  v_mfma_f32_16x16x32_bf16 v[88:91], v[24:27], v[176:179], v[88:91]
  ds_read_b64_tr_b16 v[20:21], v10 offset:0
  ds_read_b64_tr_b16 v[22:23], v10 offset:4096
  v_mfma_f32_16x16x32_bf16 v[92:95], v[28:31], v[176:179], v[92:95]
  ds_read_b64_tr_b16 v[24:25], v9 offset:512
  ds_read_b64_tr_b16 v[26:27], v9 offset:4608
  s_waitcnt lgkmcnt(2)
  v_mfma_f32_16x16x32_bf16 v[64:67], v[16:19], v[180:183], v[64:67]
  ds_read_b64_tr_b16 v[28:29], v10 offset:512
  ds_read_b64_tr_b16 v[30:31], v10 offset:4608
  v_mfma_f32_16x16x32_bf16 v[68:71], v[20:23], v[180:183], v[68:71]
  ds_read_b64_tr_b16 v[16:17], v9 offset:1024
  ds_read_b64_tr_b16 v[18:19], v9 offset:5120
  s_waitcnt lgkmcnt(2)
  v_mfma_f32_16x16x32_bf16 v[72:75], v[24:27], v[180:183], v[72:75]
  ds_read_b64_tr_b16 v[20:21], v10 offset:1024
  ds_read_b64_tr_b16 v[22:23], v10 offset:5120
  v_mfma_f32_16x16x32_bf16 v[76:79], v[28:31], v[180:183], v[76:79]
  ds_read_b64_tr_b16 v[24:25], v9 offset:1536
  ds_read_b64_tr_b16 v[26:27], v9 offset:5632
  s_waitcnt lgkmcnt(2)
  v_mfma_f32_16x16x32_bf16 v[80:83], v[16:19], v[180:183], v[80:83]
  ds_read_b64_tr_b16 v[28:29], v10 offset:1536
  ds_read_b64_tr_b16 v[30:31], v10 offset:5632
  v_mfma_f32_16x16x32_bf16 v[84:87], v[20:23], v[180:183], v[84:87]
  ds_read_b64_tr_b16 v[16:17], v9 offset:8192
  ds_read_b64_tr_b16 v[18:19], v9 offset:12288
  s_waitcnt lgkmcnt(2)
  v_mfma_f32_16x16x32_bf16 v[88:91], v[24:27], v[180:183], v[88:91]
  ds_read_b64_tr_b16 v[20:21], v10 offset:8192
  ds_read_b64_tr_b16 v[22:23], v10 offset:12288
  v_mfma_f32_16x16x32_bf16 v[92:95], v[28:31], v[180:183], v[92:95]
  ds_read_b64_tr_b16 v[24:25], v9 offset:8704
  ds_read_b64_tr_b16 v[26:27], v9 offset:12800
  s_waitcnt lgkmcnt(2)
  v_mfma_f32_16x16x32_bf16 v[64:67], v[16:19], v[184:187], v[64:67]
  ds_read_b64_tr_b16 v[28:29], v10 offset:8704
  ds_read_b64_tr_b16 v[30:31], v10 offset:12800
  v_mfma_f32_16x16x32_bf16 v[68:71], v[20:23], v[184:187], v[68:71]
  ds_read_b64_tr_b16 v[16:17], v9 offset:9216
  ds_read_b64_tr_b16 v[18:19], v9 offset:13312
  s_waitcnt lgkmcnt(2)
  v_mfma_f32_16x16x32_bf16 v[72:75], v[24:27], v[184:187], v[72:75]
  ds_read_b64_tr_b16 v[20:21], v10 offset:9216
  ds_read_b64_tr_b16 v[22:23], v10 offset:13312
  v_mfma_f32_16x16x32_bf16 v[76:79], v[28:31], v[184:187], v[76:79]
  ds_read_b64_tr_b16 v[24:25], v9 offset:9728
  ds_read_b64_tr_b16 v[26:27], v9 offset:13824
  s_waitcnt lgkmcnt(2)
  v_mfma_f32_16x16x32_bf16 v[80:83], v[16:19], v[184:187], v[80:83]
  ds_read_b64_tr_b16 v[28:29], v10 offset:9728
  ds_read_b64_tr_b16 v[30:31], v10 offset:13824
  v_mfma_f32_16x16x32_bf16 v[84:87], v[20:23], v[184:187], v[84:87]
  s_waitcnt lgkmcnt(0)
  v_mfma_f32_16x16x32_bf16 v[88:91], v[24:27], v[184:187], v[88:91]
  v_mfma_f32_16x16x32_bf16 v[92:95], v[28:31], v[184:187], v[92:95]
  s_waitcnt vmcnt(0)
  s_waitcnt lgkmcnt(0)
  s_barrier
  ds_read_b64_tr_b16 v[16:17], v9 offset:32768
  ds_read_b64_tr_b16 v[18:19], v9 offset:36864
  ds_read_b64_tr_b16 v[20:21], v10 offset:32768
  ds_read_b64_tr_b16 v[22:23], v10 offset:36864
  ds_read_b64_tr_b16 v[24:25], v9 offset:33280
  ds_read_b64_tr_b16 v[26:27], v9 offset:37376
  s_add_u32 s59, s45, 1
  s_and_b32 s59, s59, 7
  s_lshl_b32 s59, s59, 19
  s_add_u32 s59, s59, s54
  s_add_u32 s59, s59, 512
  s_add_u32 m0, s55, 155648
  s_nop 0
  buffer_load_dwordx4 v8, s[16:19], s59 offen lds
  s_add_u32 m0, s55, 156544
  s_nop 0
  buffer_load_dwordx4 v8, s[16:19], s59 offen offset:128 lds
  s_add_u32 s59, s45, 1
  s_and_b32 s59, s59, 7
  s_lshl_b32 s59, s59, 19
  s_add_u32 s59, s59, s54
  s_add_u32 s59, s59, 262656
  s_add_u32 m0, s55, 98304
  s_nop 0
  buffer_load_dwordx4 v8, s[16:19], s59 offen lds
  s_add_u32 m0, s55, 99200
  s_nop 0
  buffer_load_dwordx4 v8, s[16:19], s59 offen offset:128 lds
  s_add_u32 s59, s45, 2
  s_and_b32 s59, s59, 7
  s_lshl_b32 s59, s59, 19
  s_add_u32 s59, s59, s54
  s_add_u32 s59, s59, 512
  s_add_u32 m0, s55, 106496
  s_nop 0
  buffer_load_dwordx4 v8, s[16:19], s59 offen lds
  s_add_u32 m0, s55, 107392
  s_nop 0
  buffer_load_dwordx4 v8, s[16:19], s59 offen offset:128 lds
  s_waitcnt lgkmcnt(2)
  v_mfma_f32_16x16x32_bf16 v[64:67], v[16:19], v[188:191], v[64:67]
  ds_read_b64_tr_b16 v[28:29], v10 offset:33280
  ds_read_b64_tr_b16 v[30:31], v10 offset:37376
  v_mfma_f32_16x16x32_bf16 v[68:71], v[20:23], v[188:191], v[68:71]
  ds_read_b64_tr_b16 v[16:17], v9 offset:33792
  ds_read_b64_tr_b16 v[18:19], v9 offset:37888
  s_waitcnt lgkmcnt(2)
  v_mfma_f32_16x16x32_bf16 v[72:75], v[24:27], v[188:191], v[72:75]
  ds_read_b64_tr_b16 v[20:21], v10 offset:33792
  ds_read_b64_tr_b16 v[22:23], v10 offset:37888
  v_mfma_f32_16x16x32_bf16 v[76:79], v[28:31], v[188:191], v[76:79]
  ds_read_b64_tr_b16 v[24:25], v9 offset:34304
  ds_read_b64_tr_b16 v[26:27], v9 offset:38400
  s_waitcnt lgkmcnt(2)
  v_mfma_f32_16x16x32_bf16 v[80:83], v[16:19], v[188:191], v[80:83]
  ds_read_b64_tr_b16 v[28:29], v10 offset:34304
  ds_read_b64_tr_b16 v[30:31], v10 offset:38400
  v_mfma_f32_16x16x32_bf16 v[84:87], v[20:23], v[188:191], v[84:87]
  ds_read_b64_tr_b16 v[16:17], v9 offset:40960
  ds_read_b64_tr_b16 v[18:19], v9 offset:45056
  s_waitcnt lgkmcnt(2)
  v_mfma_f32_16x16x32_bf16 v[88:91], v[24:27], v[188:191], v[88:91]
  ds_read_b64_tr_b16 v[20:21], v10 offset:40960
  ds_read_b64_tr_b16 v[22:23], v10 offset:45056
  v_mfma_f32_16x16x32_bf16 v[92:95], v[28:31], v[188:191], v[92:95]
  ds_read_b64_tr_b16 v[24:25], v9 offset:41472
  ds_read_b64_tr_b16 v[26:27], v9 offset:45568
  v_mul_f32 v64, s50, v64
  v_mul_f32 v65, s50, v65
  v_mul_f32 v66, s50, v66
  v_mul_f32 v67, s50, v67
  v_cvt_pk_bf16_f32 v32, v64, v65
  v_cvt_pk_bf16_f32 v33, v66, v67
  s_waitcnt lgkmcnt(2)
  v_mfma_f32_16x16x32_bf16 v[64:67], v[16:19], v[128:131], 0
  ds_read_b64_tr_b16 v[28:29], v10 offset:41472
  ds_read_b64_tr_b16 v[30:31], v10 offset:45568
  v_mul_f32 v68, s50, v68
  v_mul_f32 v69, s50, v69
  v_mul_f32 v70, s50, v70
  v_mul_f32 v71, s50, v71
  v_cvt_pk_bf16_f32 v34, v68, v69
  v_cvt_pk_bf16_f32 v35, v70, v71
  s_nop 0
  v_permlane16_swap_b32 v32, v34
  v_permlane16_swap_b32 v33, v35
  v_mfma_f32_16x16x32_bf16 v[68:71], v[20:23], v[128:131], 0
  ds_read_b64_tr_b16 v[16:17], v9 offset:41984
  ds_read_b64_tr_b16 v[18:19], v9 offset:46080
  v_mul_f32 v72, s50, v72
  v_mul_f32 v73, s50, v73
  v_mul_f32 v74, s50, v74
  v_mul_f32 v75, s50, v75
  v_cvt_pk_bf16_f32 v36, v72, v73
  v_cvt_pk_bf16_f32 v37, v74, v75
  s_waitcnt lgkmcnt(2)
  v_mfma_f32_16x16x32_bf16 v[72:75], v[24:27], v[128:131], 0
  ds_read_b64_tr_b16 v[20:21], v10 offset:41984
  ds_read_b64_tr_b16 v[22:23], v10 offset:46080
  v_mul_f32 v76, s50, v76
  v_mul_f32 v77, s50, v77
  v_mul_f32 v78, s50, v78
  v_mul_f32 v79, s50, v79
  v_cvt_pk_bf16_f32 v38, v76, v77
  v_cvt_pk_bf16_f32 v39, v78, v79
  s_nop 0
  v_permlane16_swap_b32 v36, v38
  v_permlane16_swap_b32 v37, v39
  v_mfma_f32_16x16x32_bf16 v[76:79], v[28:31], v[128:131], 0
  ds_read_b64_tr_b16 v[24:25], v9 offset:42496
  ds_read_b64_tr_b16 v[26:27], v9 offset:46592
  v_mul_f32 v80, s50, v80
  v_mul_f32 v81, s50, v81
  v_mul_f32 v82, s50, v82
  v_mul_f32 v83, s50, v83
  v_cvt_pk_bf16_f32 v40, v80, v81
  v_cvt_pk_bf16_f32 v41, v82, v83
  s_waitcnt lgkmcnt(2)
  v_mfma_f32_16x16x32_bf16 v[80:83], v[16:19], v[128:131], 0
  ds_read_b64_tr_b16 v[28:29], v10 offset:42496
  ds_read_b64_tr_b16 v[30:31], v10 offset:46592
  v_mul_f32 v84, s50, v84
  v_mul_f32 v85, s50, v85
  v_mul_f32 v86, s50, v86
  v_mul_f32 v87, s50, v87
  v_cvt_pk_bf16_f32 v42, v84, v85
  v_cvt_pk_bf16_f32 v43, v86, v87
  s_nop 0
  v_permlane16_swap_b32 v40, v42
  v_permlane16_swap_b32 v41, v43
  v_mfma_f32_16x16x32_bf16 v[84:87], v[20:23], v[128:131], 0
  ds_read_b64_tr_b16 v[16:17], v9 offset:49152
  ds_read_b64_tr_b16 v[18:19], v9 offset:53248
  v_mul_f32 v88, s50, v88
  v_mul_f32 v89, s50, v89
  v_mul_f32 v90, s50, v90
  v_mul_f32 v91, s50, v91
  v_cvt_pk_bf16_f32 v44, v88, v89
  v_cvt_pk_bf16_f32 v45, v90, v91
  s_waitcnt lgkmcnt(2)
  v_mfma_f32_16x16x32_bf16 v[88:91], v[24:27], v[128:131], 0
  ds_read_b64_tr_b16 v[20:21], v10 offset:49152
  ds_read_b64_tr_b16 v[22:23], v10 offset:53248
  v_mul_f32 v92, s50, v92
  v_mul_f32 v93, s50, v93
  v_mul_f32 v94, s50, v94
  v_mul_f32 v95, s50, v95
  v_cvt_pk_bf16_f32 v46, v92, v93
  v_cvt_pk_bf16_f32 v47, v94, v95
  s_nop 0
  v_permlane16_swap_b32 v44, v46
  v_permlane16_swap_b32 v45, v47
  v_mfma_f32_16x16x32_bf16 v[92:95], v[28:31], v[128:131], 0
  ds_read_b64_tr_b16 v[24:25], v9 offset:49664
  ds_read_b64_tr_b16 v[26:27], v9 offset:53760
  s_waitcnt lgkmcnt(2)
  v_mfma_f32_16x16x32_bf16 v[64:67], v[16:19], v[132:135], v[64:67]
  ds_read_b64_tr_b16 v[28:29], v10 offset:49664
  ds_read_b64_tr_b16 v[30:31], v10 offset:53760
  v_mfma_f32_16x16x32_bf16 v[68:71], v[20:23], v[132:135], v[68:71]
  ds_read_b64_tr_b16 v[16:17], v9 offset:50176
  ds_read_b64_tr_b16 v[18:19], v9 offset:54272
  s_waitcnt lgkmcnt(2)
  v_mfma_f32_16x16x32_bf16 v[72:75], v[24:27], v[132:135], v[72:75]
  ds_read_b64_tr_b16 v[20:21], v10 offset:50176
  ds_read_b64_tr_b16 v[22:23], v10 offset:54272
  v_mfma_f32_16x16x32_bf16 v[76:79], v[28:31], v[132:135], v[76:79]
  ds_read_b64_tr_b16 v[24:25], v9 offset:50688
  ds_read_b64_tr_b16 v[26:27], v9 offset:54784
  s_waitcnt lgkmcnt(2)
  v_mfma_f32_16x16x32_bf16 v[80:83], v[16:19], v[132:135], v[80:83]
  ds_read_b64_tr_b16 v[28:29], v10 offset:50688
  ds_read_b64_tr_b16 v[30:31], v10 offset:54784
  v_mfma_f32_16x16x32_bf16 v[84:87], v[20:23], v[132:135], v[84:87]
  s_waitcnt lgkmcnt(0)
  v_mfma_f32_16x16x32_bf16 v[88:91], v[24:27], v[132:135], v[88:91]
  v_mfma_f32_16x16x32_bf16 v[92:95], v[28:31], v[132:135], v[92:95]
  s_waitcnt vmcnt(0)
  s_waitcnt lgkmcnt(0)
  s_barrier
  ds_read_b64_tr_b16 v[16:17], v9 offset:57344
  ds_read_b64_tr_b16 v[18:19], v9 offset:61440
  ds_read_b64_tr_b16 v[20:21], v10 offset:57344
  ds_read_b64_tr_b16 v[22:23], v10 offset:61440
  ds_read_b64_tr_b16 v[24:25], v9 offset:57856
  ds_read_b64_tr_b16 v[26:27], v9 offset:61952
  s_add_u32 s59, s45, 2
  s_and_b32 s59, s59, 7
  s_lshl_b32 s59, s59, 19
  s_add_u32 s59, s59, s54
  s_add_u32 s59, s59, 262656
  s_add_u32 m0, s55, 114688
  s_nop 0
  buffer_load_dwordx4 v8, s[16:19], s59 offen lds
  s_add_u32 m0, s55, 115584
  s_nop 0
  buffer_load_dwordx4 v8, s[16:19], s59 offen offset:128 lds
  s_add_u32 s59, s45, 3
  s_and_b32 s59, s59, 7
  s_lshl_b32 s59, s59, 19
  s_add_u32 s59, s59, s54
  s_add_u32 s59, s59, 512
  s_add_u32 m0, s55, 122880
  s_nop 0
  buffer_load_dwordx4 v8, s[16:19], s59 offen lds
  s_add_u32 m0, s55, 123776
  s_nop 0
  buffer_load_dwordx4 v8, s[16:19], s59 offen offset:128 lds
  s_waitcnt lgkmcnt(2)
  v_mfma_f32_16x16x32_bf16 v[64:67], v[16:19], v[136:139], v[64:67]
  ds_read_b64_tr_b16 v[28:29], v10 offset:57856
  ds_read_b64_tr_b16 v[30:31], v10 offset:61952
  v_mfma_f32_16x16x32_bf16 v[68:71], v[20:23], v[136:139], v[68:71]
  ds_read_b64_tr_b16 v[16:17], v9 offset:58368
  ds_read_b64_tr_b16 v[18:19], v9 offset:62464
  s_waitcnt lgkmcnt(2)
  v_mfma_f32_16x16x32_bf16 v[72:75], v[24:27], v[136:139], v[72:75]
  ds_read_b64_tr_b16 v[20:21], v10 offset:58368
  ds_read_b64_tr_b16 v[22:23], v10 offset:62464
  v_mfma_f32_16x16x32_bf16 v[76:79], v[28:31], v[136:139], v[76:79]
  ds_read_b64_tr_b16 v[24:25], v9 offset:58880
  ds_read_b64_tr_b16 v[26:27], v9 offset:62976
  s_waitcnt lgkmcnt(2)
  v_mfma_f32_16x16x32_bf16 v[80:83], v[16:19], v[136:139], v[80:83]
  ds_read_b64_tr_b16 v[28:29], v10 offset:58880
  ds_read_b64_tr_b16 v[30:31], v10 offset:62976
  v_mfma_f32_16x16x32_bf16 v[84:87], v[20:23], v[136:139], v[84:87]
  ds_read_b64_tr_b16 v[16:17], v9 offset:0
  ds_read_b64_tr_b16 v[18:19], v9 offset:4096
  s_waitcnt lgkmcnt(2)
  v_mfma_f32_16x16x32_bf16 v[88:91], v[24:27], v[136:139], v[88:91]
  ds_read_b64_tr_b16 v[20:21], v10 offset:0
  ds_read_b64_tr_b16 v[22:23], v10 offset:4096
  v_mfma_f32_16x16x32_bf16 v[92:95], v[28:31], v[136:139], v[92:95]
  ds_read_b64_tr_b16 v[24:25], v9 offset:512
  ds_read_b64_tr_b16 v[26:27], v9 offset:4608
  s_waitcnt lgkmcnt(2)
  v_mfma_f32_16x16x32_bf16 v[64:67], v[16:19], v[140:143], v[64:67]
  ds_read_b64_tr_b16 v[28:29], v10 offset:512
  ds_read_b64_tr_b16 v[30:31], v10 offset:4608
  v_mfma_f32_16x16x32_bf16 v[68:71], v[20:23], v[140:143], v[68:71]
  ds_read_b64_tr_b16 v[16:17], v9 offset:1024
  ds_read_b64_tr_b16 v[18:19], v9 offset:5120
  s_waitcnt lgkmcnt(2)
  v_mfma_f32_16x16x32_bf16 v[72:75], v[24:27], v[140:143], v[72:75]
  ds_read_b64_tr_b16 v[20:21], v10 offset:1024
  ds_read_b64_tr_b16 v[22:23], v10 offset:5120
  v_mfma_f32_16x16x32_bf16 v[76:79], v[28:31], v[140:143], v[76:79]
  ds_read_b64_tr_b16 v[24:25], v9 offset:1536
  ds_read_b64_tr_b16 v[26:27], v9 offset:5632
  s_waitcnt lgkmcnt(2)
  v_mfma_f32_16x16x32_bf16 v[80:83], v[16:19], v[140:143], v[80:83]
  ds_read_b64_tr_b16 v[28:29], v10 offset:1536
  ds_read_b64_tr_b16 v[30:31], v10 offset:5632
  v_mfma_f32_16x16x32_bf16 v[84:87], v[20:23], v[140:143], v[84:87]
  ds_read_b64_tr_b16 v[16:17], v9 offset:8192
  ds_read_b64_tr_b16 v[18:19], v9 offset:12288
  s_waitcnt lgkmcnt(2)
  v_mfma_f32_16x16x32_bf16 v[88:91], v[24:27], v[140:143], v[88:91]
  ds_read_b64_tr_b16 v[20:21], v10 offset:8192
  ds_read_b64_tr_b16 v[22:23], v10 offset:12288
  v_mfma_f32_16x16x32_bf16 v[92:95], v[28:31], v[140:143], v[92:95]
  ds_read_b64_tr_b16 v[24:25], v9 offset:8704
  ds_read_b64_tr_b16 v[26:27], v9 offset:12800
  s_waitcnt lgkmcnt(2)
  v_mfma_f32_16x16x32_bf16 v[64:67], v[16:19], v[144:147], v[64:67]
  ds_read_b64_tr_b16 v[28:29], v10 offset:8704
  ds_read_b64_tr_b16 v[30:31], v10 offset:12800
  v_mfma_f32_16x16x32_bf16 v[68:71], v[20:23], v[144:147], v[68:71]
  ds_read_b64_tr_b16 v[16:17], v9 offset:9216
  ds_read_b64_tr_b16 v[18:19], v9 offset:13312
  s_waitcnt lgkmcnt(2)
  v_mfma_f32_16x16x32_bf16 v[72:75], v[24:27], v[144:147], v[72:75]
  ds_read_b64_tr_b16 v[20:21], v10 offset:9216
  ds_read_b64_tr_b16 v[22:23], v10 offset:13312
  v_mfma_f32_16x16x32_bf16 v[76:79], v[28:31], v[144:147], v[76:79]
  ds_read_b64_tr_b16 v[24:25], v9 offset:9728
  ds_read_b64_tr_b16 v[26:27], v9 offset:13824
  s_waitcnt lgkmcnt(2)
  v_mfma_f32_16x16x32_bf16 v[80:83], v[16:19], v[144:147], v[80:83]
  ds_read_b64_tr_b16 v[28:29], v10 offset:9728
  ds_read_b64_tr_b16 v[30:31], v10 offset:13824
  v_mfma_f32_16x16x32_bf16 v[84:87], v[20:23], v[144:147], v[84:87]
  s_waitcnt lgkmcnt(0)
  v_mfma_f32_16x16x32_bf16 v[88:91], v[24:27], v[144:147], v[88:91]
  v_mfma_f32_16x16x32_bf16 v[92:95], v[28:31], v[144:147], v[92:95]
  s_waitcnt vmcnt(0)
  s_waitcnt lgkmcnt(0)
  s_barrier
  ds_read_b64_tr_b16 v[16:17], v9 offset:16384
  ds_read_b64_tr_b16 v[18:19], v9 offset:20480
  ds_read_b64_tr_b16 v[20:21], v10 offset:16384
  ds_read_b64_tr_b16 v[22:23], v10 offset:20480
  ds_read_b64_tr_b16 v[24:25], v9 offset:16896
  ds_read_b64_tr_b16 v[26:27], v9 offset:20992
  s_add_u32 s59, s45, 3
  s_and_b32 s59, s59, 7
  s_lshl_b32 s59, s59, 19
  s_add_u32 s59, s59, s54
  s_add_u32 s59, s59, 262656
  s_add_u32 m0, s55, 98304
  s_nop 0
  buffer_load_dwordx4 v8, s[16:19], s59 offen lds
  s_add_u32 m0, s55, 99200
  s_nop 0
  buffer_load_dwordx4 v8, s[16:19], s59 offen offset:128 lds
  s_add_u32 s59, s45, 4
  s_and_b32 s59, s59, 7
  s_lshl_b32 s59, s59, 19
  s_add_u32 s59, s59, s54
  s_add_u32 s59, s59, 512
  s_add_u32 m0, s55, 106496
  s_nop 0
  buffer_load_dwordx4 v8, s[16:19], s59 offen lds
  s_add_u32 m0, s55, 107392
  s_nop 0
  buffer_load_dwordx4 v8, s[16:19], s59 offen offset:128 lds
  s_waitcnt lgkmcnt(2)
  v_mfma_f32_16x16x32_bf16 v[64:67], v[16:19], v[148:151], v[64:67]
  ds_read_b64_tr_b16 v[28:29], v10 offset:16896
  ds_read_b64_tr_b16 v[30:31], v10 offset:20992
  v_add_u32 v13, 131072, v11
  ds_write_b128 v13, v[32:35] offset:0
  v_mfma_f32_16x16x32_bf16 v[68:71], v[20:23], v[148:151], v[68:71]
  ds_read_b64_tr_b16 v[16:17], v9 offset:17408
  ds_read_b64_tr_b16 v[18:19], v9 offset:21504
  s_waitcnt lgkmcnt(3)
  v_mfma_f32_16x16x32_bf16 v[72:75], v[24:27], v[148:151], v[72:75]
  ds_read_b64_tr_b16 v[20:21], v10 offset:17408
  ds_read_b64_tr_b16 v[22:23], v10 offset:21504
  v_mfma_f32_16x16x32_bf16 v[76:79], v[28:31], v[148:151], v[76:79]
  ds_read_b64_tr_b16 v[24:25], v9 offset:17920
  ds_read_b64_tr_b16 v[26:27], v9 offset:22016
  s_waitcnt lgkmcnt(2)
  v_mfma_f32_16x16x32_bf16 v[80:83], v[16:19], v[148:151], v[80:83]
  ds_read_b64_tr_b16 v[28:29], v10 offset:17920
  ds_read_b64_tr_b16 v[30:31], v10 offset:22016
  ds_write_b128 v13, v[36:39] offset:1024
  v_mfma_f32_16x16x32_bf16 v[84:87], v[20:23], v[148:151], v[84:87]
  ds_read_b64_tr_b16 v[16:17], v9 offset:24576
  ds_read_b64_tr_b16 v[18:19], v9 offset:28672
  s_waitcnt lgkmcnt(3)
  v_mfma_f32_16x16x32_bf16 v[88:91], v[24:27], v[148:151], v[88:91]
  ds_read_b64_tr_b16 v[20:21], v10 offset:24576
  ds_read_b64_tr_b16 v[22:23], v10 offset:28672
  v_mfma_f32_16x16x32_bf16 v[92:95], v[28:31], v[148:151], v[92:95]
  ds_read_b64_tr_b16 v[24:25], v9 offset:25088
  ds_read_b64_tr_b16 v[26:27], v9 offset:29184
  s_waitcnt lgkmcnt(2)
  v_mfma_f32_16x16x32_bf16 v[64:67], v[16:19], v[152:155], v[64:67]
  ds_read_b64_tr_b16 v[28:29], v10 offset:25088
  ds_read_b64_tr_b16 v[30:31], v10 offset:29184
  ds_write_b128 v13, v[40:43] offset:2048
  v_mfma_f32_16x16x32_bf16 v[68:71], v[20:23], v[152:155], v[68:71]
  ds_read_b64_tr_b16 v[16:17], v9 offset:25600
  ds_read_b64_tr_b16 v[18:19], v9 offset:29696
  s_waitcnt lgkmcnt(3)
  v_mfma_f32_16x16x32_bf16 v[72:75], v[24:27], v[152:155], v[72:75]
  ds_read_b64_tr_b16 v[20:21], v10 offset:25600
  ds_read_b64_tr_b16 v[22:23], v10 offset:29696
  v_mfma_f32_16x16x32_bf16 v[76:79], v[28:31], v[152:155], v[76:79]
  ds_read_b64_tr_b16 v[24:25], v9 offset:26112
  ds_read_b64_tr_b16 v[26:27], v9 offset:30208
  s_waitcnt lgkmcnt(2)
  v_mfma_f32_16x16x32_bf16 v[80:83], v[16:19], v[152:155], v[80:83]
  ds_read_b64_tr_b16 v[28:29], v10 offset:26112
  ds_read_b64_tr_b16 v[30:31], v10 offset:30208
  ds_write_b128 v13, v[44:47] offset:3072
  v_mfma_f32_16x16x32_bf16 v[84:87], v[20:23], v[152:155], v[84:87]
  s_waitcnt lgkmcnt(1)
  v_mfma_f32_16x16x32_bf16 v[88:91], v[24:27], v[152:155], v[88:91]
  v_mfma_f32_16x16x32_bf16 v[92:95], v[28:31], v[152:155], v[92:95]
  s_waitcnt vmcnt(0)
  s_waitcnt lgkmcnt(0)
  s_barrier
  ds_read_b64_tr_b16 v[16:17], v9 offset:0
  ds_read_b64_tr_b16 v[18:19], v9 offset:4096
  ds_read_b64_tr_b16 v[20:21], v10 offset:0
  ds_read_b64_tr_b16 v[22:23], v10 offset:4096
  ds_read_b64_tr_b16 v[24:25], v9 offset:512
  ds_read_b64_tr_b16 v[26:27], v9 offset:4608
  s_add_u32 s59, s45, 4
  s_and_b32 s59, s59, 7
  s_lshl_b32 s59, s59, 19
  s_add_u32 s59, s59, s54
  s_add_u32 s59, s59, 262656
  s_add_u32 m0, s55, 114688
  s_nop 0
  buffer_load_dwordx4 v8, s[16:19], s59 offen lds
  s_add_u32 m0, s55, 115584
  s_nop 0
  buffer_load_dwordx4 v8, s[16:19], s59 offen offset:128 lds
  s_add_u32 s59, s45, 5
  s_and_b32 s59, s59, 7
  s_lshl_b32 s59, s59, 19
  s_add_u32 s59, s59, s54
  s_add_u32 s59, s59, 512
  s_add_u32 m0, s55, 122880
  s_nop 0
  buffer_load_dwordx4 v8, s[16:19], s59 offen lds
  s_add_u32 m0, s55, 123776
  s_nop 0
  buffer_load_dwordx4 v8, s[16:19], s59 offen offset:128 lds
  s_waitcnt lgkmcnt(2)
  v_mfma_f32_16x16x32_bf16 v[64:67], v[16:19], v[156:159], v[64:67]
  ds_read_b64_tr_b16 v[28:29], v10 offset:512
  ds_read_b64_tr_b16 v[30:31], v10 offset:4608
  v_mfma_f32_16x16x32_bf16 v[68:71], v[20:23], v[156:159], v[68:71]
  ds_read_b64_tr_b16 v[16:17], v9 offset:1024
  ds_read_b64_tr_b16 v[18:19], v9 offset:5120
  s_waitcnt lgkmcnt(2)
  v_mfma_f32_16x16x32_bf16 v[72:75], v[24:27], v[156:159], v[72:75]
  ds_read_b64_tr_b16 v[20:21], v10 offset:1024
  ds_read_b64_tr_b16 v[22:23], v10 offset:5120
  v_mfma_f32_16x16x32_bf16 v[76:79], v[28:31], v[156:159], v[76:79]
  ds_read_b64_tr_b16 v[24:25], v9 offset:1536
  ds_read_b64_tr_b16 v[26:27], v9 offset:5632
  s_waitcnt lgkmcnt(2)
  v_mfma_f32_16x16x32_bf16 v[80:83], v[16:19], v[156:159], v[80:83]
  ds_read_b64_tr_b16 v[28:29], v10 offset:1536
  ds_read_b64_tr_b16 v[30:31], v10 offset:5632
  v_mfma_f32_16x16x32_bf16 v[84:87], v[20:23], v[156:159], v[84:87]
  ds_read_b64_tr_b16 v[16:17], v9 offset:8192
  ds_read_b64_tr_b16 v[18:19], v9 offset:12288
  s_waitcnt lgkmcnt(2)
  v_mfma_f32_16x16x32_bf16 v[88:91], v[24:27], v[156:159], v[88:91]
  ds_read_b64_tr_b16 v[20:21], v10 offset:8192
  ds_read_b64_tr_b16 v[22:23], v10 offset:12288
  v_mfma_f32_16x16x32_bf16 v[92:95], v[28:31], v[156:159], v[92:95]
  ds_read_b64_tr_b16 v[24:25], v9 offset:8704
  ds_read_b64_tr_b16 v[26:27], v9 offset:12800
  s_waitcnt lgkmcnt(2)
  v_mfma_f32_16x16x32_bf16 v[64:67], v[16:19], v[160:163], v[64:67]
  ds_read_b64_tr_b16 v[28:29], v10 offset:8704
  ds_read_b64_tr_b16 v[30:31], v10 offset:12800
  v_mfma_f32_16x16x32_bf16 v[68:71], v[20:23], v[160:163], v[68:71]
  ds_read_b64_tr_b16 v[16:17], v9 offset:9216
  ds_read_b64_tr_b16 v[18:19], v9 offset:13312
  s_waitcnt lgkmcnt(2)
  v_mfma_f32_16x16x32_bf16 v[72:75], v[24:27], v[160:163], v[72:75]
  ds_read_b64_tr_b16 v[20:21], v10 offset:9216
  ds_read_b64_tr_b16 v[22:23], v10 offset:13312
  v_mfma_f32_16x16x32_bf16 v[76:79], v[28:31], v[160:163], v[76:79]
  ds_read_b64_tr_b16 v[24:25], v9 offset:9728
  ds_read_b64_tr_b16 v[26:27], v9 offset:13824
  s_waitcnt lgkmcnt(2)
  v_mfma_f32_16x16x32_bf16 v[80:83], v[16:19], v[160:163], v[80:83]
  ds_read_b64_tr_b16 v[28:29], v10 offset:9728
  ds_read_b64_tr_b16 v[30:31], v10 offset:13824
  v_mfma_f32_16x16x32_bf16 v[84:87], v[20:23], v[160:163], v[84:87]
  s_waitcnt lgkmcnt(0)
  v_mfma_f32_16x16x32_bf16 v[88:91], v[24:27], v[160:163], v[88:91]
  v_mfma_f32_16x16x32_bf16 v[92:95], v[28:31], v[160:163], v[92:95]
  s_waitcnt vmcnt(0)
  s_waitcnt lgkmcnt(0)
  s_barrier
  ds_read_b64_tr_b16 v[16:17], v9 offset:16384
  ds_read_b64_tr_b16 v[18:19], v9 offset:20480
  ds_read_b64_tr_b16 v[20:21], v10 offset:16384
  ds_read_b64_tr_b16 v[22:23], v10 offset:20480
  ds_read_b64_tr_b16 v[24:25], v9 offset:16896
  ds_read_b64_tr_b16 v[26:27], v9 offset:20992
  s_add_u32 s59, s45, 5
  s_and_b32 s59, s59, 7
  s_lshl_b32 s59, s59, 19
  s_add_u32 s59, s59, s54
  s_add_u32 s59, s59, 262656
  s_add_u32 m0, s55, 131072
  s_nop 0
  buffer_load_dwordx4 v8, s[16:19], s59 offen lds
  s_add_u32 m0, s55, 131968
  s_nop 0
  buffer_load_dwordx4 v8, s[16:19], s59 offen offset:128 lds
  s_add_u32 s59, s45, 6
  s_and_b32 s59, s59, 7
  s_lshl_b32 s59, s59, 19
  s_add_u32 s59, s59, s54
  s_add_u32 s59, s59, 512
  s_add_u32 m0, s55, 139264
  s_nop 0
  buffer_load_dwordx4 v8, s[16:19], s59 offen lds
  s_add_u32 m0, s55, 140160
  s_nop 0
  buffer_load_dwordx4 v8, s[16:19], s59 offen offset:128 lds
  s_add_u32 s59, s45, 6
  s_and_b32 s59, s59, 7
  s_lshl_b32 s59, s59, 19
  s_add_u32 s59, s59, s54
  s_add_u32 s59, s59, 262656
  s_add_u32 m0, s55, 147456
  s_nop 0
  buffer_load_dwordx4 v8, s[16:19], s59 offen lds
  s_add_u32 m0, s55, 148352
  s_nop 0
  buffer_load_dwordx4 v8, s[16:19], s59 offen offset:128 lds
  s_waitcnt lgkmcnt(2)
  v_mfma_f32_16x16x32_bf16 v[64:67], v[16:19], v[164:167], v[64:67]
  ds_read_b64_tr_b16 v[28:29], v10 offset:16896
  ds_read_b64_tr_b16 v[30:31], v10 offset:20992
  v_mfma_f32_16x16x32_bf16 v[68:71], v[20:23], v[164:167], v[68:71]
  ds_read_b64_tr_b16 v[16:17], v9 offset:17408
  ds_read_b64_tr_b16 v[18:19], v9 offset:21504
  s_waitcnt lgkmcnt(2)
  v_mfma_f32_16x16x32_bf16 v[72:75], v[24:27], v[164:167], v[72:75]
  ds_read_b64_tr_b16 v[20:21], v10 offset:17408
  ds_read_b64_tr_b16 v[22:23], v10 offset:21504
  v_mfma_f32_16x16x32_bf16 v[76:79], v[28:31], v[164:167], v[76:79]
  ds_read_b64_tr_b16 v[24:25], v9 offset:17920
  ds_read_b64_tr_b16 v[26:27], v9 offset:22016
  s_waitcnt lgkmcnt(2)
  v_mfma_f32_16x16x32_bf16 v[80:83], v[16:19], v[164:167], v[80:83]
  ds_read_b64_tr_b16 v[28:29], v10 offset:17920
  ds_read_b64_tr_b16 v[30:31], v10 offset:22016
  v_mfma_f32_16x16x32_bf16 v[84:87], v[20:23], v[164:167], v[84:87]
  ds_read_b64_tr_b16 v[16:17], v9 offset:24576
  ds_read_b64_tr_b16 v[18:19], v9 offset:28672
  s_waitcnt lgkmcnt(2)
  v_mfma_f32_16x16x32_bf16 v[88:91], v[24:27], v[164:167], v[88:91]
  ds_read_b64_tr_b16 v[20:21], v10 offset:24576
  ds_read_b64_tr_b16 v[22:23], v10 offset:28672
  v_mfma_f32_16x16x32_bf16 v[92:95], v[28:31], v[164:167], v[92:95]
  ds_read_b64_tr_b16 v[24:25], v9 offset:25088
  ds_read_b64_tr_b16 v[26:27], v9 offset:29184
  s_waitcnt lgkmcnt(2)
  v_mfma_f32_16x16x32_bf16 v[64:67], v[16:19], v[168:171], v[64:67]
  ds_read_b64_tr_b16 v[28:29], v10 offset:25088
  ds_read_b64_tr_b16 v[30:31], v10 offset:29184
  v_mfma_f32_16x16x32_bf16 v[68:71], v[20:23], v[168:171], v[68:71]
  ds_read_b64_tr_b16 v[16:17], v9 offset:25600
  ds_read_b64_tr_b16 v[18:19], v9 offset:29696
  s_waitcnt lgkmcnt(2)
  v_mfma_f32_16x16x32_bf16 v[72:75], v[24:27], v[168:171], v[72:75]
  ds_read_b64_tr_b16 v[20:21], v10 offset:25600
  ds_read_b64_tr_b16 v[22:23], v10 offset:29696
  v_mfma_f32_16x16x32_bf16 v[76:79], v[28:31], v[168:171], v[76:79]
  ds_read_b64_tr_b16 v[24:25], v9 offset:26112
  ds_read_b64_tr_b16 v[26:27], v9 offset:30208
  s_waitcnt lgkmcnt(2)
  v_mfma_f32_16x16x32_bf16 v[80:83], v[16:19], v[168:171], v[80:83]
  ds_read_b64_tr_b16 v[28:29], v10 offset:26112
  ds_read_b64_tr_b16 v[30:31], v10 offset:30208
  v_mfma_f32_16x16x32_bf16 v[84:87], v[20:23], v[168:171], v[84:87]
  s_waitcnt lgkmcnt(0)
  v_mfma_f32_16x16x32_bf16 v[88:91], v[24:27], v[168:171], v[88:91]
  v_mfma_f32_16x16x32_bf16 v[92:95], v[28:31], v[168:171], v[92:95]
  s_waitcnt vmcnt(0)
  s_waitcnt lgkmcnt(0)
  s_barrier
  ds_read_b64_tr_b16 v[16:17], v9 offset:32768
  ds_read_b64_tr_b16 v[18:19], v9 offset:36864
  ds_read_b64_tr_b16 v[20:21], v10 offset:32768
  ds_read_b64_tr_b16 v[22:23], v10 offset:36864
  ds_read_b64_tr_b16 v[24:25], v9 offset:33280
  ds_read_b64_tr_b16 v[26:27], v9 offset:37376
  s_add_u32 s59, s45, 7
  s_and_b32 s59, s59, 7
  s_lshl_b32 s59, s59, 19
  s_add_u32 s59, s59, s54
  s_add_u32 s59, s59, 512
  s_add_u32 m0, s55, 155648
  s_nop 0
  buffer_load_dwordx4 v8, s[16:19], s59 offen lds
  s_add_u32 m0, s55, 156544
  s_nop 0
  buffer_load_dwordx4 v8, s[16:19], s59 offen offset:128 lds
  s_add_u32 s59, s45, 7
  s_and_b32 s59, s59, 7
  s_lshl_b32 s59, s59, 19
  s_add_u32 s59, s59, s54
  s_add_u32 s59, s59, 262656
  s_add_u32 m0, s55, 98304
  s_nop 0
  buffer_load_dwordx4 v8, s[16:19], s59 offen lds
  s_add_u32 m0, s55, 99200
  s_nop 0
  buffer_load_dwordx4 v8, s[16:19], s59 offen offset:128 lds
  s_add_u32 s59, s45, 0
  s_and_b32 s59, s59, 7
  s_lshl_b32 s59, s59, 19
  s_add_u32 s59, s59, s54
  s_add_u32 s59, s59, 768
  s_add_u32 m0, s55, 106496
  s_nop 0
  buffer_load_dwordx4 v8, s[16:19], s59 offen lds
  s_add_u32 m0, s55, 107392
  s_nop 0
  buffer_load_dwordx4 v8, s[16:19], s59 offen offset:128 lds
  s_waitcnt lgkmcnt(2)
  v_mfma_f32_16x16x32_bf16 v[64:67], v[16:19], v[172:175], v[64:67]
  ds_read_b64_tr_b16 v[28:29], v10 offset:33280
  ds_read_b64_tr_b16 v[30:31], v10 offset:37376
  v_mfma_f32_16x16x32_bf16 v[68:71], v[20:23], v[172:175], v[68:71]
  ds_read_b64_tr_b16 v[16:17], v9 offset:33792
  ds_read_b64_tr_b16 v[18:19], v9 offset:37888
  s_waitcnt lgkmcnt(2)
  v_mfma_f32_16x16x32_bf16 v[72:75], v[24:27], v[172:175], v[72:75]
  ds_read_b64_tr_b16 v[20:21], v10 offset:33792
  ds_read_b64_tr_b16 v[22:23], v10 offset:37888
  v_mfma_f32_16x16x32_bf16 v[76:79], v[28:31], v[172:175], v[76:79]
  ds_read_b64_tr_b16 v[24:25], v9 offset:34304
  ds_read_b64_tr_b16 v[26:27], v9 offset:38400
  s_waitcnt lgkmcnt(2)
  v_mfma_f32_16x16x32_bf16 v[80:83], v[16:19], v[172:175], v[80:83]
  ds_read_b64_tr_b16 v[28:29], v10 offset:34304
  ds_read_b64_tr_b16 v[30:31], v10 offset:38400
  v_mfma_f32_16x16x32_bf16 v[84:87], v[20:23], v[172:175], v[84:87]
  ds_read_b64_tr_b16 v[16:17], v9 offset:40960
  ds_read_b64_tr_b16 v[18:19], v9 offset:45056
  s_waitcnt lgkmcnt(2)
  v_mfma_f32_16x16x32_bf16 v[88:91], v[24:27], v[172:175], v[88:91]
  ds_read_b64_tr_b16 v[20:21], v10 offset:40960
  ds_read_b64_tr_b16 v[22:23], v10 offset:45056
  v_mfma_f32_16x16x32_bf16 v[92:95], v[28:31], v[172:175], v[92:95]
  ds_read_b64_tr_b16 v[24:25], v9 offset:41472
  ds_read_b64_tr_b16 v[26:27], v9 offset:45568
  s_waitcnt lgkmcnt(2)
  v_mfma_f32_16x16x32_bf16 v[64:67], v[16:19], v[176:179], v[64:67]
  ds_read_b64_tr_b16 v[28:29], v10 offset:41472
  ds_read_b64_tr_b16 v[30:31], v10 offset:45568
  v_mfma_f32_16x16x32_bf16 v[68:71], v[20:23], v[176:179], v[68:71]
  ds_read_b64_tr_b16 v[16:17], v9 offset:41984
  ds_read_b64_tr_b16 v[18:19], v9 offset:46080
  s_waitcnt lgkmcnt(2)
  v_mfma_f32_16x16x32_bf16 v[72:75], v[24:27], v[176:179], v[72:75]
  ds_read_b64_tr_b16 v[20:21], v10 offset:41984
  ds_read_b64_tr_b16 v[22:23], v10 offset:46080
  v_mfma_f32_16x16x32_bf16 v[76:79], v[28:31], v[176:179], v[76:79]
  ds_read_b64_tr_b16 v[24:25], v9 offset:42496
  ds_read_b64_tr_b16 v[26:27], v9 offset:46592
  s_waitcnt lgkmcnt(2)
  v_mfma_f32_16x16x32_bf16 v[80:83], v[16:19], v[176:179], v[80:83]
  ds_read_b64_tr_b16 v[28:29], v10 offset:42496
  ds_read_b64_tr_b16 v[30:31], v10 offset:46592
  v_mfma_f32_16x16x32_bf16 v[84:87], v[20:23], v[176:179], v[84:87]
  ds_read_b64_tr_b16 v[16:17], v9 offset:49152
  ds_read_b64_tr_b16 v[18:19], v9 offset:53248
  s_waitcnt lgkmcnt(2)
  v_mfma_f32_16x16x32_bf16 v[88:91], v[24:27], v[176:179], v[88:91]
  ds_read_b64_tr_b16 v[20:21], v10 offset:49152
  ds_read_b64_tr_b16 v[22:23], v10 offset:53248
  v_mfma_f32_16x16x32_bf16 v[92:95], v[28:31], v[176:179], v[92:95]
  ds_read_b64_tr_b16 v[24:25], v9 offset:49664
  ds_read_b64_tr_b16 v[26:27], v9 offset:53760
  s_waitcnt lgkmcnt(2)
  v_mfma_f32_16x16x32_bf16 v[64:67], v[16:19], v[180:183], v[64:67]
  ds_read_b64_tr_b16 v[28:29], v10 offset:49664
  ds_read_b64_tr_b16 v[30:31], v10 offset:53760
  v_mfma_f32_16x16x32_bf16 v[68:71], v[20:23], v[180:183], v[68:71]
  ds_read_b64_tr_b16 v[16:17], v9 offset:50176
  ds_read_b64_tr_b16 v[18:19], v9 offset:54272
  s_waitcnt lgkmcnt(2)
  v_mfma_f32_16x16x32_bf16 v[72:75], v[24:27], v[180:183], v[72:75]
  ds_read_b64_tr_b16 v[20:21], v10 offset:50176
  ds_read_b64_tr_b16 v[22:23], v10 offset:54272
  v_mfma_f32_16x16x32_bf16 v[76:79], v[28:31], v[180:183], v[76:79]
  ds_read_b64_tr_b16 v[24:25], v9 offset:50688
  ds_read_b64_tr_b16 v[26:27], v9 offset:54784
  s_waitcnt lgkmcnt(2)
  v_mfma_f32_16x16x32_bf16 v[80:83], v[16:19], v[180:183], v[80:83]
  ds_read_b64_tr_b16 v[28:29], v10 offset:50688
  ds_read_b64_tr_b16 v[30:31], v10 offset:54784
  v_mfma_f32_16x16x32_bf16 v[84:87], v[20:23], v[180:183], v[84:87]
  s_waitcnt lgkmcnt(0)
  v_mfma_f32_16x16x32_bf16 v[88:91], v[24:27], v[180:183], v[88:91]
  v_mfma_f32_16x16x32_bf16 v[92:95], v[28:31], v[180:183], v[92:95]
  s_waitcnt vmcnt(0)
  s_waitcnt lgkmcnt(0)
  s_barrier
  ds_read_b64_tr_b16 v[16:17], v9 offset:57344
  ds_read_b64_tr_b16 v[18:19], v9 offset:61440
  ds_read_b64_tr_b16 v[20:21], v10 offset:57344
  ds_read_b64_tr_b16 v[22:23], v10 offset:61440
  ds_read_b64_tr_b16 v[24:25], v9 offset:57856
  ds_read_b64_tr_b16 v[26:27], v9 offset:61952
  s_add_u32 s59, s45, 0
  s_and_b32 s59, s59, 7
  s_lshl_b32 s59, s59, 19
  s_add_u32 s59, s59, s54
  s_add_u32 s59, s59, 262912
  s_add_u32 m0, s55, 131072
  s_nop 0
  buffer_load_dwordx4 v8, s[16:19], s59 offen lds
  s_add_u32 m0, s55, 131968
  s_nop 0
  buffer_load_dwordx4 v8, s[16:19], s59 offen offset:128 lds
  s_add_u32 s59, s45, 1
  s_and_b32 s59, s59, 7
  s_lshl_b32 s59, s59, 19
  s_add_u32 s59, s59, s54
  s_add_u32 s59, s59, 768
  s_add_u32 m0, s55, 139264
  s_nop 0
  buffer_load_dwordx4 v8, s[16:19], s59 offen lds
  s_add_u32 m0, s55, 140160
  s_nop 0
  buffer_load_dwordx4 v8, s[16:19], s59 offen offset:128 lds
  s_add_u32 s59, s45, 1
  s_and_b32 s59, s59, 7
  s_lshl_b32 s59, s59, 19
  s_add_u32 s59, s59, s54
  s_add_u32 s59, s59, 262912
  s_add_u32 m0, s55, 147456
  s_nop 0
  buffer_load_dwordx4 v8, s[16:19], s59 offen lds
  s_add_u32 m0, s55, 148352
  s_nop 0
  buffer_load_dwordx4 v8, s[16:19], s59 offen offset:128 lds
  s_waitcnt lgkmcnt(2)
  v_mfma_f32_16x16x32_bf16 v[64:67], v[16:19], v[184:187], v[64:67]
  ds_read_b64_tr_b16 v[28:29], v10 offset:57856
  ds_read_b64_tr_b16 v[30:31], v10 offset:61952
  v_mfma_f32_16x16x32_bf16 v[68:71], v[20:23], v[184:187], v[68:71]
  ds_read_b64_tr_b16 v[16:17], v9 offset:58368
  ds_read_b64_tr_b16 v[18:19], v9 offset:62464
  s_waitcnt lgkmcnt(2)
  v_mfma_f32_16x16x32_bf16 v[72:75], v[24:27], v[184:187], v[72:75]
  ds_read_b64_tr_b16 v[20:21], v10 offset:58368
  ds_read_b64_tr_b16 v[22:23], v10 offset:62464
  v_mfma_f32_16x16x32_bf16 v[76:79], v[28:31], v[184:187], v[76:79]
  ds_read_b64_tr_b16 v[24:25], v9 offset:58880
  ds_read_b64_tr_b16 v[26:27], v9 offset:62976
  s_waitcnt lgkmcnt(2)
  v_mfma_f32_16x16x32_bf16 v[80:83], v[16:19], v[184:187], v[80:83]
  ds_read_b64_tr_b16 v[28:29], v10 offset:58880
  ds_read_b64_tr_b16 v[30:31], v10 offset:62976
  v_mfma_f32_16x16x32_bf16 v[84:87], v[20:23], v[184:187], v[84:87]
  ds_read_b64_tr_b16 v[16:17], v9 offset:0
  ds_read_b64_tr_b16 v[18:19], v9 offset:4096
  s_waitcnt lgkmcnt(2)
  v_mfma_f32_16x16x32_bf16 v[88:91], v[24:27], v[184:187], v[88:91]
  ds_read_b64_tr_b16 v[20:21], v10 offset:0
  ds_read_b64_tr_b16 v[22:23], v10 offset:4096
  v_mfma_f32_16x16x32_bf16 v[92:95], v[28:31], v[184:187], v[92:95]
  ds_read_b64_tr_b16 v[24:25], v9 offset:512
  ds_read_b64_tr_b16 v[26:27], v9 offset:4608
  s_waitcnt lgkmcnt(2)
  v_mfma_f32_16x16x32_bf16 v[64:67], v[16:19], v[188:191], v[64:67]
  ds_read_b64_tr_b16 v[28:29], v10 offset:512
  ds_read_b64_tr_b16 v[30:31], v10 offset:4608
  v_mfma_f32_16x16x32_bf16 v[68:71], v[20:23], v[188:191], v[68:71]
  ds_read_b64_tr_b16 v[16:17], v9 offset:1024
  ds_read_b64_tr_b16 v[18:19], v9 offset:5120
  s_waitcnt lgkmcnt(2)
  v_mfma_f32_16x16x32_bf16 v[72:75], v[24:27], v[188:191], v[72:75]
  ds_read_b64_tr_b16 v[20:21], v10 offset:1024
  ds_read_b64_tr_b16 v[22:23], v10 offset:5120
  v_mfma_f32_16x16x32_bf16 v[76:79], v[28:31], v[188:191], v[76:79]
  ds_read_b64_tr_b16 v[24:25], v9 offset:1536
  ds_read_b64_tr_b16 v[26:27], v9 offset:5632
  s_waitcnt lgkmcnt(2)
  v_mfma_f32_16x16x32_bf16 v[80:83], v[16:19], v[188:191], v[80:83]
  ds_read_b64_tr_b16 v[28:29], v10 offset:1536
  ds_read_b64_tr_b16 v[30:31], v10 offset:5632
  v_mfma_f32_16x16x32_bf16 v[84:87], v[20:23], v[188:191], v[84:87]
  ds_read_b64_tr_b16 v[16:17], v9 offset:8192
  ds_read_b64_tr_b16 v[18:19], v9 offset:12288
  s_waitcnt lgkmcnt(2)
  v_mfma_f32_16x16x32_bf16 v[88:91], v[24:27], v[188:191], v[88:91]
  ds_read_b64_tr_b16 v[20:21], v10 offset:8192
  ds_read_b64_tr_b16 v[22:23], v10 offset:12288
  v_mfma_f32_16x16x32_bf16 v[92:95], v[28:31], v[188:191], v[92:95]
  ds_read_b64_tr_b16 v[24:25], v9 offset:8704
  ds_read_b64_tr_b16 v[26:27], v9 offset:12800
  v_mul_f32 v64, s50, v64
  v_mul_f32 v65, s50, v65
  v_mul_f32 v66, s50, v66
  v_mul_f32 v67, s50, v67
  v_cvt_pk_bf16_f32 v32, v64, v65
  v_cvt_pk_bf16_f32 v33, v66, v67
  s_waitcnt lgkmcnt(2)
  v_mfma_f32_16x16x32_bf16 v[64:67], v[16:19], v[128:131], 0
  ds_read_b64_tr_b16 v[28:29], v10 offset:8704
  ds_read_b64_tr_b16 v[30:31], v10 offset:12800
  v_mul_f32 v68, s50, v68
  v_mul_f32 v69, s50, v69
  v_mul_f32 v70, s50, v70
  v_mul_f32 v71, s50, v71
  v_cvt_pk_bf16_f32 v34, v68, v69
  v_cvt_pk_bf16_f32 v35, v70, v71
  s_nop 0
  v_permlane16_swap_b32 v32, v34
  v_permlane16_swap_b32 v33, v35
  v_mfma_f32_16x16x32_bf16 v[68:71], v[20:23], v[128:131], 0
  ds_read_b64_tr_b16 v[16:17], v9 offset:9216
  ds_read_b64_tr_b16 v[18:19], v9 offset:13312
  v_mul_f32 v72, s50, v72
  v_mul_f32 v73, s50, v73
  v_mul_f32 v74, s50, v74
  v_mul_f32 v75, s50, v75
  v_cvt_pk_bf16_f32 v36, v72, v73
  v_cvt_pk_bf16_f32 v37, v74, v75
  s_waitcnt lgkmcnt(2)
  v_mfma_f32_16x16x32_bf16 v[72:75], v[24:27], v[128:131], 0
  ds_read_b64_tr_b16 v[20:21], v10 offset:9216
  ds_read_b64_tr_b16 v[22:23], v10 offset:13312
  v_mul_f32 v76, s50, v76
  v_mul_f32 v77, s50, v77
  v_mul_f32 v78, s50, v78
  v_mul_f32 v79, s50, v79
  v_cvt_pk_bf16_f32 v38, v76, v77
  v_cvt_pk_bf16_f32 v39, v78, v79
  s_nop 0
  v_permlane16_swap_b32 v36, v38
  v_permlane16_swap_b32 v37, v39
  v_mfma_f32_16x16x32_bf16 v[76:79], v[28:31], v[128:131], 0
  ds_read_b64_tr_b16 v[24:25], v9 offset:9728
  ds_read_b64_tr_b16 v[26:27], v9 offset:13824
  v_mul_f32 v80, s50, v80
  v_mul_f32 v81, s50, v81
  v_mul_f32 v82, s50, v82
  v_mul_f32 v83, s50, v83
  v_cvt_pk_bf16_f32 v40, v80, v81
  v_cvt_pk_bf16_f32 v41, v82, v83
  s_waitcnt lgkmcnt(2)
  v_mfma_f32_16x16x32_bf16 v[80:83], v[16:19], v[128:131], 0
  ds_read_b64_tr_b16 v[28:29], v10 offset:9728
  ds_read_b64_tr_b16 v[30:31], v10 offset:13824
  v_mul_f32 v84, s50, v84
  v_mul_f32 v85, s50, v85
  v_mul_f32 v86, s50, v86
  v_mul_f32 v87, s50, v87
  v_cvt_pk_bf16_f32 v42, v84, v85
  v_cvt_pk_bf16_f32 v43, v86, v87
  s_nop 0
  v_permlane16_swap_b32 v40, v42
  v_permlane16_swap_b32 v41, v43
  v_mfma_f32_16x16x32_bf16 v[84:87], v[20:23], v[128:131], 0
  v_mul_f32 v88, s50, v88
  v_mul_f32 v89, s50, v89
  v_mul_f32 v90, s50, v90
  v_mul_f32 v91, s50, v91
  v_cvt_pk_bf16_f32 v44, v88, v89
  v_cvt_pk_bf16_f32 v45, v90, v91
  s_waitcnt lgkmcnt(0)
  v_mfma_f32_16x16x32_bf16 v[88:91], v[24:27], v[128:131], 0
  v_mul_f32 v92, s50, v92
  v_mul_f32 v93, s50, v93
  v_mul_f32 v94, s50, v94
  v_mul_f32 v95, s50, v95
  v_cvt_pk_bf16_f32 v46, v92, v93
  v_cvt_pk_bf16_f32 v47, v94, v95
  s_nop 0
  v_permlane16_swap_b32 v44, v46
  v_permlane16_swap_b32 v45, v47
  v_mfma_f32_16x16x32_bf16 v[92:95], v[28:31], v[128:131], 0
  s_waitcnt vmcnt(0)
  s_waitcnt lgkmcnt(0)
  s_barrier
  ds_read_b64_tr_b16 v[16:17], v9 offset:32768
  ds_read_b64_tr_b16 v[18:19], v9 offset:36864
  ds_read_b64_tr_b16 v[20:21], v10 offset:32768
  ds_read_b64_tr_b16 v[22:23], v10 offset:36864
  ds_read_b64_tr_b16 v[24:25], v9 offset:33280
  ds_read_b64_tr_b16 v[26:27], v9 offset:37376
  s_add_u32 s59, s45, 2
  s_and_b32 s59, s59, 7
  s_lshl_b32 s59, s59, 19
  s_add_u32 s59, s59, s54
  s_add_u32 s59, s59, 768
  s_add_u32 m0, s55, 155648
  s_nop 0
  buffer_load_dwordx4 v8, s[16:19], s59 offen lds
  s_add_u32 m0, s55, 156544
  s_nop 0
  buffer_load_dwordx4 v8, s[16:19], s59 offen offset:128 lds
  s_add_u32 s59, s45, 2
  s_and_b32 s59, s59, 7
  s_lshl_b32 s59, s59, 19
  s_add_u32 s59, s59, s54
  s_add_u32 s59, s59, 262912
  s_add_u32 m0, s55, 98304
  s_nop 0
  buffer_load_dwordx4 v8, s[16:19], s59 offen lds
  s_add_u32 m0, s55, 99200
  s_nop 0
  buffer_load_dwordx4 v8, s[16:19], s59 offen offset:128 lds
  s_add_u32 s59, s45, 3
  s_and_b32 s59, s59, 7
  s_lshl_b32 s59, s59, 19
  s_add_u32 s59, s59, s54
  s_add_u32 s59, s59, 768
  s_add_u32 m0, s55, 106496
  s_nop 0
  buffer_load_dwordx4 v8, s[16:19], s59 offen lds
  s_add_u32 m0, s55, 107392
  s_nop 0
  buffer_load_dwordx4 v8, s[16:19], s59 offen offset:128 lds
  s_waitcnt lgkmcnt(2)
  v_mfma_f32_16x16x32_bf16 v[64:67], v[16:19], v[132:135], v[64:67]
  ds_read_b64_tr_b16 v[28:29], v10 offset:33280
  ds_read_b64_tr_b16 v[30:31], v10 offset:37376
  v_mfma_f32_16x16x32_bf16 v[68:71], v[20:23], v[132:135], v[68:71]
  ds_read_b64_tr_b16 v[16:17], v9 offset:33792
  ds_read_b64_tr_b16 v[18:19], v9 offset:37888
  s_waitcnt lgkmcnt(2)
  v_mfma_f32_16x16x32_bf16 v[72:75], v[24:27], v[132:135], v[72:75]
  ds_read_b64_tr_b16 v[20:21], v10 offset:33792
  ds_read_b64_tr_b16 v[22:23], v10 offset:37888
  v_mfma_f32_16x16x32_bf16 v[76:79], v[28:31], v[132:135], v[76:79]
  ds_read_b64_tr_b16 v[24:25], v9 offset:34304
  ds_read_b64_tr_b16 v[26:27], v9 offset:38400
  s_waitcnt lgkmcnt(2)
  v_mfma_f32_16x16x32_bf16 v[80:83], v[16:19], v[132:135], v[80:83]
  ds_read_b64_tr_b16 v[28:29], v10 offset:34304
  ds_read_b64_tr_b16 v[30:31], v10 offset:38400
  v_mfma_f32_16x16x32_bf16 v[84:87], v[20:23], v[132:135], v[84:87]
  ds_read_b64_tr_b16 v[16:17], v9 offset:40960
  ds_read_b64_tr_b16 v[18:19], v9 offset:45056
  s_waitcnt lgkmcnt(2)
  v_mfma_f32_16x16x32_bf16 v[88:91], v[24:27], v[132:135], v[88:91]
  ds_read_b64_tr_b16 v[20:21], v10 offset:40960
  ds_read_b64_tr_b16 v[22:23], v10 offset:45056
  v_mfma_f32_16x16x32_bf16 v[92:95], v[28:31], v[132:135], v[92:95]
  ds_read_b64_tr_b16 v[24:25], v9 offset:41472
  ds_read_b64_tr_b16 v[26:27], v9 offset:45568
  s_waitcnt lgkmcnt(2)
  v_mfma_f32_16x16x32_bf16 v[64:67], v[16:19], v[136:139], v[64:67]
  ds_read_b64_tr_b16 v[28:29], v10 offset:41472
  ds_read_b64_tr_b16 v[30:31], v10 offset:45568
  v_mfma_f32_16x16x32_bf16 v[68:71], v[20:23], v[136:139], v[68:71]
  ds_read_b64_tr_b16 v[16:17], v9 offset:41984
  ds_read_b64_tr_b16 v[18:19], v9 offset:46080
  s_waitcnt lgkmcnt(2)
  v_mfma_f32_16x16x32_bf16 v[72:75], v[24:27], v[136:139], v[72:75]
  ds_read_b64_tr_b16 v[20:21], v10 offset:41984
  ds_read_b64_tr_b16 v[22:23], v10 offset:46080
  v_mfma_f32_16x16x32_bf16 v[76:79], v[28:31], v[136:139], v[76:79]
  ds_read_b64_tr_b16 v[24:25], v9 offset:42496
  ds_read_b64_tr_b16 v[26:27], v9 offset:46592
  s_waitcnt lgkmcnt(2)
  v_mfma_f32_16x16x32_bf16 v[80:83], v[16:19], v[136:139], v[80:83]
  ds_read_b64_tr_b16 v[28:29], v10 offset:42496
  ds_read_b64_tr_b16 v[30:31], v10 offset:46592
  v_mfma_f32_16x16x32_bf16 v[84:87], v[20:23], v[136:139], v[84:87]
  ds_read_b64_tr_b16 v[16:17], v9 offset:49152
  ds_read_b64_tr_b16 v[18:19], v9 offset:53248
  s_waitcnt lgkmcnt(2)
  v_mfma_f32_16x16x32_bf16 v[88:91], v[24:27], v[136:139], v[88:91]
  ds_read_b64_tr_b16 v[20:21], v10 offset:49152
  ds_read_b64_tr_b16 v[22:23], v10 offset:53248
  v_mfma_f32_16x16x32_bf16 v[92:95], v[28:31], v[136:139], v[92:95]
  ds_read_b64_tr_b16 v[24:25], v9 offset:49664
  ds_read_b64_tr_b16 v[26:27], v9 offset:53760
  s_waitcnt lgkmcnt(2)
  v_mfma_f32_16x16x32_bf16 v[64:67], v[16:19], v[140:143], v[64:67]
  ds_read_b64_tr_b16 v[28:29], v10 offset:49664
  ds_read_b64_tr_b16 v[30:31], v10 offset:53760
  v_mfma_f32_16x16x32_bf16 v[68:71], v[20:23], v[140:143], v[68:71]
  ds_read_b64_tr_b16 v[16:17], v9 offset:50176
  ds_read_b64_tr_b16 v[18:19], v9 offset:54272
  s_waitcnt lgkmcnt(2)
  v_mfma_f32_16x16x32_bf16 v[72:75], v[24:27], v[140:143], v[72:75]
  ds_read_b64_tr_b16 v[20:21], v10 offset:50176
  ds_read_b64_tr_b16 v[22:23], v10 offset:54272
  v_mfma_f32_16x16x32_bf16 v[76:79], v[28:31], v[140:143], v[76:79]
  ds_read_b64_tr_b16 v[24:25], v9 offset:50688
  ds_read_b64_tr_b16 v[26:27], v9 offset:54784
  s_waitcnt lgkmcnt(2)
  v_mfma_f32_16x16x32_bf16 v[80:83], v[16:19], v[140:143], v[80:83]
  ds_read_b64_tr_b16 v[28:29], v10 offset:50688
  ds_read_b64_tr_b16 v[30:31], v10 offset:54784
  v_mfma_f32_16x16x32_bf16 v[84:87], v[20:23], v[140:143], v[84:87]
  s_waitcnt lgkmcnt(0)
  v_mfma_f32_16x16x32_bf16 v[88:91], v[24:27], v[140:143], v[88:91]
  v_mfma_f32_16x16x32_bf16 v[92:95], v[28:31], v[140:143], v[92:95]
  s_waitcnt vmcnt(0)
  s_waitcnt lgkmcnt(0)
  s_barrier
  ds_read_b64_tr_b16 v[16:17], v9 offset:57344
  ds_read_b64_tr_b16 v[18:19], v9 offset:61440
  ds_read_b64_tr_b16 v[20:21], v10 offset:57344
  ds_read_b64_tr_b16 v[22:23], v10 offset:61440
  ds_read_b64_tr_b16 v[24:25], v9 offset:57856
  ds_read_b64_tr_b16 v[26:27], v9 offset:61952
  s_add_u32 s59, s45, 3
  s_and_b32 s59, s59, 7
  s_lshl_b32 s59, s59, 19
  s_add_u32 s59, s59, s54
  s_add_u32 s59, s59, 262912
  s_add_u32 m0, s55, 131072
  s_nop 0
  buffer_load_dwordx4 v8, s[16:19], s59 offen lds
  s_add_u32 m0, s55, 131968
  s_nop 0
  buffer_load_dwordx4 v8, s[16:19], s59 offen offset:128 lds
  s_add_u32 s59, s45, 4
  s_and_b32 s59, s59, 7
  s_lshl_b32 s59, s59, 19
  s_add_u32 s59, s59, s54
  s_add_u32 s59, s59, 768
  s_add_u32 m0, s55, 139264
  s_nop 0
  buffer_load_dwordx4 v8, s[16:19], s59 offen lds
  s_add_u32 m0, s55, 140160
  s_nop 0
  buffer_load_dwordx4 v8, s[16:19], s59 offen offset:128 lds
  s_add_u32 s59, s45, 4
  s_and_b32 s59, s59, 7
  s_lshl_b32 s59, s59, 19
  s_add_u32 s59, s59, s54
  s_add_u32 s59, s59, 262912
  s_add_u32 m0, s55, 147456
  s_nop 0
  buffer_load_dwordx4 v8, s[16:19], s59 offen lds
  s_add_u32 m0, s55, 148352
  s_nop 0
  buffer_load_dwordx4 v8, s[16:19], s59 offen offset:128 lds
  s_waitcnt lgkmcnt(2)
  v_mfma_f32_16x16x32_bf16 v[64:67], v[16:19], v[144:147], v[64:67]
  ds_read_b64_tr_b16 v[28:29], v10 offset:57856
  ds_read_b64_tr_b16 v[30:31], v10 offset:61952
  v_mfma_f32_16x16x32_bf16 v[68:71], v[20:23], v[144:147], v[68:71]
  ds_read_b64_tr_b16 v[16:17], v9 offset:58368
  ds_read_b64_tr_b16 v[18:19], v9 offset:62464
  s_waitcnt lgkmcnt(2)
  v_mfma_f32_16x16x32_bf16 v[72:75], v[24:27], v[144:147], v[72:75]
  ds_read_b64_tr_b16 v[20:21], v10 offset:58368
  ds_read_b64_tr_b16 v[22:23], v10 offset:62464
  v_mfma_f32_16x16x32_bf16 v[76:79], v[28:31], v[144:147], v[76:79]
  ds_read_b64_tr_b16 v[24:25], v9 offset:58880
  ds_read_b64_tr_b16 v[26:27], v9 offset:62976
  s_waitcnt lgkmcnt(2)
  v_mfma_f32_16x16x32_bf16 v[80:83], v[16:19], v[144:147], v[80:83]
  ds_read_b64_tr_b16 v[28:29], v10 offset:58880
  ds_read_b64_tr_b16 v[30:31], v10 offset:62976
  v_mfma_f32_16x16x32_bf16 v[84:87], v[20:23], v[144:147], v[84:87]
  ds_read_b64_tr_b16 v[16:17], v9 offset:0
  ds_read_b64_tr_b16 v[18:19], v9 offset:4096
  s_waitcnt lgkmcnt(2)
  v_mfma_f32_16x16x32_bf16 v[88:91], v[24:27], v[144:147], v[88:91]
  ds_read_b64_tr_b16 v[20:21], v10 offset:0
  ds_read_b64_tr_b16 v[22:23], v10 offset:4096
  v_mfma_f32_16x16x32_bf16 v[92:95], v[28:31], v[144:147], v[92:95]
  ds_read_b64_tr_b16 v[24:25], v9 offset:512
  ds_read_b64_tr_b16 v[26:27], v9 offset:4608
  s_waitcnt lgkmcnt(2)
  v_mfma_f32_16x16x32_bf16 v[64:67], v[16:19], v[148:151], v[64:67]
  ds_read_b64_tr_b16 v[28:29], v10 offset:512
  ds_read_b64_tr_b16 v[30:31], v10 offset:4608
  v_mfma_f32_16x16x32_bf16 v[68:71], v[20:23], v[148:151], v[68:71]
  ds_read_b64_tr_b16 v[16:17], v9 offset:1024
  ds_read_b64_tr_b16 v[18:19], v9 offset:5120
  s_waitcnt lgkmcnt(2)
  v_mfma_f32_16x16x32_bf16 v[72:75], v[24:27], v[148:151], v[72:75]
  ds_read_b64_tr_b16 v[20:21], v10 offset:1024
  ds_read_b64_tr_b16 v[22:23], v10 offset:5120
  v_mfma_f32_16x16x32_bf16 v[76:79], v[28:31], v[148:151], v[76:79]
  ds_read_b64_tr_b16 v[24:25], v9 offset:1536
  ds_read_b64_tr_b16 v[26:27], v9 offset:5632
  s_waitcnt lgkmcnt(2)
  v_mfma_f32_16x16x32_bf16 v[80:83], v[16:19], v[148:151], v[80:83]
  ds_read_b64_tr_b16 v[28:29], v10 offset:1536
  ds_read_b64_tr_b16 v[30:31], v10 offset:5632
  v_mfma_f32_16x16x32_bf16 v[84:87], v[20:23], v[148:151], v[84:87]
  ds_read_b64_tr_b16 v[16:17], v9 offset:8192
  ds_read_b64_tr_b16 v[18:19], v9 offset:12288
  s_waitcnt lgkmcnt(2)
  v_mfma_f32_16x16x32_bf16 v[88:91], v[24:27], v[148:151], v[88:91]
  ds_read_b64_tr_b16 v[20:21], v10 offset:8192
  ds_read_b64_tr_b16 v[22:23], v10 offset:12288
  v_mfma_f32_16x16x32_bf16 v[92:95], v[28:31], v[148:151], v[92:95]
  ds_read_b64_tr_b16 v[24:25], v9 offset:8704
  ds_read_b64_tr_b16 v[26:27], v9 offset:12800
  s_waitcnt lgkmcnt(2)
  v_mfma_f32_16x16x32_bf16 v[64:67], v[16:19], v[152:155], v[64:67]
  ds_read_b64_tr_b16 v[28:29], v10 offset:8704
  ds_read_b64_tr_b16 v[30:31], v10 offset:12800
  v_mfma_f32_16x16x32_bf16 v[68:71], v[20:23], v[152:155], v[68:71]
  ds_read_b64_tr_b16 v[16:17], v9 offset:9216
  ds_read_b64_tr_b16 v[18:19], v9 offset:13312
  s_waitcnt lgkmcnt(2)
  v_mfma_f32_16x16x32_bf16 v[72:75], v[24:27], v[152:155], v[72:75]
  ds_read_b64_tr_b16 v[20:21], v10 offset:9216
  ds_read_b64_tr_b16 v[22:23], v10 offset:13312
  v_mfma_f32_16x16x32_bf16 v[76:79], v[28:31], v[152:155], v[76:79]
  ds_read_b64_tr_b16 v[24:25], v9 offset:9728
  ds_read_b64_tr_b16 v[26:27], v9 offset:13824
  s_waitcnt lgkmcnt(2)
  v_mfma_f32_16x16x32_bf16 v[80:83], v[16:19], v[152:155], v[80:83]
  ds_read_b64_tr_b16 v[28:29], v10 offset:9728
  ds_read_b64_tr_b16 v[30:31], v10 offset:13824
  v_mfma_f32_16x16x32_bf16 v[84:87], v[20:23], v[152:155], v[84:87]
  s_waitcnt lgkmcnt(0)
  v_mfma_f32_16x16x32_bf16 v[88:91], v[24:27], v[152:155], v[88:91]
  v_mfma_f32_16x16x32_bf16 v[92:95], v[28:31], v[152:155], v[92:95]
  s_waitcnt vmcnt(0)
  s_waitcnt lgkmcnt(0)
  s_barrier
  ds_read_b64_tr_b16 v[16:17], v9 offset:32768
  ds_read_b64_tr_b16 v[18:19], v9 offset:36864
  ds_read_b64_tr_b16 v[20:21], v10 offset:32768
  ds_read_b64_tr_b16 v[22:23], v10 offset:36864
  ds_read_b64_tr_b16 v[24:25], v9 offset:33280
  ds_read_b64_tr_b16 v[26:27], v9 offset:37376
  s_add_u32 s59, s45, 5
  s_and_b32 s59, s59, 7
  s_lshl_b32 s59, s59, 19
  s_add_u32 s59, s59, s54
  s_add_u32 s59, s59, 768
  s_add_u32 m0, s55, 98304
  s_nop 0
  buffer_load_dwordx4 v8, s[16:19], s59 offen lds
  s_add_u32 m0, s55, 99200
  s_nop 0
  buffer_load_dwordx4 v8, s[16:19], s59 offen offset:128 lds
  s_add_u32 s59, s45, 5
  s_and_b32 s59, s59, 7
  s_lshl_b32 s59, s59, 19
  s_add_u32 s59, s59, s54
  s_add_u32 s59, s59, 262912
  s_add_u32 m0, s55, 106496
  s_nop 0
  buffer_load_dwordx4 v8, s[16:19], s59 offen lds
  s_add_u32 m0, s55, 107392
  s_nop 0
  buffer_load_dwordx4 v8, s[16:19], s59 offen offset:128 lds
  s_waitcnt lgkmcnt(2)
  v_mfma_f32_16x16x32_bf16 v[64:67], v[16:19], v[156:159], v[64:67]
  ds_read_b64_tr_b16 v[28:29], v10 offset:33280
  ds_read_b64_tr_b16 v[30:31], v10 offset:37376
  v_mfma_f32_16x16x32_bf16 v[68:71], v[20:23], v[156:159], v[68:71]
  ds_read_b64_tr_b16 v[16:17], v9 offset:33792
  ds_read_b64_tr_b16 v[18:19], v9 offset:37888
  s_waitcnt lgkmcnt(2)
  v_mfma_f32_16x16x32_bf16 v[72:75], v[24:27], v[156:159], v[72:75]
  ds_read_b64_tr_b16 v[20:21], v10 offset:33792
  ds_read_b64_tr_b16 v[22:23], v10 offset:37888
  v_mfma_f32_16x16x32_bf16 v[76:79], v[28:31], v[156:159], v[76:79]
  ds_read_b64_tr_b16 v[24:25], v9 offset:34304
  ds_read_b64_tr_b16 v[26:27], v9 offset:38400
  s_waitcnt lgkmcnt(2)
  v_mfma_f32_16x16x32_bf16 v[80:83], v[16:19], v[156:159], v[80:83]
  ds_read_b64_tr_b16 v[28:29], v10 offset:34304
  ds_read_b64_tr_b16 v[30:31], v10 offset:38400
  v_mfma_f32_16x16x32_bf16 v[84:87], v[20:23], v[156:159], v[84:87]
  ds_read_b64_tr_b16 v[16:17], v9 offset:40960
  ds_read_b64_tr_b16 v[18:19], v9 offset:45056
  s_waitcnt lgkmcnt(2)
  v_mfma_f32_16x16x32_bf16 v[88:91], v[24:27], v[156:159], v[88:91]
  ds_read_b64_tr_b16 v[20:21], v10 offset:40960
  ds_read_b64_tr_b16 v[22:23], v10 offset:45056
  s_lshr_b32 s59, s2, 3
  s_lshl2_add_u32 s59, s59, s40
  s_lshl_b32 s59, s59, 8
  s_add_u32 s59, s59, L_h16-concat_heads__mha_block_cached__gqa_block_cached__near_ridge_kernel
  v_and_b32 v1, 0xf0, v7
  buffer_load_dword v1, v1, s[92:95], s59 offen
  v_mfma_f32_16x16x32_bf16 v[92:95], v[28:31], v[156:159], v[92:95]
  ds_read_b64_tr_b16 v[24:25], v9 offset:41472
  ds_read_b64_tr_b16 v[26:27], v9 offset:45568
  s_waitcnt lgkmcnt(2)
  v_mfma_f32_16x16x32_bf16 v[64:67], v[16:19], v[160:163], v[64:67]
  ds_read_b64_tr_b16 v[28:29], v10 offset:41472
  ds_read_b64_tr_b16 v[30:31], v10 offset:45568
  v_mfma_f32_16x16x32_bf16 v[68:71], v[20:23], v[160:163], v[68:71]
  ds_read_b64_tr_b16 v[16:17], v9 offset:41984
  ds_read_b64_tr_b16 v[18:19], v9 offset:46080
  s_waitcnt lgkmcnt(2)
  v_mfma_f32_16x16x32_bf16 v[72:75], v[24:27], v[160:163], v[72:75]
  ds_read_b64_tr_b16 v[20:21], v10 offset:41984
  ds_read_b64_tr_b16 v[22:23], v10 offset:46080
  v_mfma_f32_16x16x32_bf16 v[76:79], v[28:31], v[160:163], v[76:79]
  ds_read_b64_tr_b16 v[24:25], v9 offset:42496
  ds_read_b64_tr_b16 v[26:27], v9 offset:46592
  s_waitcnt lgkmcnt(2)
  v_mfma_f32_16x16x32_bf16 v[80:83], v[16:19], v[160:163], v[80:83]
  ds_read_b64_tr_b16 v[28:29], v10 offset:42496
  ds_read_b64_tr_b16 v[30:31], v10 offset:46592
  v_mfma_f32_16x16x32_bf16 v[84:87], v[20:23], v[160:163], v[84:87]
  ds_read_b64_tr_b16 v[16:17], v9 offset:49152
  ds_read_b64_tr_b16 v[18:19], v9 offset:53248
  s_waitcnt lgkmcnt(2)
  v_mfma_f32_16x16x32_bf16 v[88:91], v[24:27], v[160:163], v[88:91]
  ds_read_b64_tr_b16 v[20:21], v10 offset:49152
  ds_read_b64_tr_b16 v[22:23], v10 offset:53248
  v_mfma_f32_16x16x32_bf16 v[92:95], v[28:31], v[160:163], v[92:95]
  ds_read_b64_tr_b16 v[24:25], v9 offset:49664
  ds_read_b64_tr_b16 v[26:27], v9 offset:53760
  s_waitcnt lgkmcnt(2)
  v_mfma_f32_16x16x32_bf16 v[64:67], v[16:19], v[164:167], v[64:67]
  ds_read_b64_tr_b16 v[28:29], v10 offset:49664
  ds_read_b64_tr_b16 v[30:31], v10 offset:53760
  v_mfma_f32_16x16x32_bf16 v[68:71], v[20:23], v[164:167], v[68:71]
  ds_read_b64_tr_b16 v[16:17], v9 offset:50176
  ds_read_b64_tr_b16 v[18:19], v9 offset:54272
  s_waitcnt lgkmcnt(2)
  v_mfma_f32_16x16x32_bf16 v[72:75], v[24:27], v[164:167], v[72:75]
  ds_read_b64_tr_b16 v[20:21], v10 offset:50176
  ds_read_b64_tr_b16 v[22:23], v10 offset:54272
  v_mfma_f32_16x16x32_bf16 v[76:79], v[28:31], v[164:167], v[76:79]
  ds_read_b64_tr_b16 v[24:25], v9 offset:50688
  ds_read_b64_tr_b16 v[26:27], v9 offset:54784
  s_waitcnt lgkmcnt(2)
  v_mfma_f32_16x16x32_bf16 v[80:83], v[16:19], v[164:167], v[80:83]
  ds_read_b64_tr_b16 v[28:29], v10 offset:50688
  ds_read_b64_tr_b16 v[30:31], v10 offset:54784
  v_mfma_f32_16x16x32_bf16 v[84:87], v[20:23], v[164:167], v[84:87]
  s_waitcnt lgkmcnt(0)
  v_mfma_f32_16x16x32_bf16 v[88:91], v[24:27], v[164:167], v[88:91]
  v_mfma_f32_16x16x32_bf16 v[92:95], v[28:31], v[164:167], v[92:95]
  s_waitcnt vmcnt(1)
  s_waitcnt lgkmcnt(0)
  s_barrier
  ds_read_b64_tr_b16 v[16:17], v9 offset:0
  ds_read_b64_tr_b16 v[18:19], v9 offset:4096
  ds_read_b64_tr_b16 v[20:21], v10 offset:0
  ds_read_b64_tr_b16 v[22:23], v10 offset:4096
  ds_read_b64_tr_b16 v[24:25], v9 offset:512
  ds_read_b64_tr_b16 v[26:27], v9 offset:4608
  s_add_u32 s59, s45, 6
  s_and_b32 s59, s59, 7
  s_lshl_b32 s59, s59, 19
  s_add_u32 s59, s59, s54
  s_add_u32 s59, s59, 768
  s_add_u32 m0, s55, 114688
  s_nop 0
  buffer_load_dwordx4 v8, s[16:19], s59 offen lds
  s_add_u32 m0, s55, 115584
  s_nop 0
  buffer_load_dwordx4 v8, s[16:19], s59 offen offset:128 lds
  s_add_u32 s59, s45, 6
  s_and_b32 s59, s59, 7
  s_lshl_b32 s59, s59, 19
  s_add_u32 s59, s59, s54
  s_add_u32 s59, s59, 262912
  s_add_u32 m0, s55, 122880
  s_nop 0
  buffer_load_dwordx4 v8, s[16:19], s59 offen lds
  s_add_u32 m0, s55, 123776
  s_nop 0
  buffer_load_dwordx4 v8, s[16:19], s59 offen offset:128 lds
  s_waitcnt lgkmcnt(2)
  v_mfma_f32_16x16x32_bf16 v[64:67], v[16:19], v[168:171], v[64:67]
  ds_read_b64_tr_b16 v[28:29], v10 offset:512
  ds_read_b64_tr_b16 v[30:31], v10 offset:4608
  v_add_u32 v13, 131072, v11
  ds_write_b128 v13, v[32:35] offset:0
  v_mfma_f32_16x16x32_bf16 v[68:71], v[20:23], v[168:171], v[68:71]
  ds_read_b64_tr_b16 v[16:17], v9 offset:1024
  ds_read_b64_tr_b16 v[18:19], v9 offset:5120
  s_waitcnt lgkmcnt(3)
  v_mfma_f32_16x16x32_bf16 v[72:75], v[24:27], v[168:171], v[72:75]
  ds_read_b64_tr_b16 v[20:21], v10 offset:1024
  ds_read_b64_tr_b16 v[22:23], v10 offset:5120
  v_mfma_f32_16x16x32_bf16 v[76:79], v[28:31], v[168:171], v[76:79]
  ds_read_b64_tr_b16 v[24:25], v9 offset:1536
  ds_read_b64_tr_b16 v[26:27], v9 offset:5632
  s_waitcnt lgkmcnt(2)
  v_mfma_f32_16x16x32_bf16 v[80:83], v[16:19], v[168:171], v[80:83]
  ds_read_b64_tr_b16 v[28:29], v10 offset:1536
  ds_read_b64_tr_b16 v[30:31], v10 offset:5632
  ds_write_b128 v13, v[36:39] offset:1024
  v_mfma_f32_16x16x32_bf16 v[84:87], v[20:23], v[168:171], v[84:87]
  ds_read_b64_tr_b16 v[16:17], v9 offset:8192
  ds_read_b64_tr_b16 v[18:19], v9 offset:12288
  s_waitcnt lgkmcnt(3)
  v_mfma_f32_16x16x32_bf16 v[88:91], v[24:27], v[168:171], v[88:91]
  ds_read_b64_tr_b16 v[20:21], v10 offset:8192
  ds_read_b64_tr_b16 v[22:23], v10 offset:12288
  v_mfma_f32_16x16x32_bf16 v[92:95], v[28:31], v[168:171], v[92:95]
  ds_read_b64_tr_b16 v[24:25], v9 offset:8704
  ds_read_b64_tr_b16 v[26:27], v9 offset:12800
  s_waitcnt lgkmcnt(2)
  v_mfma_f32_16x16x32_bf16 v[64:67], v[16:19], v[172:175], v[64:67]
  ds_read_b64_tr_b16 v[28:29], v10 offset:8704
  ds_read_b64_tr_b16 v[30:31], v10 offset:12800
  ds_write_b128 v13, v[40:43] offset:2048
  v_mfma_f32_16x16x32_bf16 v[68:71], v[20:23], v[172:175], v[68:71]
  ds_read_b64_tr_b16 v[16:17], v9 offset:9216
  ds_read_b64_tr_b16 v[18:19], v9 offset:13312
  s_waitcnt lgkmcnt(3)
  v_mfma_f32_16x16x32_bf16 v[72:75], v[24:27], v[172:175], v[72:75]
  ds_read_b64_tr_b16 v[20:21], v10 offset:9216
  ds_read_b64_tr_b16 v[22:23], v10 offset:13312
  v_mfma_f32_16x16x32_bf16 v[76:79], v[28:31], v[172:175], v[76:79]
  ds_read_b64_tr_b16 v[24:25], v9 offset:9728
  ds_read_b64_tr_b16 v[26:27], v9 offset:13824
  s_waitcnt lgkmcnt(2)
  v_mfma_f32_16x16x32_bf16 v[80:83], v[16:19], v[172:175], v[80:83]
  ds_read_b64_tr_b16 v[28:29], v10 offset:9728
  ds_read_b64_tr_b16 v[30:31], v10 offset:13824
  ds_write_b128 v13, v[44:47] offset:3072
  v_mfma_f32_16x16x32_bf16 v[84:87], v[20:23], v[172:175], v[84:87]
  s_waitcnt lgkmcnt(1)
  v_mfma_f32_16x16x32_bf16 v[88:91], v[24:27], v[172:175], v[88:91]
  v_mfma_f32_16x16x32_bf16 v[92:95], v[28:31], v[172:175], v[92:95]
  s_waitcnt vmcnt(0)
  s_waitcnt lgkmcnt(0)
  s_barrier
  ds_read_b64_tr_b16 v[16:17], v9 offset:16384
  ds_read_b64_tr_b16 v[18:19], v9 offset:20480
  ds_read_b64_tr_b16 v[20:21], v10 offset:16384
  ds_read_b64_tr_b16 v[22:23], v10 offset:20480
  ds_read_b64_tr_b16 v[24:25], v9 offset:16896
  ds_read_b64_tr_b16 v[26:27], v9 offset:20992
  s_add_u32 s59, s45, 7
  s_and_b32 s59, s59, 7
  s_lshl_b32 s59, s59, 19
  s_add_u32 s59, s59, s54
  s_add_u32 s59, s59, 768
  s_add_u32 m0, s55, 98304
  s_nop 0
  buffer_load_dwordx4 v8, s[16:19], s59 offen lds
  s_add_u32 m0, s55, 99200
  s_nop 0
  buffer_load_dwordx4 v8, s[16:19], s59 offen offset:128 lds
  s_add_u32 s59, s45, 7
  s_and_b32 s59, s59, 7
  s_lshl_b32 s59, s59, 19
  s_add_u32 s59, s59, s54
  s_add_u32 s59, s59, 262912
  s_add_u32 m0, s55, 106496
  s_nop 0
  buffer_load_dwordx4 v8, s[16:19], s59 offen lds
  s_add_u32 m0, s55, 107392
  s_nop 0
  buffer_load_dwordx4 v8, s[16:19], s59 offen offset:128 lds
  s_waitcnt lgkmcnt(2)
  v_mfma_f32_16x16x32_bf16 v[64:67], v[16:19], v[176:179], v[64:67]
  ds_read_b64_tr_b16 v[28:29], v10 offset:16896
  ds_read_b64_tr_b16 v[30:31], v10 offset:20992
  v_mfma_f32_16x16x32_bf16 v[68:71], v[20:23], v[176:179], v[68:71]
  ds_read_b64_tr_b16 v[16:17], v9 offset:17408
  ds_read_b64_tr_b16 v[18:19], v9 offset:21504
  s_waitcnt lgkmcnt(2)
  v_mfma_f32_16x16x32_bf16 v[72:75], v[24:27], v[176:179], v[72:75]
  ds_read_b64_tr_b16 v[20:21], v10 offset:17408
  ds_read_b64_tr_b16 v[22:23], v10 offset:21504
  v_mfma_f32_16x16x32_bf16 v[76:79], v[28:31], v[176:179], v[76:79]
  ds_read_b64_tr_b16 v[24:25], v9 offset:17920
  ds_read_b64_tr_b16 v[26:27], v9 offset:22016
  s_waitcnt lgkmcnt(2)
  v_mfma_f32_16x16x32_bf16 v[80:83], v[16:19], v[176:179], v[80:83]
  ds_read_b64_tr_b16 v[28:29], v10 offset:17920
  ds_read_b64_tr_b16 v[30:31], v10 offset:22016
  v_mfma_f32_16x16x32_bf16 v[84:87], v[20:23], v[176:179], v[84:87]
  ds_read_b64_tr_b16 v[16:17], v9 offset:24576
  ds_read_b64_tr_b16 v[18:19], v9 offset:28672
  s_waitcnt lgkmcnt(2)
  v_mfma_f32_16x16x32_bf16 v[88:91], v[24:27], v[176:179], v[88:91]
  ds_read_b64_tr_b16 v[20:21], v10 offset:24576
  ds_read_b64_tr_b16 v[22:23], v10 offset:28672
  v_mfma_f32_16x16x32_bf16 v[92:95], v[28:31], v[176:179], v[92:95]
  ds_read_b64_tr_b16 v[24:25], v9 offset:25088
  ds_read_b64_tr_b16 v[26:27], v9 offset:29184
  s_waitcnt lgkmcnt(2)
  v_mfma_f32_16x16x32_bf16 v[64:67], v[16:19], v[180:183], v[64:67]
  ds_read_b64_tr_b16 v[28:29], v10 offset:25088
  ds_read_b64_tr_b16 v[30:31], v10 offset:29184
  v_mfma_f32_16x16x32_bf16 v[68:71], v[20:23], v[180:183], v[68:71]
  ds_read_b64_tr_b16 v[16:17], v9 offset:25600
  ds_read_b64_tr_b16 v[18:19], v9 offset:29696
  s_waitcnt lgkmcnt(2)
  v_mfma_f32_16x16x32_bf16 v[72:75], v[24:27], v[180:183], v[72:75]
  ds_read_b64_tr_b16 v[20:21], v10 offset:25600
  ds_read_b64_tr_b16 v[22:23], v10 offset:29696
  v_mfma_f32_16x16x32_bf16 v[76:79], v[28:31], v[180:183], v[76:79]
  ds_read_b64_tr_b16 v[24:25], v9 offset:26112
  ds_read_b64_tr_b16 v[26:27], v9 offset:30208
  s_waitcnt lgkmcnt(2)
  v_mfma_f32_16x16x32_bf16 v[80:83], v[16:19], v[180:183], v[80:83]
  ds_read_b64_tr_b16 v[28:29], v10 offset:26112
  ds_read_b64_tr_b16 v[30:31], v10 offset:30208
  v_mfma_f32_16x16x32_bf16 v[84:87], v[20:23], v[180:183], v[84:87]
  s_waitcnt lgkmcnt(0)
  v_mfma_f32_16x16x32_bf16 v[88:91], v[24:27], v[180:183], v[88:91]
  v_mfma_f32_16x16x32_bf16 v[92:95], v[28:31], v[180:183], v[92:95]
  s_waitcnt vmcnt(0)
  s_waitcnt lgkmcnt(0)
  s_barrier
  ds_read_b64_tr_b16 v[16:17], v9 offset:0
  ds_read_b64_tr_b16 v[18:19], v9 offset:4096
  ds_read_b64_tr_b16 v[20:21], v10 offset:0
  ds_read_b64_tr_b16 v[22:23], v10 offset:4096
  ds_read_b64_tr_b16 v[24:25], v9 offset:512
  ds_read_b64_tr_b16 v[26:27], v9 offset:4608
  s_waitcnt lgkmcnt(2)
  v_mfma_f32_16x16x32_bf16 v[64:67], v[16:19], v[184:187], v[64:67]
  ds_read_b64_tr_b16 v[28:29], v10 offset:512
  ds_read_b64_tr_b16 v[30:31], v10 offset:4608
  v_mfma_f32_16x16x32_bf16 v[68:71], v[20:23], v[184:187], v[68:71]
  ds_read_b64_tr_b16 v[16:17], v9 offset:1024
  ds_read_b64_tr_b16 v[18:19], v9 offset:5120
  s_waitcnt lgkmcnt(2)
  v_mfma_f32_16x16x32_bf16 v[72:75], v[24:27], v[184:187], v[72:75]
  ds_read_b64_tr_b16 v[20:21], v10 offset:1024
  ds_read_b64_tr_b16 v[22:23], v10 offset:5120
  v_mfma_f32_16x16x32_bf16 v[76:79], v[28:31], v[184:187], v[76:79]
  ds_read_b64_tr_b16 v[24:25], v9 offset:1536
  ds_read_b64_tr_b16 v[26:27], v9 offset:5632
  s_waitcnt lgkmcnt(2)
  v_mfma_f32_16x16x32_bf16 v[80:83], v[16:19], v[184:187], v[80:83]
  ds_read_b64_tr_b16 v[28:29], v10 offset:1536
  ds_read_b64_tr_b16 v[30:31], v10 offset:5632
  v_mfma_f32_16x16x32_bf16 v[84:87], v[20:23], v[184:187], v[84:87]
  ds_read_b64_tr_b16 v[16:17], v9 offset:8192
  ds_read_b64_tr_b16 v[18:19], v9 offset:12288
  s_waitcnt lgkmcnt(2)
  v_mfma_f32_16x16x32_bf16 v[88:91], v[24:27], v[184:187], v[88:91]
  ds_read_b64_tr_b16 v[20:21], v10 offset:8192
  ds_read_b64_tr_b16 v[22:23], v10 offset:12288
  v_mfma_f32_16x16x32_bf16 v[92:95], v[28:31], v[184:187], v[92:95]
  ds_read_b64_tr_b16 v[24:25], v9 offset:8704
  ds_read_b64_tr_b16 v[26:27], v9 offset:12800
  s_waitcnt lgkmcnt(2)
  v_mfma_f32_16x16x32_bf16 v[64:67], v[16:19], v[188:191], v[64:67]
  ds_read_b64_tr_b16 v[28:29], v10 offset:8704
  ds_read_b64_tr_b16 v[30:31], v10 offset:12800
  v_mfma_f32_16x16x32_bf16 v[68:71], v[20:23], v[188:191], v[68:71]
  ds_read_b64_tr_b16 v[16:17], v9 offset:9216
  ds_read_b64_tr_b16 v[18:19], v9 offset:13312
  s_waitcnt lgkmcnt(2)
  v_mfma_f32_16x16x32_bf16 v[72:75], v[24:27], v[188:191], v[72:75]
  ds_read_b64_tr_b16 v[20:21], v10 offset:9216
  ds_read_b64_tr_b16 v[22:23], v10 offset:13312
  v_mul_f32 v64, s50, v64
  v_mul_f32 v65, s50, v65
  v_mul_f32 v66, s50, v66
  v_mul_f32 v67, s50, v67
  v_cvt_pk_bf16_f32 v32, v64, v65
  v_cvt_pk_bf16_f32 v33, v66, v67
  v_mfma_f32_16x16x32_bf16 v[76:79], v[28:31], v[188:191], v[76:79]
  ds_read_b64_tr_b16 v[24:25], v9 offset:9728
  ds_read_b64_tr_b16 v[26:27], v9 offset:13824
  v_mul_f32 v68, s50, v68
  v_mul_f32 v69, s50, v69
  v_mul_f32 v70, s50, v70
  v_mul_f32 v71, s50, v71
  v_cvt_pk_bf16_f32 v34, v68, v69
  v_cvt_pk_bf16_f32 v35, v70, v71
  s_nop 0
  v_permlane16_swap_b32 v32, v34
  v_permlane16_swap_b32 v33, v35
  v_add_u32 v13, 131072, v11
  ds_write_b128 v13, v[32:35] offset:0
  s_waitcnt lgkmcnt(3)
  v_mfma_f32_16x16x32_bf16 v[80:83], v[16:19], v[188:191], v[80:83]
  ds_read_b64_tr_b16 v[28:29], v10 offset:9728
  ds_read_b64_tr_b16 v[30:31], v10 offset:13824
  v_mul_f32 v72, s50, v72
  v_mul_f32 v73, s50, v73
  v_mul_f32 v74, s50, v74
  v_mul_f32 v75, s50, v75
  v_cvt_pk_bf16_f32 v36, v72, v73
  v_cvt_pk_bf16_f32 v37, v74, v75
  v_mfma_f32_16x16x32_bf16 v[84:87], v[20:23], v[188:191], v[84:87]
  v_mul_f32 v76, s50, v76
  v_mul_f32 v77, s50, v77
  v_mul_f32 v78, s50, v78
  v_mul_f32 v79, s50, v79
  v_cvt_pk_bf16_f32 v38, v76, v77
  v_cvt_pk_bf16_f32 v39, v78, v79
  s_nop 0
  v_permlane16_swap_b32 v36, v38
  v_permlane16_swap_b32 v37, v39
  ds_write_b128 v13, v[36:39] offset:1024
  s_waitcnt lgkmcnt(1)
  v_mfma_f32_16x16x32_bf16 v[88:91], v[24:27], v[188:191], v[88:91]
  v_mul_f32 v80, s50, v80
  v_mul_f32 v81, s50, v81
  v_mul_f32 v82, s50, v82
  v_mul_f32 v83, s50, v83
  v_cvt_pk_bf16_f32 v40, v80, v81
  v_cvt_pk_bf16_f32 v41, v82, v83
  v_mfma_f32_16x16x32_bf16 v[92:95], v[28:31], v[188:191], v[92:95]
  v_mul_f32 v84, s50, v84
  v_mul_f32 v85, s50, v85
  v_mul_f32 v86, s50, v86
  v_mul_f32 v87, s50, v87
  v_cvt_pk_bf16_f32 v42, v84, v85
  v_cvt_pk_bf16_f32 v43, v86, v87
  s_nop 0
  v_permlane16_swap_b32 v40, v42
  v_permlane16_swap_b32 v41, v43
  ds_write_b128 v13, v[40:43] offset:2048
  v_mul_f32 v88, s50, v88
  v_mul_f32 v89, s50, v89
  v_mul_f32 v90, s50, v90
  v_mul_f32 v91, s50, v91
  v_cvt_pk_bf16_f32 v44, v88, v89
  v_cvt_pk_bf16_f32 v45, v90, v91
  v_mul_f32 v92, s50, v92
  v_mul_f32 v93, s50, v93
  v_mul_f32 v94, s50, v94
  v_mul_f32 v95, s50, v95
  v_cvt_pk_bf16_f32 v46, v92, v93
  v_cvt_pk_bf16_f32 v47, v94, v95
  s_nop 0
  v_permlane16_swap_b32 v44, v46
  v_permlane16_swap_b32 v45, v47
  ds_write_b128 v13, v[44:47] offset:3072
  s_waitcnt lgkmcnt(0)
L_h16:
  s_barrier
  s_cmp_lg_u32 s40, 3
  s_cbranch_scc1 L_skip_40
  buffer_load_dword v24, off, s[36:39], 0 sc1
L_skip_40:
  v_add_u32 v7, 98304, v7
  s_barrier
  s_xor_b32 s59, s68, 0
  s_add_u32 s59, s59, 0
  s_add_u32 m0, s69, 0
  s_nop 0
  buffer_load_dwordx4 v4, s[20:23], s59 offen lds
  s_add_u32 m0, s69, 1024
  s_add_u32 s59, s59, 8192
  buffer_load_dwordx4 v4, s[20:23], s59 offen lds
  s_add_u32 m0, s69, 2048
  s_add_u32 s59, s59, 8192
  buffer_load_dwordx4 v4, s[20:23], s59 offen lds
  s_add_u32 m0, s69, 3072
  s_add_u32 s59, s59, 8192
  buffer_load_dwordx4 v4, s[20:23], s59 offen lds
  s_xor_b32 s59, s68, 128
  s_add_u32 s59, s59, 0
  s_add_u32 m0, s69, 4096
  s_nop 0
  buffer_load_dwordx4 v4, s[20:23], s59 offen lds
  s_add_u32 m0, s69, 5120
  s_add_u32 s59, s59, 8192
  buffer_load_dwordx4 v4, s[20:23], s59 offen lds
  s_add_u32 m0, s69, 6144
  s_add_u32 s59, s59, 8192
  buffer_load_dwordx4 v4, s[20:23], s59 offen lds
  s_add_u32 m0, s69, 7168
  s_add_u32 s59, s59, 8192
  buffer_load_dwordx4 v4, s[20:23], s59 offen lds
  s_waitcnt vmcnt(4)
  s_cmp_lg_u32 s40, 3
  s_cbranch_scc1 L_skip_41
  v_cmp_eq_u32 vcc, 0, v24
  s_nop 0
  s_cbranch_vccz L_initok_42
  s_mov_b32 s64, 0
L_poll_43:
  buffer_load_dword v24, off, s[36:39], 0 sc1
  s_waitcnt vmcnt(0)
  v_cmp_eq_u32 vcc, 0, v24
  s_nop 0
  s_cbranch_vccz L_pollok_44
  s_add_u32 s64, s64, 1
  s_cmp_lt_u32 s64, 0x100000
  s_cbranch_scc1 L_poll_43
L_pollok_44:
L_initok_42:
L_skip_41:
  ds_read_b64_tr_b16 v[8:9], v5 offset:0
  ds_read_b64_tr_b16 v[10:11], v5 offset:2048
  ds_read_b64_tr_b16 v[12:13], v6 offset:0
  ds_read_b64_tr_b16 v[14:15], v6 offset:2048
  ds_read_b64_tr_b16 v[16:17], v5 offset:512
  ds_read_b64_tr_b16 v[18:19], v5 offset:2560
  ds_read_b64_tr_b16 v[20:21], v6 offset:512
  ds_read_b64_tr_b16 v[22:23], v6 offset:2560
  ds_read_b128 v[24:27], v7 offset:0
  ds_read_b128 v[28:31], v7 offset:1024
  s_waitcnt lgkmcnt(1)
  v_mfma_f32_16x16x32_bf16 v[32:35], v[8:11], v[24:27], 0
  ds_read_b128 v[0:3], v7 offset:2048
  v_mfma_f32_16x16x32_bf16 v[60:63], v[12:15], v[24:27], 0
  v_mfma_f32_16x16x32_bf16 v[88:91], v[16:19], v[24:27], 0
  v_mfma_f32_16x16x32_bf16 v[116:119], v[20:23], v[24:27], 0
  s_xor_b32 s59, s68, 32768
  s_add_u32 s59, s59, 0
  s_add_u32 m0, s69, 0
  s_nop 0
  buffer_load_dwordx4 v4, s[20:23], s59 offen lds
  s_add_u32 m0, s69, 1024
  s_add_u32 s59, s59, 8192
  buffer_load_dwordx4 v4, s[20:23], s59 offen lds
  s_add_u32 m0, s69, 2048
  s_add_u32 s59, s59, 8192
  buffer_load_dwordx4 v4, s[20:23], s59 offen lds
  s_add_u32 m0, s69, 3072
  s_add_u32 s59, s59, 8192
  buffer_load_dwordx4 v4, s[20:23], s59 offen lds
  s_waitcnt lgkmcnt(1)
  v_mfma_f32_16x16x32_bf16 v[36:39], v[8:11], v[28:31], 0
  ds_read_b128 v[24:27], v7 offset:3072
  v_mfma_f32_16x16x32_bf16 v[64:67], v[12:15], v[28:31], 0
  v_mfma_f32_16x16x32_bf16 v[92:95], v[16:19], v[28:31], 0
  v_mfma_f32_16x16x32_bf16 v[120:123], v[20:23], v[28:31], 0
  s_waitcnt lgkmcnt(1)
  v_mfma_f32_16x16x32_bf16 v[40:43], v[8:11], v[0:3], 0
  ds_read_b128 v[28:31], v7 offset:4096
  v_mfma_f32_16x16x32_bf16 v[68:71], v[12:15], v[0:3], 0
  v_mfma_f32_16x16x32_bf16 v[96:99], v[16:19], v[0:3], 0
  v_mfma_f32_16x16x32_bf16 v[124:127], v[20:23], v[0:3], 0
  s_waitcnt lgkmcnt(1)
  v_mfma_f32_16x16x32_bf16 v[44:47], v[8:11], v[24:27], 0
  ds_read_b128 v[0:3], v7 offset:5120
  v_mfma_f32_16x16x32_bf16 v[72:75], v[12:15], v[24:27], 0
  v_mfma_f32_16x16x32_bf16 v[100:103], v[16:19], v[24:27], 0
  v_mfma_f32_16x16x32_bf16 v[128:131], v[20:23], v[24:27], 0
  s_waitcnt lgkmcnt(1)
  v_mfma_f32_16x16x32_bf16 v[48:51], v[8:11], v[28:31], 0
  ds_read_b128 v[24:27], v7 offset:6144
  v_mfma_f32_16x16x32_bf16 v[76:79], v[12:15], v[28:31], 0
  v_mfma_f32_16x16x32_bf16 v[104:107], v[16:19], v[28:31], 0
  v_mfma_f32_16x16x32_bf16 v[132:135], v[20:23], v[28:31], 0
  s_waitcnt lgkmcnt(1)
  v_mfma_f32_16x16x32_bf16 v[52:55], v[8:11], v[0:3], 0
  ds_read_b128 v[28:31], v7 offset:0
  v_mfma_f32_16x16x32_bf16 v[80:83], v[12:15], v[0:3], 0
  v_mfma_f32_16x16x32_bf16 v[108:111], v[16:19], v[0:3], 0
  v_mfma_f32_16x16x32_bf16 v[136:139], v[20:23], v[0:3], 0
  s_waitcnt vmcnt(4)
  s_waitcnt lgkmcnt(1)
  v_mfma_f32_16x16x32_bf16 v[56:59], v[8:11], v[24:27], 0
  ds_read_b128 v[0:3], v7 offset:1024
  v_mfma_f32_16x16x32_bf16 v[84:87], v[12:15], v[24:27], 0
  ds_read_b64_tr_b16 v[8:9], v5 offset:4096
  ds_read_b64_tr_b16 v[10:11], v5 offset:6144
  v_mfma_f32_16x16x32_bf16 v[112:115], v[16:19], v[24:27], 0
  ds_read_b64_tr_b16 v[12:13], v6 offset:4096
  ds_read_b64_tr_b16 v[14:15], v6 offset:6144
  v_mfma_f32_16x16x32_bf16 v[140:143], v[20:23], v[24:27], 0
  ds_read_b64_tr_b16 v[16:17], v5 offset:4608
  ds_read_b64_tr_b16 v[18:19], v5 offset:6656
  ds_read_b64_tr_b16 v[20:21], v6 offset:4608
  ds_read_b64_tr_b16 v[22:23], v6 offset:6656
  s_waitcnt lgkmcnt(0)
  s_barrier
  v_mfma_f32_16x16x32_bf16 v[144:147], v[8:11], v[28:31], 0
  ds_read_b128 v[24:27], v7 offset:2048
  v_mfma_f32_16x16x32_bf16 v[172:175], v[12:15], v[28:31], 0
  v_mfma_f32_16x16x32_bf16 v[200:203], v[16:19], v[28:31], 0
  v_mfma_f32_16x16x32_bf16 v[228:231], v[20:23], v[28:31], 0
  s_xor_b32 s59, s68, 32896
  s_add_u32 s59, s59, 0
  s_add_u32 m0, s69, 4096
  s_nop 0
  buffer_load_dwordx4 v4, s[20:23], s59 offen lds
  s_add_u32 m0, s69, 5120
  s_add_u32 s59, s59, 8192
  buffer_load_dwordx4 v4, s[20:23], s59 offen lds
  s_add_u32 m0, s69, 6144
  s_add_u32 s59, s59, 8192
  buffer_load_dwordx4 v4, s[20:23], s59 offen lds
  s_add_u32 m0, s69, 7168
  s_add_u32 s59, s59, 8192
  buffer_load_dwordx4 v4, s[20:23], s59 offen lds
  v_mfma_f32_16x16x32_bf16 v[148:151], v[8:11], v[0:3], 0
  ds_read_b128 v[28:31], v7 offset:3072
  v_mfma_f32_16x16x32_bf16 v[176:179], v[12:15], v[0:3], 0
  v_mfma_f32_16x16x32_bf16 v[204:207], v[16:19], v[0:3], 0
  v_mfma_f32_16x16x32_bf16 v[232:235], v[20:23], v[0:3], 0
  s_waitcnt lgkmcnt(1)
  v_mfma_f32_16x16x32_bf16 v[152:155], v[8:11], v[24:27], 0
  ds_read_b128 v[0:3], v7 offset:4096
  v_mfma_f32_16x16x32_bf16 v[180:183], v[12:15], v[24:27], 0
  v_mfma_f32_16x16x32_bf16 v[208:211], v[16:19], v[24:27], 0
  v_mfma_f32_16x16x32_bf16 v[236:239], v[20:23], v[24:27], 0
  s_waitcnt lgkmcnt(1)
  v_mfma_f32_16x16x32_bf16 v[156:159], v[8:11], v[28:31], 0
  ds_read_b128 v[24:27], v7 offset:5120
  v_mfma_f32_16x16x32_bf16 v[184:187], v[12:15], v[28:31], 0
  v_mfma_f32_16x16x32_bf16 v[212:215], v[16:19], v[28:31], 0
  v_mfma_f32_16x16x32_bf16 v[240:243], v[20:23], v[28:31], 0
  s_waitcnt lgkmcnt(1)
  v_mfma_f32_16x16x32_bf16 v[160:163], v[8:11], v[0:3], 0
  ds_read_b128 v[28:31], v7 offset:6144
  v_mfma_f32_16x16x32_bf16 v[188:191], v[12:15], v[0:3], 0
  v_mfma_f32_16x16x32_bf16 v[216:219], v[16:19], v[0:3], 0
  v_mfma_f32_16x16x32_bf16 v[244:247], v[20:23], v[0:3], 0
  s_waitcnt lgkmcnt(1)
  v_mfma_f32_16x16x32_bf16 v[164:167], v[8:11], v[24:27], 0
  ds_read_b128 v[0:3], v7 offset:8192
  v_mfma_f32_16x16x32_bf16 v[192:195], v[12:15], v[24:27], 0
  v_mfma_f32_16x16x32_bf16 v[220:223], v[16:19], v[24:27], 0
  v_mfma_f32_16x16x32_bf16 v[248:251], v[20:23], v[24:27], 0
  s_waitcnt vmcnt(4)
  s_waitcnt lgkmcnt(1)
  v_mfma_f32_16x16x32_bf16 v[168:171], v[8:11], v[28:31], 0
  ds_read_b128 v[24:27], v7 offset:9216
  v_mfma_f32_16x16x32_bf16 v[196:199], v[12:15], v[28:31], 0
  ds_read_b64_tr_b16 v[8:9], v5 offset:0
  ds_read_b64_tr_b16 v[10:11], v5 offset:2048
  v_mfma_f32_16x16x32_bf16 v[224:227], v[16:19], v[28:31], 0
  ds_read_b64_tr_b16 v[12:13], v6 offset:0
  ds_read_b64_tr_b16 v[14:15], v6 offset:2048
  v_mfma_f32_16x16x32_bf16 v[252:255], v[20:23], v[28:31], 0
  ds_read_b64_tr_b16 v[16:17], v5 offset:512
  ds_read_b64_tr_b16 v[18:19], v5 offset:2560
  ds_read_b64_tr_b16 v[20:21], v6 offset:512
  ds_read_b64_tr_b16 v[22:23], v6 offset:2560
  s_waitcnt lgkmcnt(6)
  v_mfma_f32_16x16x32_bf16 v[32:35], v[8:11], v[0:3], v[32:35]
  ds_read_b128 v[28:31], v7 offset:10240
  s_waitcnt lgkmcnt(5)
  v_mfma_f32_16x16x32_bf16 v[60:63], v[12:15], v[0:3], v[60:63]
  s_waitcnt lgkmcnt(3)
  v_mfma_f32_16x16x32_bf16 v[88:91], v[16:19], v[0:3], v[88:91]
  s_waitcnt lgkmcnt(1)
  v_mfma_f32_16x16x32_bf16 v[116:119], v[20:23], v[0:3], v[116:119]
  v_mfma_f32_16x16x32_bf16 v[36:39], v[8:11], v[24:27], v[36:39]
  ds_read_b128 v[0:3], v7 offset:11264
  v_mfma_f32_16x16x32_bf16 v[64:67], v[12:15], v[24:27], v[64:67]
  v_mfma_f32_16x16x32_bf16 v[92:95], v[16:19], v[24:27], v[92:95]
  v_mfma_f32_16x16x32_bf16 v[120:123], v[20:23], v[24:27], v[120:123]
  s_waitcnt lgkmcnt(1)
  v_mfma_f32_16x16x32_bf16 v[40:43], v[8:11], v[28:31], v[40:43]
  ds_read_b128 v[24:27], v7 offset:12288
  v_mfma_f32_16x16x32_bf16 v[68:71], v[12:15], v[28:31], v[68:71]
  v_mfma_f32_16x16x32_bf16 v[96:99], v[16:19], v[28:31], v[96:99]
  v_mfma_f32_16x16x32_bf16 v[124:127], v[20:23], v[28:31], v[124:127]
  s_waitcnt lgkmcnt(1)
  v_mfma_f32_16x16x32_bf16 v[44:47], v[8:11], v[0:3], v[44:47]
  ds_read_b128 v[28:31], v7 offset:13312
  v_mfma_f32_16x16x32_bf16 v[72:75], v[12:15], v[0:3], v[72:75]
  v_mfma_f32_16x16x32_bf16 v[100:103], v[16:19], v[0:3], v[100:103]
  v_mfma_f32_16x16x32_bf16 v[128:131], v[20:23], v[0:3], v[128:131]
  s_waitcnt lgkmcnt(1)
  v_mfma_f32_16x16x32_bf16 v[48:51], v[8:11], v[24:27], v[48:51]
  ds_read_b128 v[0:3], v7 offset:14336
  v_mfma_f32_16x16x32_bf16 v[76:79], v[12:15], v[24:27], v[76:79]
  v_mfma_f32_16x16x32_bf16 v[104:107], v[16:19], v[24:27], v[104:107]
  v_mfma_f32_16x16x32_bf16 v[132:135], v[20:23], v[24:27], v[132:135]
  s_waitcnt lgkmcnt(0)
  s_barrier
  v_mfma_f32_16x16x32_bf16 v[52:55], v[8:11], v[28:31], v[52:55]
  ds_read_b128 v[24:27], v7 offset:8192
  v_mfma_f32_16x16x32_bf16 v[80:83], v[12:15], v[28:31], v[80:83]
  v_mfma_f32_16x16x32_bf16 v[108:111], v[16:19], v[28:31], v[108:111]
  v_mfma_f32_16x16x32_bf16 v[136:139], v[20:23], v[28:31], v[136:139]
  s_xor_b32 s59, s68, 65536
  s_add_u32 s59, s59, 0
  s_add_u32 m0, s69, 0
  s_nop 0
  buffer_load_dwordx4 v4, s[20:23], s59 offen lds
  s_add_u32 m0, s69, 1024
  s_add_u32 s59, s59, 8192
  buffer_load_dwordx4 v4, s[20:23], s59 offen lds
  s_add_u32 m0, s69, 2048
  s_add_u32 s59, s59, 8192
  buffer_load_dwordx4 v4, s[20:23], s59 offen lds
  s_add_u32 m0, s69, 3072
  s_add_u32 s59, s59, 8192
  buffer_load_dwordx4 v4, s[20:23], s59 offen lds
  s_waitcnt vmcnt(4)
  v_mfma_f32_16x16x32_bf16 v[56:59], v[8:11], v[0:3], v[56:59]
  ds_read_b128 v[28:31], v7 offset:9216
  v_mfma_f32_16x16x32_bf16 v[84:87], v[12:15], v[0:3], v[84:87]
  ds_read_b64_tr_b16 v[8:9], v5 offset:4096
  ds_read_b64_tr_b16 v[10:11], v5 offset:6144
  v_mfma_f32_16x16x32_bf16 v[112:115], v[16:19], v[0:3], v[112:115]
  ds_read_b64_tr_b16 v[12:13], v6 offset:4096
  ds_read_b64_tr_b16 v[14:15], v6 offset:6144
  v_mfma_f32_16x16x32_bf16 v[140:143], v[20:23], v[0:3], v[140:143]
  ds_read_b64_tr_b16 v[16:17], v5 offset:4608
  ds_read_b64_tr_b16 v[18:19], v5 offset:6656
  ds_read_b64_tr_b16 v[20:21], v6 offset:4608
  ds_read_b64_tr_b16 v[22:23], v6 offset:6656
  s_waitcnt lgkmcnt(6)
  v_mfma_f32_16x16x32_bf16 v[144:147], v[8:11], v[24:27], v[144:147]
  ds_read_b128 v[0:3], v7 offset:10240
  s_waitcnt lgkmcnt(5)
  v_mfma_f32_16x16x32_bf16 v[172:175], v[12:15], v[24:27], v[172:175]
  s_waitcnt lgkmcnt(3)
  v_mfma_f32_16x16x32_bf16 v[200:203], v[16:19], v[24:27], v[200:203]
  s_waitcnt lgkmcnt(1)
  v_mfma_f32_16x16x32_bf16 v[228:231], v[20:23], v[24:27], v[228:231]
  s_xor_b32 s59, s68, 65664
  s_add_u32 s59, s59, 0
  s_add_u32 m0, s69, 4096
  s_nop 0
  buffer_load_dwordx4 v4, s[20:23], s59 offen lds
  s_add_u32 m0, s69, 5120
  s_add_u32 s59, s59, 8192
  buffer_load_dwordx4 v4, s[20:23], s59 offen lds
  s_add_u32 m0, s69, 6144
  s_add_u32 s59, s59, 8192
  buffer_load_dwordx4 v4, s[20:23], s59 offen lds
  s_add_u32 m0, s69, 7168
  s_add_u32 s59, s59, 8192
  buffer_load_dwordx4 v4, s[20:23], s59 offen lds
  v_mfma_f32_16x16x32_bf16 v[148:151], v[8:11], v[28:31], v[148:151]
  ds_read_b128 v[24:27], v7 offset:11264
  v_mfma_f32_16x16x32_bf16 v[176:179], v[12:15], v[28:31], v[176:179]
  v_mfma_f32_16x16x32_bf16 v[204:207], v[16:19], v[28:31], v[204:207]
  v_mfma_f32_16x16x32_bf16 v[232:235], v[20:23], v[28:31], v[232:235]
  s_waitcnt lgkmcnt(1)
  v_mfma_f32_16x16x32_bf16 v[152:155], v[8:11], v[0:3], v[152:155]
  ds_read_b128 v[28:31], v7 offset:12288
  v_mfma_f32_16x16x32_bf16 v[180:183], v[12:15], v[0:3], v[180:183]
  v_mfma_f32_16x16x32_bf16 v[208:211], v[16:19], v[0:3], v[208:211]
  v_mfma_f32_16x16x32_bf16 v[236:239], v[20:23], v[0:3], v[236:239]
  s_waitcnt lgkmcnt(1)
  v_mfma_f32_16x16x32_bf16 v[156:159], v[8:11], v[24:27], v[156:159]
  ds_read_b128 v[0:3], v7 offset:13312
  v_mfma_f32_16x16x32_bf16 v[184:187], v[12:15], v[24:27], v[184:187]
  v_mfma_f32_16x16x32_bf16 v[212:215], v[16:19], v[24:27], v[212:215]
  v_mfma_f32_16x16x32_bf16 v[240:243], v[20:23], v[24:27], v[240:243]
  s_waitcnt lgkmcnt(1)
  v_mfma_f32_16x16x32_bf16 v[160:163], v[8:11], v[28:31], v[160:163]
  ds_read_b128 v[24:27], v7 offset:14336
  v_mfma_f32_16x16x32_bf16 v[188:191], v[12:15], v[28:31], v[188:191]
  v_mfma_f32_16x16x32_bf16 v[216:219], v[16:19], v[28:31], v[216:219]
  v_mfma_f32_16x16x32_bf16 v[244:247], v[20:23], v[28:31], v[244:247]
  s_waitcnt lgkmcnt(1)
  v_mfma_f32_16x16x32_bf16 v[164:167], v[8:11], v[0:3], v[164:167]
  ds_read_b128 v[28:31], v7 offset:16384
  v_mfma_f32_16x16x32_bf16 v[192:195], v[12:15], v[0:3], v[192:195]
  v_mfma_f32_16x16x32_bf16 v[220:223], v[16:19], v[0:3], v[220:223]
  v_mfma_f32_16x16x32_bf16 v[248:251], v[20:23], v[0:3], v[248:251]
  s_waitcnt vmcnt(4)
  s_waitcnt lgkmcnt(1)
  v_mfma_f32_16x16x32_bf16 v[168:171], v[8:11], v[24:27], v[168:171]
  ds_read_b128 v[0:3], v7 offset:17408
  v_mfma_f32_16x16x32_bf16 v[196:199], v[12:15], v[24:27], v[196:199]
  ds_read_b64_tr_b16 v[8:9], v5 offset:0
  ds_read_b64_tr_b16 v[10:11], v5 offset:2048
  v_mfma_f32_16x16x32_bf16 v[224:227], v[16:19], v[24:27], v[224:227]
  ds_read_b64_tr_b16 v[12:13], v6 offset:0
  ds_read_b64_tr_b16 v[14:15], v6 offset:2048
  v_mfma_f32_16x16x32_bf16 v[252:255], v[20:23], v[24:27], v[252:255]
  ds_read_b64_tr_b16 v[16:17], v5 offset:512
  ds_read_b64_tr_b16 v[18:19], v5 offset:2560
  ds_read_b64_tr_b16 v[20:21], v6 offset:512
  ds_read_b64_tr_b16 v[22:23], v6 offset:2560
  s_waitcnt lgkmcnt(6)
  v_mfma_f32_16x16x32_bf16 v[32:35], v[8:11], v[28:31], v[32:35]
  ds_read_b128 v[24:27], v7 offset:18432
  s_waitcnt lgkmcnt(5)
  v_mfma_f32_16x16x32_bf16 v[60:63], v[12:15], v[28:31], v[60:63]
  s_waitcnt lgkmcnt(3)
  v_mfma_f32_16x16x32_bf16 v[88:91], v[16:19], v[28:31], v[88:91]
  s_waitcnt lgkmcnt(1)
  v_mfma_f32_16x16x32_bf16 v[116:119], v[20:23], v[28:31], v[116:119]
  v_mfma_f32_16x16x32_bf16 v[36:39], v[8:11], v[0:3], v[36:39]
  ds_read_b128 v[28:31], v7 offset:19456
  v_mfma_f32_16x16x32_bf16 v[64:67], v[12:15], v[0:3], v[64:67]
  v_mfma_f32_16x16x32_bf16 v[92:95], v[16:19], v[0:3], v[92:95]
  v_mfma_f32_16x16x32_bf16 v[120:123], v[20:23], v[0:3], v[120:123]
  s_waitcnt lgkmcnt(1)
  v_mfma_f32_16x16x32_bf16 v[40:43], v[8:11], v[24:27], v[40:43]
  ds_read_b128 v[0:3], v7 offset:20480
  v_mfma_f32_16x16x32_bf16 v[68:71], v[12:15], v[24:27], v[68:71]
  v_mfma_f32_16x16x32_bf16 v[96:99], v[16:19], v[24:27], v[96:99]
  v_mfma_f32_16x16x32_bf16 v[124:127], v[20:23], v[24:27], v[124:127]
  s_waitcnt lgkmcnt(0)
  s_barrier
  v_mfma_f32_16x16x32_bf16 v[44:47], v[8:11], v[28:31], v[44:47]
  ds_read_b128 v[24:27], v7 offset:21504
  v_mfma_f32_16x16x32_bf16 v[72:75], v[12:15], v[28:31], v[72:75]
  v_mfma_f32_16x16x32_bf16 v[100:103], v[16:19], v[28:31], v[100:103]
  v_mfma_f32_16x16x32_bf16 v[128:131], v[20:23], v[28:31], v[128:131]
  s_xor_b32 s59, s68, 98304
  s_add_u32 s59, s59, 0
  s_add_u32 m0, s69, 0
  s_nop 0
  buffer_load_dwordx4 v4, s[20:23], s59 offen lds
  s_add_u32 m0, s69, 1024
  s_add_u32 s59, s59, 8192
  buffer_load_dwordx4 v4, s[20:23], s59 offen lds
  s_add_u32 m0, s69, 2048
  s_add_u32 s59, s59, 8192
  buffer_load_dwordx4 v4, s[20:23], s59 offen lds
  s_add_u32 m0, s69, 3072
  s_add_u32 s59, s59, 8192
  buffer_load_dwordx4 v4, s[20:23], s59 offen lds
  v_mfma_f32_16x16x32_bf16 v[48:51], v[8:11], v[0:3], v[48:51]
  ds_read_b128 v[28:31], v7 offset:22528
  v_mfma_f32_16x16x32_bf16 v[76:79], v[12:15], v[0:3], v[76:79]
  v_mfma_f32_16x16x32_bf16 v[104:107], v[16:19], v[0:3], v[104:107]
  v_mfma_f32_16x16x32_bf16 v[132:135], v[20:23], v[0:3], v[132:135]
  s_waitcnt lgkmcnt(1)
  v_mfma_f32_16x16x32_bf16 v[52:55], v[8:11], v[24:27], v[52:55]
  ds_read_b128 v[0:3], v7 offset:16384
  v_mfma_f32_16x16x32_bf16 v[80:83], v[12:15], v[24:27], v[80:83]
  v_mfma_f32_16x16x32_bf16 v[108:111], v[16:19], v[24:27], v[108:111]
  v_mfma_f32_16x16x32_bf16 v[136:139], v[20:23], v[24:27], v[136:139]
  s_waitcnt vmcnt(4)
  s_waitcnt lgkmcnt(1)
  v_mfma_f32_16x16x32_bf16 v[56:59], v[8:11], v[28:31], v[56:59]
  ds_read_b128 v[24:27], v7 offset:17408
  v_mfma_f32_16x16x32_bf16 v[84:87], v[12:15], v[28:31], v[84:87]
  ds_read_b64_tr_b16 v[8:9], v5 offset:4096
  ds_read_b64_tr_b16 v[10:11], v5 offset:6144
  v_mfma_f32_16x16x32_bf16 v[112:115], v[16:19], v[28:31], v[112:115]
  ds_read_b64_tr_b16 v[12:13], v6 offset:4096
  ds_read_b64_tr_b16 v[14:15], v6 offset:6144
  v_mfma_f32_16x16x32_bf16 v[140:143], v[20:23], v[28:31], v[140:143]
  ds_read_b64_tr_b16 v[16:17], v5 offset:4608
  ds_read_b64_tr_b16 v[18:19], v5 offset:6656
  ds_read_b64_tr_b16 v[20:21], v6 offset:4608
  ds_read_b64_tr_b16 v[22:23], v6 offset:6656
  s_waitcnt lgkmcnt(6)
  v_mfma_f32_16x16x32_bf16 v[144:147], v[8:11], v[0:3], v[144:147]
  ds_read_b128 v[28:31], v7 offset:18432
  s_waitcnt lgkmcnt(5)
  v_mfma_f32_16x16x32_bf16 v[172:175], v[12:15], v[0:3], v[172:175]
  s_waitcnt lgkmcnt(3)
  v_mfma_f32_16x16x32_bf16 v[200:203], v[16:19], v[0:3], v[200:203]
  s_waitcnt lgkmcnt(1)
  v_mfma_f32_16x16x32_bf16 v[228:231], v[20:23], v[0:3], v[228:231]
  s_xor_b32 s59, s68, 98432
  s_add_u32 s59, s59, 0
  s_add_u32 m0, s69, 4096
  s_nop 0
  buffer_load_dwordx4 v4, s[20:23], s59 offen lds
  s_add_u32 m0, s69, 5120
  s_add_u32 s59, s59, 8192
  buffer_load_dwordx4 v4, s[20:23], s59 offen lds
  s_add_u32 m0, s69, 6144
  s_add_u32 s59, s59, 8192
  buffer_load_dwordx4 v4, s[20:23], s59 offen lds
  s_add_u32 m0, s69, 7168
  s_add_u32 s59, s59, 8192
  buffer_load_dwordx4 v4, s[20:23], s59 offen lds
  v_mfma_f32_16x16x32_bf16 v[148:151], v[8:11], v[24:27], v[148:151]
  ds_read_b128 v[0:3], v7 offset:19456
  v_mfma_f32_16x16x32_bf16 v[176:179], v[12:15], v[24:27], v[176:179]
  v_mfma_f32_16x16x32_bf16 v[204:207], v[16:19], v[24:27], v[204:207]
  v_mfma_f32_16x16x32_bf16 v[232:235], v[20:23], v[24:27], v[232:235]
  s_waitcnt lgkmcnt(1)
  v_mfma_f32_16x16x32_bf16 v[152:155], v[8:11], v[28:31], v[152:155]
  ds_read_b128 v[24:27], v7 offset:20480
  v_mfma_f32_16x16x32_bf16 v[180:183], v[12:15], v[28:31], v[180:183]
  v_mfma_f32_16x16x32_bf16 v[208:211], v[16:19], v[28:31], v[208:211]
  v_mfma_f32_16x16x32_bf16 v[236:239], v[20:23], v[28:31], v[236:239]
  s_waitcnt lgkmcnt(1)
  v_mfma_f32_16x16x32_bf16 v[156:159], v[8:11], v[0:3], v[156:159]
  ds_read_b128 v[28:31], v7 offset:21504
  v_mfma_f32_16x16x32_bf16 v[184:187], v[12:15], v[0:3], v[184:187]
  v_mfma_f32_16x16x32_bf16 v[212:215], v[16:19], v[0:3], v[212:215]
  v_mfma_f32_16x16x32_bf16 v[240:243], v[20:23], v[0:3], v[240:243]
  s_waitcnt lgkmcnt(1)
  v_mfma_f32_16x16x32_bf16 v[160:163], v[8:11], v[24:27], v[160:163]
  ds_read_b128 v[0:3], v7 offset:22528
  v_mfma_f32_16x16x32_bf16 v[188:191], v[12:15], v[24:27], v[188:191]
  v_mfma_f32_16x16x32_bf16 v[216:219], v[16:19], v[24:27], v[216:219]
  v_mfma_f32_16x16x32_bf16 v[244:247], v[20:23], v[24:27], v[244:247]
  s_waitcnt lgkmcnt(1)
  v_mfma_f32_16x16x32_bf16 v[164:167], v[8:11], v[28:31], v[164:167]
  ds_read_b128 v[24:27], v7 offset:24576
  v_mfma_f32_16x16x32_bf16 v[192:195], v[12:15], v[28:31], v[192:195]
  v_mfma_f32_16x16x32_bf16 v[220:223], v[16:19], v[28:31], v[220:223]
  v_mfma_f32_16x16x32_bf16 v[248:251], v[20:23], v[28:31], v[248:251]
  s_waitcnt vmcnt(4)
  s_waitcnt lgkmcnt(1)
  v_mfma_f32_16x16x32_bf16 v[168:171], v[8:11], v[0:3], v[168:171]
  ds_read_b128 v[28:31], v7 offset:25600
  v_mfma_f32_16x16x32_bf16 v[196:199], v[12:15], v[0:3], v[196:199]
  ds_read_b64_tr_b16 v[8:9], v5 offset:0
  ds_read_b64_tr_b16 v[10:11], v5 offset:2048
  v_mfma_f32_16x16x32_bf16 v[224:227], v[16:19], v[0:3], v[224:227]
  ds_read_b64_tr_b16 v[12:13], v6 offset:0
  ds_read_b64_tr_b16 v[14:15], v6 offset:2048
  v_mfma_f32_16x16x32_bf16 v[252:255], v[20:23], v[0:3], v[252:255]
  ds_read_b64_tr_b16 v[16:17], v5 offset:512
  ds_read_b64_tr_b16 v[18:19], v5 offset:2560
  ds_read_b64_tr_b16 v[20:21], v6 offset:512
  ds_read_b64_tr_b16 v[22:23], v6 offset:2560
  s_waitcnt lgkmcnt(6)
  v_mfma_f32_16x16x32_bf16 v[32:35], v[8:11], v[24:27], v[32:35]
  ds_read_b128 v[0:3], v7 offset:26624
  s_waitcnt lgkmcnt(5)
  v_mfma_f32_16x16x32_bf16 v[60:63], v[12:15], v[24:27], v[60:63]
  s_waitcnt lgkmcnt(3)
  v_mfma_f32_16x16x32_bf16 v[88:91], v[16:19], v[24:27], v[88:91]
  s_waitcnt lgkmcnt(1)
  v_mfma_f32_16x16x32_bf16 v[116:119], v[20:23], v[24:27], v[116:119]
  s_waitcnt lgkmcnt(0)
  s_barrier
  v_mfma_f32_16x16x32_bf16 v[36:39], v[8:11], v[28:31], v[36:39]
  ds_read_b128 v[24:27], v7 offset:27648
  v_mfma_f32_16x16x32_bf16 v[64:67], v[12:15], v[28:31], v[64:67]
  v_mfma_f32_16x16x32_bf16 v[92:95], v[16:19], v[28:31], v[92:95]
  v_mfma_f32_16x16x32_bf16 v[120:123], v[20:23], v[28:31], v[120:123]
  s_xor_b32 s59, s68, 0
  s_add_u32 s59, s59, 131072
  s_add_u32 m0, s69, 0
  s_nop 0
  buffer_load_dwordx4 v4, s[20:23], s59 offen lds
  s_add_u32 m0, s69, 1024
  s_add_u32 s59, s59, 8192
  buffer_load_dwordx4 v4, s[20:23], s59 offen lds
  s_add_u32 m0, s69, 2048
  s_add_u32 s59, s59, 8192
  buffer_load_dwordx4 v4, s[20:23], s59 offen lds
  s_add_u32 m0, s69, 3072
  s_add_u32 s59, s59, 8192
  buffer_load_dwordx4 v4, s[20:23], s59 offen lds
  v_mfma_f32_16x16x32_bf16 v[40:43], v[8:11], v[0:3], v[40:43]
  ds_read_b128 v[28:31], v7 offset:28672
  v_mfma_f32_16x16x32_bf16 v[68:71], v[12:15], v[0:3], v[68:71]
  v_mfma_f32_16x16x32_bf16 v[96:99], v[16:19], v[0:3], v[96:99]
  v_mfma_f32_16x16x32_bf16 v[124:127], v[20:23], v[0:3], v[124:127]
  s_waitcnt lgkmcnt(1)
  v_mfma_f32_16x16x32_bf16 v[44:47], v[8:11], v[24:27], v[44:47]
  ds_read_b128 v[0:3], v7 offset:29696
  v_mfma_f32_16x16x32_bf16 v[72:75], v[12:15], v[24:27], v[72:75]
  v_mfma_f32_16x16x32_bf16 v[100:103], v[16:19], v[24:27], v[100:103]
  v_mfma_f32_16x16x32_bf16 v[128:131], v[20:23], v[24:27], v[128:131]
  s_waitcnt lgkmcnt(1)
  v_mfma_f32_16x16x32_bf16 v[48:51], v[8:11], v[28:31], v[48:51]
  ds_read_b128 v[24:27], v7 offset:30720
  v_mfma_f32_16x16x32_bf16 v[76:79], v[12:15], v[28:31], v[76:79]
  v_mfma_f32_16x16x32_bf16 v[104:107], v[16:19], v[28:31], v[104:107]
  v_mfma_f32_16x16x32_bf16 v[132:135], v[20:23], v[28:31], v[132:135]
  s_waitcnt lgkmcnt(1)
  v_mfma_f32_16x16x32_bf16 v[52:55], v[8:11], v[0:3], v[52:55]
  ds_read_b128 v[28:31], v7 offset:24576
  v_mfma_f32_16x16x32_bf16 v[80:83], v[12:15], v[0:3], v[80:83]
  v_mfma_f32_16x16x32_bf16 v[108:111], v[16:19], v[0:3], v[108:111]
  v_mfma_f32_16x16x32_bf16 v[136:139], v[20:23], v[0:3], v[136:139]
  s_waitcnt vmcnt(4)
  s_waitcnt lgkmcnt(1)
  v_mfma_f32_16x16x32_bf16 v[56:59], v[8:11], v[24:27], v[56:59]
  ds_read_b128 v[0:3], v7 offset:25600
  v_mfma_f32_16x16x32_bf16 v[84:87], v[12:15], v[24:27], v[84:87]
  ds_read_b64_tr_b16 v[8:9], v5 offset:4096
  ds_read_b64_tr_b16 v[10:11], v5 offset:6144
  v_mfma_f32_16x16x32_bf16 v[112:115], v[16:19], v[24:27], v[112:115]
  ds_read_b64_tr_b16 v[12:13], v6 offset:4096
  ds_read_b64_tr_b16 v[14:15], v6 offset:6144
  v_mfma_f32_16x16x32_bf16 v[140:143], v[20:23], v[24:27], v[140:143]
  ds_read_b64_tr_b16 v[16:17], v5 offset:4608
  ds_read_b64_tr_b16 v[18:19], v5 offset:6656
  ds_read_b64_tr_b16 v[20:21], v6 offset:4608
  ds_read_b64_tr_b16 v[22:23], v6 offset:6656
  s_waitcnt lgkmcnt(6)
  v_mfma_f32_16x16x32_bf16 v[144:147], v[8:11], v[28:31], v[144:147]
  ds_read_b128 v[24:27], v7 offset:26624
  s_waitcnt lgkmcnt(5)
  v_mfma_f32_16x16x32_bf16 v[172:175], v[12:15], v[28:31], v[172:175]
  s_waitcnt lgkmcnt(3)
  v_mfma_f32_16x16x32_bf16 v[200:203], v[16:19], v[28:31], v[200:203]
  s_waitcnt lgkmcnt(1)
  v_mfma_f32_16x16x32_bf16 v[228:231], v[20:23], v[28:31], v[228:231]
  s_xor_b32 s59, s68, 128
  s_add_u32 s59, s59, 131072
  s_add_u32 m0, s69, 4096
  s_nop 0
  buffer_load_dwordx4 v4, s[20:23], s59 offen lds
  s_add_u32 m0, s69, 5120
  s_add_u32 s59, s59, 8192
  buffer_load_dwordx4 v4, s[20:23], s59 offen lds
  s_add_u32 m0, s69, 6144
  s_add_u32 s59, s59, 8192
  buffer_load_dwordx4 v4, s[20:23], s59 offen lds
  s_add_u32 m0, s69, 7168
  s_add_u32 s59, s59, 8192
  buffer_load_dwordx4 v4, s[20:23], s59 offen lds
  v_mfma_f32_16x16x32_bf16 v[148:151], v[8:11], v[0:3], v[148:151]
  ds_read_b128 v[28:31], v7 offset:27648
  v_mfma_f32_16x16x32_bf16 v[176:179], v[12:15], v[0:3], v[176:179]
  v_mfma_f32_16x16x32_bf16 v[204:207], v[16:19], v[0:3], v[204:207]
  v_mfma_f32_16x16x32_bf16 v[232:235], v[20:23], v[0:3], v[232:235]
  s_waitcnt lgkmcnt(1)
  v_mfma_f32_16x16x32_bf16 v[152:155], v[8:11], v[24:27], v[152:155]
  ds_read_b128 v[0:3], v7 offset:28672
  v_mfma_f32_16x16x32_bf16 v[180:183], v[12:15], v[24:27], v[180:183]
  v_mfma_f32_16x16x32_bf16 v[208:211], v[16:19], v[24:27], v[208:211]
  v_mfma_f32_16x16x32_bf16 v[236:239], v[20:23], v[24:27], v[236:239]
  s_waitcnt lgkmcnt(1)
  v_mfma_f32_16x16x32_bf16 v[156:159], v[8:11], v[28:31], v[156:159]
  ds_read_b128 v[24:27], v7 offset:29696
  v_mfma_f32_16x16x32_bf16 v[184:187], v[12:15], v[28:31], v[184:187]
  v_mfma_f32_16x16x32_bf16 v[212:215], v[16:19], v[28:31], v[212:215]
  v_mfma_f32_16x16x32_bf16 v[240:243], v[20:23], v[28:31], v[240:243]
  s_waitcnt lgkmcnt(1)
  v_mfma_f32_16x16x32_bf16 v[160:163], v[8:11], v[0:3], v[160:163]
  ds_read_b128 v[28:31], v7 offset:30720
  v_mfma_f32_16x16x32_bf16 v[188:191], v[12:15], v[0:3], v[188:191]
  v_mfma_f32_16x16x32_bf16 v[216:219], v[16:19], v[0:3], v[216:219]
  v_mfma_f32_16x16x32_bf16 v[244:247], v[20:23], v[0:3], v[244:247]
  s_waitcnt lgkmcnt(1)
  v_mfma_f32_16x16x32_bf16 v[164:167], v[8:11], v[24:27], v[164:167]
  ds_read_b128 v[0:3], v7 offset:0
  v_mfma_f32_16x16x32_bf16 v[192:195], v[12:15], v[24:27], v[192:195]
  v_mfma_f32_16x16x32_bf16 v[220:223], v[16:19], v[24:27], v[220:223]
  v_mfma_f32_16x16x32_bf16 v[248:251], v[20:23], v[24:27], v[248:251]
  s_waitcnt lgkmcnt(0)
  s_barrier
  s_waitcnt vmcnt(4)
  v_mfma_f32_16x16x32_bf16 v[168:171], v[8:11], v[28:31], v[168:171]
  ds_read_b128 v[24:27], v7 offset:1024
  v_mfma_f32_16x16x32_bf16 v[196:199], v[12:15], v[28:31], v[196:199]
  ds_read_b64_tr_b16 v[8:9], v5 offset:0
  ds_read_b64_tr_b16 v[10:11], v5 offset:2048
  v_mfma_f32_16x16x32_bf16 v[224:227], v[16:19], v[28:31], v[224:227]
  ds_read_b64_tr_b16 v[12:13], v6 offset:0
  ds_read_b64_tr_b16 v[14:15], v6 offset:2048
  v_mfma_f32_16x16x32_bf16 v[252:255], v[20:23], v[28:31], v[252:255]
  ds_read_b64_tr_b16 v[16:17], v5 offset:512
  ds_read_b64_tr_b16 v[18:19], v5 offset:2560
  ds_read_b64_tr_b16 v[20:21], v6 offset:512
  ds_read_b64_tr_b16 v[22:23], v6 offset:2560
  s_waitcnt lgkmcnt(6)
  v_mfma_f32_16x16x32_bf16 v[32:35], v[8:11], v[0:3], v[32:35]
  ds_read_b128 v[28:31], v7 offset:2048
  s_waitcnt lgkmcnt(5)
  v_mfma_f32_16x16x32_bf16 v[60:63], v[12:15], v[0:3], v[60:63]
  s_waitcnt lgkmcnt(3)
  v_mfma_f32_16x16x32_bf16 v[88:91], v[16:19], v[0:3], v[88:91]
  s_waitcnt lgkmcnt(1)
  v_mfma_f32_16x16x32_bf16 v[116:119], v[20:23], v[0:3], v[116:119]
  s_xor_b32 s59, s68, 32768
  s_add_u32 s59, s59, 131072
  s_add_u32 m0, s69, 0
  s_nop 0
  buffer_load_dwordx4 v4, s[20:23], s59 offen lds
  s_add_u32 m0, s69, 1024
  s_add_u32 s59, s59, 8192
  buffer_load_dwordx4 v4, s[20:23], s59 offen lds
  s_add_u32 m0, s69, 2048
  s_add_u32 s59, s59, 8192
  buffer_load_dwordx4 v4, s[20:23], s59 offen lds
  s_add_u32 m0, s69, 3072
  s_add_u32 s59, s59, 8192
  buffer_load_dwordx4 v4, s[20:23], s59 offen lds
  v_mfma_f32_16x16x32_bf16 v[36:39], v[8:11], v[24:27], v[36:39]
  ds_read_b128 v[0:3], v7 offset:3072
  v_mfma_f32_16x16x32_bf16 v[64:67], v[12:15], v[24:27], v[64:67]
  v_mfma_f32_16x16x32_bf16 v[92:95], v[16:19], v[24:27], v[92:95]
  v_mfma_f32_16x16x32_bf16 v[120:123], v[20:23], v[24:27], v[120:123]
  s_waitcnt lgkmcnt(1)
  v_mfma_f32_16x16x32_bf16 v[40:43], v[8:11], v[28:31], v[40:43]
  ds_read_b128 v[24:27], v7 offset:4096
  v_mfma_f32_16x16x32_bf16 v[68:71], v[12:15], v[28:31], v[68:71]
  v_mfma_f32_16x16x32_bf16 v[96:99], v[16:19], v[28:31], v[96:99]
  v_mfma_f32_16x16x32_bf16 v[124:127], v[20:23], v[28:31], v[124:127]
  s_waitcnt lgkmcnt(1)
  v_mfma_f32_16x16x32_bf16 v[44:47], v[8:11], v[0:3], v[44:47]
  ds_read_b128 v[28:31], v7 offset:5120
  v_mfma_f32_16x16x32_bf16 v[72:75], v[12:15], v[0:3], v[72:75]
  v_mfma_f32_16x16x32_bf16 v[100:103], v[16:19], v[0:3], v[100:103]
  v_mfma_f32_16x16x32_bf16 v[128:131], v[20:23], v[0:3], v[128:131]
  s_waitcnt lgkmcnt(1)
  v_mfma_f32_16x16x32_bf16 v[48:51], v[8:11], v[24:27], v[48:51]
  ds_read_b128 v[0:3], v7 offset:6144
  v_mfma_f32_16x16x32_bf16 v[76:79], v[12:15], v[24:27], v[76:79]
  v_mfma_f32_16x16x32_bf16 v[104:107], v[16:19], v[24:27], v[104:107]
  v_mfma_f32_16x16x32_bf16 v[132:135], v[20:23], v[24:27], v[132:135]
  s_waitcnt lgkmcnt(1)
  v_mfma_f32_16x16x32_bf16 v[52:55], v[8:11], v[28:31], v[52:55]
  ds_read_b128 v[24:27], v7 offset:0
  v_mfma_f32_16x16x32_bf16 v[80:83], v[12:15], v[28:31], v[80:83]
  v_mfma_f32_16x16x32_bf16 v[108:111], v[16:19], v[28:31], v[108:111]
  v_mfma_f32_16x16x32_bf16 v[136:139], v[20:23], v[28:31], v[136:139]
  s_waitcnt vmcnt(4)
  s_waitcnt lgkmcnt(1)
  v_mfma_f32_16x16x32_bf16 v[56:59], v[8:11], v[0:3], v[56:59]
  ds_read_b128 v[28:31], v7 offset:1024
  v_mfma_f32_16x16x32_bf16 v[84:87], v[12:15], v[0:3], v[84:87]
  ds_read_b64_tr_b16 v[8:9], v5 offset:4096
  ds_read_b64_tr_b16 v[10:11], v5 offset:6144
  v_mfma_f32_16x16x32_bf16 v[112:115], v[16:19], v[0:3], v[112:115]
  ds_read_b64_tr_b16 v[12:13], v6 offset:4096
  ds_read_b64_tr_b16 v[14:15], v6 offset:6144
  v_mfma_f32_16x16x32_bf16 v[140:143], v[20:23], v[0:3], v[140:143]
  ds_read_b64_tr_b16 v[16:17], v5 offset:4608
  ds_read_b64_tr_b16 v[18:19], v5 offset:6656
  ds_read_b64_tr_b16 v[20:21], v6 offset:4608
  ds_read_b64_tr_b16 v[22:23], v6 offset:6656
  s_waitcnt lgkmcnt(6)
  v_mfma_f32_16x16x32_bf16 v[144:147], v[8:11], v[24:27], v[144:147]
  ds_read_b128 v[0:3], v7 offset:2048
  s_waitcnt lgkmcnt(5)
  v_mfma_f32_16x16x32_bf16 v[172:175], v[12:15], v[24:27], v[172:175]
  s_waitcnt lgkmcnt(3)
  v_mfma_f32_16x16x32_bf16 v[200:203], v[16:19], v[24:27], v[200:203]
  s_waitcnt lgkmcnt(1)
  v_mfma_f32_16x16x32_bf16 v[228:231], v[20:23], v[24:27], v[228:231]
  v_mfma_f32_16x16x32_bf16 v[148:151], v[8:11], v[28:31], v[148:151]
  ds_read_b128 v[24:27], v7 offset:3072
  v_mfma_f32_16x16x32_bf16 v[176:179], v[12:15], v[28:31], v[176:179]
  v_mfma_f32_16x16x32_bf16 v[204:207], v[16:19], v[28:31], v[204:207]
  v_mfma_f32_16x16x32_bf16 v[232:235], v[20:23], v[28:31], v[232:235]
  s_waitcnt lgkmcnt(1)
  v_mfma_f32_16x16x32_bf16 v[152:155], v[8:11], v[0:3], v[152:155]
  ds_read_b128 v[28:31], v7 offset:4096
  v_mfma_f32_16x16x32_bf16 v[180:183], v[12:15], v[0:3], v[180:183]
  v_mfma_f32_16x16x32_bf16 v[208:211], v[16:19], v[0:3], v[208:211]
  v_mfma_f32_16x16x32_bf16 v[236:239], v[20:23], v[0:3], v[236:239]
  s_waitcnt lgkmcnt(1)
  v_mfma_f32_16x16x32_bf16 v[156:159], v[8:11], v[24:27], v[156:159]
  ds_read_b128 v[0:3], v7 offset:5120
  v_mfma_f32_16x16x32_bf16 v[184:187], v[12:15], v[24:27], v[184:187]
  v_mfma_f32_16x16x32_bf16 v[212:215], v[16:19], v[24:27], v[212:215]
  v_mfma_f32_16x16x32_bf16 v[240:243], v[20:23], v[24:27], v[240:243]
  s_waitcnt lgkmcnt(0)
  s_barrier
  v_mfma_f32_16x16x32_bf16 v[160:163], v[8:11], v[28:31], v[160:163]
  ds_read_b128 v[24:27], v7 offset:6144
  v_mfma_f32_16x16x32_bf16 v[188:191], v[12:15], v[28:31], v[188:191]
  v_mfma_f32_16x16x32_bf16 v[216:219], v[16:19], v[28:31], v[216:219]
  v_mfma_f32_16x16x32_bf16 v[244:247], v[20:23], v[28:31], v[244:247]
  s_xor_b32 s59, s68, 32896
  s_add_u32 s59, s59, 131072
  s_add_u32 m0, s69, 4096
  s_nop 0
  buffer_load_dwordx4 v4, s[20:23], s59 offen lds
  s_add_u32 m0, s69, 5120
  s_add_u32 s59, s59, 8192
  buffer_load_dwordx4 v4, s[20:23], s59 offen lds
  s_add_u32 m0, s69, 6144
  s_add_u32 s59, s59, 8192
  buffer_load_dwordx4 v4, s[20:23], s59 offen lds
  s_add_u32 m0, s69, 7168
  s_add_u32 s59, s59, 8192
  buffer_load_dwordx4 v4, s[20:23], s59 offen lds
  v_mfma_f32_16x16x32_bf16 v[164:167], v[8:11], v[0:3], v[164:167]
  ds_read_b128 v[28:31], v7 offset:8192
  v_mfma_f32_16x16x32_bf16 v[192:195], v[12:15], v[0:3], v[192:195]
  v_mfma_f32_16x16x32_bf16 v[220:223], v[16:19], v[0:3], v[220:223]
  v_mfma_f32_16x16x32_bf16 v[248:251], v[20:23], v[0:3], v[248:251]
  s_waitcnt vmcnt(4)
  s_waitcnt lgkmcnt(1)
  v_mfma_f32_16x16x32_bf16 v[168:171], v[8:11], v[24:27], v[168:171]
  ds_read_b128 v[0:3], v7 offset:9216
  v_mfma_f32_16x16x32_bf16 v[196:199], v[12:15], v[24:27], v[196:199]
  ds_read_b64_tr_b16 v[8:9], v5 offset:0
  ds_read_b64_tr_b16 v[10:11], v5 offset:2048
  v_mfma_f32_16x16x32_bf16 v[224:227], v[16:19], v[24:27], v[224:227]
  ds_read_b64_tr_b16 v[12:13], v6 offset:0
  ds_read_b64_tr_b16 v[14:15], v6 offset:2048
  v_mfma_f32_16x16x32_bf16 v[252:255], v[20:23], v[24:27], v[252:255]
  ds_read_b64_tr_b16 v[16:17], v5 offset:512
  ds_read_b64_tr_b16 v[18:19], v5 offset:2560
  ds_read_b64_tr_b16 v[20:21], v6 offset:512
  ds_read_b64_tr_b16 v[22:23], v6 offset:2560
  s_waitcnt lgkmcnt(6)
  v_mfma_f32_16x16x32_bf16 v[32:35], v[8:11], v[28:31], v[32:35]
  ds_read_b128 v[24:27], v7 offset:10240
  s_waitcnt lgkmcnt(5)
  v_mfma_f32_16x16x32_bf16 v[60:63], v[12:15], v[28:31], v[60:63]
  s_waitcnt lgkmcnt(3)
  v_mfma_f32_16x16x32_bf16 v[88:91], v[16:19], v[28:31], v[88:91]
  s_waitcnt lgkmcnt(1)
  v_mfma_f32_16x16x32_bf16 v[116:119], v[20:23], v[28:31], v[116:119]
  s_xor_b32 s59, s68, 65536
  s_add_u32 s59, s59, 131072
  s_add_u32 m0, s69, 0
  s_nop 0
  buffer_load_dwordx4 v4, s[20:23], s59 offen lds
  s_add_u32 m0, s69, 1024
  s_add_u32 s59, s59, 8192
  buffer_load_dwordx4 v4, s[20:23], s59 offen lds
  s_add_u32 m0, s69, 2048
  s_add_u32 s59, s59, 8192
  buffer_load_dwordx4 v4, s[20:23], s59 offen lds
  s_add_u32 m0, s69, 3072
  s_add_u32 s59, s59, 8192
  buffer_load_dwordx4 v4, s[20:23], s59 offen lds
  v_mfma_f32_16x16x32_bf16 v[36:39], v[8:11], v[0:3], v[36:39]
  ds_read_b128 v[28:31], v7 offset:11264
  v_mfma_f32_16x16x32_bf16 v[64:67], v[12:15], v[0:3], v[64:67]
  v_mfma_f32_16x16x32_bf16 v[92:95], v[16:19], v[0:3], v[92:95]
  v_mfma_f32_16x16x32_bf16 v[120:123], v[20:23], v[0:3], v[120:123]
  s_waitcnt lgkmcnt(1)
  v_mfma_f32_16x16x32_bf16 v[40:43], v[8:11], v[24:27], v[40:43]
  ds_read_b128 v[0:3], v7 offset:12288
  v_mfma_f32_16x16x32_bf16 v[68:71], v[12:15], v[24:27], v[68:71]
  v_mfma_f32_16x16x32_bf16 v[96:99], v[16:19], v[24:27], v[96:99]
  v_mfma_f32_16x16x32_bf16 v[124:127], v[20:23], v[24:27], v[124:127]
  s_waitcnt lgkmcnt(1)
  v_mfma_f32_16x16x32_bf16 v[44:47], v[8:11], v[28:31], v[44:47]
  ds_read_b128 v[24:27], v7 offset:13312
  v_mfma_f32_16x16x32_bf16 v[72:75], v[12:15], v[28:31], v[72:75]
  v_mfma_f32_16x16x32_bf16 v[100:103], v[16:19], v[28:31], v[100:103]
  v_mfma_f32_16x16x32_bf16 v[128:131], v[20:23], v[28:31], v[128:131]
  s_waitcnt lgkmcnt(1)
  v_mfma_f32_16x16x32_bf16 v[48:51], v[8:11], v[0:3], v[48:51]
  ds_read_b128 v[28:31], v7 offset:14336
  v_mfma_f32_16x16x32_bf16 v[76:79], v[12:15], v[0:3], v[76:79]
  v_mfma_f32_16x16x32_bf16 v[104:107], v[16:19], v[0:3], v[104:107]
  v_mfma_f32_16x16x32_bf16 v[132:135], v[20:23], v[0:3], v[132:135]
  s_waitcnt lgkmcnt(1)
  v_mfma_f32_16x16x32_bf16 v[52:55], v[8:11], v[24:27], v[52:55]
  ds_read_b128 v[0:3], v7 offset:8192
  v_mfma_f32_16x16x32_bf16 v[80:83], v[12:15], v[24:27], v[80:83]
  v_mfma_f32_16x16x32_bf16 v[108:111], v[16:19], v[24:27], v[108:111]
  v_mfma_f32_16x16x32_bf16 v[136:139], v[20:23], v[24:27], v[136:139]
  s_waitcnt vmcnt(4)
  s_waitcnt lgkmcnt(1)
  v_mfma_f32_16x16x32_bf16 v[56:59], v[8:11], v[28:31], v[56:59]
  ds_read_b128 v[24:27], v7 offset:9216
  v_mfma_f32_16x16x32_bf16 v[84:87], v[12:15], v[28:31], v[84:87]
  ds_read_b64_tr_b16 v[8:9], v5 offset:4096
  ds_read_b64_tr_b16 v[10:11], v5 offset:6144
  v_mfma_f32_16x16x32_bf16 v[112:115], v[16:19], v[28:31], v[112:115]
  ds_read_b64_tr_b16 v[12:13], v6 offset:4096
  ds_read_b64_tr_b16 v[14:15], v6 offset:6144
  v_mfma_f32_16x16x32_bf16 v[140:143], v[20:23], v[28:31], v[140:143]
  ds_read_b64_tr_b16 v[16:17], v5 offset:4608
  ds_read_b64_tr_b16 v[18:19], v5 offset:6656
  ds_read_b64_tr_b16 v[20:21], v6 offset:4608
  ds_read_b64_tr_b16 v[22:23], v6 offset:6656
  s_waitcnt lgkmcnt(6)
  v_mfma_f32_16x16x32_bf16 v[144:147], v[8:11], v[0:3], v[144:147]
  ds_read_b128 v[28:31], v7 offset:10240
  s_waitcnt lgkmcnt(5)
  v_mfma_f32_16x16x32_bf16 v[172:175], v[12:15], v[0:3], v[172:175]
  s_waitcnt lgkmcnt(3)
  v_mfma_f32_16x16x32_bf16 v[200:203], v[16:19], v[0:3], v[200:203]
  s_waitcnt lgkmcnt(1)
  v_mfma_f32_16x16x32_bf16 v[228:231], v[20:23], v[0:3], v[228:231]
  v_mfma_f32_16x16x32_bf16 v[148:151], v[8:11], v[24:27], v[148:151]
  ds_read_b128 v[0:3], v7 offset:11264
  v_mfma_f32_16x16x32_bf16 v[176:179], v[12:15], v[24:27], v[176:179]
  v_mfma_f32_16x16x32_bf16 v[204:207], v[16:19], v[24:27], v[204:207]
  v_mfma_f32_16x16x32_bf16 v[232:235], v[20:23], v[24:27], v[232:235]
  s_waitcnt lgkmcnt(1)
  v_mfma_f32_16x16x32_bf16 v[152:155], v[8:11], v[28:31], v[152:155]
  ds_read_b128 v[24:27], v7 offset:12288
  v_mfma_f32_16x16x32_bf16 v[180:183], v[12:15], v[28:31], v[180:183]
  v_mfma_f32_16x16x32_bf16 v[208:211], v[16:19], v[28:31], v[208:211]
  v_mfma_f32_16x16x32_bf16 v[236:239], v[20:23], v[28:31], v[236:239]
  s_waitcnt lgkmcnt(1)
  v_mfma_f32_16x16x32_bf16 v[156:159], v[8:11], v[0:3], v[156:159]
  ds_read_b128 v[28:31], v7 offset:13312
  v_mfma_f32_16x16x32_bf16 v[184:187], v[12:15], v[0:3], v[184:187]
  v_mfma_f32_16x16x32_bf16 v[212:215], v[16:19], v[0:3], v[212:215]
  v_mfma_f32_16x16x32_bf16 v[240:243], v[20:23], v[0:3], v[240:243]
  s_waitcnt lgkmcnt(1)
  v_mfma_f32_16x16x32_bf16 v[160:163], v[8:11], v[24:27], v[160:163]
  ds_read_b128 v[0:3], v7 offset:14336
  v_mfma_f32_16x16x32_bf16 v[188:191], v[12:15], v[24:27], v[188:191]
  v_mfma_f32_16x16x32_bf16 v[216:219], v[16:19], v[24:27], v[216:219]
  v_mfma_f32_16x16x32_bf16 v[244:247], v[20:23], v[24:27], v[244:247]
  s_waitcnt lgkmcnt(0)
  s_barrier
  v_mfma_f32_16x16x32_bf16 v[164:167], v[8:11], v[28:31], v[164:167]
  ds_read_b128 v[24:27], v7 offset:16384
  v_mfma_f32_16x16x32_bf16 v[192:195], v[12:15], v[28:31], v[192:195]
  v_mfma_f32_16x16x32_bf16 v[220:223], v[16:19], v[28:31], v[220:223]
  v_mfma_f32_16x16x32_bf16 v[248:251], v[20:23], v[28:31], v[248:251]
  s_xor_b32 s59, s68, 65664
  s_add_u32 s59, s59, 131072
  s_add_u32 m0, s69, 4096
  s_nop 0
  buffer_load_dwordx4 v4, s[20:23], s59 offen lds
  s_add_u32 m0, s69, 5120
  s_add_u32 s59, s59, 8192
  buffer_load_dwordx4 v4, s[20:23], s59 offen lds
  s_add_u32 m0, s69, 6144
  s_add_u32 s59, s59, 8192
  buffer_load_dwordx4 v4, s[20:23], s59 offen lds
  s_add_u32 m0, s69, 7168
  s_add_u32 s59, s59, 8192
  buffer_load_dwordx4 v4, s[20:23], s59 offen lds
  s_waitcnt vmcnt(4)
  v_mfma_f32_16x16x32_bf16 v[168:171], v[8:11], v[0:3], v[168:171]
  ds_read_b128 v[28:31], v7 offset:17408
  v_mfma_f32_16x16x32_bf16 v[196:199], v[12:15], v[0:3], v[196:199]
  ds_read_b64_tr_b16 v[8:9], v5 offset:0
  ds_read_b64_tr_b16 v[10:11], v5 offset:2048
  v_mfma_f32_16x16x32_bf16 v[224:227], v[16:19], v[0:3], v[224:227]
  ds_read_b64_tr_b16 v[12:13], v6 offset:0
  ds_read_b64_tr_b16 v[14:15], v6 offset:2048
  v_mfma_f32_16x16x32_bf16 v[252:255], v[20:23], v[0:3], v[252:255]
  ds_read_b64_tr_b16 v[16:17], v5 offset:512
  ds_read_b64_tr_b16 v[18:19], v5 offset:2560
  ds_read_b64_tr_b16 v[20:21], v6 offset:512
  ds_read_b64_tr_b16 v[22:23], v6 offset:2560
  s_waitcnt lgkmcnt(6)
  v_mfma_f32_16x16x32_bf16 v[32:35], v[8:11], v[24:27], v[32:35]
  ds_read_b128 v[0:3], v7 offset:18432
  s_waitcnt lgkmcnt(5)
  v_mfma_f32_16x16x32_bf16 v[60:63], v[12:15], v[24:27], v[60:63]
  s_waitcnt lgkmcnt(3)
  v_mfma_f32_16x16x32_bf16 v[88:91], v[16:19], v[24:27], v[88:91]
  s_waitcnt lgkmcnt(1)
  v_mfma_f32_16x16x32_bf16 v[116:119], v[20:23], v[24:27], v[116:119]
  s_xor_b32 s59, s68, 98304
  s_add_u32 s59, s59, 131072
  s_add_u32 m0, s69, 0
  s_nop 0
  buffer_load_dwordx4 v4, s[20:23], s59 offen lds
  s_add_u32 m0, s69, 1024
  s_add_u32 s59, s59, 8192
  buffer_load_dwordx4 v4, s[20:23], s59 offen lds
  s_add_u32 m0, s69, 2048
  s_add_u32 s59, s59, 8192
  buffer_load_dwordx4 v4, s[20:23], s59 offen lds
  s_add_u32 m0, s69, 3072
  s_add_u32 s59, s59, 8192
  buffer_load_dwordx4 v4, s[20:23], s59 offen lds
  v_mfma_f32_16x16x32_bf16 v[36:39], v[8:11], v[28:31], v[36:39]
  ds_read_b128 v[24:27], v7 offset:19456
  v_mfma_f32_16x16x32_bf16 v[64:67], v[12:15], v[28:31], v[64:67]
  v_mfma_f32_16x16x32_bf16 v[92:95], v[16:19], v[28:31], v[92:95]
  v_mfma_f32_16x16x32_bf16 v[120:123], v[20:23], v[28:31], v[120:123]
  s_waitcnt lgkmcnt(1)
  v_mfma_f32_16x16x32_bf16 v[40:43], v[8:11], v[0:3], v[40:43]
  ds_read_b128 v[28:31], v7 offset:20480
  v_mfma_f32_16x16x32_bf16 v[68:71], v[12:15], v[0:3], v[68:71]
  v_mfma_f32_16x16x32_bf16 v[96:99], v[16:19], v[0:3], v[96:99]
  v_mfma_f32_16x16x32_bf16 v[124:127], v[20:23], v[0:3], v[124:127]
  s_waitcnt lgkmcnt(1)
  v_mfma_f32_16x16x32_bf16 v[44:47], v[8:11], v[24:27], v[44:47]
  ds_read_b128 v[0:3], v7 offset:21504
  v_mfma_f32_16x16x32_bf16 v[72:75], v[12:15], v[24:27], v[72:75]
  v_mfma_f32_16x16x32_bf16 v[100:103], v[16:19], v[24:27], v[100:103]
  v_mfma_f32_16x16x32_bf16 v[128:131], v[20:23], v[24:27], v[128:131]
  s_waitcnt lgkmcnt(1)
  v_mfma_f32_16x16x32_bf16 v[48:51], v[8:11], v[28:31], v[48:51]
  ds_read_b128 v[24:27], v7 offset:22528
  v_mfma_f32_16x16x32_bf16 v[76:79], v[12:15], v[28:31], v[76:79]
  v_mfma_f32_16x16x32_bf16 v[104:107], v[16:19], v[28:31], v[104:107]
  v_mfma_f32_16x16x32_bf16 v[132:135], v[20:23], v[28:31], v[132:135]
  s_waitcnt lgkmcnt(1)
  v_mfma_f32_16x16x32_bf16 v[52:55], v[8:11], v[0:3], v[52:55]
  ds_read_b128 v[28:31], v7 offset:16384
  v_mfma_f32_16x16x32_bf16 v[80:83], v[12:15], v[0:3], v[80:83]
  v_mfma_f32_16x16x32_bf16 v[108:111], v[16:19], v[0:3], v[108:111]
  v_mfma_f32_16x16x32_bf16 v[136:139], v[20:23], v[0:3], v[136:139]
  s_waitcnt vmcnt(4)
  s_waitcnt lgkmcnt(1)
  v_mfma_f32_16x16x32_bf16 v[56:59], v[8:11], v[24:27], v[56:59]
  ds_read_b128 v[0:3], v7 offset:17408
  v_mfma_f32_16x16x32_bf16 v[84:87], v[12:15], v[24:27], v[84:87]
  ds_read_b64_tr_b16 v[8:9], v5 offset:4096
  ds_read_b64_tr_b16 v[10:11], v5 offset:6144
  v_mfma_f32_16x16x32_bf16 v[112:115], v[16:19], v[24:27], v[112:115]
  ds_read_b64_tr_b16 v[12:13], v6 offset:4096
  ds_read_b64_tr_b16 v[14:15], v6 offset:6144
  v_mfma_f32_16x16x32_bf16 v[140:143], v[20:23], v[24:27], v[140:143]
  ds_read_b64_tr_b16 v[16:17], v5 offset:4608
  ds_read_b64_tr_b16 v[18:19], v5 offset:6656
  ds_read_b64_tr_b16 v[20:21], v6 offset:4608
  ds_read_b64_tr_b16 v[22:23], v6 offset:6656
  s_waitcnt lgkmcnt(6)
  v_mfma_f32_16x16x32_bf16 v[144:147], v[8:11], v[28:31], v[144:147]
  ds_read_b128 v[24:27], v7 offset:18432
  s_waitcnt lgkmcnt(5)
  v_mfma_f32_16x16x32_bf16 v[172:175], v[12:15], v[28:31], v[172:175]
  s_waitcnt lgkmcnt(3)
  v_mfma_f32_16x16x32_bf16 v[200:203], v[16:19], v[28:31], v[200:203]
  s_waitcnt lgkmcnt(1)
  v_mfma_f32_16x16x32_bf16 v[228:231], v[20:23], v[28:31], v[228:231]
  v_mfma_f32_16x16x32_bf16 v[148:151], v[8:11], v[0:3], v[148:151]
  ds_read_b128 v[28:31], v7 offset:19456
  v_mfma_f32_16x16x32_bf16 v[176:179], v[12:15], v[0:3], v[176:179]
  v_mfma_f32_16x16x32_bf16 v[204:207], v[16:19], v[0:3], v[204:207]
  v_mfma_f32_16x16x32_bf16 v[232:235], v[20:23], v[0:3], v[232:235]
  s_waitcnt lgkmcnt(1)
  v_mfma_f32_16x16x32_bf16 v[152:155], v[8:11], v[24:27], v[152:155]
  ds_read_b128 v[0:3], v7 offset:20480
  v_mfma_f32_16x16x32_bf16 v[180:183], v[12:15], v[24:27], v[180:183]
  v_mfma_f32_16x16x32_bf16 v[208:211], v[16:19], v[24:27], v[208:211]
  v_mfma_f32_16x16x32_bf16 v[236:239], v[20:23], v[24:27], v[236:239]
  s_waitcnt lgkmcnt(0)
  s_barrier
  v_mfma_f32_16x16x32_bf16 v[156:159], v[8:11], v[28:31], v[156:159]
  ds_read_b128 v[24:27], v7 offset:21504
  v_mfma_f32_16x16x32_bf16 v[184:187], v[12:15], v[28:31], v[184:187]
  v_mfma_f32_16x16x32_bf16 v[212:215], v[16:19], v[28:31], v[212:215]
  v_mfma_f32_16x16x32_bf16 v[240:243], v[20:23], v[28:31], v[240:243]
  s_xor_b32 s59, s68, 98432
  s_add_u32 s59, s59, 131072
  s_add_u32 m0, s69, 4096
  s_nop 0
  buffer_load_dwordx4 v4, s[20:23], s59 offen lds
  s_add_u32 m0, s69, 5120
  s_add_u32 s59, s59, 8192
  buffer_load_dwordx4 v4, s[20:23], s59 offen lds
  s_add_u32 m0, s69, 6144
  s_add_u32 s59, s59, 8192
  buffer_load_dwordx4 v4, s[20:23], s59 offen lds
  s_add_u32 m0, s69, 7168
  s_add_u32 s59, s59, 8192
  buffer_load_dwordx4 v4, s[20:23], s59 offen lds
  v_mfma_f32_16x16x32_bf16 v[160:163], v[8:11], v[0:3], v[160:163]
  ds_read_b128 v[28:31], v7 offset:22528
  v_mfma_f32_16x16x32_bf16 v[188:191], v[12:15], v[0:3], v[188:191]
  v_mfma_f32_16x16x32_bf16 v[216:219], v[16:19], v[0:3], v[216:219]
  v_mfma_f32_16x16x32_bf16 v[244:247], v[20:23], v[0:3], v[244:247]
  s_waitcnt lgkmcnt(1)
  v_mfma_f32_16x16x32_bf16 v[164:167], v[8:11], v[24:27], v[164:167]
  ds_read_b128 v[0:3], v7 offset:24576
  v_mfma_f32_16x16x32_bf16 v[192:195], v[12:15], v[24:27], v[192:195]
  v_mfma_f32_16x16x32_bf16 v[220:223], v[16:19], v[24:27], v[220:223]
  v_mfma_f32_16x16x32_bf16 v[248:251], v[20:23], v[24:27], v[248:251]
  s_waitcnt vmcnt(4)
  s_waitcnt lgkmcnt(1)
  v_mfma_f32_16x16x32_bf16 v[168:171], v[8:11], v[28:31], v[168:171]
  ds_read_b128 v[24:27], v7 offset:25600
  v_mfma_f32_16x16x32_bf16 v[196:199], v[12:15], v[28:31], v[196:199]
  ds_read_b64_tr_b16 v[8:9], v5 offset:0
  ds_read_b64_tr_b16 v[10:11], v5 offset:2048
  v_mfma_f32_16x16x32_bf16 v[224:227], v[16:19], v[28:31], v[224:227]
  ds_read_b64_tr_b16 v[12:13], v6 offset:0
  ds_read_b64_tr_b16 v[14:15], v6 offset:2048
  v_mfma_f32_16x16x32_bf16 v[252:255], v[20:23], v[28:31], v[252:255]
  ds_read_b64_tr_b16 v[16:17], v5 offset:512
  ds_read_b64_tr_b16 v[18:19], v5 offset:2560
  ds_read_b64_tr_b16 v[20:21], v6 offset:512
  ds_read_b64_tr_b16 v[22:23], v6 offset:2560
  s_waitcnt lgkmcnt(6)
  v_mfma_f32_16x16x32_bf16 v[32:35], v[8:11], v[0:3], v[32:35]
  ds_read_b128 v[28:31], v7 offset:26624
  s_waitcnt lgkmcnt(5)
  v_mfma_f32_16x16x32_bf16 v[60:63], v[12:15], v[0:3], v[60:63]
  s_waitcnt lgkmcnt(3)
  v_mfma_f32_16x16x32_bf16 v[88:91], v[16:19], v[0:3], v[88:91]
  s_waitcnt lgkmcnt(1)
  v_mfma_f32_16x16x32_bf16 v[116:119], v[20:23], v[0:3], v[116:119]
  s_xor_b32 s59, s68, 0
  s_add_u32 s59, s59, 262144
  s_add_u32 m0, s69, 0
  s_nop 0
  buffer_load_dwordx4 v4, s[20:23], s59 offen lds
  s_add_u32 m0, s69, 1024
  s_add_u32 s59, s59, 8192
  buffer_load_dwordx4 v4, s[20:23], s59 offen lds
  s_add_u32 m0, s69, 2048
  s_add_u32 s59, s59, 8192
  buffer_load_dwordx4 v4, s[20:23], s59 offen lds
  s_add_u32 m0, s69, 3072
  s_add_u32 s59, s59, 8192
  buffer_load_dwordx4 v4, s[20:23], s59 offen lds
  v_mfma_f32_16x16x32_bf16 v[36:39], v[8:11], v[24:27], v[36:39]
  ds_read_b128 v[0:3], v7 offset:27648
  v_mfma_f32_16x16x32_bf16 v[64:67], v[12:15], v[24:27], v[64:67]
  v_mfma_f32_16x16x32_bf16 v[92:95], v[16:19], v[24:27], v[92:95]
  v_mfma_f32_16x16x32_bf16 v[120:123], v[20:23], v[24:27], v[120:123]
  s_waitcnt lgkmcnt(1)
  v_mfma_f32_16x16x32_bf16 v[40:43], v[8:11], v[28:31], v[40:43]
  ds_read_b128 v[24:27], v7 offset:28672
  v_mfma_f32_16x16x32_bf16 v[68:71], v[12:15], v[28:31], v[68:71]
  v_mfma_f32_16x16x32_bf16 v[96:99], v[16:19], v[28:31], v[96:99]
  v_mfma_f32_16x16x32_bf16 v[124:127], v[20:23], v[28:31], v[124:127]
  s_waitcnt lgkmcnt(1)
  v_mfma_f32_16x16x32_bf16 v[44:47], v[8:11], v[0:3], v[44:47]
  ds_read_b128 v[28:31], v7 offset:29696
  v_mfma_f32_16x16x32_bf16 v[72:75], v[12:15], v[0:3], v[72:75]
  v_mfma_f32_16x16x32_bf16 v[100:103], v[16:19], v[0:3], v[100:103]
  v_mfma_f32_16x16x32_bf16 v[128:131], v[20:23], v[0:3], v[128:131]
  s_waitcnt lgkmcnt(1)
  v_mfma_f32_16x16x32_bf16 v[48:51], v[8:11], v[24:27], v[48:51]
  ds_read_b128 v[0:3], v7 offset:30720
  v_mfma_f32_16x16x32_bf16 v[76:79], v[12:15], v[24:27], v[76:79]
  v_mfma_f32_16x16x32_bf16 v[104:107], v[16:19], v[24:27], v[104:107]
  v_mfma_f32_16x16x32_bf16 v[132:135], v[20:23], v[24:27], v[132:135]
  s_waitcnt lgkmcnt(1)
  v_mfma_f32_16x16x32_bf16 v[52:55], v[8:11], v[28:31], v[52:55]
  ds_read_b128 v[24:27], v7 offset:24576
  v_mfma_f32_16x16x32_bf16 v[80:83], v[12:15], v[28:31], v[80:83]
  v_mfma_f32_16x16x32_bf16 v[108:111], v[16:19], v[28:31], v[108:111]
  v_mfma_f32_16x16x32_bf16 v[136:139], v[20:23], v[28:31], v[136:139]
  s_waitcnt vmcnt(4)
  s_waitcnt lgkmcnt(1)
  v_mfma_f32_16x16x32_bf16 v[56:59], v[8:11], v[0:3], v[56:59]
  ds_read_b128 v[28:31], v7 offset:25600
  v_mfma_f32_16x16x32_bf16 v[84:87], v[12:15], v[0:3], v[84:87]
  ds_read_b64_tr_b16 v[8:9], v5 offset:4096
  ds_read_b64_tr_b16 v[10:11], v5 offset:6144
  v_mfma_f32_16x16x32_bf16 v[112:115], v[16:19], v[0:3], v[112:115]
  ds_read_b64_tr_b16 v[12:13], v6 offset:4096
  ds_read_b64_tr_b16 v[14:15], v6 offset:6144
  v_mfma_f32_16x16x32_bf16 v[140:143], v[20:23], v[0:3], v[140:143]
  ds_read_b64_tr_b16 v[16:17], v5 offset:4608
  ds_read_b64_tr_b16 v[18:19], v5 offset:6656
  ds_read_b64_tr_b16 v[20:21], v6 offset:4608
  ds_read_b64_tr_b16 v[22:23], v6 offset:6656
  s_waitcnt lgkmcnt(6)
  v_mfma_f32_16x16x32_bf16 v[144:147], v[8:11], v[24:27], v[144:147]
  ds_read_b128 v[0:3], v7 offset:26624
  s_waitcnt lgkmcnt(5)
  v_mfma_f32_16x16x32_bf16 v[172:175], v[12:15], v[24:27], v[172:175]
  s_waitcnt lgkmcnt(3)
  v_mfma_f32_16x16x32_bf16 v[200:203], v[16:19], v[24:27], v[200:203]
  s_waitcnt lgkmcnt(1)
  v_mfma_f32_16x16x32_bf16 v[228:231], v[20:23], v[24:27], v[228:231]
  s_waitcnt lgkmcnt(0)
  s_barrier
  v_mfma_f32_16x16x32_bf16 v[148:151], v[8:11], v[28:31], v[148:151]
  ds_read_b128 v[24:27], v7 offset:27648
  v_mfma_f32_16x16x32_bf16 v[176:179], v[12:15], v[28:31], v[176:179]
  v_mfma_f32_16x16x32_bf16 v[204:207], v[16:19], v[28:31], v[204:207]
  v_mfma_f32_16x16x32_bf16 v[232:235], v[20:23], v[28:31], v[232:235]
  s_xor_b32 s59, s68, 128
  s_add_u32 s59, s59, 262144
  s_add_u32 m0, s69, 4096
  s_nop 0
  buffer_load_dwordx4 v4, s[20:23], s59 offen lds
  s_add_u32 m0, s69, 5120
  s_add_u32 s59, s59, 8192
  buffer_load_dwordx4 v4, s[20:23], s59 offen lds
  s_add_u32 m0, s69, 6144
  s_add_u32 s59, s59, 8192
  buffer_load_dwordx4 v4, s[20:23], s59 offen lds
  s_add_u32 m0, s69, 7168
  s_add_u32 s59, s59, 8192
  buffer_load_dwordx4 v4, s[20:23], s59 offen lds
  v_mfma_f32_16x16x32_bf16 v[152:155], v[8:11], v[0:3], v[152:155]
  ds_read_b128 v[28:31], v7 offset:28672
  v_mfma_f32_16x16x32_bf16 v[180:183], v[12:15], v[0:3], v[180:183]
  v_mfma_f32_16x16x32_bf16 v[208:211], v[16:19], v[0:3], v[208:211]
  v_mfma_f32_16x16x32_bf16 v[236:239], v[20:23], v[0:3], v[236:239]
  s_waitcnt lgkmcnt(1)
  v_mfma_f32_16x16x32_bf16 v[156:159], v[8:11], v[24:27], v[156:159]
  ds_read_b128 v[0:3], v7 offset:29696
  v_mfma_f32_16x16x32_bf16 v[184:187], v[12:15], v[24:27], v[184:187]
  v_mfma_f32_16x16x32_bf16 v[212:215], v[16:19], v[24:27], v[212:215]
  v_mfma_f32_16x16x32_bf16 v[240:243], v[20:23], v[24:27], v[240:243]
  s_waitcnt lgkmcnt(1)
  v_mfma_f32_16x16x32_bf16 v[160:163], v[8:11], v[28:31], v[160:163]
  ds_read_b128 v[24:27], v7 offset:30720
  v_mfma_f32_16x16x32_bf16 v[188:191], v[12:15], v[28:31], v[188:191]
  v_mfma_f32_16x16x32_bf16 v[216:219], v[16:19], v[28:31], v[216:219]
  v_mfma_f32_16x16x32_bf16 v[244:247], v[20:23], v[28:31], v[244:247]
  s_waitcnt lgkmcnt(1)
  v_mfma_f32_16x16x32_bf16 v[164:167], v[8:11], v[0:3], v[164:167]
  ds_read_b128 v[28:31], v7 offset:0
  v_mfma_f32_16x16x32_bf16 v[192:195], v[12:15], v[0:3], v[192:195]
  v_mfma_f32_16x16x32_bf16 v[220:223], v[16:19], v[0:3], v[220:223]
  v_mfma_f32_16x16x32_bf16 v[248:251], v[20:23], v[0:3], v[248:251]
  s_waitcnt vmcnt(4)
  s_waitcnt lgkmcnt(1)
  v_mfma_f32_16x16x32_bf16 v[168:171], v[8:11], v[24:27], v[168:171]
  ds_read_b128 v[0:3], v7 offset:1024
  v_mfma_f32_16x16x32_bf16 v[196:199], v[12:15], v[24:27], v[196:199]
  ds_read_b64_tr_b16 v[8:9], v5 offset:0
  ds_read_b64_tr_b16 v[10:11], v5 offset:2048
  v_mfma_f32_16x16x32_bf16 v[224:227], v[16:19], v[24:27], v[224:227]
  ds_read_b64_tr_b16 v[12:13], v6 offset:0
  ds_read_b64_tr_b16 v[14:15], v6 offset:2048
  v_mfma_f32_16x16x32_bf16 v[252:255], v[20:23], v[24:27], v[252:255]
  ds_read_b64_tr_b16 v[16:17], v5 offset:512
  ds_read_b64_tr_b16 v[18:19], v5 offset:2560
  ds_read_b64_tr_b16 v[20:21], v6 offset:512
  ds_read_b64_tr_b16 v[22:23], v6 offset:2560
  s_waitcnt lgkmcnt(6)
  v_mfma_f32_16x16x32_bf16 v[32:35], v[8:11], v[28:31], v[32:35]
  ds_read_b128 v[24:27], v7 offset:2048
  s_waitcnt lgkmcnt(5)
  v_mfma_f32_16x16x32_bf16 v[60:63], v[12:15], v[28:31], v[60:63]
  s_waitcnt lgkmcnt(3)
  v_mfma_f32_16x16x32_bf16 v[88:91], v[16:19], v[28:31], v[88:91]
  s_waitcnt lgkmcnt(1)
  v_mfma_f32_16x16x32_bf16 v[116:119], v[20:23], v[28:31], v[116:119]
  s_xor_b32 s59, s68, 32768
  s_add_u32 s59, s59, 262144
  s_add_u32 m0, s69, 0
  s_nop 0
  buffer_load_dwordx4 v4, s[20:23], s59 offen lds
  s_add_u32 m0, s69, 1024
  s_add_u32 s59, s59, 8192
  buffer_load_dwordx4 v4, s[20:23], s59 offen lds
  s_add_u32 m0, s69, 2048
  s_add_u32 s59, s59, 8192
  buffer_load_dwordx4 v4, s[20:23], s59 offen lds
  s_add_u32 m0, s69, 3072
  s_add_u32 s59, s59, 8192
  buffer_load_dwordx4 v4, s[20:23], s59 offen lds
  v_mfma_f32_16x16x32_bf16 v[36:39], v[8:11], v[0:3], v[36:39]
  ds_read_b128 v[28:31], v7 offset:3072
  v_mfma_f32_16x16x32_bf16 v[64:67], v[12:15], v[0:3], v[64:67]
  v_mfma_f32_16x16x32_bf16 v[92:95], v[16:19], v[0:3], v[92:95]
  v_mfma_f32_16x16x32_bf16 v[120:123], v[20:23], v[0:3], v[120:123]
  s_waitcnt lgkmcnt(1)
  v_mfma_f32_16x16x32_bf16 v[40:43], v[8:11], v[24:27], v[40:43]
  ds_read_b128 v[0:3], v7 offset:4096
  v_mfma_f32_16x16x32_bf16 v[68:71], v[12:15], v[24:27], v[68:71]
  v_mfma_f32_16x16x32_bf16 v[96:99], v[16:19], v[24:27], v[96:99]
  v_mfma_f32_16x16x32_bf16 v[124:127], v[20:23], v[24:27], v[124:127]
  s_waitcnt lgkmcnt(1)
  v_mfma_f32_16x16x32_bf16 v[44:47], v[8:11], v[28:31], v[44:47]
  ds_read_b128 v[24:27], v7 offset:5120
  v_mfma_f32_16x16x32_bf16 v[72:75], v[12:15], v[28:31], v[72:75]
  v_mfma_f32_16x16x32_bf16 v[100:103], v[16:19], v[28:31], v[100:103]
  v_mfma_f32_16x16x32_bf16 v[128:131], v[20:23], v[28:31], v[128:131]
  s_waitcnt lgkmcnt(1)
  v_mfma_f32_16x16x32_bf16 v[48:51], v[8:11], v[0:3], v[48:51]
  ds_read_b128 v[28:31], v7 offset:6144
  v_mfma_f32_16x16x32_bf16 v[76:79], v[12:15], v[0:3], v[76:79]
  v_mfma_f32_16x16x32_bf16 v[104:107], v[16:19], v[0:3], v[104:107]
  v_mfma_f32_16x16x32_bf16 v[132:135], v[20:23], v[0:3], v[132:135]
  s_waitcnt lgkmcnt(1)
  v_mfma_f32_16x16x32_bf16 v[52:55], v[8:11], v[24:27], v[52:55]
  ds_read_b128 v[0:3], v7 offset:0
  v_mfma_f32_16x16x32_bf16 v[80:83], v[12:15], v[24:27], v[80:83]
  v_mfma_f32_16x16x32_bf16 v[108:111], v[16:19], v[24:27], v[108:111]
  v_mfma_f32_16x16x32_bf16 v[136:139], v[20:23], v[24:27], v[136:139]
  s_waitcnt lgkmcnt(0)
  s_barrier
  s_waitcnt vmcnt(4)
  v_mfma_f32_16x16x32_bf16 v[56:59], v[8:11], v[28:31], v[56:59]
  ds_read_b128 v[24:27], v7 offset:1024
  v_mfma_f32_16x16x32_bf16 v[84:87], v[12:15], v[28:31], v[84:87]
  ds_read_b64_tr_b16 v[8:9], v5 offset:4096
  ds_read_b64_tr_b16 v[10:11], v5 offset:6144
  v_mfma_f32_16x16x32_bf16 v[112:115], v[16:19], v[28:31], v[112:115]
  ds_read_b64_tr_b16 v[12:13], v6 offset:4096
  ds_read_b64_tr_b16 v[14:15], v6 offset:6144
  v_mfma_f32_16x16x32_bf16 v[140:143], v[20:23], v[28:31], v[140:143]
  ds_read_b64_tr_b16 v[16:17], v5 offset:4608
  ds_read_b64_tr_b16 v[18:19], v5 offset:6656
  ds_read_b64_tr_b16 v[20:21], v6 offset:4608
  ds_read_b64_tr_b16 v[22:23], v6 offset:6656
  s_waitcnt lgkmcnt(6)
  v_mfma_f32_16x16x32_bf16 v[144:147], v[8:11], v[0:3], v[144:147]
  ds_read_b128 v[28:31], v7 offset:2048
  s_waitcnt lgkmcnt(5)
  v_mfma_f32_16x16x32_bf16 v[172:175], v[12:15], v[0:3], v[172:175]
  s_waitcnt lgkmcnt(3)
  v_mfma_f32_16x16x32_bf16 v[200:203], v[16:19], v[0:3], v[200:203]
  s_waitcnt lgkmcnt(1)
  v_mfma_f32_16x16x32_bf16 v[228:231], v[20:23], v[0:3], v[228:231]
  s_xor_b32 s59, s68, 32896
  s_add_u32 s59, s59, 262144
  s_add_u32 m0, s69, 4096
  s_nop 0
  buffer_load_dwordx4 v4, s[20:23], s59 offen lds
  s_add_u32 m0, s69, 5120
  s_add_u32 s59, s59, 8192
  buffer_load_dwordx4 v4, s[20:23], s59 offen lds
  s_add_u32 m0, s69, 6144
  s_add_u32 s59, s59, 8192
  buffer_load_dwordx4 v4, s[20:23], s59 offen lds
  s_add_u32 m0, s69, 7168
  s_add_u32 s59, s59, 8192
  buffer_load_dwordx4 v4, s[20:23], s59 offen lds
  v_mfma_f32_16x16x32_bf16 v[148:151], v[8:11], v[24:27], v[148:151]
  ds_read_b128 v[0:3], v7 offset:3072
  v_mfma_f32_16x16x32_bf16 v[176:179], v[12:15], v[24:27], v[176:179]
  v_mfma_f32_16x16x32_bf16 v[204:207], v[16:19], v[24:27], v[204:207]
  v_mfma_f32_16x16x32_bf16 v[232:235], v[20:23], v[24:27], v[232:235]
  s_waitcnt lgkmcnt(1)
  v_mfma_f32_16x16x32_bf16 v[152:155], v[8:11], v[28:31], v[152:155]
  ds_read_b128 v[24:27], v7 offset:4096
  v_mfma_f32_16x16x32_bf16 v[180:183], v[12:15], v[28:31], v[180:183]
  v_mfma_f32_16x16x32_bf16 v[208:211], v[16:19], v[28:31], v[208:211]
  v_mfma_f32_16x16x32_bf16 v[236:239], v[20:23], v[28:31], v[236:239]
  s_waitcnt lgkmcnt(1)
  v_mfma_f32_16x16x32_bf16 v[156:159], v[8:11], v[0:3], v[156:159]
  ds_read_b128 v[28:31], v7 offset:5120
  v_mfma_f32_16x16x32_bf16 v[184:187], v[12:15], v[0:3], v[184:187]
  v_mfma_f32_16x16x32_bf16 v[212:215], v[16:19], v[0:3], v[212:215]
  v_mfma_f32_16x16x32_bf16 v[240:243], v[20:23], v[0:3], v[240:243]
  s_waitcnt lgkmcnt(1)
  v_mfma_f32_16x16x32_bf16 v[160:163], v[8:11], v[24:27], v[160:163]
  ds_read_b128 v[0:3], v7 offset:6144
  v_mfma_f32_16x16x32_bf16 v[188:191], v[12:15], v[24:27], v[188:191]
  v_mfma_f32_16x16x32_bf16 v[216:219], v[16:19], v[24:27], v[216:219]
  v_mfma_f32_16x16x32_bf16 v[244:247], v[20:23], v[24:27], v[244:247]
  s_waitcnt lgkmcnt(1)
  v_mfma_f32_16x16x32_bf16 v[164:167], v[8:11], v[28:31], v[164:167]
  ds_read_b128 v[24:27], v7 offset:8192
  v_mfma_f32_16x16x32_bf16 v[192:195], v[12:15], v[28:31], v[192:195]
  v_mfma_f32_16x16x32_bf16 v[220:223], v[16:19], v[28:31], v[220:223]
  v_mfma_f32_16x16x32_bf16 v[248:251], v[20:23], v[28:31], v[248:251]
  s_waitcnt vmcnt(4)
  s_waitcnt lgkmcnt(1)
  v_mfma_f32_16x16x32_bf16 v[168:171], v[8:11], v[0:3], v[168:171]
  ds_read_b128 v[28:31], v7 offset:9216
  v_mfma_f32_16x16x32_bf16 v[196:199], v[12:15], v[0:3], v[196:199]
  ds_read_b64_tr_b16 v[8:9], v5 offset:0
  ds_read_b64_tr_b16 v[10:11], v5 offset:2048
  v_mfma_f32_16x16x32_bf16 v[224:227], v[16:19], v[0:3], v[224:227]
  ds_read_b64_tr_b16 v[12:13], v6 offset:0
  ds_read_b64_tr_b16 v[14:15], v6 offset:2048
  v_mfma_f32_16x16x32_bf16 v[252:255], v[20:23], v[0:3], v[252:255]
  ds_read_b64_tr_b16 v[16:17], v5 offset:512
  ds_read_b64_tr_b16 v[18:19], v5 offset:2560
  ds_read_b64_tr_b16 v[20:21], v6 offset:512
  ds_read_b64_tr_b16 v[22:23], v6 offset:2560
  s_waitcnt lgkmcnt(6)
  v_mfma_f32_16x16x32_bf16 v[32:35], v[8:11], v[24:27], v[32:35]
  ds_read_b128 v[0:3], v7 offset:10240
  s_waitcnt lgkmcnt(5)
  v_mfma_f32_16x16x32_bf16 v[60:63], v[12:15], v[24:27], v[60:63]
  s_waitcnt lgkmcnt(3)
  v_mfma_f32_16x16x32_bf16 v[88:91], v[16:19], v[24:27], v[88:91]
  s_waitcnt lgkmcnt(1)
  v_mfma_f32_16x16x32_bf16 v[116:119], v[20:23], v[24:27], v[116:119]
  v_mfma_f32_16x16x32_bf16 v[36:39], v[8:11], v[28:31], v[36:39]
  ds_read_b128 v[24:27], v7 offset:11264
  v_mfma_f32_16x16x32_bf16 v[64:67], v[12:15], v[28:31], v[64:67]
  v_mfma_f32_16x16x32_bf16 v[92:95], v[16:19], v[28:31], v[92:95]
  v_mfma_f32_16x16x32_bf16 v[120:123], v[20:23], v[28:31], v[120:123]
  s_waitcnt lgkmcnt(1)
  v_mfma_f32_16x16x32_bf16 v[40:43], v[8:11], v[0:3], v[40:43]
  ds_read_b128 v[28:31], v7 offset:12288
  v_mfma_f32_16x16x32_bf16 v[68:71], v[12:15], v[0:3], v[68:71]
  v_mfma_f32_16x16x32_bf16 v[96:99], v[16:19], v[0:3], v[96:99]
  v_mfma_f32_16x16x32_bf16 v[124:127], v[20:23], v[0:3], v[124:127]
  s_waitcnt lgkmcnt(0)
  s_barrier
  v_mfma_f32_16x16x32_bf16 v[44:47], v[8:11], v[24:27], v[44:47]
  ds_read_b128 v[0:3], v7 offset:13312
  v_mfma_f32_16x16x32_bf16 v[72:75], v[12:15], v[24:27], v[72:75]
  v_mfma_f32_16x16x32_bf16 v[100:103], v[16:19], v[24:27], v[100:103]
  v_mfma_f32_16x16x32_bf16 v[128:131], v[20:23], v[24:27], v[128:131]
  s_xor_b32 s59, s68, 65536
  s_add_u32 s59, s59, 262144
  s_add_u32 m0, s69, 0
  s_nop 0
  buffer_load_dwordx4 v4, s[20:23], s59 offen lds
  s_add_u32 m0, s69, 1024
  s_add_u32 s59, s59, 8192
  buffer_load_dwordx4 v4, s[20:23], s59 offen lds
  s_add_u32 m0, s69, 2048
  s_add_u32 s59, s59, 8192
  buffer_load_dwordx4 v4, s[20:23], s59 offen lds
  s_add_u32 m0, s69, 3072
  s_add_u32 s59, s59, 8192
  buffer_load_dwordx4 v4, s[20:23], s59 offen lds
  v_mfma_f32_16x16x32_bf16 v[48:51], v[8:11], v[28:31], v[48:51]
  ds_read_b128 v[24:27], v7 offset:14336
  v_mfma_f32_16x16x32_bf16 v[76:79], v[12:15], v[28:31], v[76:79]
  v_mfma_f32_16x16x32_bf16 v[104:107], v[16:19], v[28:31], v[104:107]
  v_mfma_f32_16x16x32_bf16 v[132:135], v[20:23], v[28:31], v[132:135]
  s_waitcnt lgkmcnt(1)
  v_mfma_f32_16x16x32_bf16 v[52:55], v[8:11], v[0:3], v[52:55]
  ds_read_b128 v[28:31], v7 offset:8192
  v_mfma_f32_16x16x32_bf16 v[80:83], v[12:15], v[0:3], v[80:83]
  v_mfma_f32_16x16x32_bf16 v[108:111], v[16:19], v[0:3], v[108:111]
  v_mfma_f32_16x16x32_bf16 v[136:139], v[20:23], v[0:3], v[136:139]
  s_waitcnt vmcnt(4)
  s_waitcnt lgkmcnt(1)
  v_mfma_f32_16x16x32_bf16 v[56:59], v[8:11], v[24:27], v[56:59]
  ds_read_b128 v[0:3], v7 offset:9216
  v_mfma_f32_16x16x32_bf16 v[84:87], v[12:15], v[24:27], v[84:87]
  ds_read_b64_tr_b16 v[8:9], v5 offset:4096
  ds_read_b64_tr_b16 v[10:11], v5 offset:6144
  v_mfma_f32_16x16x32_bf16 v[112:115], v[16:19], v[24:27], v[112:115]
  ds_read_b64_tr_b16 v[12:13], v6 offset:4096
  ds_read_b64_tr_b16 v[14:15], v6 offset:6144
  v_mfma_f32_16x16x32_bf16 v[140:143], v[20:23], v[24:27], v[140:143]
  ds_read_b64_tr_b16 v[16:17], v5 offset:4608
  ds_read_b64_tr_b16 v[18:19], v5 offset:6656
  ds_read_b64_tr_b16 v[20:21], v6 offset:4608
  ds_read_b64_tr_b16 v[22:23], v6 offset:6656
  s_waitcnt lgkmcnt(6)
  v_mfma_f32_16x16x32_bf16 v[144:147], v[8:11], v[28:31], v[144:147]
  ds_read_b128 v[24:27], v7 offset:10240
  s_waitcnt lgkmcnt(5)
  v_mfma_f32_16x16x32_bf16 v[172:175], v[12:15], v[28:31], v[172:175]
  s_waitcnt lgkmcnt(3)
  v_mfma_f32_16x16x32_bf16 v[200:203], v[16:19], v[28:31], v[200:203]
  s_waitcnt lgkmcnt(1)
  v_mfma_f32_16x16x32_bf16 v[228:231], v[20:23], v[28:31], v[228:231]
  s_xor_b32 s59, s68, 65664
  s_add_u32 s59, s59, 262144
  s_add_u32 m0, s69, 4096
  s_nop 0
  buffer_load_dwordx4 v4, s[20:23], s59 offen lds
  s_add_u32 m0, s69, 5120
  s_add_u32 s59, s59, 8192
  buffer_load_dwordx4 v4, s[20:23], s59 offen lds
  s_add_u32 m0, s69, 6144
  s_add_u32 s59, s59, 8192
  buffer_load_dwordx4 v4, s[20:23], s59 offen lds
  s_add_u32 m0, s69, 7168
  s_add_u32 s59, s59, 8192
  buffer_load_dwordx4 v4, s[20:23], s59 offen lds
  v_mfma_f32_16x16x32_bf16 v[148:151], v[8:11], v[0:3], v[148:151]
  ds_read_b128 v[28:31], v7 offset:11264
  v_mfma_f32_16x16x32_bf16 v[176:179], v[12:15], v[0:3], v[176:179]
  v_mfma_f32_16x16x32_bf16 v[204:207], v[16:19], v[0:3], v[204:207]
  v_mfma_f32_16x16x32_bf16 v[232:235], v[20:23], v[0:3], v[232:235]
  s_waitcnt lgkmcnt(1)
  v_mfma_f32_16x16x32_bf16 v[152:155], v[8:11], v[24:27], v[152:155]
  ds_read_b128 v[0:3], v7 offset:12288
  v_mfma_f32_16x16x32_bf16 v[180:183], v[12:15], v[24:27], v[180:183]
  v_mfma_f32_16x16x32_bf16 v[208:211], v[16:19], v[24:27], v[208:211]
  v_mfma_f32_16x16x32_bf16 v[236:239], v[20:23], v[24:27], v[236:239]
  s_waitcnt lgkmcnt(1)
  v_mfma_f32_16x16x32_bf16 v[156:159], v[8:11], v[28:31], v[156:159]
  ds_read_b128 v[24:27], v7 offset:13312
  v_mfma_f32_16x16x32_bf16 v[184:187], v[12:15], v[28:31], v[184:187]
  v_mfma_f32_16x16x32_bf16 v[212:215], v[16:19], v[28:31], v[212:215]
  v_mfma_f32_16x16x32_bf16 v[240:243], v[20:23], v[28:31], v[240:243]
  s_waitcnt lgkmcnt(1)
  v_mfma_f32_16x16x32_bf16 v[160:163], v[8:11], v[0:3], v[160:163]
  ds_read_b128 v[28:31], v7 offset:14336
  v_mfma_f32_16x16x32_bf16 v[188:191], v[12:15], v[0:3], v[188:191]
  v_mfma_f32_16x16x32_bf16 v[216:219], v[16:19], v[0:3], v[216:219]
  v_mfma_f32_16x16x32_bf16 v[244:247], v[20:23], v[0:3], v[244:247]
  s_waitcnt lgkmcnt(1)
  v_mfma_f32_16x16x32_bf16 v[164:167], v[8:11], v[24:27], v[164:167]
  ds_read_b128 v[0:3], v7 offset:16384
  v_mfma_f32_16x16x32_bf16 v[192:195], v[12:15], v[24:27], v[192:195]
  v_mfma_f32_16x16x32_bf16 v[220:223], v[16:19], v[24:27], v[220:223]
  v_mfma_f32_16x16x32_bf16 v[248:251], v[20:23], v[24:27], v[248:251]
  s_waitcnt vmcnt(4)
  s_waitcnt lgkmcnt(1)
  v_mfma_f32_16x16x32_bf16 v[168:171], v[8:11], v[28:31], v[168:171]
  ds_read_b128 v[24:27], v7 offset:17408
  v_mfma_f32_16x16x32_bf16 v[196:199], v[12:15], v[28:31], v[196:199]
  ds_read_b64_tr_b16 v[8:9], v5 offset:0
  ds_read_b64_tr_b16 v[10:11], v5 offset:2048
  v_mfma_f32_16x16x32_bf16 v[224:227], v[16:19], v[28:31], v[224:227]
  ds_read_b64_tr_b16 v[12:13], v6 offset:0
  ds_read_b64_tr_b16 v[14:15], v6 offset:2048
  v_mfma_f32_16x16x32_bf16 v[252:255], v[20:23], v[28:31], v[252:255]
  ds_read_b64_tr_b16 v[16:17], v5 offset:512
  ds_read_b64_tr_b16 v[18:19], v5 offset:2560
  ds_read_b64_tr_b16 v[20:21], v6 offset:512
  ds_read_b64_tr_b16 v[22:23], v6 offset:2560
  s_waitcnt lgkmcnt(0)
  s_barrier
  v_mfma_f32_16x16x32_bf16 v[32:35], v[8:11], v[0:3], v[32:35]
  ds_read_b128 v[28:31], v7 offset:18432
  v_mfma_f32_16x16x32_bf16 v[60:63], v[12:15], v[0:3], v[60:63]
  v_mfma_f32_16x16x32_bf16 v[88:91], v[16:19], v[0:3], v[88:91]
  v_mfma_f32_16x16x32_bf16 v[116:119], v[20:23], v[0:3], v[116:119]
  s_xor_b32 s59, s68, 98304
  s_add_u32 s59, s59, 262144
  s_add_u32 m0, s69, 0
  s_nop 0
  buffer_load_dwordx4 v4, s[20:23], s59 offen lds
  s_add_u32 m0, s69, 1024
  s_add_u32 s59, s59, 8192
  buffer_load_dwordx4 v4, s[20:23], s59 offen lds
  s_add_u32 m0, s69, 2048
  s_add_u32 s59, s59, 8192
  buffer_load_dwordx4 v4, s[20:23], s59 offen lds
  s_add_u32 m0, s69, 3072
  s_add_u32 s59, s59, 8192
  buffer_load_dwordx4 v4, s[20:23], s59 offen lds
  v_mfma_f32_16x16x32_bf16 v[36:39], v[8:11], v[24:27], v[36:39]
  ds_read_b128 v[0:3], v7 offset:19456
  v_mfma_f32_16x16x32_bf16 v[64:67], v[12:15], v[24:27], v[64:67]
  v_mfma_f32_16x16x32_bf16 v[92:95], v[16:19], v[24:27], v[92:95]
  v_mfma_f32_16x16x32_bf16 v[120:123], v[20:23], v[24:27], v[120:123]
  s_waitcnt lgkmcnt(1)
  v_mfma_f32_16x16x32_bf16 v[40:43], v[8:11], v[28:31], v[40:43]
  ds_read_b128 v[24:27], v7 offset:20480
  v_mfma_f32_16x16x32_bf16 v[68:71], v[12:15], v[28:31], v[68:71]
  v_mfma_f32_16x16x32_bf16 v[96:99], v[16:19], v[28:31], v[96:99]
  v_mfma_f32_16x16x32_bf16 v[124:127], v[20:23], v[28:31], v[124:127]
  s_waitcnt lgkmcnt(1)
  v_mfma_f32_16x16x32_bf16 v[44:47], v[8:11], v[0:3], v[44:47]
  ds_read_b128 v[28:31], v7 offset:21504
  v_mfma_f32_16x16x32_bf16 v[72:75], v[12:15], v[0:3], v[72:75]
  v_mfma_f32_16x16x32_bf16 v[100:103], v[16:19], v[0:3], v[100:103]
  v_mfma_f32_16x16x32_bf16 v[128:131], v[20:23], v[0:3], v[128:131]
  s_waitcnt lgkmcnt(1)
  v_mfma_f32_16x16x32_bf16 v[48:51], v[8:11], v[24:27], v[48:51]
  ds_read_b128 v[0:3], v7 offset:22528
  v_mfma_f32_16x16x32_bf16 v[76:79], v[12:15], v[24:27], v[76:79]
  v_mfma_f32_16x16x32_bf16 v[104:107], v[16:19], v[24:27], v[104:107]
  v_mfma_f32_16x16x32_bf16 v[132:135], v[20:23], v[24:27], v[132:135]
  s_waitcnt lgkmcnt(1)
  v_mfma_f32_16x16x32_bf16 v[52:55], v[8:11], v[28:31], v[52:55]
  ds_read_b128 v[24:27], v7 offset:16384
  v_mfma_f32_16x16x32_bf16 v[80:83], v[12:15], v[28:31], v[80:83]
  v_mfma_f32_16x16x32_bf16 v[108:111], v[16:19], v[28:31], v[108:111]
  v_mfma_f32_16x16x32_bf16 v[136:139], v[20:23], v[28:31], v[136:139]
  s_waitcnt vmcnt(4)
  s_waitcnt lgkmcnt(1)
  v_mfma_f32_16x16x32_bf16 v[56:59], v[8:11], v[0:3], v[56:59]
  ds_read_b128 v[28:31], v7 offset:17408
  v_mfma_f32_16x16x32_bf16 v[84:87], v[12:15], v[0:3], v[84:87]
  ds_read_b64_tr_b16 v[8:9], v5 offset:4096
  ds_read_b64_tr_b16 v[10:11], v5 offset:6144
  v_mfma_f32_16x16x32_bf16 v[112:115], v[16:19], v[0:3], v[112:115]
  ds_read_b64_tr_b16 v[12:13], v6 offset:4096
  ds_read_b64_tr_b16 v[14:15], v6 offset:6144
  v_mfma_f32_16x16x32_bf16 v[140:143], v[20:23], v[0:3], v[140:143]
  ds_read_b64_tr_b16 v[16:17], v5 offset:4608
  ds_read_b64_tr_b16 v[18:19], v5 offset:6656
  ds_read_b64_tr_b16 v[20:21], v6 offset:4608
  ds_read_b64_tr_b16 v[22:23], v6 offset:6656
  s_waitcnt lgkmcnt(6)
  v_mfma_f32_16x16x32_bf16 v[144:147], v[8:11], v[24:27], v[144:147]
  ds_read_b128 v[0:3], v7 offset:18432
  s_waitcnt lgkmcnt(5)
  v_mfma_f32_16x16x32_bf16 v[172:175], v[12:15], v[24:27], v[172:175]
  s_waitcnt lgkmcnt(3)
  v_mfma_f32_16x16x32_bf16 v[200:203], v[16:19], v[24:27], v[200:203]
  s_waitcnt lgkmcnt(1)
  v_mfma_f32_16x16x32_bf16 v[228:231], v[20:23], v[24:27], v[228:231]
  v_mfma_f32_16x16x32_bf16 v[148:151], v[8:11], v[28:31], v[148:151]
  ds_read_b128 v[24:27], v7 offset:19456
  v_mfma_f32_16x16x32_bf16 v[176:179], v[12:15], v[28:31], v[176:179]
  v_mfma_f32_16x16x32_bf16 v[204:207], v[16:19], v[28:31], v[204:207]
  v_mfma_f32_16x16x32_bf16 v[232:235], v[20:23], v[28:31], v[232:235]
  s_waitcnt lgkmcnt(1)
  v_mfma_f32_16x16x32_bf16 v[152:155], v[8:11], v[0:3], v[152:155]
  ds_read_b128 v[28:31], v7 offset:20480
  v_mfma_f32_16x16x32_bf16 v[180:183], v[12:15], v[0:3], v[180:183]
  v_mfma_f32_16x16x32_bf16 v[208:211], v[16:19], v[0:3], v[208:211]
  v_mfma_f32_16x16x32_bf16 v[236:239], v[20:23], v[0:3], v[236:239]
  s_waitcnt lgkmcnt(1)
  v_mfma_f32_16x16x32_bf16 v[156:159], v[8:11], v[24:27], v[156:159]
  ds_read_b128 v[0:3], v7 offset:21504
  v_mfma_f32_16x16x32_bf16 v[184:187], v[12:15], v[24:27], v[184:187]
  v_mfma_f32_16x16x32_bf16 v[212:215], v[16:19], v[24:27], v[212:215]
  v_mfma_f32_16x16x32_bf16 v[240:243], v[20:23], v[24:27], v[240:243]
  s_waitcnt lgkmcnt(0)
  s_barrier
  v_mfma_f32_16x16x32_bf16 v[160:163], v[8:11], v[28:31], v[160:163]
  ds_read_b128 v[24:27], v7 offset:22528
  v_mfma_f32_16x16x32_bf16 v[188:191], v[12:15], v[28:31], v[188:191]
  v_mfma_f32_16x16x32_bf16 v[216:219], v[16:19], v[28:31], v[216:219]
  v_mfma_f32_16x16x32_bf16 v[244:247], v[20:23], v[28:31], v[244:247]
  s_xor_b32 s59, s68, 98432
  s_add_u32 s59, s59, 262144
  s_add_u32 m0, s69, 4096
  s_nop 0
  buffer_load_dwordx4 v4, s[20:23], s59 offen lds
  s_add_u32 m0, s69, 5120
  s_add_u32 s59, s59, 8192
  buffer_load_dwordx4 v4, s[20:23], s59 offen lds
  s_add_u32 m0, s69, 6144
  s_add_u32 s59, s59, 8192
  buffer_load_dwordx4 v4, s[20:23], s59 offen lds
  s_add_u32 m0, s69, 7168
  s_add_u32 s59, s59, 8192
  buffer_load_dwordx4 v4, s[20:23], s59 offen lds
  v_mfma_f32_16x16x32_bf16 v[164:167], v[8:11], v[0:3], v[164:167]
  ds_read_b128 v[28:31], v7 offset:24576
  v_mfma_f32_16x16x32_bf16 v[192:195], v[12:15], v[0:3], v[192:195]
  v_mfma_f32_16x16x32_bf16 v[220:223], v[16:19], v[0:3], v[220:223]
  v_mfma_f32_16x16x32_bf16 v[248:251], v[20:23], v[0:3], v[248:251]
  s_waitcnt vmcnt(4)
  s_waitcnt lgkmcnt(1)
  v_mfma_f32_16x16x32_bf16 v[168:171], v[8:11], v[24:27], v[168:171]
  ds_read_b128 v[0:3], v7 offset:25600
  v_mfma_f32_16x16x32_bf16 v[196:199], v[12:15], v[24:27], v[196:199]
  ds_read_b64_tr_b16 v[8:9], v5 offset:0
  ds_read_b64_tr_b16 v[10:11], v5 offset:2048
  v_mfma_f32_16x16x32_bf16 v[224:227], v[16:19], v[24:27], v[224:227]
  ds_read_b64_tr_b16 v[12:13], v6 offset:0
  ds_read_b64_tr_b16 v[14:15], v6 offset:2048
  v_mfma_f32_16x16x32_bf16 v[252:255], v[20:23], v[24:27], v[252:255]
  ds_read_b64_tr_b16 v[16:17], v5 offset:512
  ds_read_b64_tr_b16 v[18:19], v5 offset:2560
  ds_read_b64_tr_b16 v[20:21], v6 offset:512
  ds_read_b64_tr_b16 v[22:23], v6 offset:2560
  s_waitcnt lgkmcnt(6)
  v_mfma_f32_16x16x32_bf16 v[32:35], v[8:11], v[28:31], v[32:35]
  ds_read_b128 v[24:27], v7 offset:26624
  s_waitcnt lgkmcnt(5)
  v_mfma_f32_16x16x32_bf16 v[60:63], v[12:15], v[28:31], v[60:63]
  s_waitcnt lgkmcnt(3)
  v_mfma_f32_16x16x32_bf16 v[88:91], v[16:19], v[28:31], v[88:91]
  s_waitcnt lgkmcnt(1)
  v_mfma_f32_16x16x32_bf16 v[116:119], v[20:23], v[28:31], v[116:119]
  s_xor_b32 s59, s68, 0
  s_add_u32 s59, s59, 393216
  s_add_u32 m0, s69, 0
  s_nop 0
  buffer_load_dwordx4 v4, s[20:23], s59 offen lds
  s_add_u32 m0, s69, 1024
  s_add_u32 s59, s59, 8192
  buffer_load_dwordx4 v4, s[20:23], s59 offen lds
  s_add_u32 m0, s69, 2048
  s_add_u32 s59, s59, 8192
  buffer_load_dwordx4 v4, s[20:23], s59 offen lds
  s_add_u32 m0, s69, 3072
  s_add_u32 s59, s59, 8192
  buffer_load_dwordx4 v4, s[20:23], s59 offen lds
  v_mfma_f32_16x16x32_bf16 v[36:39], v[8:11], v[0:3], v[36:39]
  ds_read_b128 v[28:31], v7 offset:27648
  v_mfma_f32_16x16x32_bf16 v[64:67], v[12:15], v[0:3], v[64:67]
  v_mfma_f32_16x16x32_bf16 v[92:95], v[16:19], v[0:3], v[92:95]
  v_mfma_f32_16x16x32_bf16 v[120:123], v[20:23], v[0:3], v[120:123]
  s_waitcnt lgkmcnt(1)
  v_mfma_f32_16x16x32_bf16 v[40:43], v[8:11], v[24:27], v[40:43]
  ds_read_b128 v[0:3], v7 offset:28672
  v_mfma_f32_16x16x32_bf16 v[68:71], v[12:15], v[24:27], v[68:71]
  v_mfma_f32_16x16x32_bf16 v[96:99], v[16:19], v[24:27], v[96:99]
  v_mfma_f32_16x16x32_bf16 v[124:127], v[20:23], v[24:27], v[124:127]
  s_waitcnt lgkmcnt(1)
  v_mfma_f32_16x16x32_bf16 v[44:47], v[8:11], v[28:31], v[44:47]
  ds_read_b128 v[24:27], v7 offset:29696
  v_mfma_f32_16x16x32_bf16 v[72:75], v[12:15], v[28:31], v[72:75]
  v_mfma_f32_16x16x32_bf16 v[100:103], v[16:19], v[28:31], v[100:103]
  v_mfma_f32_16x16x32_bf16 v[128:131], v[20:23], v[28:31], v[128:131]
  s_waitcnt lgkmcnt(1)
  v_mfma_f32_16x16x32_bf16 v[48:51], v[8:11], v[0:3], v[48:51]
  ds_read_b128 v[28:31], v7 offset:30720
  v_mfma_f32_16x16x32_bf16 v[76:79], v[12:15], v[0:3], v[76:79]
  v_mfma_f32_16x16x32_bf16 v[104:107], v[16:19], v[0:3], v[104:107]
  v_mfma_f32_16x16x32_bf16 v[132:135], v[20:23], v[0:3], v[132:135]
  s_waitcnt lgkmcnt(1)
  v_mfma_f32_16x16x32_bf16 v[52:55], v[8:11], v[24:27], v[52:55]
  ds_read_b128 v[0:3], v7 offset:24576
  v_mfma_f32_16x16x32_bf16 v[80:83], v[12:15], v[24:27], v[80:83]
  v_mfma_f32_16x16x32_bf16 v[108:111], v[16:19], v[24:27], v[108:111]
  v_mfma_f32_16x16x32_bf16 v[136:139], v[20:23], v[24:27], v[136:139]
  s_waitcnt vmcnt(4)
  s_waitcnt lgkmcnt(1)
  v_mfma_f32_16x16x32_bf16 v[56:59], v[8:11], v[28:31], v[56:59]
  ds_read_b128 v[24:27], v7 offset:25600
  v_mfma_f32_16x16x32_bf16 v[84:87], v[12:15], v[28:31], v[84:87]
  ds_read_b64_tr_b16 v[8:9], v5 offset:4096
  ds_read_b64_tr_b16 v[10:11], v5 offset:6144
  v_mfma_f32_16x16x32_bf16 v[112:115], v[16:19], v[28:31], v[112:115]
  ds_read_b64_tr_b16 v[12:13], v6 offset:4096
  ds_read_b64_tr_b16 v[14:15], v6 offset:6144
  v_mfma_f32_16x16x32_bf16 v[140:143], v[20:23], v[28:31], v[140:143]
  ds_read_b64_tr_b16 v[16:17], v5 offset:4608
  ds_read_b64_tr_b16 v[18:19], v5 offset:6656
  ds_read_b64_tr_b16 v[20:21], v6 offset:4608
  ds_read_b64_tr_b16 v[22:23], v6 offset:6656
  s_waitcnt lgkmcnt(6)
  v_mfma_f32_16x16x32_bf16 v[144:147], v[8:11], v[0:3], v[144:147]
  ds_read_b128 v[28:31], v7 offset:26624
  s_waitcnt lgkmcnt(5)
  v_mfma_f32_16x16x32_bf16 v[172:175], v[12:15], v[0:3], v[172:175]
  s_waitcnt lgkmcnt(3)
  v_mfma_f32_16x16x32_bf16 v[200:203], v[16:19], v[0:3], v[200:203]
  s_waitcnt lgkmcnt(1)
  v_mfma_f32_16x16x32_bf16 v[228:231], v[20:23], v[0:3], v[228:231]
  s_waitcnt lgkmcnt(0)
  s_barrier
  v_mfma_f32_16x16x32_bf16 v[148:151], v[8:11], v[24:27], v[148:151]
  ds_read_b128 v[0:3], v7 offset:27648
  v_mfma_f32_16x16x32_bf16 v[176:179], v[12:15], v[24:27], v[176:179]
  v_mfma_f32_16x16x32_bf16 v[204:207], v[16:19], v[24:27], v[204:207]
  v_mfma_f32_16x16x32_bf16 v[232:235], v[20:23], v[24:27], v[232:235]
  s_xor_b32 s59, s68, 32768
  s_add_u32 s59, s59, 393216
  s_add_u32 m0, s69, 4096
  s_nop 0
  buffer_load_dwordx4 v4, s[20:23], s59 offen lds
  s_add_u32 m0, s69, 5120
  s_add_u32 s59, s59, 8192
  buffer_load_dwordx4 v4, s[20:23], s59 offen lds
  s_add_u32 m0, s69, 6144
  s_add_u32 s59, s59, 8192
  buffer_load_dwordx4 v4, s[20:23], s59 offen lds
  s_add_u32 m0, s69, 7168
  s_add_u32 s59, s59, 8192
  buffer_load_dwordx4 v4, s[20:23], s59 offen lds
  v_mfma_f32_16x16x32_bf16 v[152:155], v[8:11], v[28:31], v[152:155]
  ds_read_b128 v[24:27], v7 offset:28672
  v_mfma_f32_16x16x32_bf16 v[180:183], v[12:15], v[28:31], v[180:183]
  v_mfma_f32_16x16x32_bf16 v[208:211], v[16:19], v[28:31], v[208:211]
  v_mfma_f32_16x16x32_bf16 v[236:239], v[20:23], v[28:31], v[236:239]
  s_waitcnt lgkmcnt(1)
  v_mfma_f32_16x16x32_bf16 v[156:159], v[8:11], v[0:3], v[156:159]
  ds_read_b128 v[28:31], v7 offset:29696
  v_mfma_f32_16x16x32_bf16 v[184:187], v[12:15], v[0:3], v[184:187]
  v_mfma_f32_16x16x32_bf16 v[212:215], v[16:19], v[0:3], v[212:215]
  v_mfma_f32_16x16x32_bf16 v[240:243], v[20:23], v[0:3], v[240:243]
  s_waitcnt lgkmcnt(1)
  v_mfma_f32_16x16x32_bf16 v[160:163], v[8:11], v[24:27], v[160:163]
  ds_read_b128 v[0:3], v7 offset:30720
  v_mfma_f32_16x16x32_bf16 v[188:191], v[12:15], v[24:27], v[188:191]
  v_mfma_f32_16x16x32_bf16 v[216:219], v[16:19], v[24:27], v[216:219]
  v_mfma_f32_16x16x32_bf16 v[244:247], v[20:23], v[24:27], v[244:247]
  s_waitcnt lgkmcnt(1)
  v_mfma_f32_16x16x32_bf16 v[164:167], v[8:11], v[28:31], v[164:167]
  v_mfma_f32_16x16x32_bf16 v[192:195], v[12:15], v[28:31], v[192:195]
  v_mfma_f32_16x16x32_bf16 v[220:223], v[16:19], v[28:31], v[220:223]
  v_mfma_f32_16x16x32_bf16 v[248:251], v[20:23], v[28:31], v[248:251]
  s_waitcnt vmcnt(4)
  s_waitcnt lgkmcnt(0)
  v_mfma_f32_16x16x32_bf16 v[168:171], v[8:11], v[0:3], v[168:171]
  v_mfma_f32_16x16x32_bf16 v[196:199], v[12:15], v[0:3], v[196:199]
  ds_read_b64_tr_b16 v[8:9], v5 offset:0
  ds_read_b64_tr_b16 v[10:11], v5 offset:2048
  v_mfma_f32_16x16x32_bf16 v[224:227], v[16:19], v[0:3], v[224:227]
  ds_read_b64_tr_b16 v[12:13], v6 offset:0
  ds_read_b64_tr_b16 v[14:15], v6 offset:2048
  v_mfma_f32_16x16x32_bf16 v[252:255], v[20:23], v[0:3], v[252:255]
  ds_read_b64_tr_b16 v[16:17], v5 offset:512
  ds_read_b64_tr_b16 v[18:19], v5 offset:2560
  ds_read_b64_tr_b16 v[20:21], v6 offset:512
  ds_read_b64_tr_b16 v[22:23], v6 offset:2560
  s_waitcnt lgkmcnt(0)
  s_barrier
  v_subrev_u32 v7, 98304, v7
  s_mov_b32 s71, 0
  ds_read_b128 v[24:27], v7 offset:32768
  ds_read_b128 v[28:31], v7 offset:33792
  s_waitcnt lgkmcnt(1)
  v_mfma_f32_16x16x32_bf16 v[32:35], v[8:11], v[24:27], v[32:35]
  ds_read_b128 v[0:3], v7 offset:34816
  v_mfma_f32_16x16x32_bf16 v[60:63], v[12:15], v[24:27], v[60:63]
  v_mfma_f32_16x16x32_bf16 v[88:91], v[16:19], v[24:27], v[88:91]
  v_mfma_f32_16x16x32_bf16 v[116:119], v[20:23], v[24:27], v[116:119]
  s_xor_b32 s59, s68, 65536
  s_add_u32 s59, s59, 393216
  s_add_u32 m0, s69, 0
  s_nop 0
  buffer_load_dwordx4 v4, s[20:23], s59 offen lds
  s_add_u32 m0, s69, 1024
  s_add_u32 s59, s59, 8192
  buffer_load_dwordx4 v4, s[20:23], s59 offen lds
  s_add_u32 m0, s69, 2048
  s_add_u32 s59, s59, 8192
  buffer_load_dwordx4 v4, s[20:23], s59 offen lds
  s_add_u32 m0, s69, 3072
  s_add_u32 s59, s59, 8192
  buffer_load_dwordx4 v4, s[20:23], s59 offen lds
  s_waitcnt lgkmcnt(1)
  v_mfma_f32_16x16x32_bf16 v[36:39], v[8:11], v[28:31], v[36:39]
  ds_read_b128 v[24:27], v7 offset:35840
  v_mfma_f32_16x16x32_bf16 v[64:67], v[12:15], v[28:31], v[64:67]
  v_mfma_f32_16x16x32_bf16 v[92:95], v[16:19], v[28:31], v[92:95]
  v_mfma_f32_16x16x32_bf16 v[120:123], v[20:23], v[28:31], v[120:123]
  s_waitcnt lgkmcnt(1)
  v_mfma_f32_16x16x32_bf16 v[40:43], v[8:11], v[0:3], v[40:43]
  ds_read_b128 v[28:31], v7 offset:36864
  v_mfma_f32_16x16x32_bf16 v[68:71], v[12:15], v[0:3], v[68:71]
  v_mfma_f32_16x16x32_bf16 v[96:99], v[16:19], v[0:3], v[96:99]
  v_mfma_f32_16x16x32_bf16 v[124:127], v[20:23], v[0:3], v[124:127]
  s_waitcnt lgkmcnt(1)
  v_mfma_f32_16x16x32_bf16 v[44:47], v[8:11], v[24:27], v[44:47]
  ds_read_b128 v[0:3], v7 offset:37888
  v_mfma_f32_16x16x32_bf16 v[72:75], v[12:15], v[24:27], v[72:75]
  v_mfma_f32_16x16x32_bf16 v[100:103], v[16:19], v[24:27], v[100:103]
  v_mfma_f32_16x16x32_bf16 v[128:131], v[20:23], v[24:27], v[128:131]
  s_waitcnt lgkmcnt(1)
  v_mfma_f32_16x16x32_bf16 v[48:51], v[8:11], v[28:31], v[48:51]
  ds_read_b128 v[24:27], v7 offset:38912
  v_mfma_f32_16x16x32_bf16 v[76:79], v[12:15], v[28:31], v[76:79]
  v_mfma_f32_16x16x32_bf16 v[104:107], v[16:19], v[28:31], v[104:107]
  v_mfma_f32_16x16x32_bf16 v[132:135], v[20:23], v[28:31], v[132:135]
  s_waitcnt lgkmcnt(1)
  v_mfma_f32_16x16x32_bf16 v[52:55], v[8:11], v[0:3], v[52:55]
  ds_read_b128 v[28:31], v7 offset:40960
  v_mfma_f32_16x16x32_bf16 v[80:83], v[12:15], v[0:3], v[80:83]
  v_mfma_f32_16x16x32_bf16 v[108:111], v[16:19], v[0:3], v[108:111]
  v_mfma_f32_16x16x32_bf16 v[136:139], v[20:23], v[0:3], v[136:139]
  s_waitcnt vmcnt(4)
  s_waitcnt lgkmcnt(1)
  v_mfma_f32_16x16x32_bf16 v[56:59], v[8:11], v[24:27], v[56:59]
  ds_read_b128 v[0:3], v7 offset:41984
  v_mfma_f32_16x16x32_bf16 v[84:87], v[12:15], v[24:27], v[84:87]
  ds_read_b64_tr_b16 v[8:9], v5 offset:4096
  ds_read_b64_tr_b16 v[10:11], v5 offset:6144
  v_mfma_f32_16x16x32_bf16 v[112:115], v[16:19], v[24:27], v[112:115]
  ds_read_b64_tr_b16 v[12:13], v6 offset:4096
  ds_read_b64_tr_b16 v[14:15], v6 offset:6144
  v_mfma_f32_16x16x32_bf16 v[140:143], v[20:23], v[24:27], v[140:143]
  ds_read_b64_tr_b16 v[16:17], v5 offset:4608
  ds_read_b64_tr_b16 v[18:19], v5 offset:6656
  ds_read_b64_tr_b16 v[20:21], v6 offset:4608
  ds_read_b64_tr_b16 v[22:23], v6 offset:6656
  s_waitcnt lgkmcnt(6)
  v_mfma_f32_16x16x32_bf16 v[32:35], v[8:11], v[28:31], v[32:35]
  ds_read_b128 v[24:27], v7 offset:43008
  s_waitcnt lgkmcnt(5)
  v_mfma_f32_16x16x32_bf16 v[60:63], v[12:15], v[28:31], v[60:63]
  s_waitcnt lgkmcnt(3)
  v_mfma_f32_16x16x32_bf16 v[88:91], v[16:19], v[28:31], v[88:91]
  s_waitcnt lgkmcnt(1)
  v_mfma_f32_16x16x32_bf16 v[116:119], v[20:23], v[28:31], v[116:119]
  s_xor_b32 s59, s68, 98304
  s_add_u32 s59, s59, 393216
  s_add_u32 m0, s69, 4096
  s_nop 0
  buffer_load_dwordx4 v4, s[20:23], s59 offen lds
  s_add_u32 m0, s69, 5120
  s_add_u32 s59, s59, 8192
  buffer_load_dwordx4 v4, s[20:23], s59 offen lds
  s_add_u32 m0, s69, 6144
  s_add_u32 s59, s59, 8192
  buffer_load_dwordx4 v4, s[20:23], s59 offen lds
  s_add_u32 m0, s69, 7168
  s_add_u32 s59, s59, 8192
  buffer_load_dwordx4 v4, s[20:23], s59 offen lds
  v_mfma_f32_16x16x32_bf16 v[36:39], v[8:11], v[0:3], v[36:39]
  ds_read_b128 v[28:31], v7 offset:44032
  v_mfma_f32_16x16x32_bf16 v[64:67], v[12:15], v[0:3], v[64:67]
  v_mfma_f32_16x16x32_bf16 v[92:95], v[16:19], v[0:3], v[92:95]
  v_mfma_f32_16x16x32_bf16 v[120:123], v[20:23], v[0:3], v[120:123]
  s_xor_b32 s59, s68, 128
  s_add_u32 s59, s59, 393216
  s_add_u32 m0, s69, -32768
  s_nop 0
  buffer_load_dwordx4 v4, s[20:23], s59 offen lds
  s_add_u32 m0, s69, -31744
  s_add_u32 s59, s59, 8192
  buffer_load_dwordx4 v4, s[20:23], s59 offen lds
  s_add_u32 m0, s69, -30720
  s_add_u32 s59, s59, 8192
  buffer_load_dwordx4 v4, s[20:23], s59 offen lds
  s_add_u32 m0, s69, -29696
  s_add_u32 s59, s59, 8192
  buffer_load_dwordx4 v4, s[20:23], s59 offen lds
  s_waitcnt lgkmcnt(1)
  v_mfma_f32_16x16x32_bf16 v[40:43], v[8:11], v[24:27], v[40:43]
  ds_read_b128 v[0:3], v7 offset:45056
  v_mfma_f32_16x16x32_bf16 v[68:71], v[12:15], v[24:27], v[68:71]
  v_mfma_f32_16x16x32_bf16 v[96:99], v[16:19], v[24:27], v[96:99]
  v_mfma_f32_16x16x32_bf16 v[124:127], v[20:23], v[24:27], v[124:127]
  s_xor_b32 s59, s68, 32896
  s_add_u32 s59, s59, 393216
  s_add_u32 m0, s69, -28672
  s_nop 0
  buffer_load_dwordx4 v4, s[20:23], s59 offen lds
  s_add_u32 m0, s69, -27648
  s_add_u32 s59, s59, 8192
  buffer_load_dwordx4 v4, s[20:23], s59 offen lds
  s_add_u32 m0, s69, -26624
  s_add_u32 s59, s59, 8192
  buffer_load_dwordx4 v4, s[20:23], s59 offen lds
  s_add_u32 m0, s69, -25600
  s_add_u32 s59, s59, 8192
  buffer_load_dwordx4 v4, s[20:23], s59 offen lds
  s_waitcnt lgkmcnt(1)
  v_mfma_f32_16x16x32_bf16 v[44:47], v[8:11], v[28:31], v[44:47]
  ds_read_b128 v[24:27], v7 offset:46080
  v_mfma_f32_16x16x32_bf16 v[72:75], v[12:15], v[28:31], v[72:75]
  v_mfma_f32_16x16x32_bf16 v[100:103], v[16:19], v[28:31], v[100:103]
  v_mfma_f32_16x16x32_bf16 v[128:131], v[20:23], v[28:31], v[128:131]
  s_xor_b32 s59, s68, 65664
  s_add_u32 s59, s59, 393216
  s_add_u32 m0, s69, -65536
  s_nop 0
  buffer_load_dwordx4 v4, s[20:23], s59 offen lds
  s_add_u32 m0, s69, -64512
  s_add_u32 s59, s59, 8192
  buffer_load_dwordx4 v4, s[20:23], s59 offen lds
  s_add_u32 m0, s69, -63488
  s_add_u32 s59, s59, 8192
  buffer_load_dwordx4 v4, s[20:23], s59 offen lds
  s_add_u32 m0, s69, -62464
  s_add_u32 s59, s59, 8192
  buffer_load_dwordx4 v4, s[20:23], s59 offen lds
  s_waitcnt lgkmcnt(1)
  v_mfma_f32_16x16x32_bf16 v[48:51], v[8:11], v[0:3], v[48:51]
  ds_read_b128 v[28:31], v7 offset:47104
  v_mfma_f32_16x16x32_bf16 v[76:79], v[12:15], v[0:3], v[76:79]
  v_mfma_f32_16x16x32_bf16 v[104:107], v[16:19], v[0:3], v[104:107]
  v_mfma_f32_16x16x32_bf16 v[132:135], v[20:23], v[0:3], v[132:135]
  s_xor_b32 s59, s68, 98432
  s_add_u32 s59, s59, 393216
  s_add_u32 m0, s69, -61440
  s_nop 0
  buffer_load_dwordx4 v4, s[20:23], s59 offen lds
  s_add_u32 m0, s69, -60416
  s_add_u32 s59, s59, 8192
  buffer_load_dwordx4 v4, s[20:23], s59 offen lds
  s_add_u32 m0, s69, -59392
  s_add_u32 s59, s59, 8192
  buffer_load_dwordx4 v4, s[20:23], s59 offen lds
  s_add_u32 m0, s69, -58368
  s_add_u32 s59, s59, 8192
  buffer_load_dwordx4 v4, s[20:23], s59 offen lds
  s_waitcnt lgkmcnt(1)
  v_mfma_f32_16x16x32_bf16 v[52:55], v[8:11], v[24:27], v[52:55]
  ds_read_b128 v[0:3], v7 offset:49152
  v_mfma_f32_16x16x32_bf16 v[80:83], v[12:15], v[24:27], v[80:83]
  v_mfma_f32_16x16x32_bf16 v[108:111], v[16:19], v[24:27], v[108:111]
  v_mfma_f32_16x16x32_bf16 v[136:139], v[20:23], v[24:27], v[136:139]
  s_waitcnt vmcnt(20)
  s_waitcnt lgkmcnt(1)
  v_mfma_f32_16x16x32_bf16 v[56:59], v[8:11], v[28:31], v[56:59]
  ds_read_b128 v[24:27], v7 offset:50176
  v_mfma_f32_16x16x32_bf16 v[84:87], v[12:15], v[28:31], v[84:87]
  ds_read_b64_tr_b16 v[8:9], v5 offset:0
  ds_read_b64_tr_b16 v[10:11], v5 offset:2048
  v_mfma_f32_16x16x32_bf16 v[112:115], v[16:19], v[28:31], v[112:115]
  ds_read_b64_tr_b16 v[12:13], v6 offset:0
  ds_read_b64_tr_b16 v[14:15], v6 offset:2048
  v_mfma_f32_16x16x32_bf16 v[140:143], v[20:23], v[28:31], v[140:143]
  ds_read_b64_tr_b16 v[16:17], v5 offset:512
  ds_read_b64_tr_b16 v[18:19], v5 offset:2560
  ds_read_b64_tr_b16 v[20:21], v6 offset:512
  ds_read_b64_tr_b16 v[22:23], v6 offset:2560
  s_waitcnt lgkmcnt(6)
  v_mfma_f32_16x16x32_bf16 v[32:35], v[8:11], v[0:3], v[32:35]
  ds_read_b128 v[28:31], v7 offset:51200
  s_waitcnt lgkmcnt(5)
  v_mfma_f32_16x16x32_bf16 v[60:63], v[12:15], v[0:3], v[60:63]
  s_waitcnt lgkmcnt(3)
  v_mfma_f32_16x16x32_bf16 v[88:91], v[16:19], v[0:3], v[88:91]
  s_waitcnt lgkmcnt(1)
  v_mfma_f32_16x16x32_bf16 v[116:119], v[20:23], v[0:3], v[116:119]
  v_mfma_f32_16x16x32_bf16 v[36:39], v[8:11], v[24:27], v[36:39]
  ds_read_b128 v[0:3], v7 offset:52224
  v_mfma_f32_16x16x32_bf16 v[64:67], v[12:15], v[24:27], v[64:67]
  v_mfma_f32_16x16x32_bf16 v[92:95], v[16:19], v[24:27], v[92:95]
  v_mfma_f32_16x16x32_bf16 v[120:123], v[20:23], v[24:27], v[120:123]
  s_waitcnt lgkmcnt(1)
  v_mfma_f32_16x16x32_bf16 v[40:43], v[8:11], v[28:31], v[40:43]
  ds_read_b128 v[24:27], v7 offset:53248
  v_mfma_f32_16x16x32_bf16 v[68:71], v[12:15], v[28:31], v[68:71]
  v_mfma_f32_16x16x32_bf16 v[96:99], v[16:19], v[28:31], v[96:99]
  v_mfma_f32_16x16x32_bf16 v[124:127], v[20:23], v[28:31], v[124:127]
  s_waitcnt lgkmcnt(1)
  v_mfma_f32_16x16x32_bf16 v[44:47], v[8:11], v[0:3], v[44:47]
  ds_read_b128 v[28:31], v7 offset:54272
  v_mfma_f32_16x16x32_bf16 v[72:75], v[12:15], v[0:3], v[72:75]
  v_mfma_f32_16x16x32_bf16 v[100:103], v[16:19], v[0:3], v[100:103]
  v_mfma_f32_16x16x32_bf16 v[128:131], v[20:23], v[0:3], v[128:131]
  s_waitcnt lgkmcnt(1)
  v_mfma_f32_16x16x32_bf16 v[48:51], v[8:11], v[24:27], v[48:51]
  ds_read_b128 v[0:3], v7 offset:55296
  v_mfma_f32_16x16x32_bf16 v[76:79], v[12:15], v[24:27], v[76:79]
  v_mfma_f32_16x16x32_bf16 v[104:107], v[16:19], v[24:27], v[104:107]
  v_mfma_f32_16x16x32_bf16 v[132:135], v[20:23], v[24:27], v[132:135]
  s_waitcnt lgkmcnt(1)
  v_mfma_f32_16x16x32_bf16 v[52:55], v[8:11], v[28:31], v[52:55]
  ds_read_b128 v[24:27], v7 offset:57344
  v_mfma_f32_16x16x32_bf16 v[80:83], v[12:15], v[28:31], v[80:83]
  v_mfma_f32_16x16x32_bf16 v[108:111], v[16:19], v[28:31], v[108:111]
  v_mfma_f32_16x16x32_bf16 v[136:139], v[20:23], v[28:31], v[136:139]
  s_waitcnt vmcnt(16)
  s_waitcnt lgkmcnt(1)
  v_mfma_f32_16x16x32_bf16 v[56:59], v[8:11], v[0:3], v[56:59]
  ds_read_b128 v[28:31], v7 offset:58368
  v_mfma_f32_16x16x32_bf16 v[84:87], v[12:15], v[0:3], v[84:87]
  ds_read_b64_tr_b16 v[8:9], v5 offset:4096
  ds_read_b64_tr_b16 v[10:11], v5 offset:6144
  v_mfma_f32_16x16x32_bf16 v[112:115], v[16:19], v[0:3], v[112:115]
  ds_read_b64_tr_b16 v[12:13], v6 offset:4096
  ds_read_b64_tr_b16 v[14:15], v6 offset:6144
  v_mfma_f32_16x16x32_bf16 v[140:143], v[20:23], v[0:3], v[140:143]
  ds_read_b64_tr_b16 v[16:17], v5 offset:4608
  ds_read_b64_tr_b16 v[18:19], v5 offset:6656
  ds_read_b64_tr_b16 v[20:21], v6 offset:4608
  ds_read_b64_tr_b16 v[22:23], v6 offset:6656
  s_lshl1_add_u32 s61, s40, s47
  s_xor_b32 s61, s61, 0
  s_cmp_eq_u32 s61, s41
  s_cselect_b32 s62, 16384, s71
  s_cselect_b32 s60, 1073741824, 0
  s_lshl3_add_u32 s61, s61, s41
  s_lshl_b32 s61, s61, 14
  s_add_u32 s61, s61, s60
  v_add_u32 v4, s62, v7
  s_waitcnt lgkmcnt(6)
  v_mfma_f32_16x16x32_bf16 v[32:35], v[8:11], v[24:27], v[32:35]
  ds_read_b128 v[0:3], v7 offset:59392
  s_waitcnt lgkmcnt(5)
  v_mfma_f32_16x16x32_bf16 v[60:63], v[12:15], v[24:27], v[60:63]
  s_waitcnt lgkmcnt(3)
  v_mfma_f32_16x16x32_bf16 v[88:91], v[16:19], v[24:27], v[88:91]
  s_waitcnt lgkmcnt(1)
  v_mfma_f32_16x16x32_bf16 v[116:119], v[20:23], v[24:27], v[116:119]
  v_mfma_f32_16x16x32_bf16 v[36:39], v[8:11], v[28:31], v[36:39]
  ds_read_b128 v[24:27], v7 offset:60416
  v_cvt_pk_bf16_f32 v32, v32, v33
  v_cvt_pk_bf16_f32 v33, v34, v35
  v_mfma_f32_16x16x32_bf16 v[64:67], v[12:15], v[28:31], v[64:67]
  v_cvt_pk_bf16_f32 v34, v60, v61
  v_cvt_pk_bf16_f32 v35, v62, v63
  buffer_store_dwordx4 v[32:35], v7, s[28:31], s61 offen sc1
  ds_write_b128 v4, v[32:35] offset:0
  v_mfma_f32_16x16x32_bf16 v[92:95], v[16:19], v[28:31], v[92:95]
  v_cvt_pk_bf16_f32 v88, v88, v89
  v_cvt_pk_bf16_f32 v89, v90, v91
  v_mfma_f32_16x16x32_bf16 v[120:123], v[20:23], v[28:31], v[120:123]
  v_cvt_pk_bf16_f32 v90, v116, v117
  v_cvt_pk_bf16_f32 v91, v118, v119
  buffer_store_dwordx4 v[88:91], v7, s[28:31], s61 offen offset:1024 sc1
  ds_write_b128 v4, v[88:91] offset:1024
  s_waitcnt lgkmcnt(3)
  v_mfma_f32_16x16x32_bf16 v[40:43], v[8:11], v[0:3], v[40:43]
  ds_read_b128 v[28:31], v7 offset:61440
  v_cvt_pk_bf16_f32 v36, v36, v37
  v_cvt_pk_bf16_f32 v37, v38, v39
  v_mfma_f32_16x16x32_bf16 v[68:71], v[12:15], v[0:3], v[68:71]
  v_cvt_pk_bf16_f32 v38, v64, v65
  v_cvt_pk_bf16_f32 v39, v66, v67
  buffer_store_dwordx4 v[36:39], v7, s[28:31], s61 offen offset:2048 sc1
  ds_write_b128 v4, v[36:39] offset:2048
  v_mfma_f32_16x16x32_bf16 v[96:99], v[16:19], v[0:3], v[96:99]
  v_cvt_pk_bf16_f32 v92, v92, v93
  v_cvt_pk_bf16_f32 v93, v94, v95
  v_mfma_f32_16x16x32_bf16 v[124:127], v[20:23], v[0:3], v[124:127]
  v_cvt_pk_bf16_f32 v94, v120, v121
  v_cvt_pk_bf16_f32 v95, v122, v123
  buffer_store_dwordx4 v[92:95], v7, s[28:31], s61 offen offset:3072 sc1
  ds_write_b128 v4, v[92:95] offset:3072
  s_waitcnt lgkmcnt(5)
  v_mfma_f32_16x16x32_bf16 v[44:47], v[8:11], v[24:27], v[44:47]
  ds_read_b128 v[0:3], v7 offset:62464
  v_cvt_pk_bf16_f32 v40, v40, v41
  v_cvt_pk_bf16_f32 v41, v42, v43
  v_mfma_f32_16x16x32_bf16 v[72:75], v[12:15], v[24:27], v[72:75]
  v_cvt_pk_bf16_f32 v42, v68, v69
  v_cvt_pk_bf16_f32 v43, v70, v71
  s_add_u32 s61, s61, 4096
  buffer_store_dwordx4 v[40:43], v7, s[28:31], s61 offen sc1
  ds_write_b128 v4, v[40:43] offset:4096
  v_mfma_f32_16x16x32_bf16 v[100:103], v[16:19], v[24:27], v[100:103]
  v_cvt_pk_bf16_f32 v96, v96, v97
  v_cvt_pk_bf16_f32 v97, v98, v99
  v_mfma_f32_16x16x32_bf16 v[128:131], v[20:23], v[24:27], v[128:131]
  v_cvt_pk_bf16_f32 v98, v124, v125
  v_cvt_pk_bf16_f32 v99, v126, v127
  buffer_store_dwordx4 v[96:99], v7, s[28:31], s61 offen offset:1024 sc1
  ds_write_b128 v4, v[96:99] offset:5120
  s_waitcnt lgkmcnt(5)
  v_mfma_f32_16x16x32_bf16 v[48:51], v[8:11], v[28:31], v[48:51]
  ds_read_b128 v[24:27], v7 offset:63488
  v_cvt_pk_bf16_f32 v44, v44, v45
  v_cvt_pk_bf16_f32 v45, v46, v47
  v_mfma_f32_16x16x32_bf16 v[76:79], v[12:15], v[28:31], v[76:79]
  v_cvt_pk_bf16_f32 v46, v72, v73
  v_cvt_pk_bf16_f32 v47, v74, v75
  buffer_store_dwordx4 v[44:47], v7, s[28:31], s61 offen offset:2048 sc1
  ds_write_b128 v4, v[44:47] offset:6144
  v_mfma_f32_16x16x32_bf16 v[104:107], v[16:19], v[28:31], v[104:107]
  v_cvt_pk_bf16_f32 v100, v100, v101
  v_cvt_pk_bf16_f32 v101, v102, v103
  v_mfma_f32_16x16x32_bf16 v[132:135], v[20:23], v[28:31], v[132:135]
  v_cvt_pk_bf16_f32 v102, v128, v129
  v_cvt_pk_bf16_f32 v103, v130, v131
  buffer_store_dwordx4 v[100:103], v7, s[28:31], s61 offen offset:3072 sc1
  ds_write_b128 v4, v[100:103] offset:7168
  s_waitcnt lgkmcnt(5)
  v_mfma_f32_16x16x32_bf16 v[52:55], v[8:11], v[0:3], v[52:55]
  ds_read_b128 v[28:31], v7 offset:32768
  v_cvt_pk_bf16_f32 v48, v48, v49
  v_cvt_pk_bf16_f32 v49, v50, v51
  v_mfma_f32_16x16x32_bf16 v[80:83], v[12:15], v[0:3], v[80:83]
  v_cvt_pk_bf16_f32 v50, v76, v77
  v_cvt_pk_bf16_f32 v51, v78, v79
  s_add_u32 s61, s61, 4096
  buffer_store_dwordx4 v[48:51], v7, s[28:31], s61 offen sc1
  ds_write_b128 v4, v[48:51] offset:8192
  v_mfma_f32_16x16x32_bf16 v[108:111], v[16:19], v[0:3], v[108:111]
  v_cvt_pk_bf16_f32 v104, v104, v105
  v_cvt_pk_bf16_f32 v105, v106, v107
  v_mfma_f32_16x16x32_bf16 v[136:139], v[20:23], v[0:3], v[136:139]
  v_cvt_pk_bf16_f32 v106, v132, v133
  v_cvt_pk_bf16_f32 v107, v134, v135
  buffer_store_dwordx4 v[104:107], v7, s[28:31], s61 offen offset:1024 sc1
  ds_write_b128 v4, v[104:107] offset:9216
  s_waitcnt vmcnt(22)
  s_waitcnt lgkmcnt(5)
  v_mfma_f32_16x16x32_bf16 v[56:59], v[8:11], v[24:27], v[56:59]
  ds_read_b128 v[0:3], v7 offset:33792
  v_cvt_pk_bf16_f32 v52, v52, v53
  v_cvt_pk_bf16_f32 v53, v54, v55
  v_mfma_f32_16x16x32_bf16 v[84:87], v[12:15], v[24:27], v[84:87]
  v_add_u32 v5, -32768, v5
  v_add_u32 v6, -32768, v6
  ds_read_b64_tr_b16 v[8:9], v5 offset:0
  ds_read_b64_tr_b16 v[10:11], v5 offset:2048
  v_cvt_pk_bf16_f32 v54, v80, v81
  v_cvt_pk_bf16_f32 v55, v82, v83
  buffer_store_dwordx4 v[52:55], v7, s[28:31], s61 offen offset:2048 sc1
  ds_write_b128 v4, v[52:55] offset:10240
  v_mfma_f32_16x16x32_bf16 v[112:115], v[16:19], v[24:27], v[112:115]
  ds_read_b64_tr_b16 v[12:13], v6 offset:0
  ds_read_b64_tr_b16 v[14:15], v6 offset:2048
  v_cvt_pk_bf16_f32 v108, v108, v109
  v_cvt_pk_bf16_f32 v109, v110, v111
  v_mfma_f32_16x16x32_bf16 v[140:143], v[20:23], v[24:27], v[140:143]
  ds_read_b64_tr_b16 v[16:17], v5 offset:512
  ds_read_b64_tr_b16 v[18:19], v5 offset:2560
  v_cvt_pk_bf16_f32 v110, v136, v137
  v_cvt_pk_bf16_f32 v111, v138, v139
  buffer_store_dwordx4 v[108:111], v7, s[28:31], s61 offen offset:3072 sc1
  ds_write_b128 v4, v[108:111] offset:11264
  ds_read_b64_tr_b16 v[20:21], v6 offset:512
  ds_read_b64_tr_b16 v[22:23], v6 offset:2560
  s_waitcnt lgkmcnt(8)
  v_mfma_f32_16x16x32_bf16 v[144:147], v[8:11], v[28:31], v[144:147]
  ds_read_b128 v[24:27], v7 offset:34816
  v_cvt_pk_bf16_f32 v56, v56, v57
  v_cvt_pk_bf16_f32 v57, v58, v59
  s_waitcnt lgkmcnt(6)
  v_mfma_f32_16x16x32_bf16 v[172:175], v[12:15], v[28:31], v[172:175]
  v_cvt_pk_bf16_f32 v58, v84, v85
  v_cvt_pk_bf16_f32 v59, v86, v87
  s_add_u32 s61, s61, 4096
  buffer_store_dwordx4 v[56:59], v7, s[28:31], s61 offen sc1
  ds_write_b128 v4, v[56:59] offset:12288
  s_waitcnt lgkmcnt(5)
  v_mfma_f32_16x16x32_bf16 v[200:203], v[16:19], v[28:31], v[200:203]
  v_cvt_pk_bf16_f32 v112, v112, v113
  v_cvt_pk_bf16_f32 v113, v114, v115
  s_waitcnt lgkmcnt(2)
  v_mfma_f32_16x16x32_bf16 v[228:231], v[20:23], v[28:31], v[228:231]
  v_cvt_pk_bf16_f32 v114, v140, v141
  v_cvt_pk_bf16_f32 v115, v142, v143
  buffer_store_dwordx4 v[112:115], v7, s[28:31], s61 offen offset:1024 sc1
  ds_write_b128 v4, v[112:115] offset:13312
  v_mfma_f32_16x16x32_bf16 v[148:151], v[8:11], v[0:3], v[148:151]
  ds_read_b128 v[28:31], v7 offset:35840
  v_mfma_f32_16x16x32_bf16 v[176:179], v[12:15], v[0:3], v[176:179]
  v_mfma_f32_16x16x32_bf16 v[204:207], v[16:19], v[0:3], v[204:207]
  v_mfma_f32_16x16x32_bf16 v[232:235], v[20:23], v[0:3], v[232:235]
  s_waitcnt lgkmcnt(3)
  v_mfma_f32_16x16x32_bf16 v[152:155], v[8:11], v[24:27], v[152:155]
  ds_read_b128 v[0:3], v7 offset:36864
  v_mfma_f32_16x16x32_bf16 v[180:183], v[12:15], v[24:27], v[180:183]
  v_mfma_f32_16x16x32_bf16 v[208:211], v[16:19], v[24:27], v[208:211]
  v_mfma_f32_16x16x32_bf16 v[236:239], v[20:23], v[24:27], v[236:239]
  s_waitcnt lgkmcnt(1)
  v_mfma_f32_16x16x32_bf16 v[156:159], v[8:11], v[28:31], v[156:159]
  ds_read_b128 v[24:27], v7 offset:37888
  v_mfma_f32_16x16x32_bf16 v[184:187], v[12:15], v[28:31], v[184:187]
  v_mfma_f32_16x16x32_bf16 v[212:215], v[16:19], v[28:31], v[212:215]
  v_mfma_f32_16x16x32_bf16 v[240:243], v[20:23], v[28:31], v[240:243]
  s_waitcnt lgkmcnt(1)
  v_mfma_f32_16x16x32_bf16 v[160:163], v[8:11], v[0:3], v[160:163]
  ds_read_b128 v[28:31], v7 offset:38912
  v_mfma_f32_16x16x32_bf16 v[188:191], v[12:15], v[0:3], v[188:191]
  v_mfma_f32_16x16x32_bf16 v[216:219], v[16:19], v[0:3], v[216:219]
  v_mfma_f32_16x16x32_bf16 v[244:247], v[20:23], v[0:3], v[244:247]
  s_waitcnt lgkmcnt(1)
  v_mfma_f32_16x16x32_bf16 v[164:167], v[8:11], v[24:27], v[164:167]
  ds_read_b128 v[0:3], v7 offset:40960
  v_mfma_f32_16x16x32_bf16 v[192:195], v[12:15], v[24:27], v[192:195]
  v_mfma_f32_16x16x32_bf16 v[220:223], v[16:19], v[24:27], v[220:223]
  v_mfma_f32_16x16x32_bf16 v[248:251], v[20:23], v[24:27], v[248:251]
  s_waitcnt vmcnt(22)
  s_waitcnt lgkmcnt(1)
  v_mfma_f32_16x16x32_bf16 v[168:171], v[8:11], v[28:31], v[168:171]
  ds_read_b128 v[24:27], v7 offset:41984
  v_mfma_f32_16x16x32_bf16 v[196:199], v[12:15], v[28:31], v[196:199]
  ds_read_b64_tr_b16 v[8:9], v5 offset:4096
  ds_read_b64_tr_b16 v[10:11], v5 offset:6144
  v_mfma_f32_16x16x32_bf16 v[224:227], v[16:19], v[28:31], v[224:227]
  ds_read_b64_tr_b16 v[12:13], v6 offset:4096
  ds_read_b64_tr_b16 v[14:15], v6 offset:6144
  v_mfma_f32_16x16x32_bf16 v[252:255], v[20:23], v[28:31], v[252:255]
  ds_read_b64_tr_b16 v[16:17], v5 offset:4608
  ds_read_b64_tr_b16 v[18:19], v5 offset:6656
  ds_read_b64_tr_b16 v[20:21], v6 offset:4608
  ds_read_b64_tr_b16 v[22:23], v6 offset:6656
  s_waitcnt lgkmcnt(6)
  v_mfma_f32_16x16x32_bf16 v[144:147], v[8:11], v[0:3], v[144:147]
  ds_read_b128 v[28:31], v7 offset:43008
  s_waitcnt lgkmcnt(5)
  v_mfma_f32_16x16x32_bf16 v[172:175], v[12:15], v[0:3], v[172:175]
  s_waitcnt lgkmcnt(3)
  v_mfma_f32_16x16x32_bf16 v[200:203], v[16:19], v[0:3], v[200:203]
  s_waitcnt lgkmcnt(1)
  v_mfma_f32_16x16x32_bf16 v[228:231], v[20:23], v[0:3], v[228:231]
  v_mfma_f32_16x16x32_bf16 v[148:151], v[8:11], v[24:27], v[148:151]
  ds_read_b128 v[0:3], v7 offset:44032
  v_mfma_f32_16x16x32_bf16 v[176:179], v[12:15], v[24:27], v[176:179]
  v_mfma_f32_16x16x32_bf16 v[204:207], v[16:19], v[24:27], v[204:207]
  v_mfma_f32_16x16x32_bf16 v[232:235], v[20:23], v[24:27], v[232:235]
  s_waitcnt lgkmcnt(1)
  v_mfma_f32_16x16x32_bf16 v[152:155], v[8:11], v[28:31], v[152:155]
  ds_read_b128 v[24:27], v7 offset:45056
  v_mfma_f32_16x16x32_bf16 v[180:183], v[12:15], v[28:31], v[180:183]
  v_mfma_f32_16x16x32_bf16 v[208:211], v[16:19], v[28:31], v[208:211]
  v_mfma_f32_16x16x32_bf16 v[236:239], v[20:23], v[28:31], v[236:239]
  s_waitcnt lgkmcnt(1)
  v_mfma_f32_16x16x32_bf16 v[156:159], v[8:11], v[0:3], v[156:159]
  ds_read_b128 v[28:31], v7 offset:46080
  v_mfma_f32_16x16x32_bf16 v[184:187], v[12:15], v[0:3], v[184:187]
  v_mfma_f32_16x16x32_bf16 v[212:215], v[16:19], v[0:3], v[212:215]
  v_mfma_f32_16x16x32_bf16 v[240:243], v[20:23], v[0:3], v[240:243]
  s_waitcnt lgkmcnt(1)
  v_mfma_f32_16x16x32_bf16 v[160:163], v[8:11], v[24:27], v[160:163]
  ds_read_b128 v[0:3], v7 offset:47104
  v_mfma_f32_16x16x32_bf16 v[188:191], v[12:15], v[24:27], v[188:191]
  v_mfma_f32_16x16x32_bf16 v[216:219], v[16:19], v[24:27], v[216:219]
  v_mfma_f32_16x16x32_bf16 v[244:247], v[20:23], v[24:27], v[244:247]
  s_waitcnt lgkmcnt(1)
  v_mfma_f32_16x16x32_bf16 v[164:167], v[8:11], v[28:31], v[164:167]
  ds_read_b128 v[24:27], v7 offset:49152
  v_mfma_f32_16x16x32_bf16 v[192:195], v[12:15], v[28:31], v[192:195]
  v_mfma_f32_16x16x32_bf16 v[220:223], v[16:19], v[28:31], v[220:223]
  v_mfma_f32_16x16x32_bf16 v[248:251], v[20:23], v[28:31], v[248:251]
  s_waitcnt vmcnt(18)
  s_waitcnt lgkmcnt(1)
  v_mfma_f32_16x16x32_bf16 v[168:171], v[8:11], v[0:3], v[168:171]
  ds_read_b128 v[28:31], v7 offset:50176
  v_mfma_f32_16x16x32_bf16 v[196:199], v[12:15], v[0:3], v[196:199]
  v_add_u32 v5, -32768, v5
  v_add_u32 v6, -32768, v6
  ds_read_b64_tr_b16 v[8:9], v5 offset:0
  ds_read_b64_tr_b16 v[10:11], v5 offset:2048
  v_mfma_f32_16x16x32_bf16 v[224:227], v[16:19], v[0:3], v[224:227]
  ds_read_b64_tr_b16 v[12:13], v6 offset:0
  ds_read_b64_tr_b16 v[14:15], v6 offset:2048
  v_mfma_f32_16x16x32_bf16 v[252:255], v[20:23], v[0:3], v[252:255]
  ds_read_b64_tr_b16 v[16:17], v5 offset:512
  ds_read_b64_tr_b16 v[18:19], v5 offset:2560
  ds_read_b64_tr_b16 v[20:21], v6 offset:512
  ds_read_b64_tr_b16 v[22:23], v6 offset:2560
  s_waitcnt lgkmcnt(6)
  v_mfma_f32_16x16x32_bf16 v[144:147], v[8:11], v[24:27], v[144:147]
  ds_read_b128 v[0:3], v7 offset:51200
  s_waitcnt lgkmcnt(5)
  v_mfma_f32_16x16x32_bf16 v[172:175], v[12:15], v[24:27], v[172:175]
  s_waitcnt lgkmcnt(3)
  v_mfma_f32_16x16x32_bf16 v[200:203], v[16:19], v[24:27], v[200:203]
  s_waitcnt lgkmcnt(1)
  v_mfma_f32_16x16x32_bf16 v[228:231], v[20:23], v[24:27], v[228:231]
  v_mfma_f32_16x16x32_bf16 v[148:151], v[8:11], v[28:31], v[148:151]
  ds_read_b128 v[24:27], v7 offset:52224
  v_mfma_f32_16x16x32_bf16 v[176:179], v[12:15], v[28:31], v[176:179]
  v_mfma_f32_16x16x32_bf16 v[204:207], v[16:19], v[28:31], v[204:207]
  v_mfma_f32_16x16x32_bf16 v[232:235], v[20:23], v[28:31], v[232:235]
  s_waitcnt lgkmcnt(1)
  v_mfma_f32_16x16x32_bf16 v[152:155], v[8:11], v[0:3], v[152:155]
  ds_read_b128 v[28:31], v7 offset:53248
  v_mfma_f32_16x16x32_bf16 v[180:183], v[12:15], v[0:3], v[180:183]
  v_mfma_f32_16x16x32_bf16 v[208:211], v[16:19], v[0:3], v[208:211]
  v_mfma_f32_16x16x32_bf16 v[236:239], v[20:23], v[0:3], v[236:239]
  s_waitcnt lgkmcnt(1)
  v_mfma_f32_16x16x32_bf16 v[156:159], v[8:11], v[24:27], v[156:159]
  ds_read_b128 v[0:3], v7 offset:54272
  v_mfma_f32_16x16x32_bf16 v[184:187], v[12:15], v[24:27], v[184:187]
  v_mfma_f32_16x16x32_bf16 v[212:215], v[16:19], v[24:27], v[212:215]
  v_mfma_f32_16x16x32_bf16 v[240:243], v[20:23], v[24:27], v[240:243]
  s_waitcnt lgkmcnt(1)
  v_mfma_f32_16x16x32_bf16 v[160:163], v[8:11], v[28:31], v[160:163]
  ds_read_b128 v[24:27], v7 offset:55296
  v_mfma_f32_16x16x32_bf16 v[188:191], v[12:15], v[28:31], v[188:191]
  v_mfma_f32_16x16x32_bf16 v[216:219], v[16:19], v[28:31], v[216:219]
  v_mfma_f32_16x16x32_bf16 v[244:247], v[20:23], v[28:31], v[244:247]
  s_waitcnt lgkmcnt(1)
  v_mfma_f32_16x16x32_bf16 v[164:167], v[8:11], v[0:3], v[164:167]
  ds_read_b128 v[28:31], v7 offset:57344
  v_mfma_f32_16x16x32_bf16 v[192:195], v[12:15], v[0:3], v[192:195]
  v_mfma_f32_16x16x32_bf16 v[220:223], v[16:19], v[0:3], v[220:223]
  v_mfma_f32_16x16x32_bf16 v[248:251], v[20:23], v[0:3], v[248:251]
  s_waitcnt vmcnt(14)
  s_waitcnt lgkmcnt(1)
  v_mfma_f32_16x16x32_bf16 v[168:171], v[8:11], v[24:27], v[168:171]
  ds_read_b128 v[0:3], v7 offset:58368
  v_mfma_f32_16x16x32_bf16 v[196:199], v[12:15], v[24:27], v[196:199]
  ds_read_b64_tr_b16 v[8:9], v5 offset:4096
  ds_read_b64_tr_b16 v[10:11], v5 offset:6144
  v_mfma_f32_16x16x32_bf16 v[224:227], v[16:19], v[24:27], v[224:227]
  ds_read_b64_tr_b16 v[12:13], v6 offset:4096
  ds_read_b64_tr_b16 v[14:15], v6 offset:6144
  v_mfma_f32_16x16x32_bf16 v[252:255], v[20:23], v[24:27], v[252:255]
  ds_read_b64_tr_b16 v[16:17], v5 offset:4608
  ds_read_b64_tr_b16 v[18:19], v5 offset:6656
  ds_read_b64_tr_b16 v[20:21], v6 offset:4608
  ds_read_b64_tr_b16 v[22:23], v6 offset:6656
  s_lshl1_add_u32 s61, s40, s47
  s_xor_b32 s61, s61, 1
  s_cmp_eq_u32 s61, s41
  s_cselect_b32 s62, 16384, s71
  s_cselect_b32 s60, 1073741824, 0
  s_lshl3_add_u32 s61, s61, s41
  s_lshl_b32 s61, s61, 14
  s_add_u32 s61, s61, s60
  v_add_u32 v4, s62, v7
  s_waitcnt lgkmcnt(6)
  v_mfma_f32_16x16x32_bf16 v[144:147], v[8:11], v[28:31], v[144:147]
  ds_read_b128 v[24:27], v7 offset:59392
  s_waitcnt lgkmcnt(5)
  v_mfma_f32_16x16x32_bf16 v[172:175], v[12:15], v[28:31], v[172:175]
  s_waitcnt lgkmcnt(3)
  v_mfma_f32_16x16x32_bf16 v[200:203], v[16:19], v[28:31], v[200:203]
  s_waitcnt lgkmcnt(1)
  v_mfma_f32_16x16x32_bf16 v[228:231], v[20:23], v[28:31], v[228:231]
  v_mfma_f32_16x16x32_bf16 v[148:151], v[8:11], v[0:3], v[148:151]
  ds_read_b128 v[28:31], v7 offset:60416
  v_cvt_pk_bf16_f32 v144, v144, v145
  v_cvt_pk_bf16_f32 v145, v146, v147
  v_mfma_f32_16x16x32_bf16 v[176:179], v[12:15], v[0:3], v[176:179]
  v_cvt_pk_bf16_f32 v146, v172, v173
  v_cvt_pk_bf16_f32 v147, v174, v175
  buffer_store_dwordx4 v[144:147], v7, s[28:31], s61 offen sc1
  ds_write_b128 v4, v[144:147] offset:0
  v_mfma_f32_16x16x32_bf16 v[204:207], v[16:19], v[0:3], v[204:207]
  v_cvt_pk_bf16_f32 v200, v200, v201
  v_cvt_pk_bf16_f32 v201, v202, v203
  v_mfma_f32_16x16x32_bf16 v[232:235], v[20:23], v[0:3], v[232:235]
  v_cvt_pk_bf16_f32 v202, v228, v229
  v_cvt_pk_bf16_f32 v203, v230, v231
  buffer_store_dwordx4 v[200:203], v7, s[28:31], s61 offen offset:1024 sc1
  ds_write_b128 v4, v[200:203] offset:1024
  s_waitcnt lgkmcnt(3)
  v_mfma_f32_16x16x32_bf16 v[152:155], v[8:11], v[24:27], v[152:155]
  ds_read_b128 v[0:3], v7 offset:61440
  v_cvt_pk_bf16_f32 v148, v148, v149
  v_cvt_pk_bf16_f32 v149, v150, v151
  v_mfma_f32_16x16x32_bf16 v[180:183], v[12:15], v[24:27], v[180:183]
  v_cvt_pk_bf16_f32 v150, v176, v177
  v_cvt_pk_bf16_f32 v151, v178, v179
  buffer_store_dwordx4 v[148:151], v7, s[28:31], s61 offen offset:2048 sc1
  ds_write_b128 v4, v[148:151] offset:2048
  v_mfma_f32_16x16x32_bf16 v[208:211], v[16:19], v[24:27], v[208:211]
  v_cvt_pk_bf16_f32 v204, v204, v205
  v_cvt_pk_bf16_f32 v205, v206, v207
  v_mfma_f32_16x16x32_bf16 v[236:239], v[20:23], v[24:27], v[236:239]
  v_cvt_pk_bf16_f32 v206, v232, v233
  v_cvt_pk_bf16_f32 v207, v234, v235
  buffer_store_dwordx4 v[204:207], v7, s[28:31], s61 offen offset:3072 sc1
  ds_write_b128 v4, v[204:207] offset:3072
  s_waitcnt lgkmcnt(5)
  v_mfma_f32_16x16x32_bf16 v[156:159], v[8:11], v[28:31], v[156:159]
  ds_read_b128 v[24:27], v7 offset:62464
  v_cvt_pk_bf16_f32 v152, v152, v153
  v_cvt_pk_bf16_f32 v153, v154, v155
  v_mfma_f32_16x16x32_bf16 v[184:187], v[12:15], v[28:31], v[184:187]
  v_cvt_pk_bf16_f32 v154, v180, v181
  v_cvt_pk_bf16_f32 v155, v182, v183
  s_add_u32 s61, s61, 4096
  buffer_store_dwordx4 v[152:155], v7, s[28:31], s61 offen sc1
  ds_write_b128 v4, v[152:155] offset:4096
  v_mfma_f32_16x16x32_bf16 v[212:215], v[16:19], v[28:31], v[212:215]
  v_cvt_pk_bf16_f32 v208, v208, v209
  v_cvt_pk_bf16_f32 v209, v210, v211
  v_mfma_f32_16x16x32_bf16 v[240:243], v[20:23], v[28:31], v[240:243]
  v_cvt_pk_bf16_f32 v210, v236, v237
  v_cvt_pk_bf16_f32 v211, v238, v239
  buffer_store_dwordx4 v[208:211], v7, s[28:31], s61 offen offset:1024 sc1
  ds_write_b128 v4, v[208:211] offset:5120
  s_waitcnt lgkmcnt(5)
  v_mfma_f32_16x16x32_bf16 v[160:163], v[8:11], v[0:3], v[160:163]
  ds_read_b128 v[28:31], v7 offset:63488
  v_cvt_pk_bf16_f32 v156, v156, v157
  v_cvt_pk_bf16_f32 v157, v158, v159
  v_mfma_f32_16x16x32_bf16 v[188:191], v[12:15], v[0:3], v[188:191]
  v_cvt_pk_bf16_f32 v158, v184, v185
  v_cvt_pk_bf16_f32 v159, v186, v187
  buffer_store_dwordx4 v[156:159], v7, s[28:31], s61 offen offset:2048 sc1
  ds_write_b128 v4, v[156:159] offset:6144
  v_mfma_f32_16x16x32_bf16 v[216:219], v[16:19], v[0:3], v[216:219]
  v_cvt_pk_bf16_f32 v212, v212, v213
  v_cvt_pk_bf16_f32 v213, v214, v215
  v_mfma_f32_16x16x32_bf16 v[244:247], v[20:23], v[0:3], v[244:247]
  v_cvt_pk_bf16_f32 v214, v240, v241
  v_cvt_pk_bf16_f32 v215, v242, v243
  buffer_store_dwordx4 v[212:215], v7, s[28:31], s61 offen offset:3072 sc1
  ds_write_b128 v4, v[212:215] offset:7168
  s_waitcnt lgkmcnt(5)
  v_mfma_f32_16x16x32_bf16 v[164:167], v[8:11], v[24:27], v[164:167]
  v_cvt_pk_bf16_f32 v160, v160, v161
  v_cvt_pk_bf16_f32 v161, v162, v163
  v_mfma_f32_16x16x32_bf16 v[192:195], v[12:15], v[24:27], v[192:195]
  v_cvt_pk_bf16_f32 v162, v188, v189
  v_cvt_pk_bf16_f32 v163, v190, v191
  s_add_u32 s61, s61, 4096
  buffer_store_dwordx4 v[160:163], v7, s[28:31], s61 offen sc1
  ds_write_b128 v4, v[160:163] offset:8192
  v_mfma_f32_16x16x32_bf16 v[220:223], v[16:19], v[24:27], v[220:223]
  v_cvt_pk_bf16_f32 v216, v216, v217
  v_cvt_pk_bf16_f32 v217, v218, v219
  v_mfma_f32_16x16x32_bf16 v[248:251], v[20:23], v[24:27], v[248:251]
  v_cvt_pk_bf16_f32 v218, v244, v245
  v_cvt_pk_bf16_f32 v219, v246, v247
  buffer_store_dwordx4 v[216:219], v7, s[28:31], s61 offen offset:1024 sc1
  ds_write_b128 v4, v[216:219] offset:9216
  s_waitcnt lgkmcnt(4)
  v_mfma_f32_16x16x32_bf16 v[168:171], v[8:11], v[28:31], v[168:171]
  v_cvt_pk_bf16_f32 v164, v164, v165
  v_cvt_pk_bf16_f32 v165, v166, v167
  v_mfma_f32_16x16x32_bf16 v[196:199], v[12:15], v[28:31], v[196:199]
  v_cvt_pk_bf16_f32 v166, v192, v193
  v_cvt_pk_bf16_f32 v167, v194, v195
  buffer_store_dwordx4 v[164:167], v7, s[28:31], s61 offen offset:2048 sc1
  ds_write_b128 v4, v[164:167] offset:10240
  v_mfma_f32_16x16x32_bf16 v[224:227], v[16:19], v[28:31], v[224:227]
  v_cvt_pk_bf16_f32 v220, v220, v221
  v_cvt_pk_bf16_f32 v221, v222, v223
  v_mfma_f32_16x16x32_bf16 v[252:255], v[20:23], v[28:31], v[252:255]
  v_cvt_pk_bf16_f32 v222, v248, v249
  v_cvt_pk_bf16_f32 v223, v250, v251
  buffer_store_dwordx4 v[220:223], v7, s[28:31], s61 offen offset:3072 sc1
  ds_write_b128 v4, v[220:223] offset:11264
  v_cvt_pk_bf16_f32 v168, v168, v169
  v_cvt_pk_bf16_f32 v169, v170, v171
  v_cvt_pk_bf16_f32 v170, v196, v197
  v_cvt_pk_bf16_f32 v171, v198, v199
  s_add_u32 s61, s61, 4096
  buffer_store_dwordx4 v[168:171], v7, s[28:31], s61 offen sc1
  ds_write_b128 v4, v[168:171] offset:12288
  v_cvt_pk_bf16_f32 v224, v224, v225
  v_cvt_pk_bf16_f32 v225, v226, v227
  v_cvt_pk_bf16_f32 v226, v252, v253
  v_cvt_pk_bf16_f32 v227, v254, v255
  buffer_store_dwordx4 v[224:227], v7, s[28:31], s61 offen offset:1024 sc1
  ds_write_b128 v4, v[224:227] offset:13312
  v_lshlrev_b32 v10, 20, v7
  v_mov_b32 v11, 1
  v_and_b32 v1, 0x70, v7
  s_mov_b32 s60, 14336
  s_lshl4_add_u32 s62, s41, s60
  s_waitcnt vmcnt(0) lgkmcnt(0)
  v_mov_b32 v4, v7
L_reduce:
  s_barrier
  s_cmp_lg_u32 s42, 7
  s_cbranch_scc1 L_red2
  buffer_store_dword v11, v10, s[28:31], s62 offen sc1
  s_mov_b32 s64, 0
L_poll_45:
  buffer_load_dword v2, v1, s[28:31], s60 offen sc1
  s_waitcnt vmcnt(0)
  v_cmp_eq_u32 vcc, 0, v2
  s_nop 0
  s_cbranch_vccz L_pollok_46
  s_add_u32 s64, s64, 1
  s_cmp_lt_u32 s64, 0x100000
  s_cbranch_scc1 L_poll_45
L_pollok_46:
  s_barrier
  s_endpgm
L_red2:
  v_and_b32 v1, 0x70, v4
  s_lshl_b32 s61, s41, 17
  s_lshl_b32 s59, s42, 11
  s_add_u32 s61, s61, s59
  v_add_u32 v7, s59, v4
  v_bfe_u32 v3, v4, 4, 4
  v_lshlrev_b32 v3, 7, v3
  v_lshrrev_b32 v6, 8, v4
  v_lshl_add_u32 v3, v6, 3, v3
  v_xor_b32 v3, v3, v1
  v_add_u32 v3, s59, v3
  v_xor_b32 v21, 32, v3
  v_xor_b32 v22, 64, v3
  v_xor_b32 v23, 96, v3
  v_lshrrev_b32 v5, 3, v4
  v_and_b32 v5, 0x70, v5
  v_xor_b32 v5, v5, v7
  v_lshrrev_b32 v6, 7, v4
  v_lshl_add_u32 v6, v6, 11, v1
  s_mov_b32 s49, 0xffff0000
  ds_read_b128 v[120:123], v7 offset:16384
  ds_read_b128 v[124:127], v7 offset:17408
  s_waitcnt lgkmcnt(1)
  v_lshlrev_b32 v32, 16, v120
  v_and_b32 v33, s49, v120
  v_lshlrev_b32 v34, 16, v121
  v_and_b32 v35, s49, v121
  v_lshlrev_b32 v36, 16, v122
  v_and_b32 v37, s49, v122
  v_lshlrev_b32 v38, 16, v123
  v_and_b32 v39, s49, v123
  s_waitcnt lgkmcnt(0)
  v_lshlrev_b32 v40, 16, v124
  v_and_b32 v41, s49, v124
  v_lshlrev_b32 v42, 16, v125
  v_and_b32 v43, s49, v125
  v_lshlrev_b32 v44, 16, v126
  v_and_b32 v45, s49, v126
  v_lshlrev_b32 v46, 16, v127
  v_and_b32 v47, s49, v127
  s_barrier
  s_add_u32 s62, s41, 1
  s_and_b32 s62, s62, 7
  s_lshl_b32 s62, s62, 14
  s_add_u32 s62, s62, s61
  buffer_load_dwordx4 v[64:67], v4, s[28:31], s62 offen sc1
  buffer_load_dwordx4 v[68:71], v4, s[28:31], s62 offen offset:1024 sc1
  s_add_u32 s62, s41, 2
  s_and_b32 s62, s62, 7
  s_lshl_b32 s62, s62, 14
  s_add_u32 s62, s62, s61
  buffer_load_dwordx4 v[72:75], v4, s[28:31], s62 offen sc1
  buffer_load_dwordx4 v[76:79], v4, s[28:31], s62 offen offset:1024 sc1
  s_add_u32 s62, s41, 3
  s_and_b32 s62, s62, 7
  s_lshl_b32 s62, s62, 14
  s_add_u32 s62, s62, s61
  buffer_load_dwordx4 v[80:83], v4, s[28:31], s62 offen sc1
  buffer_load_dwordx4 v[84:87], v4, s[28:31], s62 offen offset:1024 sc1
  s_add_u32 s62, s41, 4
  s_and_b32 s62, s62, 7
  s_lshl_b32 s62, s62, 14
  s_add_u32 s62, s62, s61
  buffer_load_dwordx4 v[88:91], v4, s[28:31], s62 offen sc1
  buffer_load_dwordx4 v[92:95], v4, s[28:31], s62 offen offset:1024 sc1
  s_add_u32 s62, s41, 5
  s_and_b32 s62, s62, 7
  s_lshl_b32 s62, s62, 14
  s_add_u32 s62, s62, s61
  buffer_load_dwordx4 v[96:99], v4, s[28:31], s62 offen sc1
  buffer_load_dwordx4 v[100:103], v4, s[28:31], s62 offen offset:1024 sc1
  s_add_u32 s62, s41, 6
  s_and_b32 s62, s62, 7
  s_lshl_b32 s62, s62, 14
  s_add_u32 s62, s62, s61
  buffer_load_dwordx4 v[104:107], v4, s[28:31], s62 offen sc1
  buffer_load_dwordx4 v[108:111], v4, s[28:31], s62 offen offset:1024 sc1
  s_add_u32 s62, s41, 7
  s_and_b32 s62, s62, 7
  s_lshl_b32 s62, s62, 14
  s_add_u32 s62, s62, s61
  buffer_load_dwordx4 v[112:115], v4, s[28:31], s62 offen sc1
  buffer_load_dwordx4 v[116:119], v4, s[28:31], s62 offen offset:1024 sc1
  s_waitcnt vmcnt(12)
  v_lshlrev_b32 v12, 16, v64
  v_and_b32 v13, s49, v64
  v_pk_add_f32 v[32:33], v[32:33], v[12:13]
  v_lshlrev_b32 v14, 16, v65
  v_and_b32 v15, s49, v65
  v_pk_add_f32 v[34:35], v[34:35], v[14:15]
  v_lshlrev_b32 v12, 16, v66
  v_and_b32 v13, s49, v66
  v_pk_add_f32 v[36:37], v[36:37], v[12:13]
  v_lshlrev_b32 v14, 16, v67
  v_and_b32 v15, s49, v67
  v_pk_add_f32 v[38:39], v[38:39], v[14:15]
  v_lshlrev_b32 v12, 16, v68
  v_and_b32 v13, s49, v68
  v_pk_add_f32 v[40:41], v[40:41], v[12:13]
  v_lshlrev_b32 v14, 16, v69
  v_and_b32 v15, s49, v69
  v_pk_add_f32 v[42:43], v[42:43], v[14:15]
  v_lshlrev_b32 v12, 16, v70
  v_and_b32 v13, s49, v70
  v_pk_add_f32 v[44:45], v[44:45], v[12:13]
  v_lshlrev_b32 v14, 16, v71
  v_and_b32 v15, s49, v71
  v_pk_add_f32 v[46:47], v[46:47], v[14:15]
  s_waitcnt vmcnt(10)
  v_lshlrev_b32 v12, 16, v72
  v_and_b32 v13, s49, v72
  v_pk_add_f32 v[32:33], v[32:33], v[12:13]
  v_lshlrev_b32 v14, 16, v73
  v_and_b32 v15, s49, v73
  v_pk_add_f32 v[34:35], v[34:35], v[14:15]
  v_lshlrev_b32 v12, 16, v74
  v_and_b32 v13, s49, v74
  v_pk_add_f32 v[36:37], v[36:37], v[12:13]
  v_lshlrev_b32 v14, 16, v75
  v_and_b32 v15, s49, v75
  v_pk_add_f32 v[38:39], v[38:39], v[14:15]
  v_lshlrev_b32 v12, 16, v76
  v_and_b32 v13, s49, v76
  v_pk_add_f32 v[40:41], v[40:41], v[12:13]
  v_lshlrev_b32 v14, 16, v77
  v_and_b32 v15, s49, v77
  v_pk_add_f32 v[42:43], v[42:43], v[14:15]
  v_lshlrev_b32 v12, 16, v78
  v_and_b32 v13, s49, v78
  v_pk_add_f32 v[44:45], v[44:45], v[12:13]
  v_lshlrev_b32 v14, 16, v79
  v_and_b32 v15, s49, v79
  v_pk_add_f32 v[46:47], v[46:47], v[14:15]
  s_waitcnt vmcnt(8)
  v_lshlrev_b32 v12, 16, v80
  v_and_b32 v13, s49, v80
  v_pk_add_f32 v[32:33], v[32:33], v[12:13]
  v_lshlrev_b32 v14, 16, v81
  v_and_b32 v15, s49, v81
  v_pk_add_f32 v[34:35], v[34:35], v[14:15]
  v_lshlrev_b32 v12, 16, v82
  v_and_b32 v13, s49, v82
  v_pk_add_f32 v[36:37], v[36:37], v[12:13]
  v_lshlrev_b32 v14, 16, v83
  v_and_b32 v15, s49, v83
  v_pk_add_f32 v[38:39], v[38:39], v[14:15]
  v_lshlrev_b32 v12, 16, v84
  v_and_b32 v13, s49, v84
  v_pk_add_f32 v[40:41], v[40:41], v[12:13]
  v_lshlrev_b32 v14, 16, v85
  v_and_b32 v15, s49, v85
  v_pk_add_f32 v[42:43], v[42:43], v[14:15]
  v_lshlrev_b32 v12, 16, v86
  v_and_b32 v13, s49, v86
  v_pk_add_f32 v[44:45], v[44:45], v[12:13]
  v_lshlrev_b32 v14, 16, v87
  v_and_b32 v15, s49, v87
  v_pk_add_f32 v[46:47], v[46:47], v[14:15]
  s_waitcnt vmcnt(6)
  v_lshlrev_b32 v12, 16, v88
  v_and_b32 v13, s49, v88
  v_pk_add_f32 v[32:33], v[32:33], v[12:13]
  v_lshlrev_b32 v14, 16, v89
  v_and_b32 v15, s49, v89
  v_pk_add_f32 v[34:35], v[34:35], v[14:15]
  v_lshlrev_b32 v12, 16, v90
  v_and_b32 v13, s49, v90
  v_pk_add_f32 v[36:37], v[36:37], v[12:13]
  v_lshlrev_b32 v14, 16, v91
  v_and_b32 v15, s49, v91
  v_pk_add_f32 v[38:39], v[38:39], v[14:15]
  v_lshlrev_b32 v12, 16, v92
  v_and_b32 v13, s49, v92
  v_pk_add_f32 v[40:41], v[40:41], v[12:13]
  v_lshlrev_b32 v14, 16, v93
  v_and_b32 v15, s49, v93
  v_pk_add_f32 v[42:43], v[42:43], v[14:15]
  v_lshlrev_b32 v12, 16, v94
  v_and_b32 v13, s49, v94
  v_pk_add_f32 v[44:45], v[44:45], v[12:13]
  v_lshlrev_b32 v14, 16, v95
  v_and_b32 v15, s49, v95
  v_pk_add_f32 v[46:47], v[46:47], v[14:15]
  s_waitcnt vmcnt(4)
  v_lshlrev_b32 v12, 16, v96
  v_and_b32 v13, s49, v96
  v_pk_add_f32 v[32:33], v[32:33], v[12:13]
  v_lshlrev_b32 v14, 16, v97
  v_and_b32 v15, s49, v97
  v_pk_add_f32 v[34:35], v[34:35], v[14:15]
  v_lshlrev_b32 v12, 16, v98
  v_and_b32 v13, s49, v98
  v_pk_add_f32 v[36:37], v[36:37], v[12:13]
  v_lshlrev_b32 v14, 16, v99
  v_and_b32 v15, s49, v99
  v_pk_add_f32 v[38:39], v[38:39], v[14:15]
  v_lshlrev_b32 v12, 16, v100
  v_and_b32 v13, s49, v100
  v_pk_add_f32 v[40:41], v[40:41], v[12:13]
  v_lshlrev_b32 v14, 16, v101
  v_and_b32 v15, s49, v101
  v_pk_add_f32 v[42:43], v[42:43], v[14:15]
  v_lshlrev_b32 v12, 16, v102
  v_and_b32 v13, s49, v102
  v_pk_add_f32 v[44:45], v[44:45], v[12:13]
  v_lshlrev_b32 v14, 16, v103
  v_and_b32 v15, s49, v103
  v_pk_add_f32 v[46:47], v[46:47], v[14:15]
  s_waitcnt vmcnt(2)
  v_lshlrev_b32 v12, 16, v104
  v_and_b32 v13, s49, v104
  v_pk_add_f32 v[32:33], v[32:33], v[12:13]
  v_lshlrev_b32 v14, 16, v105
  v_and_b32 v15, s49, v105
  v_pk_add_f32 v[34:35], v[34:35], v[14:15]
  v_lshlrev_b32 v12, 16, v106
  v_and_b32 v13, s49, v106
  v_pk_add_f32 v[36:37], v[36:37], v[12:13]
  v_lshlrev_b32 v14, 16, v107
  v_and_b32 v15, s49, v107
  v_pk_add_f32 v[38:39], v[38:39], v[14:15]
  v_lshlrev_b32 v12, 16, v108
  v_and_b32 v13, s49, v108
  v_pk_add_f32 v[40:41], v[40:41], v[12:13]
  v_lshlrev_b32 v14, 16, v109
  v_and_b32 v15, s49, v109
  v_pk_add_f32 v[42:43], v[42:43], v[14:15]
  v_lshlrev_b32 v12, 16, v110
  v_and_b32 v13, s49, v110
  v_pk_add_f32 v[44:45], v[44:45], v[12:13]
  v_lshlrev_b32 v14, 16, v111
  v_and_b32 v15, s49, v111
  v_pk_add_f32 v[46:47], v[46:47], v[14:15]
  s_waitcnt vmcnt(0)
  v_lshlrev_b32 v12, 16, v112
  v_and_b32 v13, s49, v112
  v_pk_add_f32 v[32:33], v[32:33], v[12:13]
  v_lshlrev_b32 v14, 16, v113
  v_and_b32 v15, s49, v113
  v_pk_add_f32 v[34:35], v[34:35], v[14:15]
  v_lshlrev_b32 v12, 16, v114
  v_and_b32 v13, s49, v114
  v_pk_add_f32 v[36:37], v[36:37], v[12:13]
  v_lshlrev_b32 v14, 16, v115
  v_and_b32 v15, s49, v115
  v_pk_add_f32 v[38:39], v[38:39], v[14:15]
  v_lshlrev_b32 v12, 16, v116
  v_and_b32 v13, s49, v116
  v_pk_add_f32 v[40:41], v[40:41], v[12:13]
  v_lshlrev_b32 v14, 16, v117
  v_and_b32 v15, s49, v117
  v_pk_add_f32 v[42:43], v[42:43], v[14:15]
  v_lshlrev_b32 v12, 16, v118
  v_and_b32 v13, s49, v118
  v_pk_add_f32 v[44:45], v[44:45], v[12:13]
  v_lshlrev_b32 v14, 16, v119
  v_and_b32 v15, s49, v119
  v_pk_add_f32 v[46:47], v[46:47], v[14:15]
  v_cvt_pk_bf16_f32 v64, v32, v33
  v_cvt_pk_bf16_f32 v65, v34, v35
  v_cvt_pk_bf16_f32 v66, v36, v37
  v_cvt_pk_bf16_f32 v67, v38, v39
  v_cvt_pk_bf16_f32 v68, v40, v41
  v_cvt_pk_bf16_f32 v69, v42, v43
  v_cvt_pk_bf16_f32 v70, v44, v45
  v_cvt_pk_bf16_f32 v71, v46, v47
  ds_write_b64 v3, v[64:65] offset:0
  ds_write_b64 v21, v[66:67] offset:0
  ds_write_b64 v22, v[68:69] offset:0
  ds_write_b64 v23, v[70:71] offset:0
  s_waitcnt lgkmcnt(0)
  ds_read_b128 v[80:83], v5 offset:0
  ds_read_b128 v[84:87], v5 offset:1024
  s_lshl_b32 s59, s42, 15
  s_add_u32 s60, s59, 16384
  s_waitcnt lgkmcnt(1)
  buffer_store_dwordx4 v[80:83], v6, s[32:35], s59 offen
  s_waitcnt lgkmcnt(0)
  buffer_store_dwordx4 v[84:87], v6, s[32:35], s60 offen
L_end:
  s_endpgm
L_codeend:
.section .rodata,"a"
.p2align 6
.amdhsa_kernel concat_heads__mha_block_cached__gqa_block_cached__near_ridge_kernel
  .amdhsa_next_free_vgpr 256
  .amdhsa_next_free_sgpr 102
  .amdhsa_accum_offset 256
  .amdhsa_group_segment_fixed_size 0
  .amdhsa_kernarg_size 104
  .amdhsa_user_sgpr_count 2
  .amdhsa_user_sgpr_kernarg_segment_ptr 1
  .amdhsa_system_sgpr_workgroup_id_x 1
.end_amdhsa_kernel
```
